```python
import torch

def _softmax(x, axis=-1):
    return torch.softmax(x, dim=axis)
def _gelu(x):
    return torch.nn.functional.gelu(x, approximate="tanh")
def _silu(x):
    return torch.nn.functional.silu(x)
def _sigmoid(x):
    return torch.sigmoid(x)
def _layernorm(x, axis=-1, eps=1e-5):
    m = x.mean(dim=axis, keepdim=True)
    v = x.var(dim=axis, keepdim=True, unbiased=False)
    return (x - m) / torch.sqrt(v + eps)
def _scatter_add(tgt, idx, src, axis=0):
    return tgt.clone().index_add_(axis, idx, src)
def _segment_sum(src, seg, n):
    out = torch.zeros((n,) + src.shape[1:], dtype=src.dtype)
    return out.index_add_(0, seg, src)
def _pad(x, pw):
    flat = tuple(v for pair in reversed(pw) for v in pair)
    return torch.nn.functional.pad(x, flat)

kernel_name = 'sequential_preLN__mha_block__mixer_s_mlp__prompt'

def setup_inputs():

    _w = (lambda a: (lambda t: t.to(torch.bfloat16) if t.is_floating_point() else t)(torch.as_tensor(a)))
    def _A_setup():
        B, S, D, H = 1, 2048, 640, 32
        return {
            "x": _w((lambda *s: torch.randn(*s, dtype=torch.bfloat16) * 0.05)(B, S, D)),
            "wqkv": _w((lambda *s: torch.randn(*s, dtype=torch.bfloat16) * 0.05)(D, 3 * D)),
            "wo": _w((lambda *s: torch.randn(*s, dtype=torch.bfloat16) * 0.05)(D, D)),
        }
    _A_in = _A_setup()

    def _B_setup():
        B, S, D, F = 1, 2048, 640, 1728
        return {
            "x":  _w((lambda *s: torch.randn(*s, dtype=torch.bfloat16) * 0.05)(B, S, D)),
            "w1": _w((lambda *s: torch.randn(*s, dtype=torch.bfloat16) * 3.2)(D, D) * (D ** -0.5)),
            "w2": _w((lambda *s: torch.randn(*s, dtype=torch.bfloat16) * 3.2)(D, D) * (D ** -0.5)),
            "w3": _w((lambda *s: torch.randn(*s, dtype=torch.bfloat16) * 3.2)(D, F) * (D ** -0.5)),
            "w4": _w((lambda *s: torch.randn(*s, dtype=torch.bfloat16) * 3.2)(F, D) * (F ** -0.5)),
        }
    _B_in = _B_setup()

    return {
        "A_x": _A_in["x"],
        "A_wqkv": _A_in["wqkv"],
        "A_wo": _A_in["wo"],
        "B_x": _B_in["x"],
        "B_w1": _B_in["w1"],
        "B_w2": _B_in["w2"],
        "B_w3": _B_in["w3"],
        "B_w4": _B_in["w4"],
    }

def reference(A_x, A_wqkv, A_wo, B_x, B_w1, B_w2, B_w3, B_w4):
    def _A_ref(x, wqkv, wo):
        B, S, D = x.shape
        H = 32
        Dh = D // H
        qkv = (lambda x, *d: x.permute(*d))((x @ wqkv).reshape(B, S, 3, H, Dh), 2, 0, 3, 1, 4)
        q, k, v = qkv[0], qkv[1], qkv[2]
        scores = torch.einsum("bhqd,bhkd->bhqk", q, k) * (Dh ** -0.5)
        p = _softmax(scores, axis=-1)
        o = torch.einsum("bhqk,bhkd->bhqd", p, v)
        return (lambda x, *d: x.permute(*d))(o, 0, 2, 1, 3).reshape(B, S, D) @ wo

    def _B_ref(x, w1, w2, w3, w4):
        B, S, D = x.shape
        h = _gelu(_layernorm(x, axis=-1) @ w1)
        c = D // 4
        g0 = _pad(h[:, :, 0*c:1*c], ((0, 0), (1, 0), (0, 0)))[:, :S, :]
        g1 = _pad(h[:, :, 1*c:2*c], ((0, 0), (0, 1), (0, 0)))[:, 1:, :]
        g2 = _pad(h[:, :, 2*c:3*c], ((0, 0), (2, 0), (0, 0)))[:, :S, :]
        g3 = _pad(h[:, :, 3*c:   ], ((0, 0), (0, 2), (0, 0)))[:, 2:, :]
        hs = torch.concatenate([g0, g1, g2, g3], axis=-1) @ w2
        x1 = x + hs
        h2 = _gelu(_layernorm(x1, axis=-1) @ w3) @ w4
        return x1 + h2

    x = A_x
    h = x + _A_ref(_layernorm(x, axis=-1), A_wqkv, A_wo)
    h2 = h + _B_ref(_layernorm(h, axis=-1), B_w1, B_w2, B_w3, B_w4)
    return h2
```

```asm
; @launch grid=(256,1,1) block=(512,1,1) lds=163840
.amdgcn_target "amdgcn-amd-amdhsa--gfx950"
.text
.globl sequential_preLN__mha_block__mixer_s_mlp__prompt_kernel
.p2align 8
.type sequential_preLN__mha_block__mixer_s_mlp__prompt_kernel,@function
sequential_preLN__mha_block__mixer_s_mlp__prompt_kernel:
    s_cmp_ge_u32 s2, 256
    s_cbranch_scc1 K1_END
    s_load_dwordx4 s[4:7], s[0:1], 0
    s_load_dwordx2 s[8:9], s[0:1], 80
    v_and_b32 v1, 63, v0
    v_lshrrev_b32 v60, 6, v0
    s_and_b32 s30, s2, 7
    v_readfirstlane_b32 s27, v60
    s_lshr_b32 s31, s2, 3
    s_cmp_ge_u32 s31, 30
    s_cbranch_scc1 K1_SPARE
    s_mul_i32 s30, s30, 30
    s_add_u32 s30, s30, s31
    s_mul_i32 s31, s30, 205
    s_lshr_b32 s31, s31, 10
    s_mul_i32 s32, s31, 5
    s_sub_u32 s25, s30, s32
    s_lshr_b32 s26, s31, 4
    s_and_b32 s24, s31, 15
    s_mul_i32 s101, s26, 5
    s_add_u32 s101, s101, s25
    s_cmp_lt_u32 s27, 4
    s_cbranch_scc1 K1_COMPUTE
    s_and_b32 s27, s27, 3
    s_lshl_b32 s42, s27, 12
    s_add_u32 s43, s42, 16384
    v_lshrrev_b32 v52, 3, v1
    v_and_b32 v53, 7, v1
    v_lshrrev_b32 v54, 1, v52
    v_xor_b32 v55, v53, v54
    v_xor_b32 v56, 4, v55
    s_lshl_b32 s33, s27, 5
    v_add_u32 v57, s33, v52
    v_mul_u32_u24 v57, 1280, v57
    v_lshl_add_u32 v2, v55, 4, v57
    v_lshl_add_u32 v3, v56, 4, v57
    v_add_u32 v3, 10240, v3
    v_add_u32 v4, 20480, v2
    v_add_u32 v5, 20480, v3
    v_lshrrev_b32 v53, 4, v1
    v_and_b32 v54, 15, v1
    v_lshlrev_b32 v55, 2, v53
    v_xor_b32 v54, v54, v55
    s_lshl_b32 s33, s27, 4
    v_add_u32 v53, s33, v53
    v_mul_u32_u24 v53, 3840, v53
    v_lshl_add_u32 v6, v54, 4, v53
    v_add_u32 v7, 15360, v6
    v_add_u32 v8, 30720, v6
    v_add_u32 v9, 46080, v6
    s_add_u32 s44, s24, s25
    s_mul_i32 s45, s44, 205
    s_lshr_b32 s45, s45, 10
    s_mul_i32 s45, s45, 5
    s_sub_u32 s44, s44, s45
    s_lshl_b32 s44, s44, 1
    s_mov_b32 s44, 0
    s_mul_i32 s33, s24, 163840
    s_mul_i32 s34, s26, 5
    s_add_u32 s34, s34, s25
    s_lshl_b32 s34, s34, 8
    s_mov_b32 s14, 163840
    s_mov_b32 s15, 0x00020000
    s_sub_u32 s18, 2457600, s34
    s_mov_b32 s19, 0x00020000
    s_waitcnt lgkmcnt(0)
    s_add_u32 s12, s4, s33
    s_addc_u32 s13, s5, 0
    s_add_u32 s16, s6, s34
    s_addc_u32 s17, s7, 0
    s_lshl_b32 s40, s44, 7
    s_mul_i32 s41, s44, 245760
    s_add_u32 m0, s42, 0
    s_nop 0
    buffer_load_dwordx4 v2, s[12:15], s40 offen lds
    s_add_u32 m0, s43, 0
    s_nop 0
    buffer_load_dwordx4 v6, s[16:19], s41 offen lds
    s_add_u32 m0, s42, 1024
    s_nop 0
    buffer_load_dwordx4 v3, s[12:15], s40 offen lds
    s_add_u32 m0, s43, 1024
    s_nop 0
    buffer_load_dwordx4 v7, s[16:19], s41 offen lds
    s_add_u32 m0, s42, 2048
    s_nop 0
    buffer_load_dwordx4 v4, s[12:15], s40 offen lds
    s_add_u32 m0, s43, 2048
    s_nop 0
    buffer_load_dwordx4 v8, s[16:19], s41 offen lds
    s_add_u32 m0, s42, 3072
    s_nop 0
    buffer_load_dwordx4 v5, s[12:15], s40 offen lds
    s_add_u32 m0, s43, 3072
    s_nop 0
    buffer_load_dwordx4 v9, s[16:19], s41 offen lds
    s_add_u32 s44, s44, 1
    s_cmp_eq_u32 s44, 10
    s_cselect_b32 s44, 0, s44
    s_lshl_b32 s33, s101, 2
    s_add_u32 s33, s33, s27
    s_mul_i32 s33, s33, 2560
    s_mul_i32 s34, s24, 40
    s_mul_i32 s35, s27, 10
    s_add_u32 s34, s34, s35
    s_mul_i32 s34, s34, 3840
    v_lshlrev_b32 v200, 2, v1
    v_lshrrev_b32 v228, 5, v1
    v_mul_u32_u24 v228, 1280, v228
    v_and_b32 v229, 31, v1
    v_lshl_add_u32 v228, v229, 3, v228
    buffer_load_dwordx2 v[216:217], v228, s[12:15], s33 offen offset:0
    buffer_load_dwordx2 v[218:219], v228, s[12:15], s33 offen offset:256
    buffer_load_dwordx2 v[220:221], v228, s[12:15], s33 offen offset:512
    buffer_load_dwordx2 v[222:223], v228, s[12:15], s33 offen offset:768
    buffer_load_dwordx2 v[224:225], v228, s[12:15], s33 offen offset:1024
    buffer_load_dword v201, v200, s[16:19], s34 offen
    s_add_u32 s34, s34, 3840
    buffer_load_dword v202, v200, s[16:19], s34 offen
    s_add_u32 s34, s34, 3840
    buffer_load_dword v203, v200, s[16:19], s34 offen
    s_add_u32 s34, s34, 3840
    buffer_load_dword v204, v200, s[16:19], s34 offen
    s_add_u32 s34, s34, 3840
    buffer_load_dword v205, v200, s[16:19], s34 offen
    s_add_u32 s34, s34, 3840
    buffer_load_dword v206, v200, s[16:19], s34 offen
    s_add_u32 s34, s34, 3840
    buffer_load_dword v207, v200, s[16:19], s34 offen
    s_add_u32 s34, s34, 3840
    buffer_load_dword v208, v200, s[16:19], s34 offen
    s_add_u32 s34, s34, 3840
    buffer_load_dword v209, v200, s[16:19], s34 offen
    s_add_u32 s34, s34, 3840
    buffer_load_dword v210, v200, s[16:19], s34 offen
    s_add_u32 s34, s34, 3840
    s_lshl_b32 s40, s44, 7
    s_mul_i32 s41, s44, 245760
    s_add_u32 m0, s42, 32768
    s_nop 0
    buffer_load_dwordx4 v2, s[12:15], s40 offen lds
    s_add_u32 m0, s43, 32768
    s_nop 0
    buffer_load_dwordx4 v6, s[16:19], s41 offen lds
    s_add_u32 m0, s42, 33792
    s_nop 0
    buffer_load_dwordx4 v3, s[12:15], s40 offen lds
    s_add_u32 m0, s43, 33792
    s_nop 0
    buffer_load_dwordx4 v7, s[16:19], s41 offen lds
    s_add_u32 m0, s42, 34816
    s_nop 0
    buffer_load_dwordx4 v4, s[12:15], s40 offen lds
    s_add_u32 m0, s43, 34816
    s_nop 0
    buffer_load_dwordx4 v8, s[16:19], s41 offen lds
    s_add_u32 m0, s42, 35840
    s_nop 0
    buffer_load_dwordx4 v5, s[12:15], s40 offen lds
    s_add_u32 m0, s43, 35840
    s_nop 0
    buffer_load_dwordx4 v9, s[16:19], s41 offen lds
    s_add_u32 s44, s44, 1
    s_cmp_eq_u32 s44, 10
    s_cselect_b32 s44, 0, s44
    v_lshlrev_b32 v10, 4, v1
    s_mov_b32 s20, s8
    s_mov_b32 s21, s9
    s_mov_b32 s22, 49283072
    s_mov_b32 s23, 0x00020000
    s_load_dwordx2 s[92:93], s[0:1], 72
    v_mov_b32 v44, 0
    v_mov_b32 v46, 1
    v_add_u32 v12, s43, v10
    v_add_u32 v13, 65536, v12
    s_mov_b32 s47, 0xffff0000
    v_mov_b64 v[80:81], 0
    v_mov_b64 v[82:83], 0
    v_mov_b64 v[84:85], 0
    v_mov_b64 v[86:87], 0
    v_and_b32 v45, 15, v1
    v_lshlrev_b32 v45, 2, v45
    v_add_u32 v45, 131072, v45
    ds_write_b32 v45, v44 offset:1536
    s_mov_b32 s94, 256
    s_mov_b32 s95, 0x00020000
    s_lshl_b32 s58, s24, 4
    s_lshl_b32 s59, s24, 10
    s_add_u32 s59, s59, 47513600
    s_mul_i32 s97, s26, 5
    s_add_u32 s97, s97, s25
    s_lshl_b32 s99, s97, 13
    s_add_u32 s99, s99, 47579136
    s_lshl_b32 s98, s24, 9
    s_add_u32 s98, s98, s99
    v_and_b32 v50, 15, v1
    v_lshlrev_b32 v50, 4, v50
    s_lshl_b32 s97, s97, 5
    s_add_u32 s97, s97, s59
    s_waitcnt lgkmcnt(0)
    s_waitcnt vmcnt(23)
    s_barrier
    s_lshl_b32 s40, s44, 7
    s_mul_i32 s41, s44, 245760
    s_add_u32 m0, s42, 65536
    s_nop 0
    buffer_load_dwordx4 v2, s[12:15], s40 offen lds
    s_add_u32 m0, s43, 65536
    s_nop 0
    buffer_load_dwordx4 v6, s[16:19], s41 offen lds
    s_add_u32 m0, s42, 66560
    s_nop 0
    buffer_load_dwordx4 v3, s[12:15], s40 offen lds
    s_add_u32 m0, s43, 66560
    s_nop 0
    buffer_load_dwordx4 v7, s[16:19], s41 offen lds
    s_add_u32 m0, s42, 67584
    s_nop 0
    buffer_load_dwordx4 v4, s[12:15], s40 offen lds
    s_add_u32 m0, s43, 67584
    s_nop 0
    buffer_load_dwordx4 v8, s[16:19], s41 offen lds
    s_add_u32 m0, s42, 68608
    s_nop 0
    buffer_load_dwordx4 v5, s[12:15], s40 offen lds
    s_add_u32 m0, s43, 68608
    s_nop 0
    buffer_load_dwordx4 v9, s[16:19], s41 offen lds
    s_add_u32 s44, s44, 1
    s_cmp_eq_u32 s44, 10
    s_cselect_b32 s44, 0, s44
    s_waitcnt vmcnt(16)
    s_mov_b32 s46, 0x3f803f80
    v_mov_b64 v[230:231], 0
    v_mov_b64 v[232:233], 0
    v_dot2c_f32_bf16 v230, s46, v216
    v_dot2c_f32_bf16 v231, v216, v216
    v_dot2c_f32_bf16 v232, s46, v217
    v_dot2c_f32_bf16 v233, v217, v217
    v_dot2c_f32_bf16 v230, s46, v218
    v_dot2c_f32_bf16 v231, v218, v218
    v_dot2c_f32_bf16 v232, s46, v219
    v_dot2c_f32_bf16 v233, v219, v219
    v_dot2c_f32_bf16 v230, s46, v220
    v_dot2c_f32_bf16 v231, v220, v220
    v_dot2c_f32_bf16 v232, s46, v221
    v_dot2c_f32_bf16 v233, v221, v221
    v_dot2c_f32_bf16 v230, s46, v222
    v_dot2c_f32_bf16 v231, v222, v222
    v_dot2c_f32_bf16 v232, s46, v223
    v_dot2c_f32_bf16 v233, v223, v223
    v_dot2c_f32_bf16 v230, s46, v224
    v_dot2c_f32_bf16 v231, v224, v224
    v_dot2c_f32_bf16 v232, s46, v225
    v_dot2c_f32_bf16 v233, v225, v225
    s_nop 2
    v_add_f32 v230, v230, v232
    v_add_f32 v231, v231, v233
    s_nop 0
    v_add_f32_dpp v230, v230, v230 row_ror:1 row_mask:0xf bank_mask:0xf
    v_add_f32_dpp v231, v231, v231 row_ror:1 row_mask:0xf bank_mask:0xf
    s_nop 0
    v_add_f32_dpp v230, v230, v230 row_ror:2 row_mask:0xf bank_mask:0xf
    v_add_f32_dpp v231, v231, v231 row_ror:2 row_mask:0xf bank_mask:0xf
    s_nop 0
    v_add_f32_dpp v230, v230, v230 row_ror:4 row_mask:0xf bank_mask:0xf
    v_add_f32_dpp v231, v231, v231 row_ror:4 row_mask:0xf bank_mask:0xf
    s_nop 0
    v_add_f32_dpp v230, v230, v230 row_ror:8 row_mask:0xf bank_mask:0xf
    v_add_f32_dpp v231, v231, v231 row_ror:8 row_mask:0xf bank_mask:0xf
    s_nop 0
    v_mov_b32 v232, v230
    v_mov_b32 v233, v231
    v_lshrrev_b32 v228, 5, v1
    v_permlane16_swap_b32 v230, v232
    v_permlane16_swap_b32 v231, v233
    v_add_f32 v230, v230, v232
    v_add_f32 v231, v231, v233
    v_mul_f32 v230, 0xbacccccd, v230
    v_mul_f32 v231, 0x3acccccd, v231
    v_fma_f32 v231, -v230, v230, v231
    v_max_f32 v231, 0, v231
    v_add_f32 v231, 0x3727c5ac, v231
    v_rsq_f32 v231, v231
    s_lshl_b32 s46, s27, 3
    s_add_u32 s46, s46, 132864
    v_lshl_add_u32 v228, v228, 2, s46
    ds_write_b32 v228, v230
    ds_write_b32 v228, v231 offset:32
    s_waitcnt lgkmcnt(0)
    v_lshlrev_b32 v212, 16, v201
    v_and_b32 v213, s47, v201
    v_lshlrev_b32 v214, 16, v202
    v_and_b32 v215, s47, v202
    v_pk_add_f32 v[212:213], v[212:213], v[214:215]
    v_lshlrev_b32 v214, 16, v203
    v_and_b32 v215, s47, v203
    v_pk_add_f32 v[212:213], v[212:213], v[214:215]
    v_lshlrev_b32 v214, 16, v204
    v_and_b32 v215, s47, v204
    v_pk_add_f32 v[212:213], v[212:213], v[214:215]
    v_lshlrev_b32 v214, 16, v205
    v_and_b32 v215, s47, v205
    v_pk_add_f32 v[212:213], v[212:213], v[214:215]
    v_lshlrev_b32 v214, 16, v206
    v_and_b32 v215, s47, v206
    v_pk_add_f32 v[212:213], v[212:213], v[214:215]
    v_lshlrev_b32 v214, 16, v207
    v_and_b32 v215, s47, v207
    v_pk_add_f32 v[212:213], v[212:213], v[214:215]
    v_lshlrev_b32 v214, 16, v208
    v_and_b32 v215, s47, v208
    v_pk_add_f32 v[212:213], v[212:213], v[214:215]
    v_lshlrev_b32 v214, 16, v209
    v_and_b32 v215, s47, v209
    v_pk_add_f32 v[212:213], v[212:213], v[214:215]
    v_lshlrev_b32 v214, 16, v210
    v_and_b32 v215, s47, v210
    v_pk_add_f32 v[212:213], v[212:213], v[214:215]
    s_lshl_b32 s46, s27, 9
    s_add_u32 s46, s46, 133120
    v_lshl_add_u32 v200, v200, 1, s46
    ds_write_b64 v200, v[212:213]
    s_waitcnt lgkmcnt(0)
    s_waitcnt vmcnt(8)
    s_barrier
    s_cmp_lg_u32 s27, 0
    s_cbranch_scc1 K1_Oa
    v_lshlrev_b32 v47, 4, v1
    v_add_u32 v48, 132864, v47
    s_mov_b64 exec, 15
    ds_read_b128 v[52:55], v48
    v_lshrrev_b32 v48, 1, v1
    v_mul_u32_u24 v48, 480, v48
    v_add_u32 v47, v47, v48
    s_waitcnt lgkmcnt(0)
    buffer_store_dwordx4 v[52:55], v47, s[20:23], s97 offen sc1
    s_mov_b64 exec, -1
    v_and_b32 v47, 31, v1
    v_lshlrev_b32 v47, 4, v47
    v_add_u32 v48, 133120, v47
    ds_read_b128 v[64:67], v48 offset:0
    ds_read_b128 v[68:71], v48 offset:512
    ds_read_b128 v[72:75], v48 offset:1024
    ds_read_b128 v[76:79], v48 offset:1536
    s_waitcnt lgkmcnt(0)
    v_add_f32 v64, v64, v68
    v_add_f32 v65, v65, v69
    v_add_f32 v66, v66, v70
    v_add_f32 v67, v67, v71
    v_add_f32 v64, v64, v72
    v_add_f32 v65, v65, v73
    v_add_f32 v66, v66, v74
    v_add_f32 v67, v67, v75
    v_add_f32 v64, v64, v76
    v_add_f32 v65, v65, v77
    v_add_f32 v66, v66, v78
    v_add_f32 v67, v67, v79
    s_mov_b32 exec_hi, 0
    buffer_store_dwordx4 v[64:67], v47, s[20:23], s98 offen sc1
    s_mov_b64 exec, -1
K1_Oa:
    s_lshl_b32 s40, s44, 7
    s_mul_i32 s41, s44, 245760
    s_add_u32 m0, s42, 98304
    s_nop 0
    buffer_load_dwordx4 v2, s[12:15], s40 offen lds
    s_add_u32 m0, s43, 98304
    s_nop 0
    buffer_load_dwordx4 v6, s[16:19], s41 offen lds
    s_add_u32 m0, s42, 99328
    s_nop 0
    buffer_load_dwordx4 v3, s[12:15], s40 offen lds
    s_add_u32 m0, s43, 99328
    s_nop 0
    buffer_load_dwordx4 v7, s[16:19], s41 offen lds
    s_add_u32 m0, s42, 100352
    s_nop 0
    buffer_load_dwordx4 v4, s[12:15], s40 offen lds
    s_add_u32 m0, s43, 100352
    s_nop 0
    buffer_load_dwordx4 v8, s[16:19], s41 offen lds
    s_add_u32 m0, s42, 101376
    s_nop 0
    buffer_load_dwordx4 v5, s[12:15], s40 offen lds
    s_add_u32 m0, s43, 101376
    s_nop 0
    buffer_load_dwordx4 v9, s[16:19], s41 offen lds
    s_add_u32 s44, s44, 1
    s_cmp_eq_u32 s44, 10
    s_cselect_b32 s44, 0, s44
    s_lshl_b32 s40, s44, 7
    s_mul_i32 s41, s44, 245760
    s_add_u32 m0, s42, 0
    s_nop 0
    buffer_load_dwordx4 v2, s[12:15], s40 offen lds
    s_add_u32 m0, s43, 0
    s_nop 0
    buffer_load_dwordx4 v6, s[16:19], s41 offen lds
    s_add_u32 m0, s42, 1024
    s_nop 0
    buffer_load_dwordx4 v3, s[12:15], s40 offen lds
    s_add_u32 m0, s43, 1024
    s_nop 0
    buffer_load_dwordx4 v7, s[16:19], s41 offen lds
    s_add_u32 m0, s42, 2048
    s_nop 0
    buffer_load_dwordx4 v4, s[12:15], s40 offen lds
    s_add_u32 m0, s43, 2048
    s_nop 0
    buffer_load_dwordx4 v8, s[16:19], s41 offen lds
    s_add_u32 m0, s42, 3072
    s_nop 0
    buffer_load_dwordx4 v5, s[12:15], s40 offen lds
    s_add_u32 m0, s43, 3072
    s_nop 0
    buffer_load_dwordx4 v9, s[16:19], s41 offen lds
    s_add_u32 s44, s44, 1
    s_cmp_eq_u32 s44, 10
    s_cselect_b32 s44, 0, s44
    s_waitcnt vmcnt(16)
    s_barrier
    s_cmp_lg_u32 s27, 0
    s_cbranch_scc1 K1_Ob
    s_waitcnt vmcnt(16)
    s_mov_b64 exec, 1
    buffer_atomic_add v46, v44, s[92:95], s58 offen sc1
    s_mov_b64 exec, -1
K1_Ob:
    s_lshl_b32 s40, s44, 7
    s_mul_i32 s41, s44, 245760
    s_add_u32 m0, s42, 32768
    s_nop 0
    buffer_load_dwordx4 v2, s[12:15], s40 offen lds
    s_add_u32 m0, s43, 32768
    s_nop 0
    buffer_load_dwordx4 v6, s[16:19], s41 offen lds
    s_add_u32 m0, s42, 33792
    s_nop 0
    buffer_load_dwordx4 v3, s[12:15], s40 offen lds
    s_add_u32 m0, s43, 33792
    s_nop 0
    buffer_load_dwordx4 v7, s[16:19], s41 offen lds
    s_add_u32 m0, s42, 34816
    s_nop 0
    buffer_load_dwordx4 v4, s[12:15], s40 offen lds
    s_add_u32 m0, s43, 34816
    s_nop 0
    buffer_load_dwordx4 v8, s[16:19], s41 offen lds
    s_add_u32 m0, s42, 35840
    s_nop 0
    buffer_load_dwordx4 v5, s[12:15], s40 offen lds
    s_add_u32 m0, s43, 35840
    s_nop 0
    buffer_load_dwordx4 v9, s[16:19], s41 offen lds
    s_add_u32 s44, s44, 1
    s_cmp_eq_u32 s44, 10
    s_cselect_b32 s44, 0, s44
    s_waitcnt vmcnt(16)
    s_barrier
    s_lshl_b32 s40, s44, 7
    s_mul_i32 s41, s44, 245760
    s_add_u32 m0, s42, 65536
    s_nop 0
    buffer_load_dwordx4 v2, s[12:15], s40 offen lds
    s_add_u32 m0, s43, 65536
    s_nop 0
    buffer_load_dwordx4 v6, s[16:19], s41 offen lds
    s_add_u32 m0, s42, 66560
    s_nop 0
    buffer_load_dwordx4 v3, s[12:15], s40 offen lds
    s_add_u32 m0, s43, 66560
    s_nop 0
    buffer_load_dwordx4 v7, s[16:19], s41 offen lds
    s_add_u32 m0, s42, 67584
    s_nop 0
    buffer_load_dwordx4 v4, s[12:15], s40 offen lds
    s_add_u32 m0, s43, 67584
    s_nop 0
    buffer_load_dwordx4 v8, s[16:19], s41 offen lds
    s_add_u32 m0, s42, 68608
    s_nop 0
    buffer_load_dwordx4 v5, s[12:15], s40 offen lds
    s_add_u32 m0, s43, 68608
    s_nop 0
    buffer_load_dwordx4 v9, s[16:19], s41 offen lds
    s_add_u32 s44, s44, 1
    s_cmp_eq_u32 s44, 10
    s_cselect_b32 s44, 0, s44
    s_waitcnt vmcnt(16)
    s_barrier
    s_lshl_b32 s40, s44, 7
    s_mul_i32 s41, s44, 245760
    s_add_u32 m0, s42, 98304
    s_nop 0
    buffer_load_dwordx4 v2, s[12:15], s40 offen lds
    s_add_u32 m0, s43, 98304
    s_nop 0
    buffer_load_dwordx4 v6, s[16:19], s41 offen lds
    s_add_u32 m0, s42, 99328
    s_nop 0
    buffer_load_dwordx4 v3, s[12:15], s40 offen lds
    s_add_u32 m0, s43, 99328
    s_nop 0
    buffer_load_dwordx4 v7, s[16:19], s41 offen lds
    s_add_u32 m0, s42, 100352
    s_nop 0
    buffer_load_dwordx4 v4, s[12:15], s40 offen lds
    s_add_u32 m0, s43, 100352
    s_nop 0
    buffer_load_dwordx4 v8, s[16:19], s41 offen lds
    s_add_u32 m0, s42, 101376
    s_nop 0
    buffer_load_dwordx4 v5, s[12:15], s40 offen lds
    s_add_u32 m0, s43, 101376
    s_nop 0
    buffer_load_dwordx4 v9, s[16:19], s41 offen lds
    s_add_u32 s44, s44, 1
    s_cmp_eq_u32 s44, 10
    s_cselect_b32 s44, 0, s44
    s_waitcnt vmcnt(16)
    s_barrier
    s_lshl_b32 s40, s44, 7
    s_mul_i32 s41, s44, 245760
    s_add_u32 m0, s42, 0
    s_nop 0
    buffer_load_dwordx4 v2, s[12:15], s40 offen lds
    s_add_u32 m0, s43, 0
    s_nop 0
    buffer_load_dwordx4 v6, s[16:19], s41 offen lds
    s_add_u32 m0, s42, 1024
    s_nop 0
    buffer_load_dwordx4 v3, s[12:15], s40 offen lds
    s_add_u32 m0, s43, 1024
    s_nop 0
    buffer_load_dwordx4 v7, s[16:19], s41 offen lds
    s_add_u32 m0, s42, 2048
    s_nop 0
    buffer_load_dwordx4 v4, s[12:15], s40 offen lds
    s_add_u32 m0, s43, 2048
    s_nop 0
    buffer_load_dwordx4 v8, s[16:19], s41 offen lds
    s_add_u32 m0, s42, 3072
    s_nop 0
    buffer_load_dwordx4 v5, s[12:15], s40 offen lds
    s_add_u32 m0, s43, 3072
    s_nop 0
    buffer_load_dwordx4 v9, s[16:19], s41 offen lds
    s_add_u32 s44, s44, 1
    s_cmp_eq_u32 s44, 10
    s_cselect_b32 s44, 0, s44
    s_waitcnt vmcnt(16)
    s_barrier
    s_cmp_lg_u32 s27, 0
    s_cbranch_scc1 K1_Oc
    buffer_load_dword v49, v50, s[92:95], 0 offen sc1
K1_Oc:
    s_lshl_b32 s40, s44, 7
    s_mul_i32 s41, s44, 245760
    s_add_u32 m0, s42, 32768
    s_nop 0
    buffer_load_dwordx4 v2, s[12:15], s40 offen lds
    s_add_u32 m0, s43, 32768
    s_nop 0
    buffer_load_dwordx4 v6, s[16:19], s41 offen lds
    s_add_u32 m0, s42, 33792
    s_nop 0
    buffer_load_dwordx4 v3, s[12:15], s40 offen lds
    s_add_u32 m0, s43, 33792
    s_nop 0
    buffer_load_dwordx4 v7, s[16:19], s41 offen lds
    s_add_u32 m0, s42, 34816
    s_nop 0
    buffer_load_dwordx4 v4, s[12:15], s40 offen lds
    s_add_u32 m0, s43, 34816
    s_nop 0
    buffer_load_dwordx4 v8, s[16:19], s41 offen lds
    s_add_u32 m0, s42, 35840
    s_nop 0
    buffer_load_dwordx4 v5, s[12:15], s40 offen lds
    s_add_u32 m0, s43, 35840
    s_nop 0
    buffer_load_dwordx4 v9, s[16:19], s41 offen lds
    s_add_u32 s44, s44, 1
    s_cmp_eq_u32 s44, 10
    s_cselect_b32 s44, 0, s44
    s_waitcnt vmcnt(16)
    s_barrier
    s_cmp_lg_u32 s27, 0
    s_cbranch_scc1 K1_Od
    s_waitcnt vmcnt(8)
    v_cmp_gt_u32 vcc, 16, v49
    s_cbranch_vccz K1_STD
    s_mov_b32 s33, 32768
    s_mov_b64 exec, 0xffff
    K1_STP:
    s_sleep 4
    buffer_load_dword v49, v50, s[92:95], 0 offen sc1
    s_sub_u32 s33, s33, 1
    s_cmp_eq_u32 s33, 0
    s_cbranch_scc1 K1_STD
    s_waitcnt vmcnt(0)
    v_cmp_gt_u32 vcc, 16, v49
    s_cbranch_vccnz K1_STP
    K1_STD:
    s_mov_b64 exec, -1
    s_mov_b32 m0, 131072
    s_nop 0
    buffer_load_dwordx4 v10, s[20:23], s59 offen sc1 lds
    buffer_load_dwordx4 v[64:67], v10, s[20:23], s99 offen offset:0 sc1
    buffer_load_dwordx4 v[68:71], v10, s[20:23], s99 offen offset:1024 sc1
    buffer_load_dwordx4 v[72:75], v10, s[20:23], s99 offen offset:2048 sc1
    buffer_load_dwordx4 v[76:79], v10, s[20:23], s99 offen offset:3072 sc1
    s_add_u32 s99, s99, 4096
    buffer_load_dwordx4 v[80:83], v10, s[20:23], s99 offen offset:0 sc1
    buffer_load_dwordx4 v[84:87], v10, s[20:23], s99 offen offset:1024 sc1
    buffer_load_dwordx4 v[88:91], v10, s[20:23], s99 offen offset:2048 sc1
    buffer_load_dwordx4 v[92:95], v10, s[20:23], s99 offen offset:3072 sc1
K1_Od:
    s_waitcnt vmcnt(8)
    s_barrier
    s_waitcnt vmcnt(0)
    s_barrier
    s_cmp_lg_u32 s27, 0
    s_cbranch_scc1 K1_Oe
    s_waitcnt vmcnt(0)
    v_add_f32 v64, v64, v68
    v_add_f32 v65, v65, v69
    v_add_f32 v66, v66, v70
    v_add_f32 v67, v67, v71
    v_add_f32 v64, v64, v72
    v_add_f32 v65, v65, v73
    v_add_f32 v66, v66, v74
    v_add_f32 v67, v67, v75
    v_add_f32 v64, v64, v76
    v_add_f32 v65, v65, v77
    v_add_f32 v66, v66, v78
    v_add_f32 v67, v67, v79
    v_add_f32 v64, v64, v80
    v_add_f32 v65, v65, v81
    v_add_f32 v66, v66, v82
    v_add_f32 v67, v67, v83
    v_add_f32 v64, v64, v84
    v_add_f32 v65, v65, v85
    v_add_f32 v66, v66, v86
    v_add_f32 v67, v67, v87
    v_add_f32 v64, v64, v88
    v_add_f32 v65, v65, v89
    v_add_f32 v66, v66, v90
    v_add_f32 v67, v67, v91
    v_add_f32 v64, v64, v92
    v_add_f32 v65, v65, v93
    v_add_f32 v66, v66, v94
    v_add_f32 v67, v67, v95
    v_mov_b32 v68, v64
    v_mov_b32 v69, v65
    v_mov_b32 v70, v66
    v_mov_b32 v71, v67
    v_permlane32_swap_b32 v64, v68
    v_permlane32_swap_b32 v65, v69
    v_permlane32_swap_b32 v66, v70
    v_permlane32_swap_b32 v67, v71
    v_add_f32 v64, v64, v68
    v_add_f32 v65, v65, v69
    v_add_f32 v66, v66, v70
    v_add_f32 v67, v67, v71
    v_and_b32 v47, 31, v1
    v_lshlrev_b32 v47, 4, v47
    v_add_u32 v47, 132096, v47
    ds_write_b128 v47, v[64:67]
    v_mov_b32 v45, 131072
    ds_write_b32 v45, v46 offset:1552
K1_Oe:
    s_cmp_lg_u32 s27, 3
    s_cbranch_scc1 K1_NODRY
    v_mov_b32 v2, 0
    v_mov_b32 v3, 0
    v_mov_b32 v4, 0
    v_mov_b32 v5, 0
    v_mov_b32 v6, 0
    v_mov_b32 v7, 0
    v_mov_b32 v8, 0
    v_mov_b32 v9, 0
    v_mov_b32 v40, 0
    v_mov_b32 v41, 0
    v_mov_b32 v42, 0
    v_mov_b32 v43, 0
    v_mov_b32 v44, 0
    v_mov_b32 v45, 0
    v_mov_b32 v46, 0
    v_mov_b32 v47, 0
    s_mov_b32 s44, 0
    s_mov_b32 s45, 0
    s_mov_b32 s58, 0
    s_mov_b32 s59, 0
    s_mov_b64 exec, 0
    s_cmp_eq_u32 s26, 2
    s_cbranch_scc1 K1_LV_wd
    s_branch K1_LQ_wd
K1_NODRY:
    s_mov_b64 exec, -1
    s_branch K2_ENTRY
K1_SPARE:
    s_getpc_b64 s[52:53]
    K1_PC:
    s_sub_u32 s52, s52, K1_PC - sequential_preLN__mha_block__mixer_s_mlp__prompt_kernel
    s_subb_u32 s53, s53, 0
    s_mov_b32 s54, CODE_END - sequential_preLN__mha_block__mixer_s_mlp__prompt_kernel
    s_mov_b32 s55, 0x00020000
    s_xor_b32 s56, s31, 31
    s_lshl_b32 s56, s56, 16
    v_lshlrev_b32 v61, 7, v0
    buffer_load_dword v62, v61, s[52:55], s56 offen
    s_sub_u32 s33, s2, 240
    s_load_dwordx2 s[92:93], s[0:1], 72
    s_mov_b32 s94, 256
    s_mov_b32 s95, 0x00020000
    s_lshl_b32 s34, s33, 7
    s_and_b32 s35, s27, 3
    s_lshl_b32 s36, s35, 1
    s_add_u32 s34, s34, s36
    s_add_u32 s34, s34, 120
    s_mul_i32 s34, s34, 1280
    s_waitcnt lgkmcnt(0)
    s_mov_b32 s6, 2621440
    s_mov_b32 s7, 0x00020000
    v_lshrrev_b32 v228, 5, v1
    v_mul_u32_u24 v228, 1280, v228
    v_and_b32 v229, 31, v1
    v_lshl_add_u32 v228, v229, 3, v228
    buffer_load_dwordx2 v[216:217], v228, s[4:7], s34 offen offset:0
    buffer_load_dwordx2 v[218:219], v228, s[4:7], s34 offen offset:256
    buffer_load_dwordx2 v[220:221], v228, s[4:7], s34 offen offset:512
    buffer_load_dwordx2 v[222:223], v228, s[4:7], s34 offen offset:768
    buffer_load_dwordx2 v[224:225], v228, s[4:7], s34 offen offset:1024
    s_mov_b32 s20, s8
    s_mov_b32 s21, s9
    s_mov_b32 s22, 19517440
    s_mov_b32 s23, 0x00020000
    s_lshl_b32 s34, s33, 13
    s_add_u32 s34, s34, 19398656
    v_lshlrev_b32 v7, 4, v0
    v_mov_b64 v[20:21], 0
    v_mov_b64 v[22:23], 0
    buffer_store_dwordx4 v[20:23], v7, s[20:23], s34 offen sc1
    s_mov_b32 s22, 49283072
    s_mov_b32 s46, 0x3f803f80
    v_mov_b64 v[230:231], 0
    v_mov_b64 v[232:233], 0
    s_waitcnt vmcnt(0)
    v_dot2c_f32_bf16 v230, s46, v216
    v_dot2c_f32_bf16 v231, v216, v216
    v_dot2c_f32_bf16 v232, s46, v217
    v_dot2c_f32_bf16 v233, v217, v217
    v_dot2c_f32_bf16 v230, s46, v218
    v_dot2c_f32_bf16 v231, v218, v218
    v_dot2c_f32_bf16 v232, s46, v219
    v_dot2c_f32_bf16 v233, v219, v219
    v_dot2c_f32_bf16 v230, s46, v220
    v_dot2c_f32_bf16 v231, v220, v220
    v_dot2c_f32_bf16 v232, s46, v221
    v_dot2c_f32_bf16 v233, v221, v221
    v_dot2c_f32_bf16 v230, s46, v222
    v_dot2c_f32_bf16 v231, v222, v222
    v_dot2c_f32_bf16 v232, s46, v223
    v_dot2c_f32_bf16 v233, v223, v223
    v_dot2c_f32_bf16 v230, s46, v224
    v_dot2c_f32_bf16 v231, v224, v224
    v_dot2c_f32_bf16 v232, s46, v225
    v_dot2c_f32_bf16 v233, v225, v225
    s_nop 2
    v_add_f32 v230, v230, v232
    v_add_f32 v231, v231, v233
    s_nop 0
    v_add_f32_dpp v230, v230, v230 row_ror:1 row_mask:0xf bank_mask:0xf
    v_add_f32_dpp v231, v231, v231 row_ror:1 row_mask:0xf bank_mask:0xf
    s_nop 0
    v_add_f32_dpp v230, v230, v230 row_ror:2 row_mask:0xf bank_mask:0xf
    v_add_f32_dpp v231, v231, v231 row_ror:2 row_mask:0xf bank_mask:0xf
    s_nop 0
    v_add_f32_dpp v230, v230, v230 row_ror:4 row_mask:0xf bank_mask:0xf
    v_add_f32_dpp v231, v231, v231 row_ror:4 row_mask:0xf bank_mask:0xf
    s_nop 0
    v_add_f32_dpp v230, v230, v230 row_ror:8 row_mask:0xf bank_mask:0xf
    v_add_f32_dpp v231, v231, v231 row_ror:8 row_mask:0xf bank_mask:0xf
    s_nop 0
    v_mov_b32 v232, v230
    v_mov_b32 v233, v231
    v_lshrrev_b32 v228, 5, v1
    v_permlane16_swap_b32 v230, v232
    v_permlane16_swap_b32 v231, v233
    v_add_f32 v230, v230, v232
    v_add_f32 v231, v231, v233
    v_mul_f32 v230, 0xbacccccd, v230
    v_mul_f32 v231, 0x3acccccd, v231
    v_fma_f32 v231, -v230, v230, v231
    v_max_f32 v231, 0, v231
    v_add_f32 v231, 0x3727c5ac, v231
    v_rsq_f32 v231, v231
    s_lshl_b32 s46, s35, 3
    s_add_u32 s46, s46, 132864
    v_lshl_add_u32 v228, v228, 2, s46
    ds_write_b32 v228, v230
    ds_write_b32 v228, v231 offset:32
    s_waitcnt lgkmcnt(0)
    s_mov_b32 s101, -1
    s_barrier
    s_cmp_lg_u32 s27, 0
    s_cbranch_scc1 K2_ENTRY
    s_lshl_b32 s34, s33, 10
    s_add_u32 s34, s34, 47514080
    s_lshl_b32 s35, s33, 4
    v_mov_b32 v10, 0
    v_mov_b32 v11, 1
    v_lshlrev_b32 v47, 4, v1
    v_add_u32 v48, 132864, v47
    s_mov_b64 exec, 15
    ds_read_b128 v[52:55], v48
    v_lshrrev_b32 v48, 1, v1
    v_mul_u32_u24 v48, 480, v48
    v_add_u32 v47, v47, v48
    s_waitcnt lgkmcnt(0)
    buffer_store_dwordx4 v[52:55], v47, s[20:23], s34 offen sc1
    s_mov_b64 exec, -1
    s_mov_b64 exec, 1
    s_waitcnt vmcnt(0)
    buffer_atomic_add v11, v10, s[92:95], s35 offen sc1
    s_mov_b64 exec, 0xffff
    v_lshlrev_b32 v10, 4, v1
    s_mov_b32 s33, 32768
    s_sleep 127
    K1_SPW:
    s_sleep 16
    buffer_load_dword v11, v10, s[92:95], 0 offen sc1
    s_sub_u32 s33, s33, 1
    s_cmp_eq_u32 s33, 0
    s_cbranch_scc1 K1_SPX
    s_waitcnt vmcnt(0)
    v_cmp_gt_u32 vcc, 16, v11
    s_cbranch_vccnz K1_SPW
    K1_SPX:
    s_mov_b64 exec, -1
    s_branch K2_ENTRY
K1_COMPUTE:
    s_mul_i32 s33, s26, 5
    s_add_u32 s33, s33, s25
    s_lshl_b32 s33, s33, 2
    s_add_u32 s33, s33, s27
    s_lshl_b32 s33, s33, 1
    s_lshl_b32 s34, s24, 7
    s_add_u32 s33, s33, s34
    s_mul_i32 s33, s33, 1280
    s_mul_i32 s34, s24, 40
    s_mul_i32 s35, s27, 10
    s_add_u32 s34, s34, s35
    s_mul_i32 s34, s34, 3840
    s_mul_i32 s35, s26, 5
    s_add_u32 s35, s35, s25
    s_lshl_b32 s35, s35, 8
    s_add_u32 s34, s34, s35
    s_mov_b32 s18, 2457600
    s_mov_b32 s19, 0x00020000
    v_lshlrev_b32 v200, 2, v1
    s_waitcnt lgkmcnt(0)
    s_mov_b32 s16, s6
    s_mov_b32 s17, s7
    s_lshr_b32 s28, s27, 1
    s_and_b32 s29, s27, 1
    v_and_b32 v52, 31, v1
    v_lshrrev_b32 v53, 5, v1
    v_bfe_u32 v54, v1, 1, 3
    v_xor_b32 v54, v54, v53
    s_lshl_b32 s33, s28, 13
    s_lshl_b32 s34, s29, 12
    s_add_u32 s35, s33, s34
    s_xor_b32 s36, s35, 4096
    v_lshlrev_b32 v55, 7, v52
    v_xor_b32 v56, 0, v54
    v_lshl_add_u32 v56, v56, 4, v55
    v_add_u32 v10, s35, v56
    v_add_u32 v14, s36, v56
    v_xor_b32 v56, 2, v54
    v_lshl_add_u32 v56, v56, 4, v55
    v_add_u32 v11, s35, v56
    v_add_u32 v15, s36, v56
    v_xor_b32 v56, 4, v54
    v_lshl_add_u32 v56, v56, 4, v55
    v_add_u32 v12, s35, v56
    v_add_u32 v16, s36, v56
    v_xor_b32 v56, 6, v54
    v_lshl_add_u32 v56, v56, 4, v55
    v_add_u32 v13, s35, v56
    v_add_u32 v17, s36, v56
    v_bfe_u32 v56, v1, 4, 1
    v_and_b32 v57, 3, v1
    v_lshlrev_b32 v57, 3, v57
    v_lshl_add_u32 v57, v56, 5, v57
    v_lshl_add_u32 v57, v53, 11, v57
    v_bfe_u32 v56, v1, 2, 2
    v_lshl_add_u32 v57, v56, 8, v57
    s_lshl_b32 s33, s29, 1
    s_add_u32 s33, s33, s28
    v_xor_b32 v56, s33, v56
    v_lshl_add_u32 v57, v56, 6, v57
    v_add_u32 v18, 16384, v57
    v_xor_b32 v19, 64, v18
    v_mov_b32 v50, 0
    v_mov_b32 v51, 0
    v_mov_b32 v36, 0x3f803f80
    v_mov_b32 v37, 0x3f803f80
    s_mov_b32 s47, 0xffff0000
    s_mov_b32 s49, 0x10000
    v_mov_b64 v[20:21], 0
    v_mov_b64 v[22:23], 0
    v_mov_b64 v[24:25], 0
    v_mov_b64 v[26:27], 0
    v_mov_b64 v[28:29], 0
    v_mov_b64 v[30:31], 0
    v_mov_b64 v[32:33], 0
    v_mov_b64 v[34:35], 0
    v_mov_b64 v[96:97], 0
    v_mov_b64 v[98:99], 0
    v_mov_b64 v[100:101], 0
    v_mov_b64 v[102:103], 0
    v_mov_b64 v[104:105], 0
    v_mov_b64 v[106:107], 0
    v_mov_b64 v[108:109], 0
    v_mov_b64 v[110:111], 0
    v_mov_b64 v[112:113], 0
    v_mov_b64 v[114:115], 0
    v_mov_b64 v[116:117], 0
    v_mov_b64 v[118:119], 0
    v_mov_b64 v[120:121], 0
    v_mov_b64 v[122:123], 0
    v_mov_b64 v[124:125], 0
    v_mov_b64 v[126:127], 0
    v_mov_b64 v[128:129], 0
    v_mov_b64 v[130:131], 0
    v_mov_b64 v[132:133], 0
    v_mov_b64 v[134:135], 0
    v_mov_b64 v[136:137], 0
    v_mov_b64 v[138:139], 0
    v_mov_b64 v[140:141], 0
    v_mov_b64 v[142:143], 0
    v_mov_b64 v[144:145], 0
    v_mov_b64 v[146:147], 0
    v_mov_b64 v[148:149], 0
    v_mov_b64 v[150:151], 0
    v_mov_b64 v[152:153], 0
    v_mov_b64 v[154:155], 0
    v_mov_b64 v[156:157], 0
    v_mov_b64 v[158:159], 0
    s_cmp_eq_u32 s26, 2
    s_cbranch_scc1 K1_VADDR
    s_lshl_b32 s37, 81920, s26
    s_lshl_b32 s38, 1280, s26
    s_cmp_eq_u32 s26, 0
    s_cselect_b32 s39, 0, 4194304
    s_cselect_b32 s48, 0x3ea52b5c, 1.0
    s_lshl_b32 s33, s25, 4
    s_lshl_b32 s34, s29, 3
    s_add_u32 s33, s33, s34
    v_lshlrev_b32 v56, 4, v52
    v_lshlrev_b32 v57, 3, v52
    v_add_u32 v57, 1024, v57
    s_lshl_b32 s51, s37, 1
    s_sub_u32 s56, s37, 1536
    v_mov_b32 v63, 0x7fffffff
    s_xor_b32 s34, s28, 0
    s_lshl_b32 s34, s34, 2
    s_add_u32 s34, s34, s33
    v_add_u32 v58, s34, v53
    v_add_u32 v58, 0, v58
    v_mul_u32_u24 v59, 205, v58
    v_lshrrev_b32 v59, 10, v59
    v_mul_u32_u24 v61, 5, v59
    v_sub_u32 v58, v58, v61
    v_mul_lo_u32 v59, v59, s51
    v_lshl_add_u32 v61, v58, 9, v56
    v_add_u32 v61, v61, v59
    v_add_u32 v62, s56, v61
    v_cmp_lt_u32 vcc, 2, v58
    v_add_u32 v59, v59, v57
    v_cmp_eq_u32 s[60:61], 2, v58
    v_cndmask_b32 v61, v61, v62, vcc
    v_nop
    v_cndmask_b32 v40, v61, v63, s[60:61]
    v_cndmask_b32 v44, v63, v59, s[60:61]
    v_add_u32 v58, s34, v53
    v_add_u32 v58, 2, v58
    v_mul_u32_u24 v59, 205, v58
    v_lshrrev_b32 v59, 10, v59
    v_mul_u32_u24 v61, 5, v59
    v_sub_u32 v58, v58, v61
    v_mul_lo_u32 v59, v59, s51
    v_lshl_add_u32 v61, v58, 9, v56
    v_add_u32 v61, v61, v59
    v_add_u32 v62, s56, v61
    v_cmp_lt_u32 vcc, 2, v58
    v_add_u32 v59, v59, v57
    v_cmp_eq_u32 s[62:63], 2, v58
    v_cndmask_b32 v61, v61, v62, vcc
    v_nop
    v_cndmask_b32 v41, v61, v63, s[62:63]
    v_cndmask_b32 v45, v63, v59, s[62:63]
    s_xor_b32 s34, s28, 1
    s_lshl_b32 s34, s34, 2
    s_add_u32 s34, s34, s33
    v_add_u32 v58, s34, v53
    v_add_u32 v58, 0, v58
    v_mul_u32_u24 v59, 205, v58
    v_lshrrev_b32 v59, 10, v59
    v_mul_u32_u24 v61, 5, v59
    v_sub_u32 v58, v58, v61
    v_mul_lo_u32 v59, v59, s51
    v_lshl_add_u32 v61, v58, 9, v56
    v_add_u32 v61, v61, v59
    v_add_u32 v62, s56, v61
    v_cmp_lt_u32 vcc, 2, v58
    v_add_u32 v59, v59, v57
    v_cmp_eq_u32 s[64:65], 2, v58
    v_cndmask_b32 v61, v61, v62, vcc
    v_nop
    v_cndmask_b32 v42, v61, v63, s[64:65]
    v_cndmask_b32 v46, v63, v59, s[64:65]
    v_add_u32 v58, s34, v53
    v_add_u32 v58, 2, v58
    v_mul_u32_u24 v59, 205, v58
    v_lshrrev_b32 v59, 10, v59
    v_mul_u32_u24 v61, 5, v59
    v_sub_u32 v58, v58, v61
    v_mul_lo_u32 v59, v59, s51
    v_lshl_add_u32 v61, v58, 9, v56
    v_add_u32 v61, v61, v59
    v_add_u32 v62, s56, v61
    v_cmp_lt_u32 vcc, 2, v58
    v_add_u32 v59, v59, v57
    v_cmp_eq_u32 s[66:67], 2, v58
    v_cndmask_b32 v61, v61, v62, vcc
    v_nop
    v_cndmask_b32 v43, v61, v63, s[66:67]
    v_cndmask_b32 v47, v63, v59, s[66:67]
    s_branch K1_ADDR_DONE
K1_VADDR:
    s_mov_b32 s38, 2560
    s_mov_b32 s39, 4195584
    s_mov_b32 s48, 1.0
    s_mov_b32 s37, 163840
    s_lshl_b32 s33, s25, 7
    s_lshl_b32 s34, s29, 6
    s_add_u32 s33, s33, s34
    v_mul_u32_u24 v56, 320, v53
    s_xor_b32 s34, s28, 0
    s_lshl_b32 s34, s34, 5
    s_add_u32 s34, s34, s33
    v_add_u32 v58, s34, v52
    v_mul_u32_u24 v59, 3277, v58
    v_lshrrev_b32 v59, 16, v59
    v_mul_u32_u24 v61, 20, v59
    v_sub_u32 v58, v58, v61
    v_mul_lo_u32 v59, v59, s37
    v_lshl_add_u32 v58, v58, 4, v56
    v_add_u32 v40, v58, v59
    s_xor_b32 s34, s28, 1
    s_lshl_b32 s34, s34, 5
    s_add_u32 s34, s34, s33
    v_add_u32 v58, s34, v52
    v_mul_u32_u24 v59, 3277, v58
    v_lshrrev_b32 v59, 16, v59
    v_mul_u32_u24 v61, 20, v59
    v_sub_u32 v58, v58, v61
    v_mul_lo_u32 v59, v59, s37
    v_lshl_add_u32 v58, v58, 4, v56
    v_add_u32 v41, v58, v59
    v_mov_b32 v42, 0
    v_mov_b32 v43, 0
    v_mov_b32 v44, 0
    v_mov_b32 v45, 0
    v_mov_b32 v46, 0
    v_mov_b32 v47, 0
K1_ADDR_DONE:
    s_lshl_b32 s33, s24, 2
    s_lshl_b32 s34, s28, 1
    s_add_u32 s33, s33, s34
    s_add_u32 s34, s33, s29
    s_xor_b32 s35, s34, 1
    s_mul_i32 s44, s34, s38
    s_mul_i32 s45, s35, s38
    s_add_u32 s44, s44, s39
    s_add_u32 s45, s45, s39
    s_add_u32 s58, s44, s37
    s_add_u32 s59, s45, s37
    s_lshl_b32 s33, s28, 8
    s_lshl_b32 s34, s29, 7
    s_add_u32 s35, s33, s34
    s_add_u32 s35, s35, 131072
    v_lshl_add_u32 v2, v52, 2, s35
    s_lshl_b32 s33, s29, 8
    s_lshl_b32 s34, s28, 7
    s_add_u32 s36, s33, s34
    s_add_u32 s36, s36, 131072
    v_lshl_add_u32 v3, v52, 2, s36
    v_xor_b32 v4, 128, v2
    v_xor_b32 v5, 128, v3
    v_lshl_add_u32 v6, v53, 4, s35
    v_lshl_add_u32 v7, v53, 4, s36
    v_xor_b32 v8, 128, v6
    v_xor_b32 v9, 128, v7
    v_mov_b32 v38, 4
    v_lshlrev_b32 v38, 2, v38
    v_add_u32 v38, 131072, v38
    s_mov_b32 s50, 5
    s_waitcnt lgkmcnt(0)
    s_mov_b32 s20, s8
    s_mov_b32 s21, s9
    s_mov_b32 s22, 49283072
    s_mov_b32 s23, 0x00020000
    s_cmp_eq_u32 s26, 2
    s_cbranch_scc1 K1_MAIN_V
    s_barrier
    ds_read_b128 v[64:67], v10 offset:0
    ds_read_b64_tr_b16 v[80:81], v18 offset:0
    ds_read_b64_tr_b16 v[82:83], v18 offset:1024
    ds_read_b64_tr_b16 v[84:85], v19 offset:0
    ds_read_b64_tr_b16 v[86:87], v19 offset:1024
    ds_read_b128 v[68:71], v14 offset:0
.p2align 6
K1_LQ:
    s_waitcnt lgkmcnt(0)
    v_mfma_f32_32x32x16_bf16 v[96:111], v[80:83], v[64:67], v[96:111]
    ds_read_b128 v[72:75], v11 offset:0
    ds_read_b64_tr_b16 v[88:89], v18 offset:4096
    v_mfma_f32_32x32x16_bf16 v[112:127], v[84:87], v[64:67], v[112:127]
    ds_read_b64_tr_b16 v[90:91], v18 offset:5120
    ds_read_b64_tr_b16 v[92:93], v19 offset:4096
    v_mfma_f32_32x32x16_bf16 v[128:143], v[80:83], v[68:71], v[128:143]
    ds_read_b64_tr_b16 v[94:95], v19 offset:5120
    ds_read_b128 v[76:79], v15 offset:0
    v_mfma_f32_32x32x16_bf16 v[144:159], v[84:87], v[68:71], v[144:159]
    s_waitcnt lgkmcnt(0)
    v_mfma_f32_32x32x16_bf16 v[96:111], v[88:91], v[72:75], v[96:111]
    ds_read_b128 v[64:67], v12 offset:0
    ds_read_b64_tr_b16 v[80:81], v18 offset:8192
    v_mfma_f32_32x32x16_bf16 v[112:127], v[92:95], v[72:75], v[112:127]
    ds_read_b64_tr_b16 v[82:83], v18 offset:9216
    ds_read_b64_tr_b16 v[84:85], v19 offset:8192
    v_mfma_f32_32x32x16_bf16 v[128:143], v[88:91], v[76:79], v[128:143]
    ds_read_b64_tr_b16 v[86:87], v19 offset:9216
    ds_read_b128 v[68:71], v16 offset:0
    v_mfma_f32_32x32x16_bf16 v[144:159], v[92:95], v[76:79], v[144:159]
    s_waitcnt lgkmcnt(0)
    v_mfma_f32_32x32x16_bf16 v[96:111], v[80:83], v[64:67], v[96:111]
    ds_read_b128 v[72:75], v13 offset:0
    ds_read_b64_tr_b16 v[88:89], v18 offset:12288
    v_mfma_f32_32x32x16_bf16 v[112:127], v[84:87], v[64:67], v[112:127]
    ds_read_b64_tr_b16 v[90:91], v18 offset:13312
    ds_read_b64_tr_b16 v[92:93], v19 offset:12288
    v_mfma_f32_32x32x16_bf16 v[128:143], v[80:83], v[68:71], v[128:143]
    ds_read_b64_tr_b16 v[94:95], v19 offset:13312
    ds_read_b128 v[76:79], v17 offset:0
    v_mfma_f32_32x32x16_bf16 v[144:159], v[84:87], v[68:71], v[144:159]
    s_waitcnt lgkmcnt(0)
    s_barrier
    v_mfma_f32_32x32x16_bf16 v[96:111], v[88:91], v[72:75], v[96:111]
    ds_read_b128 v[64:67], v10 offset:32768
    ds_read_b64_tr_b16 v[80:81], v18 offset:32768
    v_mfma_f32_32x32x16_bf16 v[112:127], v[92:95], v[72:75], v[112:127]
    ds_read_b64_tr_b16 v[82:83], v18 offset:33792
    ds_read_b64_tr_b16 v[84:85], v19 offset:32768
    v_mfma_f32_32x32x16_bf16 v[128:143], v[88:91], v[76:79], v[128:143]
    ds_read_b64_tr_b16 v[86:87], v19 offset:33792
    ds_read_b128 v[68:71], v14 offset:32768
    v_mfma_f32_32x32x16_bf16 v[144:159], v[92:95], v[76:79], v[144:159]
    s_waitcnt lgkmcnt(0)
    v_mfma_f32_32x32x16_bf16 v[96:111], v[80:83], v[64:67], v[96:111]
    ds_read_b128 v[72:75], v11 offset:32768
    ds_read_b64_tr_b16 v[88:89], v18 offset:36864
    v_mfma_f32_32x32x16_bf16 v[112:127], v[84:87], v[64:67], v[112:127]
    ds_read_b64_tr_b16 v[90:91], v18 offset:37888
    ds_read_b64_tr_b16 v[92:93], v19 offset:36864
    v_mfma_f32_32x32x16_bf16 v[128:143], v[80:83], v[68:71], v[128:143]
    ds_read_b64_tr_b16 v[94:95], v19 offset:37888
    ds_read_b128 v[76:79], v15 offset:32768
    v_mfma_f32_32x32x16_bf16 v[144:159], v[84:87], v[68:71], v[144:159]
    v_xor_b32 v10, s49, v10
    v_xor_b32 v14, s49, v14
    s_waitcnt lgkmcnt(0)
    v_mfma_f32_32x32x16_bf16 v[96:111], v[88:91], v[72:75], v[96:111]
    ds_read_b128 v[64:67], v12 offset:32768
    ds_read_b64_tr_b16 v[80:81], v18 offset:40960
    v_mfma_f32_32x32x16_bf16 v[112:127], v[92:95], v[72:75], v[112:127]
    ds_read_b64_tr_b16 v[82:83], v18 offset:41984
    ds_read_b64_tr_b16 v[84:85], v19 offset:40960
    v_mfma_f32_32x32x16_bf16 v[128:143], v[88:91], v[76:79], v[128:143]
    ds_read_b64_tr_b16 v[86:87], v19 offset:41984
    ds_read_b128 v[68:71], v16 offset:32768
    v_mfma_f32_32x32x16_bf16 v[144:159], v[92:95], v[76:79], v[144:159]
    v_xor_b32 v11, s49, v11
    v_xor_b32 v15, s49, v15
    s_waitcnt lgkmcnt(0)
    v_mfma_f32_32x32x16_bf16 v[96:111], v[80:83], v[64:67], v[96:111]
    ds_read_b128 v[72:75], v13 offset:32768
    ds_read_b64_tr_b16 v[88:89], v18 offset:45056
    v_mfma_f32_32x32x16_bf16 v[112:127], v[84:87], v[64:67], v[112:127]
    ds_read_b64_tr_b16 v[90:91], v18 offset:46080
    ds_read_b64_tr_b16 v[92:93], v19 offset:45056
    v_mfma_f32_32x32x16_bf16 v[128:143], v[80:83], v[68:71], v[128:143]
    ds_read_b64_tr_b16 v[94:95], v19 offset:46080
    ds_read_b128 v[76:79], v17 offset:32768
    v_mfma_f32_32x32x16_bf16 v[144:159], v[84:87], v[68:71], v[144:159]
    v_xor_b32 v12, s49, v12
    v_xor_b32 v16, s49, v16
    s_waitcnt lgkmcnt(0)
    s_cmp_eq_u32 s50, 1
    s_cbranch_scc1 K1_LQ_nb
    s_barrier
    K1_LQ_nb:
    v_mfma_f32_32x32x16_bf16 v[96:111], v[88:91], v[72:75], v[96:111]
    v_xor_b32 v18, s49, v18
    v_xor_b32 v19, s49, v19
    ds_read_b128 v[64:67], v10 offset:0
    ds_read_b64_tr_b16 v[80:81], v18 offset:0
    v_mfma_f32_32x32x16_bf16 v[112:127], v[92:95], v[72:75], v[112:127]
    ds_read_b64_tr_b16 v[82:83], v18 offset:1024
    ds_read_b64_tr_b16 v[84:85], v19 offset:0
    v_mfma_f32_32x32x16_bf16 v[128:143], v[88:91], v[76:79], v[128:143]
    ds_read_b64_tr_b16 v[86:87], v19 offset:1024
    ds_read_b128 v[68:71], v14 offset:0
    v_mfma_f32_32x32x16_bf16 v[144:159], v[92:95], v[76:79], v[144:159]
    v_xor_b32 v13, s49, v13
    v_xor_b32 v17, s49, v17
    s_sub_u32 s50, s50, 1
    s_cmp_lg_u32 s50, 0
    s_cbranch_scc1 K1_LQ
    s_mov_b32 s33, 65536
    K1_LQ_w:
    ds_read_b32 v58, v38 offset:1536
    s_sub_u32 s33, s33, 1
    s_cmp_eq_u32 s33, 0
    s_cbranch_scc1 K1_LQ_wd
    s_waitcnt lgkmcnt(0)
    v_cmp_eq_u32 vcc, 0, v58
    s_cbranch_vccnz K1_LQ_w
    K1_LQ_wd:
    ds_read_b32 v160, v2
    ds_read_b32 v162, v2 offset:512
    ds_read_b32 v164, v4
    ds_read_b32 v166, v4 offset:512
    ds_read_b128 v[176:179], v7 offset:1024
    ds_read_b128 v[180:183], v7 offset:1056
    ds_read_b128 v[184:187], v7 offset:1088
    ds_read_b128 v[188:191], v7 offset:1120
    ds_read_b128 v[192:195], v9 offset:1024
    ds_read_b128 v[196:199], v9 offset:1056
    ds_read_b128 v[200:203], v9 offset:1088
    ds_read_b128 v[204:207], v9 offset:1120
    s_waitcnt lgkmcnt(0)
    v_mul_f32 v162, s48, v162
    v_mul_f32 v166, s48, v166
    v_pk_fma_f32 v[96:97], v[176:177], v[160:161], v[96:97] op_sel_hi:[1,0,1]
    v_pk_fma_f32 v[98:99], v[178:179], v[160:161], v[98:99] op_sel_hi:[1,0,1]
    v_pk_mul_f32 v[96:97], v[96:97], v[162:163] op_sel_hi:[1,0]
    v_pk_mul_f32 v[98:99], v[98:99], v[162:163] op_sel_hi:[1,0]
    v_cvt_pk_bf16_f32 v96, v96, v97
    v_cvt_pk_bf16_f32 v97, v98, v99
    v_pk_fma_f32 v[100:101], v[180:181], v[160:161], v[100:101] op_sel_hi:[1,0,1]
    v_pk_fma_f32 v[102:103], v[182:183], v[160:161], v[102:103] op_sel_hi:[1,0,1]
    v_pk_mul_f32 v[100:101], v[100:101], v[162:163] op_sel_hi:[1,0]
    v_pk_mul_f32 v[102:103], v[102:103], v[162:163] op_sel_hi:[1,0]
    v_cvt_pk_bf16_f32 v98, v100, v101
    v_cvt_pk_bf16_f32 v99, v102, v103
    s_cmp_eq_u64 s[60:61], 0
    s_nop 0
    v_permlane32_swap_b32 v96, v98
    v_permlane32_swap_b32 v97, v99
    buffer_store_dwordx4 v[96:99], v40, s[20:23], s44 offen sc1
    s_cbranch_scc1 K1_KB_1
    buffer_store_dwordx2 v[96:97], v44, s[20:23], s44 offen sc1
    buffer_store_dwordx2 v[98:99], v44, s[20:23], s58 offen sc1
K1_KB_1:
    v_pk_fma_f32 v[104:105], v[184:185], v[160:161], v[104:105] op_sel_hi:[1,0,1]
    v_pk_fma_f32 v[106:107], v[186:187], v[160:161], v[106:107] op_sel_hi:[1,0,1]
    v_pk_mul_f32 v[104:105], v[104:105], v[162:163] op_sel_hi:[1,0]
    v_pk_mul_f32 v[106:107], v[106:107], v[162:163] op_sel_hi:[1,0]
    v_cvt_pk_bf16_f32 v104, v104, v105
    v_cvt_pk_bf16_f32 v105, v106, v107
    v_pk_fma_f32 v[108:109], v[188:189], v[160:161], v[108:109] op_sel_hi:[1,0,1]
    v_pk_fma_f32 v[110:111], v[190:191], v[160:161], v[110:111] op_sel_hi:[1,0,1]
    v_pk_mul_f32 v[108:109], v[108:109], v[162:163] op_sel_hi:[1,0]
    v_pk_mul_f32 v[110:111], v[110:111], v[162:163] op_sel_hi:[1,0]
    v_cvt_pk_bf16_f32 v106, v108, v109
    v_cvt_pk_bf16_f32 v107, v110, v111
    s_cmp_eq_u64 s[62:63], 0
    s_nop 0
    v_permlane32_swap_b32 v104, v106
    v_permlane32_swap_b32 v105, v107
    buffer_store_dwordx4 v[104:107], v41, s[20:23], s44 offen sc1
    s_cbranch_scc1 K1_KB_2
    buffer_store_dwordx2 v[104:105], v45, s[20:23], s44 offen sc1
    buffer_store_dwordx2 v[106:107], v45, s[20:23], s58 offen sc1
K1_KB_2:
    v_pk_fma_f32 v[112:113], v[192:193], v[160:161], v[112:113] op_sel_hi:[1,0,1]
    v_pk_fma_f32 v[114:115], v[194:195], v[160:161], v[114:115] op_sel_hi:[1,0,1]
    v_pk_mul_f32 v[112:113], v[112:113], v[162:163] op_sel_hi:[1,0]
    v_pk_mul_f32 v[114:115], v[114:115], v[162:163] op_sel_hi:[1,0]
    v_cvt_pk_bf16_f32 v112, v112, v113
    v_cvt_pk_bf16_f32 v113, v114, v115
    v_pk_fma_f32 v[116:117], v[196:197], v[160:161], v[116:117] op_sel_hi:[1,0,1]
    v_pk_fma_f32 v[118:119], v[198:199], v[160:161], v[118:119] op_sel_hi:[1,0,1]
    v_pk_mul_f32 v[116:117], v[116:117], v[162:163] op_sel_hi:[1,0]
    v_pk_mul_f32 v[118:119], v[118:119], v[162:163] op_sel_hi:[1,0]
    v_cvt_pk_bf16_f32 v114, v116, v117
    v_cvt_pk_bf16_f32 v115, v118, v119
    s_cmp_eq_u64 s[64:65], 0
    s_nop 0
    v_permlane32_swap_b32 v112, v114
    v_permlane32_swap_b32 v113, v115
    buffer_store_dwordx4 v[112:115], v42, s[20:23], s44 offen sc1
    s_cbranch_scc1 K1_KB_3
    buffer_store_dwordx2 v[112:113], v46, s[20:23], s44 offen sc1
    buffer_store_dwordx2 v[114:115], v46, s[20:23], s58 offen sc1
K1_KB_3:
    v_pk_fma_f32 v[120:121], v[200:201], v[160:161], v[120:121] op_sel_hi:[1,0,1]
    v_pk_fma_f32 v[122:123], v[202:203], v[160:161], v[122:123] op_sel_hi:[1,0,1]
    v_pk_mul_f32 v[120:121], v[120:121], v[162:163] op_sel_hi:[1,0]
    v_pk_mul_f32 v[122:123], v[122:123], v[162:163] op_sel_hi:[1,0]
    v_cvt_pk_bf16_f32 v120, v120, v121
    v_cvt_pk_bf16_f32 v121, v122, v123
    v_pk_fma_f32 v[124:125], v[204:205], v[160:161], v[124:125] op_sel_hi:[1,0,1]
    v_pk_fma_f32 v[126:127], v[206:207], v[160:161], v[126:127] op_sel_hi:[1,0,1]
    v_pk_mul_f32 v[124:125], v[124:125], v[162:163] op_sel_hi:[1,0]
    v_pk_mul_f32 v[126:127], v[126:127], v[162:163] op_sel_hi:[1,0]
    v_cvt_pk_bf16_f32 v122, v124, v125
    v_cvt_pk_bf16_f32 v123, v126, v127
    s_cmp_eq_u64 s[66:67], 0
    s_nop 0
    v_permlane32_swap_b32 v120, v122
    v_permlane32_swap_b32 v121, v123
    buffer_store_dwordx4 v[120:123], v43, s[20:23], s44 offen sc1
    s_cbranch_scc1 K1_KB_4
    buffer_store_dwordx2 v[120:121], v47, s[20:23], s44 offen sc1
    buffer_store_dwordx2 v[122:123], v47, s[20:23], s58 offen sc1
K1_KB_4:
    v_pk_fma_f32 v[128:129], v[176:177], v[164:165], v[128:129] op_sel_hi:[1,0,1]
    v_pk_fma_f32 v[130:131], v[178:179], v[164:165], v[130:131] op_sel_hi:[1,0,1]
    v_pk_mul_f32 v[128:129], v[128:129], v[166:167] op_sel_hi:[1,0]
    v_pk_mul_f32 v[130:131], v[130:131], v[166:167] op_sel_hi:[1,0]
    v_cvt_pk_bf16_f32 v128, v128, v129
    v_cvt_pk_bf16_f32 v129, v130, v131
    v_pk_fma_f32 v[132:133], v[180:181], v[164:165], v[132:133] op_sel_hi:[1,0,1]
    v_pk_fma_f32 v[134:135], v[182:183], v[164:165], v[134:135] op_sel_hi:[1,0,1]
    v_pk_mul_f32 v[132:133], v[132:133], v[166:167] op_sel_hi:[1,0]
    v_pk_mul_f32 v[134:135], v[134:135], v[166:167] op_sel_hi:[1,0]
    v_cvt_pk_bf16_f32 v130, v132, v133
    v_cvt_pk_bf16_f32 v131, v134, v135
    s_cmp_eq_u64 s[60:61], 0
    s_nop 0
    v_permlane32_swap_b32 v128, v130
    v_permlane32_swap_b32 v129, v131
    buffer_store_dwordx4 v[128:131], v40, s[20:23], s45 offen sc1
    s_cbranch_scc1 K1_KB_5
    buffer_store_dwordx2 v[128:129], v44, s[20:23], s45 offen sc1
    buffer_store_dwordx2 v[130:131], v44, s[20:23], s59 offen sc1
K1_KB_5:
    v_pk_fma_f32 v[136:137], v[184:185], v[164:165], v[136:137] op_sel_hi:[1,0,1]
    v_pk_fma_f32 v[138:139], v[186:187], v[164:165], v[138:139] op_sel_hi:[1,0,1]
    v_pk_mul_f32 v[136:137], v[136:137], v[166:167] op_sel_hi:[1,0]
    v_pk_mul_f32 v[138:139], v[138:139], v[166:167] op_sel_hi:[1,0]
    v_cvt_pk_bf16_f32 v136, v136, v137
    v_cvt_pk_bf16_f32 v137, v138, v139
    v_pk_fma_f32 v[140:141], v[188:189], v[164:165], v[140:141] op_sel_hi:[1,0,1]
    v_pk_fma_f32 v[142:143], v[190:191], v[164:165], v[142:143] op_sel_hi:[1,0,1]
    v_pk_mul_f32 v[140:141], v[140:141], v[166:167] op_sel_hi:[1,0]
    v_pk_mul_f32 v[142:143], v[142:143], v[166:167] op_sel_hi:[1,0]
    v_cvt_pk_bf16_f32 v138, v140, v141
    v_cvt_pk_bf16_f32 v139, v142, v143
    s_cmp_eq_u64 s[62:63], 0
    s_nop 0
    v_permlane32_swap_b32 v136, v138
    v_permlane32_swap_b32 v137, v139
    buffer_store_dwordx4 v[136:139], v41, s[20:23], s45 offen sc1
    s_cbranch_scc1 K1_KB_6
    buffer_store_dwordx2 v[136:137], v45, s[20:23], s45 offen sc1
    buffer_store_dwordx2 v[138:139], v45, s[20:23], s59 offen sc1
K1_KB_6:
    v_pk_fma_f32 v[144:145], v[192:193], v[164:165], v[144:145] op_sel_hi:[1,0,1]
    v_pk_fma_f32 v[146:147], v[194:195], v[164:165], v[146:147] op_sel_hi:[1,0,1]
    v_pk_mul_f32 v[144:145], v[144:145], v[166:167] op_sel_hi:[1,0]
    v_pk_mul_f32 v[146:147], v[146:147], v[166:167] op_sel_hi:[1,0]
    v_cvt_pk_bf16_f32 v144, v144, v145
    v_cvt_pk_bf16_f32 v145, v146, v147
    v_pk_fma_f32 v[148:149], v[196:197], v[164:165], v[148:149] op_sel_hi:[1,0,1]
    v_pk_fma_f32 v[150:151], v[198:199], v[164:165], v[150:151] op_sel_hi:[1,0,1]
    v_pk_mul_f32 v[148:149], v[148:149], v[166:167] op_sel_hi:[1,0]
    v_pk_mul_f32 v[150:151], v[150:151], v[166:167] op_sel_hi:[1,0]
    v_cvt_pk_bf16_f32 v146, v148, v149
    v_cvt_pk_bf16_f32 v147, v150, v151
    s_cmp_eq_u64 s[64:65], 0
    s_nop 0
    v_permlane32_swap_b32 v144, v146
    v_permlane32_swap_b32 v145, v147
    buffer_store_dwordx4 v[144:147], v42, s[20:23], s45 offen sc1
    s_cbranch_scc1 K1_KB_7
    buffer_store_dwordx2 v[144:145], v46, s[20:23], s45 offen sc1
    buffer_store_dwordx2 v[146:147], v46, s[20:23], s59 offen sc1
K1_KB_7:
    v_pk_fma_f32 v[152:153], v[200:201], v[164:165], v[152:153] op_sel_hi:[1,0,1]
    v_pk_fma_f32 v[154:155], v[202:203], v[164:165], v[154:155] op_sel_hi:[1,0,1]
    v_pk_mul_f32 v[152:153], v[152:153], v[166:167] op_sel_hi:[1,0]
    v_pk_mul_f32 v[154:155], v[154:155], v[166:167] op_sel_hi:[1,0]
    v_cvt_pk_bf16_f32 v152, v152, v153
    v_cvt_pk_bf16_f32 v153, v154, v155
    v_pk_fma_f32 v[156:157], v[204:205], v[164:165], v[156:157] op_sel_hi:[1,0,1]
    v_pk_fma_f32 v[158:159], v[206:207], v[164:165], v[158:159] op_sel_hi:[1,0,1]
    v_pk_mul_f32 v[156:157], v[156:157], v[166:167] op_sel_hi:[1,0]
    v_pk_mul_f32 v[158:159], v[158:159], v[166:167] op_sel_hi:[1,0]
    v_cvt_pk_bf16_f32 v154, v156, v157
    v_cvt_pk_bf16_f32 v155, v158, v159
    s_cmp_eq_u64 s[66:67], 0
    s_nop 0
    v_permlane32_swap_b32 v152, v154
    v_permlane32_swap_b32 v153, v155
    buffer_store_dwordx4 v[152:155], v43, s[20:23], s45 offen sc1
    s_cbranch_scc1 K1_KB_8
    buffer_store_dwordx2 v[152:153], v47, s[20:23], s45 offen sc1
    buffer_store_dwordx2 v[154:155], v47, s[20:23], s59 offen sc1
K1_KB_8:
    s_mov_b64 exec, -1
    s_branch K2_ENTRY
K1_MAIN_V:
    s_barrier
    ds_read_b128 v[64:67], v10 offset:0
    ds_read_b64_tr_b16 v[80:81], v18 offset:0
    ds_read_b64_tr_b16 v[82:83], v18 offset:1024
    ds_read_b64_tr_b16 v[84:85], v19 offset:0
    ds_read_b64_tr_b16 v[86:87], v19 offset:1024
    ds_read_b128 v[68:71], v14 offset:0
.p2align 6
K1_LV:
    s_waitcnt lgkmcnt(0)
    v_mfma_f32_32x32x16_bf16 v[96:111], v[64:67], v[80:83], v[96:111]
    ds_read_b128 v[72:75], v11 offset:0
    ds_read_b64_tr_b16 v[88:89], v18 offset:4096
    v_mfma_f32_32x32x16_bf16 v[112:127], v[64:67], v[84:87], v[112:127]
    ds_read_b64_tr_b16 v[90:91], v18 offset:5120
    ds_read_b64_tr_b16 v[92:93], v19 offset:4096
    v_mfma_f32_32x32x16_bf16 v[128:143], v[68:71], v[80:83], v[128:143]
    ds_read_b64_tr_b16 v[94:95], v19 offset:5120
    ds_read_b128 v[76:79], v15 offset:0
    v_mfma_f32_32x32x16_bf16 v[144:159], v[68:71], v[84:87], v[144:159]
    s_waitcnt lgkmcnt(0)
    v_mfma_f32_32x32x16_bf16 v[96:111], v[72:75], v[88:91], v[96:111]
    ds_read_b128 v[64:67], v12 offset:0
    ds_read_b64_tr_b16 v[80:81], v18 offset:8192
    v_mfma_f32_32x32x16_bf16 v[112:127], v[72:75], v[92:95], v[112:127]
    ds_read_b64_tr_b16 v[82:83], v18 offset:9216
    ds_read_b64_tr_b16 v[84:85], v19 offset:8192
    v_mfma_f32_32x32x16_bf16 v[128:143], v[76:79], v[88:91], v[128:143]
    ds_read_b64_tr_b16 v[86:87], v19 offset:9216
    ds_read_b128 v[68:71], v16 offset:0
    v_mfma_f32_32x32x16_bf16 v[144:159], v[76:79], v[92:95], v[144:159]
    s_waitcnt lgkmcnt(0)
    v_mfma_f32_32x32x16_bf16 v[96:111], v[64:67], v[80:83], v[96:111]
    ds_read_b128 v[72:75], v13 offset:0
    ds_read_b64_tr_b16 v[88:89], v18 offset:12288
    v_mfma_f32_32x32x16_bf16 v[112:127], v[64:67], v[84:87], v[112:127]
    ds_read_b64_tr_b16 v[90:91], v18 offset:13312
    ds_read_b64_tr_b16 v[92:93], v19 offset:12288
    v_mfma_f32_32x32x16_bf16 v[128:143], v[68:71], v[80:83], v[128:143]
    ds_read_b64_tr_b16 v[94:95], v19 offset:13312
    ds_read_b128 v[76:79], v17 offset:0
    v_mfma_f32_32x32x16_bf16 v[144:159], v[68:71], v[84:87], v[144:159]
    s_waitcnt lgkmcnt(0)
    s_barrier
    v_mfma_f32_32x32x16_bf16 v[96:111], v[72:75], v[88:91], v[96:111]
    ds_read_b128 v[64:67], v10 offset:32768
    ds_read_b64_tr_b16 v[80:81], v18 offset:32768
    v_mfma_f32_32x32x16_bf16 v[112:127], v[72:75], v[92:95], v[112:127]
    ds_read_b64_tr_b16 v[82:83], v18 offset:33792
    ds_read_b64_tr_b16 v[84:85], v19 offset:32768
    v_mfma_f32_32x32x16_bf16 v[128:143], v[76:79], v[88:91], v[128:143]
    ds_read_b64_tr_b16 v[86:87], v19 offset:33792
    ds_read_b128 v[68:71], v14 offset:32768
    v_mfma_f32_32x32x16_bf16 v[144:159], v[76:79], v[92:95], v[144:159]
    s_waitcnt lgkmcnt(0)
    v_mfma_f32_32x32x16_bf16 v[96:111], v[64:67], v[80:83], v[96:111]
    ds_read_b128 v[72:75], v11 offset:32768
    ds_read_b64_tr_b16 v[88:89], v18 offset:36864
    v_mfma_f32_32x32x16_bf16 v[112:127], v[64:67], v[84:87], v[112:127]
    ds_read_b64_tr_b16 v[90:91], v18 offset:37888
    ds_read_b64_tr_b16 v[92:93], v19 offset:36864
    v_mfma_f32_32x32x16_bf16 v[128:143], v[68:71], v[80:83], v[128:143]
    ds_read_b64_tr_b16 v[94:95], v19 offset:37888
    ds_read_b128 v[76:79], v15 offset:32768
    v_mfma_f32_32x32x16_bf16 v[144:159], v[68:71], v[84:87], v[144:159]
    v_xor_b32 v10, s49, v10
    v_xor_b32 v14, s49, v14
    s_waitcnt lgkmcnt(0)
    v_mfma_f32_32x32x16_bf16 v[96:111], v[72:75], v[88:91], v[96:111]
    ds_read_b128 v[64:67], v12 offset:32768
    ds_read_b64_tr_b16 v[80:81], v18 offset:40960
    v_mfma_f32_32x32x16_bf16 v[112:127], v[72:75], v[92:95], v[112:127]
    ds_read_b64_tr_b16 v[82:83], v18 offset:41984
    ds_read_b64_tr_b16 v[84:85], v19 offset:40960
    v_mfma_f32_32x32x16_bf16 v[128:143], v[76:79], v[88:91], v[128:143]
    ds_read_b64_tr_b16 v[86:87], v19 offset:41984
    ds_read_b128 v[68:71], v16 offset:32768
    v_mfma_f32_32x32x16_bf16 v[144:159], v[76:79], v[92:95], v[144:159]
    v_xor_b32 v11, s49, v11
    v_xor_b32 v15, s49, v15
    s_waitcnt lgkmcnt(0)
    v_mfma_f32_32x32x16_bf16 v[96:111], v[64:67], v[80:83], v[96:111]
    ds_read_b128 v[72:75], v13 offset:32768
    ds_read_b64_tr_b16 v[88:89], v18 offset:45056
    v_mfma_f32_32x32x16_bf16 v[112:127], v[64:67], v[84:87], v[112:127]
    ds_read_b64_tr_b16 v[90:91], v18 offset:46080
    ds_read_b64_tr_b16 v[92:93], v19 offset:45056
    v_mfma_f32_32x32x16_bf16 v[128:143], v[68:71], v[80:83], v[128:143]
    ds_read_b64_tr_b16 v[94:95], v19 offset:46080
    ds_read_b128 v[76:79], v17 offset:32768
    v_mfma_f32_32x32x16_bf16 v[144:159], v[68:71], v[84:87], v[144:159]
    v_xor_b32 v12, s49, v12
    v_xor_b32 v16, s49, v16
    s_waitcnt lgkmcnt(0)
    s_cmp_eq_u32 s50, 1
    s_cbranch_scc1 K1_LV_nb
    s_barrier
    K1_LV_nb:
    v_mfma_f32_32x32x16_bf16 v[96:111], v[72:75], v[88:91], v[96:111]
    v_xor_b32 v18, s49, v18
    v_xor_b32 v19, s49, v19
    ds_read_b128 v[64:67], v10 offset:0
    ds_read_b64_tr_b16 v[80:81], v18 offset:0
    v_mfma_f32_32x32x16_bf16 v[112:127], v[72:75], v[92:95], v[112:127]
    ds_read_b64_tr_b16 v[82:83], v18 offset:1024
    ds_read_b64_tr_b16 v[84:85], v19 offset:0
    v_mfma_f32_32x32x16_bf16 v[128:143], v[76:79], v[88:91], v[128:143]
    ds_read_b64_tr_b16 v[86:87], v19 offset:1024
    ds_read_b128 v[68:71], v14 offset:0
    v_mfma_f32_32x32x16_bf16 v[144:159], v[76:79], v[92:95], v[144:159]
    v_xor_b32 v13, s49, v13
    v_xor_b32 v17, s49, v17
    s_sub_u32 s50, s50, 1
    s_cmp_lg_u32 s50, 0
    s_cbranch_scc1 K1_LV
    s_mov_b32 s33, 65536
    K1_LV_w:
    ds_read_b32 v58, v38 offset:1536
    s_sub_u32 s33, s33, 1
    s_cmp_eq_u32 s33, 0
    s_cbranch_scc1 K1_LV_wd
    s_waitcnt lgkmcnt(0)
    v_cmp_eq_u32 vcc, 0, v58
    s_cbranch_vccnz K1_LV_w
    K1_LV_wd:
    ds_read_b32 v162, v5 offset:1024
    ds_read_b32 v160, v3 offset:1024
    ds_read_b128 v[176:179], v6 offset:0
    ds_read_b128 v[208:211], v6 offset:512
    ds_read_b128 v[180:183], v6 offset:32
    ds_read_b128 v[212:215], v6 offset:544
    ds_read_b128 v[184:187], v6 offset:64
    ds_read_b128 v[216:219], v6 offset:576
    ds_read_b128 v[188:191], v6 offset:96
    ds_read_b128 v[220:223], v6 offset:608
    ds_read_b128 v[192:195], v8 offset:0
    ds_read_b128 v[224:227], v8 offset:512
    ds_read_b128 v[196:199], v8 offset:32
    ds_read_b128 v[228:231], v8 offset:544
    ds_read_b128 v[200:203], v8 offset:64
    ds_read_b128 v[232:235], v8 offset:576
    ds_read_b128 v[204:207], v8 offset:96
    ds_read_b128 v[236:239], v8 offset:608
    s_waitcnt lgkmcnt(0)
    v_pk_fma_f32 v[96:97], v[176:177], v[160:161], v[96:97] op_sel_hi:[1,0,1]
    v_pk_fma_f32 v[98:99], v[178:179], v[160:161], v[98:99] op_sel_hi:[1,0,1]
    v_pk_fma_f32 v[100:101], v[180:181], v[160:161], v[100:101] op_sel_hi:[1,0,1]
    v_pk_fma_f32 v[102:103], v[182:183], v[160:161], v[102:103] op_sel_hi:[1,0,1]
    v_pk_mul_f32 v[96:97], v[96:97], v[208:209]
    v_pk_mul_f32 v[98:99], v[98:99], v[210:211]
    v_pk_mul_f32 v[100:101], v[100:101], v[212:213]
    v_pk_mul_f32 v[102:103], v[102:103], v[214:215]
    v_cvt_pk_bf16_f32 v96, v96, v97
    v_cvt_pk_bf16_f32 v97, v98, v99
    v_cvt_pk_bf16_f32 v98, v100, v101
    v_cvt_pk_bf16_f32 v99, v102, v103
    buffer_store_dwordx4 v[96:99], v40, s[20:23], s44 offen offset:0 sc1
    v_pk_fma_f32 v[104:105], v[184:185], v[160:161], v[104:105] op_sel_hi:[1,0,1]
    v_pk_fma_f32 v[106:107], v[186:187], v[160:161], v[106:107] op_sel_hi:[1,0,1]
    v_pk_fma_f32 v[108:109], v[188:189], v[160:161], v[108:109] op_sel_hi:[1,0,1]
    v_pk_fma_f32 v[110:111], v[190:191], v[160:161], v[110:111] op_sel_hi:[1,0,1]
    v_pk_mul_f32 v[104:105], v[104:105], v[216:217]
    v_pk_mul_f32 v[106:107], v[106:107], v[218:219]
    v_pk_mul_f32 v[108:109], v[108:109], v[220:221]
    v_pk_mul_f32 v[110:111], v[110:111], v[222:223]
    v_cvt_pk_bf16_f32 v104, v104, v105
    v_cvt_pk_bf16_f32 v105, v106, v107
    v_cvt_pk_bf16_f32 v106, v108, v109
    v_cvt_pk_bf16_f32 v107, v110, v111
    buffer_store_dwordx4 v[104:107], v40, s[20:23], s44 offen offset:640 sc1
    v_pk_fma_f32 v[112:113], v[176:177], v[162:163], v[112:113] op_sel_hi:[1,0,1]
    v_pk_fma_f32 v[114:115], v[178:179], v[162:163], v[114:115] op_sel_hi:[1,0,1]
    v_pk_fma_f32 v[116:117], v[180:181], v[162:163], v[116:117] op_sel_hi:[1,0,1]
    v_pk_fma_f32 v[118:119], v[182:183], v[162:163], v[118:119] op_sel_hi:[1,0,1]
    v_pk_mul_f32 v[112:113], v[112:113], v[208:209]
    v_pk_mul_f32 v[114:115], v[114:115], v[210:211]
    v_pk_mul_f32 v[116:117], v[116:117], v[212:213]
    v_pk_mul_f32 v[118:119], v[118:119], v[214:215]
    v_cvt_pk_bf16_f32 v112, v112, v113
    v_cvt_pk_bf16_f32 v113, v114, v115
    v_cvt_pk_bf16_f32 v114, v116, v117
    v_cvt_pk_bf16_f32 v115, v118, v119
    buffer_store_dwordx4 v[112:115], v41, s[20:23], s44 offen offset:0 sc1
    v_pk_fma_f32 v[120:121], v[184:185], v[162:163], v[120:121] op_sel_hi:[1,0,1]
    v_pk_fma_f32 v[122:123], v[186:187], v[162:163], v[122:123] op_sel_hi:[1,0,1]
    v_pk_fma_f32 v[124:125], v[188:189], v[162:163], v[124:125] op_sel_hi:[1,0,1]
    v_pk_fma_f32 v[126:127], v[190:191], v[162:163], v[126:127] op_sel_hi:[1,0,1]
    v_pk_mul_f32 v[120:121], v[120:121], v[216:217]
    v_pk_mul_f32 v[122:123], v[122:123], v[218:219]
    v_pk_mul_f32 v[124:125], v[124:125], v[220:221]
    v_pk_mul_f32 v[126:127], v[126:127], v[222:223]
    v_cvt_pk_bf16_f32 v120, v120, v121
    v_cvt_pk_bf16_f32 v121, v122, v123
    v_cvt_pk_bf16_f32 v122, v124, v125
    v_cvt_pk_bf16_f32 v123, v126, v127
    buffer_store_dwordx4 v[120:123], v41, s[20:23], s44 offen offset:640 sc1
    v_pk_fma_f32 v[128:129], v[192:193], v[160:161], v[128:129] op_sel_hi:[1,0,1]
    v_pk_fma_f32 v[130:131], v[194:195], v[160:161], v[130:131] op_sel_hi:[1,0,1]
    v_pk_fma_f32 v[132:133], v[196:197], v[160:161], v[132:133] op_sel_hi:[1,0,1]
    v_pk_fma_f32 v[134:135], v[198:199], v[160:161], v[134:135] op_sel_hi:[1,0,1]
    v_pk_mul_f32 v[128:129], v[128:129], v[224:225]
    v_pk_mul_f32 v[130:131], v[130:131], v[226:227]
    v_pk_mul_f32 v[132:133], v[132:133], v[228:229]
    v_pk_mul_f32 v[134:135], v[134:135], v[230:231]
    v_cvt_pk_bf16_f32 v128, v128, v129
    v_cvt_pk_bf16_f32 v129, v130, v131
    v_cvt_pk_bf16_f32 v130, v132, v133
    v_cvt_pk_bf16_f32 v131, v134, v135
    buffer_store_dwordx4 v[128:131], v40, s[20:23], s45 offen offset:0 sc1
    v_pk_fma_f32 v[136:137], v[200:201], v[160:161], v[136:137] op_sel_hi:[1,0,1]
    v_pk_fma_f32 v[138:139], v[202:203], v[160:161], v[138:139] op_sel_hi:[1,0,1]
    v_pk_fma_f32 v[140:141], v[204:205], v[160:161], v[140:141] op_sel_hi:[1,0,1]
    v_pk_fma_f32 v[142:143], v[206:207], v[160:161], v[142:143] op_sel_hi:[1,0,1]
    v_pk_mul_f32 v[136:137], v[136:137], v[232:233]
    v_pk_mul_f32 v[138:139], v[138:139], v[234:235]
    v_pk_mul_f32 v[140:141], v[140:141], v[236:237]
    v_pk_mul_f32 v[142:143], v[142:143], v[238:239]
    v_cvt_pk_bf16_f32 v136, v136, v137
    v_cvt_pk_bf16_f32 v137, v138, v139
    v_cvt_pk_bf16_f32 v138, v140, v141
    v_cvt_pk_bf16_f32 v139, v142, v143
    buffer_store_dwordx4 v[136:139], v40, s[20:23], s45 offen offset:640 sc1
    v_pk_fma_f32 v[144:145], v[192:193], v[162:163], v[144:145] op_sel_hi:[1,0,1]
    v_pk_fma_f32 v[146:147], v[194:195], v[162:163], v[146:147] op_sel_hi:[1,0,1]
    v_pk_fma_f32 v[148:149], v[196:197], v[162:163], v[148:149] op_sel_hi:[1,0,1]
    v_pk_fma_f32 v[150:151], v[198:199], v[162:163], v[150:151] op_sel_hi:[1,0,1]
    v_pk_mul_f32 v[144:145], v[144:145], v[224:225]
    v_pk_mul_f32 v[146:147], v[146:147], v[226:227]
    v_pk_mul_f32 v[148:149], v[148:149], v[228:229]
    v_pk_mul_f32 v[150:151], v[150:151], v[230:231]
    v_cvt_pk_bf16_f32 v144, v144, v145
    v_cvt_pk_bf16_f32 v145, v146, v147
    v_cvt_pk_bf16_f32 v146, v148, v149
    v_cvt_pk_bf16_f32 v147, v150, v151
    buffer_store_dwordx4 v[144:147], v41, s[20:23], s45 offen offset:0 sc1
    v_pk_fma_f32 v[152:153], v[200:201], v[162:163], v[152:153] op_sel_hi:[1,0,1]
    v_pk_fma_f32 v[154:155], v[202:203], v[162:163], v[154:155] op_sel_hi:[1,0,1]
    v_pk_fma_f32 v[156:157], v[204:205], v[162:163], v[156:157] op_sel_hi:[1,0,1]
    v_pk_fma_f32 v[158:159], v[206:207], v[162:163], v[158:159] op_sel_hi:[1,0,1]
    v_pk_mul_f32 v[152:153], v[152:153], v[232:233]
    v_pk_mul_f32 v[154:155], v[154:155], v[234:235]
    v_pk_mul_f32 v[156:157], v[156:157], v[236:237]
    v_pk_mul_f32 v[158:159], v[158:159], v[238:239]
    v_cvt_pk_bf16_f32 v152, v152, v153
    v_cvt_pk_bf16_f32 v153, v154, v155
    v_cvt_pk_bf16_f32 v154, v156, v157
    v_cvt_pk_bf16_f32 v155, v158, v159
    buffer_store_dwordx4 v[152:155], v41, s[20:23], s45 offen offset:640 sc1
    s_mov_b64 exec, -1
    s_branch K2_ENTRY
K1_END:
    s_endpgm
K2_ENTRY:
    s_load_dwordx2 s[20:21], s[0:1], 80
    s_load_dwordx2 s[4:5], s[0:1], 0
    s_load_dwordx2 s[6:7], s[0:1], 16
    s_load_dwordx8 s[8:15], s[0:1], 32
    s_load_dwordx2 s[32:33], s[0:1], 64
    v_and_b32 v1, 63, v0
    v_lshrrev_b32 v3, 6, v0
    v_lshlrev_b32 v2, 4, v1
    v_readfirstlane_b32 s40, v3
    s_and_b32 s43, s2, 7
    s_lshr_b32 s44, s2, 3
    s_and_b32 s42, s44, 7
    s_lshr_b32 s44, s44, 3
    s_lshl_b32 s41, s43, 2
    s_add_u32 s41, s41, s44
    s_mov_b32 s60, 0x000fffff
    s_mov_b32 s61, 0x000fffff
    v_and_b32 v18, 31, v1
    v_lshrrev_b32 v19, 5, v1
    v_lshlrev_b32 v20, 3, v18
    v_lshl_add_u32 v6, v19, 2, v20
    v_add_u32 v6, 1024, v6
    s_lshl_b32 s45, s42, 3
    s_add_u32 s45, s45, s40
    s_mul_i32 s46, s41, 81920
    s_mul_i32 s47, s45, 1280
    s_add_u32 s46, s46, s47
    s_mul_i32 s48, s41, 163840
    s_add_u32 s48, s48, 4194304
    s_lshl_b32 s49, s40, 10
    s_add_u32 s50, s48, s49
    s_mov_b32 s22, 49283072
    s_mov_b32 s23, 0x00020000
    s_mov_b32 s69, 0
    s_waitcnt lgkmcnt(0)
    v_and_b32 v21, 1, v1
    v_mul_u32_u24 v21, 19, v21
    s_mul_i32 s51, s41, 20
    v_add_u32 v21, s51, v21
    v_lshrrev_b32 v21, 7, v21
    v_lshrrev_b32 v22, 1, v1
    v_mul_u32_u24 v22, 5, v22
    v_add_lshl_u32 v31, v21, v22, 10
    s_lshl_b32 s100, s42, 7
    s_add_u32 s100, s100, 19496960
    s_lshl_b32 s70, s40, 8
    s_add_u32 s70, s70, s2
    s_cmp_ge_u32 s70, 1680
    s_cselect_b32 s52, 1680, 0
    s_sub_u32 s51, s70, s52
    s_mov_b32 s62, 1280
    s_mov_b32 s63, 5
    s_mov_b32 s64, 0
    s_mov_b32 s66, 0
    s_mov_b32 s26, 819200
    s_cmp_ge_u32 s51, 600
    s_cbranch_scc1 K2_PU34
    s_cmp_ge_u32 s51, 200
    s_cbranch_scc1 K2_PU12
    s_mov_b32 s24, s6
    s_mov_b32 s25, s7
    s_mov_b32 s65, 37748736
    s_mul_i32 s53, s51, 205
    s_lshr_b32 s53, s53, 11
    s_mul_i32 s54, s53, 10
    s_sub_u32 s54, s51, s54
    s_cmp_ge_u32 s53, 16
    s_cbranch_scc1 K2_PUOL
    s_mul_i32 s55, s53, 40
    s_mov_b32 s56, 8
    s_mov_b32 s57, 20
    s_mov_b32 s58, 4
    s_branch K2_PUDONE
    K2_PUOL:
    s_sub_u32 s55, s53, 16
    s_mul_i32 s55, s55, 160
    s_add_u32 s55, s55, 16
    s_mov_b32 s56, 20
    s_mov_b32 s57, 80
    s_mov_b32 s58, 40
    s_branch K2_PUDONE
    K2_PU12:
    s_cmp_ge_u32 s51, 400
    s_cselect_b32 s24, s10, s8
    s_cselect_b32 s25, s11, s9
    s_cselect_b32 s64, 0, 1
    s_cselect_b32 s52, 200, 0
    s_cselect_b32 s65, 409600, 0
    s_add_u32 s65, s65, 38158336
    s_sub_u32 s51, s51, s52
    s_sub_u32 s51, s51, 200
    s_mul_i32 s53, s51, 205
    s_lshr_b32 s53, s53, 11
    s_mul_i32 s54, s53, 10
    s_sub_u32 s54, s51, s54
    s_branch K2_PUACT
    K2_PU34:
    s_mov_b32 s26, 2211840
    s_cmp_ge_u32 s51, 1140
    s_cbranch_scc1 K2_PU4
    s_mov_b32 s24, s12
    s_mov_b32 s25, s13
    s_mov_b32 s62, 3456
    s_mov_b32 s63, 14
    s_mov_b32 s64, 1
    s_mov_b32 s65, 38977536
    s_mov_b32 s66, 640
    s_sub_u32 s51, s51, 600
    s_mul_i32 s53, s51, 2428
    s_lshr_b32 s53, s53, 16
    s_mul_i32 s54, s53, 27
    s_sub_u32 s54, s51, s54
    K2_PUACT:
    s_mul_i32 s55, s53, 205
    s_lshr_b32 s55, s55, 10
    s_mul_i32 s56, s55, 5
    s_sub_u32 s56, s53, s56
    s_mul_i32 s55, s55, 160
    s_lshl_b32 s57, s56, 5
    s_add_u32 s55, s55, s57
    s_cmp_ge_u32 s56, 3
    s_cselect_b32 s57, 16, 0
    s_sub_u32 s55, s55, s57
    s_cmp_eq_u32 s56, 2
    s_cselect_b32 s56, 80, 16
    s_mov_b32 s57, 8
    s_mov_b32 s58, 4
    s_branch K2_PUDONE
    K2_PU4:
    s_mov_b32 s24, s14
    s_mov_b32 s25, s15
    s_mov_b32 s65, 40124416
    s_sub_u32 s51, s51, 1140
    s_mul_i32 s53, s51, 6554
    s_lshr_b32 s53, s53, 16
    s_mul_i32 s54, s53, 10
    s_sub_u32 s54, s51, s54
    s_lshl_b32 s55, s53, 5
    s_mov_b32 s56, 16
    s_mov_b32 s57, 8
    s_mov_b32 s58, 4
    K2_PUDONE:
    s_mov_b32 s27, 0x00020000
    v_bfe_u32 v22, v1, 3, 2
    v_mul_lo_u32 v21, v19, s56
    v_add_u32 v21, v21, v22
    v_mul_lo_u32 v21, v21, s62
    v_and_b32 v22, 7, v1
    v_lshl_add_u32 v24, v22, 4, v21
    s_mul_i32 s55, s55, s62
    s_lshl_b32 s52, s54, 7
    s_add_u32 s36, s55, s52
    s_mul_i32 s57, s57, s62
    s_mul_i32 s58, s58, s62
    s_add_u32 s37, s36, s58
    s_add_u32 s38, s36, s57
    s_add_u32 s39, s38, s58
    s_mul_i32 s52, s53, s63
    s_add_u32 s52, s52, s54
    s_cmp_ge_u32 s54, s63
    s_cselect_b32 s55, s63, 0
    s_cselect_b32 s59, 3670016, 0
    s_sub_u32 s52, s52, s55
    s_lshl_b32 s52, s52, 12
    s_add_u32 s65, s65, s52
    s_add_u32 s65, s65, s59
    s_mul_i32 s52, s53, 2368
    s_lshl_b32 s55, s54, 6
    s_add_u32 s52, s52, s55
    s_add_u32 s52, s52, s66
    s_lshl_b32 s52, s52, 2
    s_add_u32 s66, s52, 47185920
    s_mov_b32 s28, s4
    s_mov_b32 s29, s5
    s_mov_b32 s30, 2621440
    s_mov_b32 s31, 0x00020000
    s_mov_b32 s34, 2621440
    s_mov_b32 s35, 0x00020000
    s_lshl_b32 s67, s41, 2
    s_and_b32 s52, s40, 3
    s_add_u32 s67, s67, s52
    s_lshr_b32 s3, s42, 2
    s_and_b32 s44, s42, 3
    s_mul_i32 s3, s3, 3670016
    v_and_b32 v22, 15, v1
    v_lshrrev_b32 v23, 4, v1
    v_mul_u32_u24 v244, 1280, v22
    v_lshl_add_u32 v244, v23, 3, v244
    s_mul_i32 s52, s67, 20480
    s_mul_i32 s53, s42, 160
    s_add_u32 s68, s52, s53
    s_mul_i32 s52, s44, 5120
    s_add_u32 s52, s52, s3
    v_add_u32 v245, s52, v2
    v_mov_b32 v3, v2
    v_mul_u32_u24 v9, 320, v19
    v_lshl_add_u32 v9, v18, 4, v9
    v_add_u32 v9, 1280, v9
    v_lshlrev_b32 v28, 7, v1
    v_bfe_u32 v21, v1, 1, 2
    v_lshlrev_b32 v25, 13, v21
    v_lshl_add_u32 v25, v19, 9, v25
    v_bfe_u32 v22, v1, 3, 2
    v_xor_b32 v22, v22, v21
    v_lshl_add_u32 v25, v22, 5, v25
    v_and_b32 v22, 1, v1
    v_lshl_add_u32 v25, v22, 4, v25
    s_add_u32 s52, s49, 131072
    v_add_u32 v25, s52, v25
    v_lshl_add_u32 v188, v1, 3, s52
    v_xor_b32 v189, 32, v188
    v_xor_b32 v190, 64, v188
    v_xor_b32 v191, 0x60, v188
    v_mov_b32 v255, 0
    v_mov_b32 v243, 1
    v_and_b32 v22, 27, v1
    v_cmp_eq_u32 vcc, 24, v22
    v_mov_b32 v23, 0x3f803f80
    v_mov_b32 v17, 0
    v_cndmask_b32 v116, 0, v23, vcc
    v_mov_b32 v113, 0
    v_mov_b32 v115, 0
    v_add_u32 v4, 61440, v3
    v_add_u32 v7, 61440, v6
    v_add_u32 v10, 61440, v9
    v_add_u32 v5, 122880, v3
    v_add_u32 v8, 122880, v6
    v_add_u32 v11, 122880, v9
    v_mov_b32 v117, v116
    v_mov_b32 v118, v116
    v_mov_b32 v119, v116
    v_mov_b32 v120, v116
    v_mov_b32 v121, v116
    v_mov_b32 v122, v116
    v_mov_b32 v123, v116
    v_mov_b32 v124, v116
    v_mov_b32 v125, v116
    v_mov_b32 v126, v116
    v_mov_b32 v127, v116
    v_mov_b32 v128, v116
    v_mov_b32 v129, v116
    v_mov_b32 v130, v116
    v_mov_b32 v131, v116
    v_mov_b32 v164, v23
    v_mov_b32 v165, v23
    v_mov_b32 v166, v23
    v_mov_b32 v167, v23
    s_cmp_ge_u32 s40, 4
    s_cbranch_scc1 K2_QN
    s_waitcnt vmcnt(0)
    K2_QN:
    s_waitcnt lgkmcnt(0)
    s_barrier
    s_cmp_lg_u32 s40, 0
    s_cbranch_scc1 K2_QD
    s_cmp_eq_u32 s101, -1
    s_cbranch_scc1 K2_QP
    s_lshl_b32 s51, s101, 10
    s_add_u32 s51, s51, 19496960
    s_mov_b64 exec, 0xff
    buffer_atomic_add v243, v28, s[20:23], s51 offen sc1
    K2_QP:
    s_mov_b64 exec, 63
    s_mov_b32 s51, 32768
    v_mov_b32 v29, 0
    buffer_atomic_add v29, v31, s[20:23], s100 offen sc0 sc1
    s_sleep 4
    v_mov_b32 v30, 0
    buffer_atomic_add v30, v31, s[20:23], s100 offen sc0 sc1
    K2_QL:
    s_waitcnt vmcnt(1)
    v_cmp_gt_u32 vcc, 16, v29
    s_cbranch_vccz K2_QX
    v_mov_b32 v29, 0
    buffer_atomic_add v29, v31, s[20:23], s100 offen sc0 sc1
    s_waitcnt vmcnt(1)
    v_cmp_gt_u32 vcc, 16, v30
    s_cbranch_vccz K2_QX
    v_mov_b32 v30, 0
    buffer_atomic_add v30, v31, s[20:23], s100 offen sc0 sc1
    s_sub_u32 s51, s51, 1
    s_cmp_lg_u32 s51, 0
    s_cbranch_scc1 K2_QL
    K2_QX:
    s_mov_b64 exec, -1
    K2_QD:
    s_barrier
    s_add_u32 m0, s49, 0
    s_add_u32 s51, s50, 0
    buffer_load_dwordx4 v2, s[20:23], s51 offen sc1 lds
    buffer_load_dwordx4 v[12:15], v2, s[20:23], s46 offen sc1
    buffer_load_dword v16, v6, s[20:23], s46 offen sc1
    s_add_u32 m0, s49, 8192
    s_add_u32 s51, s50, 8192
    buffer_load_dwordx4 v2, s[20:23], s51 offen sc1 lds
    s_waitcnt vmcnt(1)
    s_barrier
    ds_read_b128 v[104:107], v3 offset:0
    ds_read_b32 v112, v6 offset:0
    ds_read_b128 v[108:111], v3 offset:2560
    ds_read_b32 v114, v6 offset:2560
    s_mov_b64 exec, s[60:61]
    ds_read_b128 v[116:119], v9 offset:0
    ds_read_b128 v[120:123], v9 offset:640
    s_mov_b64 exec, -1
    s_waitcnt lgkmcnt(4)
    v_mfma_f32_32x32x16_bf16 v[48:63], v[104:107], v[12:15], 0
    v_mfma_f32_32x32x8_bf16 v[48:63], v[112:113], v[16:17], v[48:63]
    s_nop 15
    v_max3_f32 v22, v48, v49, v50
    v_max_f32 v22, v22, v51
    v_max3_f32 v22, v22, v52, v53
    v_max3_f32 v22, v22, v54, v55
    v_max3_f32 v22, v22, v56, v57
    v_max3_f32 v22, v22, v58, v59
    v_max3_f32 v22, v22, v60, v61
    v_max3_f32 v22, v22, v62, v63
    v_mov_b32 v23, v22
    s_nop 1
    v_permlane32_swap_b32 v22, v23
    v_max_f32 v22, v22, v23
    v_sub_f32 v32, 0, v22
    v_sub_f32 v33, 0, v22
    v_sub_f32 v34, 0, v22
    v_sub_f32 v35, 0, v22
    v_sub_f32 v36, 0, v22
    v_sub_f32 v37, 0, v22
    v_sub_f32 v38, 0, v22
    v_sub_f32 v39, 0, v22
    v_sub_f32 v40, 0, v22
    v_sub_f32 v41, 0, v22
    v_sub_f32 v42, 0, v22
    v_sub_f32 v43, 0, v22
    v_sub_f32 v44, 0, v22
    v_sub_f32 v45, 0, v22
    v_sub_f32 v46, 0, v22
    v_sub_f32 v47, 0, v22
    s_nop 1
    v_mfma_f32_32x32x16_bf16 v[48:63], v[104:107], v[12:15], v[32:47]
    v_mfma_f32_32x32x8_bf16 v[48:63], v[112:113], v[16:17], v[48:63]
    s_nop 7
    s_setprio 3
    s_waitcnt lgkmcnt(0)
    v_mfma_f32_32x32x16_bf16 v[64:79], v[108:111], v[12:15], v[32:47]
    ds_read_b128 v[104:107], v3 offset:5120
    ds_read_b32 v112, v6 offset:5120
    v_exp_f32 v48, v48
    v_exp_f32 v49, v49
    v_exp_f32 v50, v50
    v_exp_f32 v51, v51
    v_exp_f32 v52, v52
    s_setprio 2
    s_mov_b64 exec, s[60:61]
    ds_read_b128 v[124:127], v9 offset:2560
    ds_read_b128 v[128:131], v9 offset:3200
    s_mov_b64 exec, -1
    v_exp_f32 v53, v53
    v_exp_f32 v54, v54
    v_exp_f32 v55, v55
    v_cvt_pk_bf16_f32 v96, v48, v49
    v_cvt_pk_bf16_f32 v97, v50, v51
    v_cvt_pk_bf16_f32 v98, v52, v53
    v_cvt_pk_bf16_f32 v99, v54, v55
    s_setprio 1
    v_mfma_f32_32x32x8_bf16 v[64:79], v[114:115], v[16:17], v[64:79]
    s_add_u32 m0, s49, 16384
    s_add_u32 s51, s50, 16384
    buffer_load_dwordx4 v2, s[20:23], s51 offen sc1 lds
    v_exp_f32 v56, v56
    v_exp_f32 v57, v57
    v_exp_f32 v58, v58
    v_exp_f32 v59, v59
    v_exp_f32 v60, v60
    s_setprio 0
    v_mfma_f32_32x32x16_bf16 v[80:95], v[116:119], v[96:99], 0
    s_add_u32 m0, s49, 24576
    s_add_u32 s51, s50, 24576
    buffer_load_dwordx4 v2, s[20:23], s51 offen sc1 lds
    v_exp_f32 v61, v61
    v_exp_f32 v62, v62
    v_exp_f32 v63, v63
    v_cvt_pk_bf16_f32 v100, v56, v57
    v_cvt_pk_bf16_f32 v101, v58, v59
    v_cvt_pk_bf16_f32 v102, v60, v61
    v_cvt_pk_bf16_f32 v103, v62, v63
    s_waitcnt vmcnt(2)
    s_barrier
    s_setprio 3
    s_waitcnt lgkmcnt(0)
    v_mfma_f32_32x32x16_bf16 v[48:63], v[104:107], v[12:15], v[32:47]
    ds_read_b128 v[108:111], v3 offset:7680
    ds_read_b32 v114, v6 offset:7680
    v_exp_f32 v64, v64
    v_exp_f32 v65, v65
    v_exp_f32 v66, v66
    v_exp_f32 v67, v67
    v_exp_f32 v68, v68
    s_setprio 2
    v_mfma_f32_32x32x16_bf16 v[80:95], v[120:123], v[100:103], v[80:95]
    s_mov_b64 exec, s[60:61]
    ds_read_b128 v[116:119], v9 offset:5120
    ds_read_b128 v[120:123], v9 offset:5760
    s_mov_b64 exec, -1
    v_exp_f32 v69, v69
    v_exp_f32 v70, v70
    v_exp_f32 v71, v71
    v_cvt_pk_bf16_f32 v96, v64, v65
    v_cvt_pk_bf16_f32 v97, v66, v67
    v_cvt_pk_bf16_f32 v98, v68, v69
    v_cvt_pk_bf16_f32 v99, v70, v71
    s_setprio 1
    v_mfma_f32_32x32x8_bf16 v[48:63], v[112:113], v[16:17], v[48:63]
    s_add_u32 m0, s49, 32768
    s_add_u32 s51, s50, 32768
    buffer_load_dwordx4 v2, s[20:23], s51 offen sc1 lds
    v_exp_f32 v72, v72
    v_exp_f32 v73, v73
    v_exp_f32 v74, v74
    v_exp_f32 v75, v75
    v_exp_f32 v76, v76
    s_setprio 0
    v_mfma_f32_32x32x16_bf16 v[80:95], v[124:127], v[96:99], v[80:95]
    s_add_u32 m0, s49, 40960
    s_add_u32 s51, s50, 40960
    buffer_load_dwordx4 v2, s[20:23], s51 offen sc1 lds
    v_exp_f32 v77, v77
    v_exp_f32 v78, v78
    v_exp_f32 v79, v79
    v_cvt_pk_bf16_f32 v100, v72, v73
    v_cvt_pk_bf16_f32 v101, v74, v75
    v_cvt_pk_bf16_f32 v102, v76, v77
    v_cvt_pk_bf16_f32 v103, v78, v79
    s_setprio 3
    s_waitcnt lgkmcnt(0)
    v_mfma_f32_32x32x16_bf16 v[64:79], v[108:111], v[12:15], v[32:47]
    ds_read_b128 v[104:107], v3 offset:10240
    ds_read_b32 v112, v6 offset:10240
    v_exp_f32 v48, v48
    v_exp_f32 v49, v49
    v_exp_f32 v50, v50
    v_exp_f32 v51, v51
    v_exp_f32 v52, v52
    s_setprio 2
    v_mfma_f32_32x32x16_bf16 v[80:95], v[128:131], v[100:103], v[80:95]
    s_mov_b64 exec, s[60:61]
    ds_read_b128 v[124:127], v9 offset:7680
    ds_read_b128 v[128:131], v9 offset:8320
    s_mov_b64 exec, -1
    v_exp_f32 v53, v53
    v_exp_f32 v54, v54
    v_exp_f32 v55, v55
    v_cvt_pk_bf16_f32 v96, v48, v49
    v_cvt_pk_bf16_f32 v97, v50, v51
    v_cvt_pk_bf16_f32 v98, v52, v53
    v_cvt_pk_bf16_f32 v99, v54, v55
    s_setprio 1
    v_mfma_f32_32x32x8_bf16 v[64:79], v[114:115], v[16:17], v[64:79]
    s_add_u32 m0, s49, 49152
    s_add_u32 s51, s50, 49152
    buffer_load_dwordx4 v2, s[20:23], s51 offen sc1 lds
    v_exp_f32 v56, v56
    v_exp_f32 v57, v57
    v_exp_f32 v58, v58
    v_exp_f32 v59, v59
    v_exp_f32 v60, v60
    s_setprio 0
    v_mfma_f32_32x32x16_bf16 v[80:95], v[116:119], v[96:99], v[80:95]
    s_add_u32 m0, s49, 57344
    s_add_u32 s51, s50, 57344
    buffer_load_dwordx4 v2, s[20:23], s51 offen sc1 lds
    v_exp_f32 v61, v61
    v_exp_f32 v62, v62
    v_exp_f32 v63, v63
    v_cvt_pk_bf16_f32 v100, v56, v57
    v_cvt_pk_bf16_f32 v101, v58, v59
    v_cvt_pk_bf16_f32 v102, v60, v61
    v_cvt_pk_bf16_f32 v103, v62, v63
    s_setprio 3
    s_waitcnt lgkmcnt(0)
    v_mfma_f32_32x32x16_bf16 v[48:63], v[104:107], v[12:15], v[32:47]
    ds_read_b128 v[108:111], v3 offset:12800
    ds_read_b32 v114, v6 offset:12800
    v_exp_f32 v64, v64
    v_exp_f32 v65, v65
    v_exp_f32 v66, v66
    v_exp_f32 v67, v67
    v_exp_f32 v68, v68
    s_setprio 2
    v_mfma_f32_32x32x16_bf16 v[80:95], v[120:123], v[100:103], v[80:95]
    s_mov_b64 exec, s[60:61]
    ds_read_b128 v[116:119], v9 offset:10240
    ds_read_b128 v[120:123], v9 offset:10880
    s_mov_b64 exec, -1
    v_exp_f32 v69, v69
    v_exp_f32 v70, v70
    v_exp_f32 v71, v71
    v_cvt_pk_bf16_f32 v96, v64, v65
    v_cvt_pk_bf16_f32 v97, v66, v67
    v_cvt_pk_bf16_f32 v98, v68, v69
    v_cvt_pk_bf16_f32 v99, v70, v71
    s_setprio 1
    v_mfma_f32_32x32x8_bf16 v[48:63], v[112:113], v[16:17], v[48:63]
    s_add_u32 m0, s49, 65536
    s_add_u32 s51, s50, 65536
    buffer_load_dwordx4 v2, s[20:23], s51 offen sc1 lds
    v_exp_f32 v72, v72
    v_exp_f32 v73, v73
    v_exp_f32 v74, v74
    v_exp_f32 v75, v75
    v_exp_f32 v76, v76
    s_setprio 0
    v_mfma_f32_32x32x16_bf16 v[80:95], v[124:127], v[96:99], v[80:95]
    s_add_u32 m0, s49, 73728
    s_add_u32 s51, s50, 73728
    buffer_load_dwordx4 v2, s[20:23], s51 offen sc1 lds
    v_exp_f32 v77, v77
    v_exp_f32 v78, v78
    v_exp_f32 v79, v79
    v_cvt_pk_bf16_f32 v100, v72, v73
    v_cvt_pk_bf16_f32 v101, v74, v75
    v_cvt_pk_bf16_f32 v102, v76, v77
    v_cvt_pk_bf16_f32 v103, v78, v79
    s_waitcnt vmcnt(4)
    s_barrier
    s_setprio 3
    s_waitcnt lgkmcnt(0)
    v_mfma_f32_32x32x16_bf16 v[64:79], v[108:111], v[12:15], v[32:47]
    ds_read_b128 v[104:107], v3 offset:15360
    ds_read_b32 v112, v6 offset:15360
    v_exp_f32 v48, v48
    v_exp_f32 v49, v49
    v_exp_f32 v50, v50
    v_exp_f32 v51, v51
    v_exp_f32 v52, v52
    s_setprio 2
    v_mfma_f32_32x32x16_bf16 v[80:95], v[128:131], v[100:103], v[80:95]
    s_mov_b64 exec, s[60:61]
    ds_read_b128 v[124:127], v9 offset:12800
    ds_read_b128 v[128:131], v9 offset:13440
    s_mov_b64 exec, -1
    v_exp_f32 v53, v53
    v_exp_f32 v54, v54
    v_exp_f32 v55, v55
    v_cvt_pk_bf16_f32 v96, v48, v49
    v_cvt_pk_bf16_f32 v97, v50, v51
    v_cvt_pk_bf16_f32 v98, v52, v53
    v_cvt_pk_bf16_f32 v99, v54, v55
    s_setprio 1
    v_mfma_f32_32x32x8_bf16 v[64:79], v[114:115], v[16:17], v[64:79]
    s_add_u32 m0, s49, 81920
    s_add_u32 s51, s50, 81920
    buffer_load_dwordx4 v2, s[20:23], s51 offen sc1 lds
    v_exp_f32 v56, v56
    v_exp_f32 v57, v57
    v_exp_f32 v58, v58
    v_exp_f32 v59, v59
    v_exp_f32 v60, v60
    s_setprio 0
    v_mfma_f32_32x32x16_bf16 v[80:95], v[116:119], v[96:99], v[80:95]
    s_add_u32 m0, s49, 90112
    s_add_u32 s51, s50, 90112
    buffer_load_dwordx4 v2, s[20:23], s51 offen sc1 lds
    v_exp_f32 v61, v61
    v_exp_f32 v62, v62
    v_exp_f32 v63, v63
    v_cvt_pk_bf16_f32 v100, v56, v57
    v_cvt_pk_bf16_f32 v101, v58, v59
    v_cvt_pk_bf16_f32 v102, v60, v61
    v_cvt_pk_bf16_f32 v103, v62, v63
    s_setprio 3
    s_waitcnt lgkmcnt(0)
    v_mfma_f32_32x32x16_bf16 v[48:63], v[104:107], v[12:15], v[32:47]
    ds_read_b128 v[108:111], v3 offset:17920
    ds_read_b32 v114, v6 offset:17920
    v_exp_f32 v64, v64
    v_exp_f32 v65, v65
    v_exp_f32 v66, v66
    v_exp_f32 v67, v67
    v_exp_f32 v68, v68
    s_setprio 2
    v_mfma_f32_32x32x16_bf16 v[80:95], v[120:123], v[100:103], v[80:95]
    s_mov_b64 exec, s[60:61]
    ds_read_b128 v[116:119], v9 offset:15360
    ds_read_b128 v[120:123], v9 offset:16000
    s_mov_b64 exec, -1
    v_exp_f32 v69, v69
    v_exp_f32 v70, v70
    v_exp_f32 v71, v71
    v_cvt_pk_bf16_f32 v96, v64, v65
    v_cvt_pk_bf16_f32 v97, v66, v67
    v_cvt_pk_bf16_f32 v98, v68, v69
    v_cvt_pk_bf16_f32 v99, v70, v71
    s_setprio 1
    v_mfma_f32_32x32x8_bf16 v[48:63], v[112:113], v[16:17], v[48:63]
    s_add_u32 m0, s49, 98304
    s_add_u32 s51, s50, 98304
    buffer_load_dwordx4 v2, s[20:23], s51 offen sc1 lds
    v_exp_f32 v72, v72
    v_exp_f32 v73, v73
    v_exp_f32 v74, v74
    v_exp_f32 v75, v75
    v_exp_f32 v76, v76
    s_setprio 0
    v_mfma_f32_32x32x16_bf16 v[80:95], v[124:127], v[96:99], v[80:95]
    s_add_u32 m0, s49, 106496
    s_add_u32 s51, s50, 106496
    buffer_load_dwordx4 v2, s[20:23], s51 offen sc1 lds
    v_exp_f32 v77, v77
    v_exp_f32 v78, v78
    v_exp_f32 v79, v79
    v_cvt_pk_bf16_f32 v100, v72, v73
    v_cvt_pk_bf16_f32 v101, v74, v75
    v_cvt_pk_bf16_f32 v102, v76, v77
    v_cvt_pk_bf16_f32 v103, v78, v79
    s_setprio 3
    s_waitcnt lgkmcnt(0)
    v_mfma_f32_32x32x16_bf16 v[64:79], v[108:111], v[12:15], v[32:47]
    ds_read_b128 v[104:107], v3 offset:20480
    ds_read_b32 v112, v6 offset:20480
    v_exp_f32 v48, v48
    v_exp_f32 v49, v49
    v_exp_f32 v50, v50
    v_exp_f32 v51, v51
    v_exp_f32 v52, v52
    s_setprio 2
    v_mfma_f32_32x32x16_bf16 v[80:95], v[128:131], v[100:103], v[80:95]
    s_mov_b64 exec, s[60:61]
    ds_read_b128 v[124:127], v9 offset:17920
    ds_read_b128 v[128:131], v9 offset:18560
    s_mov_b64 exec, -1
    v_exp_f32 v53, v53
    v_exp_f32 v54, v54
    v_exp_f32 v55, v55
    v_cvt_pk_bf16_f32 v96, v48, v49
    v_cvt_pk_bf16_f32 v97, v50, v51
    v_cvt_pk_bf16_f32 v98, v52, v53
    v_cvt_pk_bf16_f32 v99, v54, v55
    s_setprio 1
    v_mfma_f32_32x32x8_bf16 v[64:79], v[114:115], v[16:17], v[64:79]
    s_add_u32 m0, s49, 114688
    s_add_u32 s51, s50, 114688
    buffer_load_dwordx4 v2, s[20:23], s51 offen sc1 lds
    v_exp_f32 v56, v56
    v_exp_f32 v57, v57
    v_exp_f32 v58, v58
    v_exp_f32 v59, v59
    v_exp_f32 v60, v60
    s_setprio 0
    v_mfma_f32_32x32x16_bf16 v[80:95], v[116:119], v[96:99], v[80:95]
    s_add_u32 m0, s49, 122880
    s_add_u32 s51, s50, 122880
    buffer_load_dwordx4 v2, s[20:23], s51 offen sc1 lds
    v_exp_f32 v61, v61
    v_exp_f32 v62, v62
    v_exp_f32 v63, v63
    v_cvt_pk_bf16_f32 v100, v56, v57
    v_cvt_pk_bf16_f32 v101, v58, v59
    v_cvt_pk_bf16_f32 v102, v60, v61
    v_cvt_pk_bf16_f32 v103, v62, v63
    s_setprio 3
    s_waitcnt lgkmcnt(0)
    v_mfma_f32_32x32x16_bf16 v[48:63], v[104:107], v[12:15], v[32:47]
    ds_read_b128 v[108:111], v3 offset:23040
    ds_read_b32 v114, v6 offset:23040
    v_exp_f32 v64, v64
    v_exp_f32 v65, v65
    v_exp_f32 v66, v66
    v_exp_f32 v67, v67
    v_exp_f32 v68, v68
    s_setprio 2
    v_mfma_f32_32x32x16_bf16 v[80:95], v[120:123], v[100:103], v[80:95]
    s_mov_b64 exec, s[60:61]
    ds_read_b128 v[116:119], v9 offset:20480
    ds_read_b128 v[120:123], v9 offset:21120
    s_mov_b64 exec, -1
    v_exp_f32 v69, v69
    v_exp_f32 v70, v70
    v_exp_f32 v71, v71
    v_cvt_pk_bf16_f32 v96, v64, v65
    v_cvt_pk_bf16_f32 v97, v66, v67
    v_cvt_pk_bf16_f32 v98, v68, v69
    v_cvt_pk_bf16_f32 v99, v70, v71
    s_setprio 1
    v_mfma_f32_32x32x8_bf16 v[48:63], v[112:113], v[16:17], v[48:63]
    buffer_load_dwordx4 v[132:135], v24, s[24:27], s36 offen
    v_exp_f32 v72, v72
    v_exp_f32 v73, v73
    v_exp_f32 v74, v74
    v_exp_f32 v75, v75
    v_exp_f32 v76, v76
    s_setprio 0
    v_mfma_f32_32x32x16_bf16 v[80:95], v[124:127], v[96:99], v[80:95]
    v_exp_f32 v77, v77
    v_exp_f32 v78, v78
    v_exp_f32 v79, v79
    v_cvt_pk_bf16_f32 v100, v72, v73
    v_cvt_pk_bf16_f32 v101, v74, v75
    v_cvt_pk_bf16_f32 v102, v76, v77
    v_cvt_pk_bf16_f32 v103, v78, v79
    s_setprio 3
    s_waitcnt lgkmcnt(0)
    v_mfma_f32_32x32x16_bf16 v[64:79], v[108:111], v[12:15], v[32:47]
    ds_read_b128 v[104:107], v3 offset:25600
    ds_read_b32 v112, v6 offset:25600
    v_exp_f32 v48, v48
    v_exp_f32 v49, v49
    v_exp_f32 v50, v50
    v_exp_f32 v51, v51
    v_exp_f32 v52, v52
    s_setprio 2
    v_mfma_f32_32x32x16_bf16 v[80:95], v[128:131], v[100:103], v[80:95]
    s_mov_b64 exec, s[60:61]
    ds_read_b128 v[124:127], v9 offset:23040
    ds_read_b128 v[128:131], v9 offset:23680
    s_mov_b64 exec, -1
    v_exp_f32 v53, v53
    v_exp_f32 v54, v54
    v_exp_f32 v55, v55
    v_cvt_pk_bf16_f32 v96, v48, v49
    v_cvt_pk_bf16_f32 v97, v50, v51
    v_cvt_pk_bf16_f32 v98, v52, v53
    v_cvt_pk_bf16_f32 v99, v54, v55
    s_setprio 1
    v_mfma_f32_32x32x8_bf16 v[64:79], v[114:115], v[16:17], v[64:79]
    v_exp_f32 v56, v56
    v_exp_f32 v57, v57
    v_exp_f32 v58, v58
    v_exp_f32 v59, v59
    v_exp_f32 v60, v60
    s_setprio 0
    v_mfma_f32_32x32x16_bf16 v[80:95], v[116:119], v[96:99], v[80:95]
    v_exp_f32 v61, v61
    v_exp_f32 v62, v62
    v_exp_f32 v63, v63
    v_cvt_pk_bf16_f32 v100, v56, v57
    v_cvt_pk_bf16_f32 v101, v58, v59
    v_cvt_pk_bf16_f32 v102, v60, v61
    v_cvt_pk_bf16_f32 v103, v62, v63
    s_setprio 3
    s_waitcnt lgkmcnt(0)
    v_mfma_f32_32x32x16_bf16 v[48:63], v[104:107], v[12:15], v[32:47]
    ds_read_b128 v[108:111], v3 offset:28160
    ds_read_b32 v114, v6 offset:28160
    v_exp_f32 v64, v64
    v_exp_f32 v65, v65
    v_exp_f32 v66, v66
    v_exp_f32 v67, v67
    v_exp_f32 v68, v68
    s_setprio 2
    v_mfma_f32_32x32x16_bf16 v[80:95], v[120:123], v[100:103], v[80:95]
    s_mov_b64 exec, s[60:61]
    ds_read_b128 v[116:119], v9 offset:25600
    ds_read_b128 v[120:123], v9 offset:26240
    s_mov_b64 exec, -1
    v_exp_f32 v69, v69
    v_exp_f32 v70, v70
    v_exp_f32 v71, v71
    v_cvt_pk_bf16_f32 v96, v64, v65
    v_cvt_pk_bf16_f32 v97, v66, v67
    v_cvt_pk_bf16_f32 v98, v68, v69
    v_cvt_pk_bf16_f32 v99, v70, v71
    s_setprio 1
    v_mfma_f32_32x32x8_bf16 v[48:63], v[112:113], v[16:17], v[48:63]
    buffer_load_dwordx4 v[136:139], v24, s[24:27], s37 offen
    v_exp_f32 v72, v72
    v_exp_f32 v73, v73
    v_exp_f32 v74, v74
    v_exp_f32 v75, v75
    v_exp_f32 v76, v76
    s_setprio 0
    v_mfma_f32_32x32x16_bf16 v[80:95], v[124:127], v[96:99], v[80:95]
    v_exp_f32 v77, v77
    v_exp_f32 v78, v78
    v_exp_f32 v79, v79
    v_cvt_pk_bf16_f32 v100, v72, v73
    v_cvt_pk_bf16_f32 v101, v74, v75
    v_cvt_pk_bf16_f32 v102, v76, v77
    v_cvt_pk_bf16_f32 v103, v78, v79
    s_setprio 3
    s_waitcnt lgkmcnt(0)
    v_mfma_f32_32x32x16_bf16 v[64:79], v[108:111], v[12:15], v[32:47]
    ds_read_b128 v[104:107], v3 offset:30720
    ds_read_b32 v112, v6 offset:30720
    v_exp_f32 v48, v48
    v_exp_f32 v49, v49
    v_exp_f32 v50, v50
    v_exp_f32 v51, v51
    v_exp_f32 v52, v52
    s_setprio 2
    v_mfma_f32_32x32x16_bf16 v[80:95], v[128:131], v[100:103], v[80:95]
    s_mov_b64 exec, s[60:61]
    ds_read_b128 v[124:127], v9 offset:28160
    ds_read_b128 v[128:131], v9 offset:28800
    s_mov_b64 exec, -1
    v_exp_f32 v53, v53
    v_exp_f32 v54, v54
    v_exp_f32 v55, v55
    v_cvt_pk_bf16_f32 v96, v48, v49
    v_cvt_pk_bf16_f32 v97, v50, v51
    v_cvt_pk_bf16_f32 v98, v52, v53
    v_cvt_pk_bf16_f32 v99, v54, v55
    s_setprio 1
    v_mfma_f32_32x32x8_bf16 v[64:79], v[114:115], v[16:17], v[64:79]
    v_exp_f32 v56, v56
    v_exp_f32 v57, v57
    v_exp_f32 v58, v58
    v_exp_f32 v59, v59
    v_exp_f32 v60, v60
    s_setprio 0
    v_mfma_f32_32x32x16_bf16 v[80:95], v[116:119], v[96:99], v[80:95]
    v_exp_f32 v61, v61
    v_exp_f32 v62, v62
    v_exp_f32 v63, v63
    v_cvt_pk_bf16_f32 v100, v56, v57
    v_cvt_pk_bf16_f32 v101, v58, v59
    v_cvt_pk_bf16_f32 v102, v60, v61
    v_cvt_pk_bf16_f32 v103, v62, v63
    s_setprio 3
    s_waitcnt lgkmcnt(0)
    v_mfma_f32_32x32x16_bf16 v[48:63], v[104:107], v[12:15], v[32:47]
    ds_read_b128 v[108:111], v3 offset:33280
    ds_read_b32 v114, v6 offset:33280
    v_exp_f32 v64, v64
    v_exp_f32 v65, v65
    v_exp_f32 v66, v66
    v_exp_f32 v67, v67
    v_exp_f32 v68, v68
    s_setprio 2
    v_mfma_f32_32x32x16_bf16 v[80:95], v[120:123], v[100:103], v[80:95]
    s_mov_b64 exec, s[60:61]
    ds_read_b128 v[116:119], v9 offset:30720
    ds_read_b128 v[120:123], v9 offset:31360
    s_mov_b64 exec, -1
    v_exp_f32 v69, v69
    v_exp_f32 v70, v70
    v_exp_f32 v71, v71
    v_cvt_pk_bf16_f32 v96, v64, v65
    v_cvt_pk_bf16_f32 v97, v66, v67
    v_cvt_pk_bf16_f32 v98, v68, v69
    v_cvt_pk_bf16_f32 v99, v70, v71
    s_setprio 1
    v_mfma_f32_32x32x8_bf16 v[48:63], v[112:113], v[16:17], v[48:63]
    buffer_load_dwordx4 v[140:143], v24, s[24:27], s38 offen
    v_exp_f32 v72, v72
    v_exp_f32 v73, v73
    v_exp_f32 v74, v74
    v_exp_f32 v75, v75
    v_exp_f32 v76, v76
    s_setprio 0
    v_mfma_f32_32x32x16_bf16 v[80:95], v[124:127], v[96:99], v[80:95]
    v_exp_f32 v77, v77
    v_exp_f32 v78, v78
    v_exp_f32 v79, v79
    v_cvt_pk_bf16_f32 v100, v72, v73
    v_cvt_pk_bf16_f32 v101, v74, v75
    v_cvt_pk_bf16_f32 v102, v76, v77
    v_cvt_pk_bf16_f32 v103, v78, v79
    s_waitcnt vmcnt(3)
    s_barrier
    s_setprio 3
    s_waitcnt lgkmcnt(0)
    v_mfma_f32_32x32x16_bf16 v[64:79], v[108:111], v[12:15], v[32:47]
    ds_read_b128 v[104:107], v3 offset:35840
    ds_read_b32 v112, v6 offset:35840
    v_exp_f32 v48, v48
    v_exp_f32 v49, v49
    v_exp_f32 v50, v50
    v_exp_f32 v51, v51
    v_exp_f32 v52, v52
    s_setprio 2
    v_mfma_f32_32x32x16_bf16 v[80:95], v[128:131], v[100:103], v[80:95]
    s_mov_b64 exec, s[60:61]
    ds_read_b128 v[124:127], v9 offset:33280
    ds_read_b128 v[128:131], v9 offset:33920
    s_mov_b64 exec, -1
    v_exp_f32 v53, v53
    v_exp_f32 v54, v54
    v_exp_f32 v55, v55
    v_cvt_pk_bf16_f32 v96, v48, v49
    v_cvt_pk_bf16_f32 v97, v50, v51
    v_cvt_pk_bf16_f32 v98, v52, v53
    v_cvt_pk_bf16_f32 v99, v54, v55
    s_setprio 1
    v_mfma_f32_32x32x8_bf16 v[64:79], v[114:115], v[16:17], v[64:79]
    v_exp_f32 v56, v56
    v_exp_f32 v57, v57
    v_exp_f32 v58, v58
    v_exp_f32 v59, v59
    v_exp_f32 v60, v60
    s_setprio 0
    v_mfma_f32_32x32x16_bf16 v[80:95], v[116:119], v[96:99], v[80:95]
    v_exp_f32 v61, v61
    v_exp_f32 v62, v62
    v_exp_f32 v63, v63
    v_cvt_pk_bf16_f32 v100, v56, v57
    v_cvt_pk_bf16_f32 v101, v58, v59
    v_cvt_pk_bf16_f32 v102, v60, v61
    v_cvt_pk_bf16_f32 v103, v62, v63
    s_setprio 3
    s_waitcnt lgkmcnt(0)
    v_mfma_f32_32x32x16_bf16 v[48:63], v[104:107], v[12:15], v[32:47]
    ds_read_b128 v[108:111], v3 offset:38400
    ds_read_b32 v114, v6 offset:38400
    v_exp_f32 v64, v64
    v_exp_f32 v65, v65
    v_exp_f32 v66, v66
    v_exp_f32 v67, v67
    v_exp_f32 v68, v68
    s_setprio 2
    v_mfma_f32_32x32x16_bf16 v[80:95], v[120:123], v[100:103], v[80:95]
    s_mov_b64 exec, s[60:61]
    ds_read_b128 v[116:119], v9 offset:35840
    ds_read_b128 v[120:123], v9 offset:36480
    s_mov_b64 exec, -1
    v_exp_f32 v69, v69
    v_exp_f32 v70, v70
    v_exp_f32 v71, v71
    v_cvt_pk_bf16_f32 v96, v64, v65
    v_cvt_pk_bf16_f32 v97, v66, v67
    v_cvt_pk_bf16_f32 v98, v68, v69
    v_cvt_pk_bf16_f32 v99, v70, v71
    s_setprio 1
    v_mfma_f32_32x32x8_bf16 v[48:63], v[112:113], v[16:17], v[48:63]
    buffer_load_dwordx4 v[144:147], v24, s[24:27], s39 offen
    v_exp_f32 v72, v72
    v_exp_f32 v73, v73
    v_exp_f32 v74, v74
    v_exp_f32 v75, v75
    v_exp_f32 v76, v76
    s_setprio 0
    v_mfma_f32_32x32x16_bf16 v[80:95], v[124:127], v[96:99], v[80:95]
    v_exp_f32 v77, v77
    v_exp_f32 v78, v78
    v_exp_f32 v79, v79
    v_cvt_pk_bf16_f32 v100, v72, v73
    v_cvt_pk_bf16_f32 v101, v74, v75
    v_cvt_pk_bf16_f32 v102, v76, v77
    v_cvt_pk_bf16_f32 v103, v78, v79
    s_setprio 3
    s_waitcnt lgkmcnt(0)
    v_mfma_f32_32x32x16_bf16 v[64:79], v[108:111], v[12:15], v[32:47]
    ds_read_b128 v[104:107], v3 offset:40960
    ds_read_b32 v112, v6 offset:40960
    v_exp_f32 v48, v48
    v_exp_f32 v49, v49
    v_exp_f32 v50, v50
    v_exp_f32 v51, v51
    v_exp_f32 v52, v52
    s_setprio 2
    v_mfma_f32_32x32x16_bf16 v[80:95], v[128:131], v[100:103], v[80:95]
    s_mov_b64 exec, s[60:61]
    ds_read_b128 v[124:127], v9 offset:38400
    ds_read_b128 v[128:131], v9 offset:39040
    s_mov_b64 exec, -1
    v_exp_f32 v53, v53
    v_exp_f32 v54, v54
    v_exp_f32 v55, v55
    v_cvt_pk_bf16_f32 v96, v48, v49
    v_cvt_pk_bf16_f32 v97, v50, v51
    v_cvt_pk_bf16_f32 v98, v52, v53
    v_cvt_pk_bf16_f32 v99, v54, v55
    s_setprio 1
    v_mfma_f32_32x32x8_bf16 v[64:79], v[114:115], v[16:17], v[64:79]
    v_exp_f32 v56, v56
    v_exp_f32 v57, v57
    v_exp_f32 v58, v58
    v_exp_f32 v59, v59
    v_exp_f32 v60, v60
    s_setprio 0
    v_mfma_f32_32x32x16_bf16 v[80:95], v[116:119], v[96:99], v[80:95]
    v_exp_f32 v61, v61
    v_exp_f32 v62, v62
    v_exp_f32 v63, v63
    v_cvt_pk_bf16_f32 v100, v56, v57
    v_cvt_pk_bf16_f32 v101, v58, v59
    v_cvt_pk_bf16_f32 v102, v60, v61
    v_cvt_pk_bf16_f32 v103, v62, v63
    s_setprio 3
    s_waitcnt lgkmcnt(0)
    v_mfma_f32_32x32x16_bf16 v[48:63], v[104:107], v[12:15], v[32:47]
    ds_read_b128 v[108:111], v3 offset:43520
    ds_read_b32 v114, v6 offset:43520
    v_exp_f32 v64, v64
    v_exp_f32 v65, v65
    v_exp_f32 v66, v66
    v_exp_f32 v67, v67
    v_exp_f32 v68, v68
    s_setprio 2
    v_mfma_f32_32x32x16_bf16 v[80:95], v[120:123], v[100:103], v[80:95]
    s_mov_b64 exec, s[60:61]
    ds_read_b128 v[116:119], v9 offset:40960
    ds_read_b128 v[120:123], v9 offset:41600
    s_mov_b64 exec, -1
    v_exp_f32 v69, v69
    v_exp_f32 v70, v70
    v_exp_f32 v71, v71
    v_cvt_pk_bf16_f32 v96, v64, v65
    v_cvt_pk_bf16_f32 v97, v66, v67
    v_cvt_pk_bf16_f32 v98, v68, v69
    v_cvt_pk_bf16_f32 v99, v70, v71
    s_setprio 1
    v_mfma_f32_32x32x8_bf16 v[48:63], v[112:113], v[16:17], v[48:63]
    v_exp_f32 v72, v72
    v_exp_f32 v73, v73
    v_exp_f32 v74, v74
    v_exp_f32 v75, v75
    v_exp_f32 v76, v76
    s_setprio 0
    v_mfma_f32_32x32x16_bf16 v[80:95], v[124:127], v[96:99], v[80:95]
    v_exp_f32 v77, v77
    v_exp_f32 v78, v78
    v_exp_f32 v79, v79
    v_cvt_pk_bf16_f32 v100, v72, v73
    v_cvt_pk_bf16_f32 v101, v74, v75
    v_cvt_pk_bf16_f32 v102, v76, v77
    v_cvt_pk_bf16_f32 v103, v78, v79
    s_setprio 3
    s_waitcnt lgkmcnt(0)
    v_mfma_f32_32x32x16_bf16 v[64:79], v[108:111], v[12:15], v[32:47]
    ds_read_b128 v[104:107], v3 offset:46080
    ds_read_b32 v112, v6 offset:46080
    v_exp_f32 v48, v48
    v_exp_f32 v49, v49
    v_exp_f32 v50, v50
    v_exp_f32 v51, v51
    v_exp_f32 v52, v52
    s_setprio 2
    v_mfma_f32_32x32x16_bf16 v[80:95], v[128:131], v[100:103], v[80:95]
    s_mov_b64 exec, s[60:61]
    ds_read_b128 v[124:127], v9 offset:43520
    ds_read_b128 v[128:131], v9 offset:44160
    s_mov_b64 exec, -1
    v_exp_f32 v53, v53
    v_exp_f32 v54, v54
    v_exp_f32 v55, v55
    v_cvt_pk_bf16_f32 v96, v48, v49
    v_cvt_pk_bf16_f32 v97, v50, v51
    v_cvt_pk_bf16_f32 v98, v52, v53
    v_cvt_pk_bf16_f32 v99, v54, v55
    s_setprio 1
    v_mfma_f32_32x32x8_bf16 v[64:79], v[114:115], v[16:17], v[64:79]
    v_exp_f32 v56, v56
    v_exp_f32 v57, v57
    v_exp_f32 v58, v58
    v_exp_f32 v59, v59
    v_exp_f32 v60, v60
    s_setprio 0
    v_mfma_f32_32x32x16_bf16 v[80:95], v[116:119], v[96:99], v[80:95]
    v_exp_f32 v61, v61
    v_exp_f32 v62, v62
    v_exp_f32 v63, v63
    v_cvt_pk_bf16_f32 v100, v56, v57
    v_cvt_pk_bf16_f32 v101, v58, v59
    v_cvt_pk_bf16_f32 v102, v60, v61
    v_cvt_pk_bf16_f32 v103, v62, v63
    s_setprio 3
    s_waitcnt lgkmcnt(0)
    v_mfma_f32_32x32x16_bf16 v[48:63], v[104:107], v[12:15], v[32:47]
    ds_read_b128 v[108:111], v3 offset:48640
    ds_read_b32 v114, v6 offset:48640
    v_exp_f32 v64, v64
    v_exp_f32 v65, v65
    v_exp_f32 v66, v66
    v_exp_f32 v67, v67
    v_exp_f32 v68, v68
    s_setprio 2
    v_mfma_f32_32x32x16_bf16 v[80:95], v[120:123], v[100:103], v[80:95]
    s_mov_b64 exec, s[60:61]
    ds_read_b128 v[116:119], v9 offset:46080
    ds_read_b128 v[120:123], v9 offset:46720
    s_mov_b64 exec, -1
    v_exp_f32 v69, v69
    v_exp_f32 v70, v70
    v_exp_f32 v71, v71
    v_cvt_pk_bf16_f32 v96, v64, v65
    v_cvt_pk_bf16_f32 v97, v66, v67
    v_cvt_pk_bf16_f32 v98, v68, v69
    v_cvt_pk_bf16_f32 v99, v70, v71
    s_setprio 1
    v_mfma_f32_32x32x8_bf16 v[48:63], v[112:113], v[16:17], v[48:63]
    v_exp_f32 v72, v72
    v_exp_f32 v73, v73
    v_exp_f32 v74, v74
    v_exp_f32 v75, v75
    v_exp_f32 v76, v76
    s_setprio 0
    v_mfma_f32_32x32x16_bf16 v[80:95], v[124:127], v[96:99], v[80:95]
    v_exp_f32 v77, v77
    v_exp_f32 v78, v78
    v_exp_f32 v79, v79
    v_cvt_pk_bf16_f32 v100, v72, v73
    v_cvt_pk_bf16_f32 v101, v74, v75
    v_cvt_pk_bf16_f32 v102, v76, v77
    v_cvt_pk_bf16_f32 v103, v78, v79
    s_setprio 3
    s_waitcnt lgkmcnt(0)
    v_mfma_f32_32x32x16_bf16 v[64:79], v[108:111], v[12:15], v[32:47]
    ds_read_b128 v[104:107], v3 offset:51200
    ds_read_b32 v112, v6 offset:51200
    v_exp_f32 v48, v48
    v_exp_f32 v49, v49
    v_exp_f32 v50, v50
    v_exp_f32 v51, v51
    v_exp_f32 v52, v52
    s_setprio 2
    v_mfma_f32_32x32x16_bf16 v[80:95], v[128:131], v[100:103], v[80:95]
    s_mov_b64 exec, s[60:61]
    ds_read_b128 v[124:127], v9 offset:48640
    ds_read_b128 v[128:131], v9 offset:49280
    s_mov_b64 exec, -1
    v_exp_f32 v53, v53
    v_exp_f32 v54, v54
    v_exp_f32 v55, v55
    v_cvt_pk_bf16_f32 v96, v48, v49
    v_cvt_pk_bf16_f32 v97, v50, v51
    v_cvt_pk_bf16_f32 v98, v52, v53
    v_cvt_pk_bf16_f32 v99, v54, v55
    s_setprio 1
    v_mfma_f32_32x32x8_bf16 v[64:79], v[114:115], v[16:17], v[64:79]
    v_exp_f32 v56, v56
    v_exp_f32 v57, v57
    v_exp_f32 v58, v58
    v_exp_f32 v59, v59
    v_exp_f32 v60, v60
    s_setprio 0
    v_mfma_f32_32x32x16_bf16 v[80:95], v[116:119], v[96:99], v[80:95]
    s_waitcnt vmcnt(0)
    ds_write_b128 v25, v[132:135] offset:0
    ds_write_b128 v25, v[136:139] offset:128
    ds_write_b128 v25, v[140:143] offset:256
    ds_write_b128 v25, v[144:147] offset:384
    v_exp_f32 v61, v61
    v_exp_f32 v62, v62
    v_exp_f32 v63, v63
    v_cvt_pk_bf16_f32 v100, v56, v57
    v_cvt_pk_bf16_f32 v101, v58, v59
    v_cvt_pk_bf16_f32 v102, v60, v61
    v_cvt_pk_bf16_f32 v103, v62, v63
    s_setprio 3
    s_waitcnt lgkmcnt(0)
    v_mfma_f32_32x32x16_bf16 v[48:63], v[104:107], v[12:15], v[32:47]
    ds_read_b128 v[108:111], v3 offset:53760
    ds_read_b32 v114, v6 offset:53760
    v_exp_f32 v64, v64
    v_exp_f32 v65, v65
    v_exp_f32 v66, v66
    v_exp_f32 v67, v67
    v_exp_f32 v68, v68
    s_setprio 2
    v_mfma_f32_32x32x16_bf16 v[80:95], v[120:123], v[100:103], v[80:95]
    s_mov_b64 exec, s[60:61]
    ds_read_b128 v[116:119], v9 offset:51200
    ds_read_b128 v[120:123], v9 offset:51840
    s_mov_b64 exec, -1
    v_exp_f32 v69, v69
    v_exp_f32 v70, v70
    v_exp_f32 v71, v71
    v_cvt_pk_bf16_f32 v96, v64, v65
    v_cvt_pk_bf16_f32 v97, v66, v67
    v_cvt_pk_bf16_f32 v98, v68, v69
    v_cvt_pk_bf16_f32 v99, v70, v71
    s_setprio 1
    v_mfma_f32_32x32x8_bf16 v[48:63], v[112:113], v[16:17], v[48:63]
    ds_read_b64_tr_b16 v[148:149], v188 offset:0
    ds_read_b64_tr_b16 v[150:151], v188 offset:512
    v_exp_f32 v72, v72
    v_exp_f32 v73, v73
    v_exp_f32 v74, v74
    v_exp_f32 v75, v75
    v_exp_f32 v76, v76
    s_setprio 0
    v_mfma_f32_32x32x16_bf16 v[80:95], v[124:127], v[96:99], v[80:95]
    ds_read_b64_tr_b16 v[156:157], v190 offset:16384
    ds_read_b64_tr_b16 v[158:159], v190 offset:16896
    v_exp_f32 v77, v77
    v_exp_f32 v78, v78
    v_exp_f32 v79, v79
    v_cvt_pk_bf16_f32 v100, v72, v73
    v_cvt_pk_bf16_f32 v101, v74, v75
    v_cvt_pk_bf16_f32 v102, v76, v77
    v_cvt_pk_bf16_f32 v103, v78, v79
    s_setprio 3
    s_waitcnt lgkmcnt(0)
    v_mfma_f32_32x32x16_bf16 v[64:79], v[108:111], v[12:15], v[32:47]
    ds_read_b128 v[104:107], v3 offset:56320
    ds_read_b32 v112, v6 offset:56320
    v_exp_f32 v48, v48
    v_exp_f32 v49, v49
    v_exp_f32 v50, v50
    v_exp_f32 v51, v51
    v_exp_f32 v52, v52
    s_setprio 2
    v_mfma_f32_32x32x16_bf16 v[80:95], v[128:131], v[100:103], v[80:95]
    s_mov_b64 exec, s[60:61]
    ds_read_b128 v[124:127], v9 offset:53760
    ds_read_b128 v[128:131], v9 offset:54400
    s_mov_b64 exec, -1
    v_exp_f32 v53, v53
    v_exp_f32 v54, v54
    v_exp_f32 v55, v55
    v_cvt_pk_bf16_f32 v96, v48, v49
    v_cvt_pk_bf16_f32 v97, v50, v51
    v_cvt_pk_bf16_f32 v98, v52, v53
    v_cvt_pk_bf16_f32 v99, v54, v55
    s_setprio 1
    v_mfma_f32_32x32x8_bf16 v[64:79], v[114:115], v[16:17], v[64:79]
    ds_read_b64_tr_b16 v[152:153], v189 offset:8192
    ds_read_b64_tr_b16 v[154:155], v189 offset:8704
    v_exp_f32 v56, v56
    v_exp_f32 v57, v57
    v_exp_f32 v58, v58
    v_exp_f32 v59, v59
    v_exp_f32 v60, v60
    s_setprio 0
    v_mfma_f32_32x32x16_bf16 v[80:95], v[116:119], v[96:99], v[80:95]
    ds_read_b64_tr_b16 v[160:161], v191 offset:24576
    ds_read_b64_tr_b16 v[162:163], v191 offset:25088
    v_exp_f32 v61, v61
    v_exp_f32 v62, v62
    v_exp_f32 v63, v63
    v_cvt_pk_bf16_f32 v100, v56, v57
    v_cvt_pk_bf16_f32 v101, v58, v59
    v_cvt_pk_bf16_f32 v102, v60, v61
    v_cvt_pk_bf16_f32 v103, v62, v63
    s_setprio 3
    s_waitcnt lgkmcnt(0)
    v_mfma_f32_32x32x16_bf16 v[48:63], v[104:107], v[12:15], v[32:47]
    ds_read_b128 v[108:111], v3 offset:58880
    ds_read_b32 v114, v6 offset:58880
    v_exp_f32 v64, v64
    v_exp_f32 v65, v65
    v_exp_f32 v66, v66
    v_exp_f32 v67, v67
    v_exp_f32 v68, v68
    s_setprio 2
    v_mfma_f32_32x32x16_bf16 v[80:95], v[120:123], v[100:103], v[80:95]
    s_mov_b64 exec, s[60:61]
    ds_read_b128 v[116:119], v9 offset:56320
    ds_read_b128 v[120:123], v9 offset:56960
    s_mov_b64 exec, -1
    v_exp_f32 v69, v69
    v_exp_f32 v70, v70
    v_exp_f32 v71, v71
    v_cvt_pk_bf16_f32 v96, v64, v65
    v_cvt_pk_bf16_f32 v97, v66, v67
    v_cvt_pk_bf16_f32 v98, v68, v69
    v_cvt_pk_bf16_f32 v99, v70, v71
    s_setprio 1
    v_mfma_f32_32x32x8_bf16 v[48:63], v[112:113], v[16:17], v[48:63]
    v_exp_f32 v72, v72
    v_exp_f32 v73, v73
    v_exp_f32 v74, v74
    v_exp_f32 v75, v75
    v_exp_f32 v76, v76
    s_setprio 0
    v_mfma_f32_32x32x16_bf16 v[80:95], v[124:127], v[96:99], v[80:95]
    buffer_store_dwordx4 v[148:151], v2, s[20:23], s65 offen offset:0 sc1
    v_mfma_f32_16x16x32_bf16 v[168:171], v[148:151], v[164:167], 0
    v_exp_f32 v77, v77
    v_exp_f32 v78, v78
    v_exp_f32 v79, v79
    v_cvt_pk_bf16_f32 v100, v72, v73
    v_cvt_pk_bf16_f32 v101, v74, v75
    v_cvt_pk_bf16_f32 v102, v76, v77
    v_cvt_pk_bf16_f32 v103, v78, v79
    s_setprio 3
    s_waitcnt lgkmcnt(0)
    v_mfma_f32_32x32x16_bf16 v[64:79], v[108:111], v[12:15], v[32:47]
    ds_read_b128 v[104:107], v4 offset:0
    ds_read_b32 v112, v7 offset:0
    v_exp_f32 v48, v48
    v_exp_f32 v49, v49
    v_exp_f32 v50, v50
    v_exp_f32 v51, v51
    v_exp_f32 v52, v52
    s_setprio 2
    v_mfma_f32_32x32x16_bf16 v[80:95], v[128:131], v[100:103], v[80:95]
    s_mov_b64 exec, s[60:61]
    ds_read_b128 v[124:127], v9 offset:58880
    ds_read_b128 v[128:131], v9 offset:59520
    s_mov_b64 exec, -1
    v_exp_f32 v53, v53
    v_exp_f32 v54, v54
    v_exp_f32 v55, v55
    v_cvt_pk_bf16_f32 v96, v48, v49
    v_cvt_pk_bf16_f32 v97, v50, v51
    v_cvt_pk_bf16_f32 v98, v52, v53
    v_cvt_pk_bf16_f32 v99, v54, v55
    s_setprio 1
    v_mfma_f32_32x32x8_bf16 v[64:79], v[114:115], v[16:17], v[64:79]
    s_cmp_eq_u32 s64, 0
    s_cbranch_scc1 K2_NOCS_9
    s_mov_b32 exec_lo, 0x00010001
    s_mov_b32 exec_hi, 0x00010001
    buffer_store_dwordx4 v[168:171], v1, s[20:23], s66 offen offset:0 sc1
    s_mov_b64 exec, -1
K2_NOCS_9:
    v_exp_f32 v56, v56
    v_exp_f32 v57, v57
    v_exp_f32 v58, v58
    v_exp_f32 v59, v59
    v_exp_f32 v60, v60
    s_setprio 0
    v_mfma_f32_32x32x16_bf16 v[80:95], v[116:119], v[96:99], v[80:95]
    buffer_store_dwordx4 v[152:155], v2, s[20:23], s65 offen offset:1024 sc1
    v_mfma_f32_16x16x32_bf16 v[172:175], v[152:155], v[164:167], 0
    v_exp_f32 v61, v61
    v_exp_f32 v62, v62
    v_exp_f32 v63, v63
    s_add_u32 m0, s49, 131072
    s_add_u32 s51, s50, 131072
    buffer_load_dwordx4 v2, s[20:23], s51 offen sc1 lds
    v_cvt_pk_bf16_f32 v100, v56, v57
    v_cvt_pk_bf16_f32 v101, v58, v59
    v_cvt_pk_bf16_f32 v102, v60, v61
    v_cvt_pk_bf16_f32 v103, v62, v63
    s_setprio 3
    s_waitcnt lgkmcnt(0)
    v_mfma_f32_32x32x16_bf16 v[48:63], v[104:107], v[12:15], v[32:47]
    ds_read_b128 v[108:111], v4 offset:2560
    ds_read_b32 v114, v7 offset:2560
    v_exp_f32 v64, v64
    v_exp_f32 v65, v65
    v_exp_f32 v66, v66
    v_exp_f32 v67, v67
    v_exp_f32 v68, v68
    s_setprio 2
    v_mfma_f32_32x32x16_bf16 v[80:95], v[120:123], v[100:103], v[80:95]
    s_mov_b64 exec, s[60:61]
    ds_read_b128 v[116:119], v10 offset:0
    ds_read_b128 v[120:123], v10 offset:640
    s_mov_b64 exec, -1
    v_exp_f32 v69, v69
    v_exp_f32 v70, v70
    v_exp_f32 v71, v71
    v_cvt_pk_bf16_f32 v96, v64, v65
    v_cvt_pk_bf16_f32 v97, v66, v67
    v_cvt_pk_bf16_f32 v98, v68, v69
    v_cvt_pk_bf16_f32 v99, v70, v71
    s_setprio 1
    v_mfma_f32_32x32x8_bf16 v[48:63], v[112:113], v[16:17], v[48:63]
    s_cmp_eq_u32 s64, 0
    s_cbranch_scc1 K2_NOCS_10
    s_mov_b32 exec_lo, 0x00010001
    s_mov_b32 exec_hi, 0x00010001
    buffer_store_dwordx4 v[172:175], v1, s[20:23], s66 offen offset:64 sc1
    s_mov_b64 exec, -1
K2_NOCS_10:
    v_exp_f32 v72, v72
    v_exp_f32 v73, v73
    v_exp_f32 v74, v74
    v_exp_f32 v75, v75
    v_exp_f32 v76, v76
    s_setprio 0
    v_mfma_f32_32x32x16_bf16 v[80:95], v[124:127], v[96:99], v[80:95]
    buffer_store_dwordx4 v[156:159], v2, s[20:23], s65 offen offset:2048 sc1
    v_mfma_f32_16x16x32_bf16 v[176:179], v[156:159], v[164:167], 0
    v_exp_f32 v77, v77
    v_exp_f32 v78, v78
    v_exp_f32 v79, v79
    s_add_u32 m0, s49, 139264
    s_add_u32 s51, s50, 139264
    buffer_load_dwordx4 v2, s[20:23], s51 offen sc1 lds
    v_cvt_pk_bf16_f32 v100, v72, v73
    v_cvt_pk_bf16_f32 v101, v74, v75
    v_cvt_pk_bf16_f32 v102, v76, v77
    v_cvt_pk_bf16_f32 v103, v78, v79
    s_setprio 3
    s_waitcnt lgkmcnt(0)
    v_mfma_f32_32x32x16_bf16 v[64:79], v[108:111], v[12:15], v[32:47]
    ds_read_b128 v[104:107], v4 offset:5120
    ds_read_b32 v112, v7 offset:5120
    v_exp_f32 v48, v48
    v_exp_f32 v49, v49
    v_exp_f32 v50, v50
    v_exp_f32 v51, v51
    v_exp_f32 v52, v52
    s_setprio 2
    v_mfma_f32_32x32x16_bf16 v[80:95], v[128:131], v[100:103], v[80:95]
    s_mov_b64 exec, s[60:61]
    ds_read_b128 v[124:127], v10 offset:2560
    ds_read_b128 v[128:131], v10 offset:3200
    s_mov_b64 exec, -1
    v_exp_f32 v53, v53
    v_exp_f32 v54, v54
    v_exp_f32 v55, v55
    v_cvt_pk_bf16_f32 v96, v48, v49
    v_cvt_pk_bf16_f32 v97, v50, v51
    v_cvt_pk_bf16_f32 v98, v52, v53
    v_cvt_pk_bf16_f32 v99, v54, v55
    s_setprio 1
    v_mfma_f32_32x32x8_bf16 v[64:79], v[114:115], v[16:17], v[64:79]
    s_cmp_eq_u32 s64, 0
    s_cbranch_scc1 K2_NOCS_11
    s_mov_b32 exec_lo, 0x00010001
    s_mov_b32 exec_hi, 0x00010001
    buffer_store_dwordx4 v[176:179], v1, s[20:23], s66 offen offset:128 sc1
    s_mov_b64 exec, -1
K2_NOCS_11:
    v_exp_f32 v56, v56
    v_exp_f32 v57, v57
    v_exp_f32 v58, v58
    v_exp_f32 v59, v59
    v_exp_f32 v60, v60
    s_setprio 0
    v_mfma_f32_32x32x16_bf16 v[80:95], v[116:119], v[96:99], v[80:95]
    buffer_store_dwordx4 v[160:163], v2, s[20:23], s65 offen offset:3072 sc1
    v_mfma_f32_16x16x32_bf16 v[180:183], v[160:163], v[164:167], 0
    v_exp_f32 v61, v61
    v_exp_f32 v62, v62
    v_exp_f32 v63, v63
    s_add_u32 m0, s49, 147456
    s_add_u32 s51, s50, 147456
    buffer_load_dwordx4 v2, s[20:23], s51 offen sc1 lds
    v_cvt_pk_bf16_f32 v100, v56, v57
    v_cvt_pk_bf16_f32 v101, v58, v59
    v_cvt_pk_bf16_f32 v102, v60, v61
    v_cvt_pk_bf16_f32 v103, v62, v63
    s_setprio 3
    s_waitcnt lgkmcnt(0)
    v_mfma_f32_32x32x16_bf16 v[48:63], v[104:107], v[12:15], v[32:47]
    ds_read_b128 v[108:111], v4 offset:7680
    ds_read_b32 v114, v7 offset:7680
    v_exp_f32 v64, v64
    v_exp_f32 v65, v65
    v_exp_f32 v66, v66
    v_exp_f32 v67, v67
    v_exp_f32 v68, v68
    s_setprio 2
    v_mfma_f32_32x32x16_bf16 v[80:95], v[120:123], v[100:103], v[80:95]
    s_mov_b64 exec, s[60:61]
    ds_read_b128 v[116:119], v10 offset:5120
    ds_read_b128 v[120:123], v10 offset:5760
    s_mov_b64 exec, -1
    v_exp_f32 v69, v69
    v_exp_f32 v70, v70
    v_exp_f32 v71, v71
    v_cvt_pk_bf16_f32 v96, v64, v65
    v_cvt_pk_bf16_f32 v97, v66, v67
    v_cvt_pk_bf16_f32 v98, v68, v69
    v_cvt_pk_bf16_f32 v99, v70, v71
    s_setprio 1
    v_mfma_f32_32x32x8_bf16 v[48:63], v[112:113], v[16:17], v[48:63]
    s_cmp_eq_u32 s64, 0
    s_cbranch_scc1 K2_NOCS_12
    s_mov_b32 exec_lo, 0x00010001
    s_mov_b32 exec_hi, 0x00010001
    buffer_store_dwordx4 v[180:183], v1, s[20:23], s66 offen offset:192 sc1
    s_mov_b64 exec, -1
K2_NOCS_12:
    v_exp_f32 v72, v72
    v_exp_f32 v73, v73
    v_exp_f32 v74, v74
    v_exp_f32 v75, v75
    v_exp_f32 v76, v76
    s_setprio 0
    v_mfma_f32_32x32x16_bf16 v[80:95], v[124:127], v[96:99], v[80:95]
    v_exp_f32 v77, v77
    v_exp_f32 v78, v78
    v_exp_f32 v79, v79
    s_add_u32 m0, s49, 155648
    s_add_u32 s51, s50, 155648
    buffer_load_dwordx4 v2, s[20:23], s51 offen sc1 lds
    v_cvt_pk_bf16_f32 v100, v72, v73
    v_cvt_pk_bf16_f32 v101, v74, v75
    v_cvt_pk_bf16_f32 v102, v76, v77
    v_cvt_pk_bf16_f32 v103, v78, v79
    s_setprio 3
    s_waitcnt lgkmcnt(0)
    v_mfma_f32_32x32x16_bf16 v[64:79], v[108:111], v[12:15], v[32:47]
    ds_read_b128 v[104:107], v4 offset:10240
    ds_read_b32 v112, v7 offset:10240
    v_exp_f32 v48, v48
    v_exp_f32 v49, v49
    v_exp_f32 v50, v50
    v_exp_f32 v51, v51
    v_exp_f32 v52, v52
    s_setprio 2
    v_mfma_f32_32x32x16_bf16 v[80:95], v[128:131], v[100:103], v[80:95]
    s_mov_b64 exec, s[60:61]
    ds_read_b128 v[124:127], v10 offset:7680
    ds_read_b128 v[128:131], v10 offset:8320
    s_mov_b64 exec, -1
    v_exp_f32 v53, v53
    v_exp_f32 v54, v54
    v_exp_f32 v55, v55
    v_cvt_pk_bf16_f32 v96, v48, v49
    v_cvt_pk_bf16_f32 v97, v50, v51
    v_cvt_pk_bf16_f32 v98, v52, v53
    v_cvt_pk_bf16_f32 v99, v54, v55
    s_setprio 1
    v_mfma_f32_32x32x8_bf16 v[64:79], v[114:115], v[16:17], v[64:79]
    v_exp_f32 v56, v56
    v_exp_f32 v57, v57
    v_exp_f32 v58, v58
    v_exp_f32 v59, v59
    v_exp_f32 v60, v60
    s_setprio 0
    v_mfma_f32_32x32x16_bf16 v[80:95], v[116:119], v[96:99], v[80:95]
    v_exp_f32 v61, v61
    v_exp_f32 v62, v62
    v_exp_f32 v63, v63
    v_cvt_pk_bf16_f32 v100, v56, v57
    v_cvt_pk_bf16_f32 v101, v58, v59
    v_cvt_pk_bf16_f32 v102, v60, v61
    v_cvt_pk_bf16_f32 v103, v62, v63
    s_setprio 3
    s_waitcnt lgkmcnt(0)
    v_mfma_f32_32x32x16_bf16 v[48:63], v[104:107], v[12:15], v[32:47]
    ds_read_b128 v[108:111], v4 offset:12800
    ds_read_b32 v114, v7 offset:12800
    v_exp_f32 v64, v64
    v_exp_f32 v65, v65
    v_exp_f32 v66, v66
    v_exp_f32 v67, v67
    v_exp_f32 v68, v68
    s_setprio 2
    v_mfma_f32_32x32x16_bf16 v[80:95], v[120:123], v[100:103], v[80:95]
    s_mov_b64 exec, s[60:61]
    ds_read_b128 v[116:119], v10 offset:10240
    ds_read_b128 v[120:123], v10 offset:10880
    s_mov_b64 exec, -1
    v_exp_f32 v69, v69
    v_exp_f32 v70, v70
    v_exp_f32 v71, v71
    v_cvt_pk_bf16_f32 v96, v64, v65
    v_cvt_pk_bf16_f32 v97, v66, v67
    v_cvt_pk_bf16_f32 v98, v68, v69
    v_cvt_pk_bf16_f32 v99, v70, v71
    s_setprio 1
    v_mfma_f32_32x32x8_bf16 v[48:63], v[112:113], v[16:17], v[48:63]
    v_exp_f32 v72, v72
    v_exp_f32 v73, v73
    v_exp_f32 v74, v74
    v_exp_f32 v75, v75
    v_exp_f32 v76, v76
    s_setprio 0
    v_mfma_f32_32x32x16_bf16 v[80:95], v[124:127], v[96:99], v[80:95]
    v_exp_f32 v77, v77
    v_exp_f32 v78, v78
    v_exp_f32 v79, v79
    v_cvt_pk_bf16_f32 v100, v72, v73
    v_cvt_pk_bf16_f32 v101, v74, v75
    v_cvt_pk_bf16_f32 v102, v76, v77
    v_cvt_pk_bf16_f32 v103, v78, v79
    s_setprio 3
    s_waitcnt lgkmcnt(0)
    v_mfma_f32_32x32x16_bf16 v[64:79], v[108:111], v[12:15], v[32:47]
    ds_read_b128 v[104:107], v4 offset:15360
    ds_read_b32 v112, v7 offset:15360
    v_exp_f32 v48, v48
    v_exp_f32 v49, v49
    v_exp_f32 v50, v50
    v_exp_f32 v51, v51
    v_exp_f32 v52, v52
    s_setprio 2
    v_mfma_f32_32x32x16_bf16 v[80:95], v[128:131], v[100:103], v[80:95]
    s_mov_b64 exec, s[60:61]
    ds_read_b128 v[124:127], v10 offset:12800
    ds_read_b128 v[128:131], v10 offset:13440
    s_mov_b64 exec, -1
    v_exp_f32 v53, v53
    v_exp_f32 v54, v54
    v_exp_f32 v55, v55
    v_cvt_pk_bf16_f32 v96, v48, v49
    v_cvt_pk_bf16_f32 v97, v50, v51
    v_cvt_pk_bf16_f32 v98, v52, v53
    v_cvt_pk_bf16_f32 v99, v54, v55
    s_setprio 1
    v_mfma_f32_32x32x8_bf16 v[64:79], v[114:115], v[16:17], v[64:79]
    v_exp_f32 v56, v56
    v_exp_f32 v57, v57
    v_exp_f32 v58, v58
    v_exp_f32 v59, v59
    v_exp_f32 v60, v60
    s_setprio 0
    v_mfma_f32_32x32x16_bf16 v[80:95], v[116:119], v[96:99], v[80:95]
    v_exp_f32 v61, v61
    v_exp_f32 v62, v62
    v_exp_f32 v63, v63
    v_cvt_pk_bf16_f32 v100, v56, v57
    v_cvt_pk_bf16_f32 v101, v58, v59
    v_cvt_pk_bf16_f32 v102, v60, v61
    v_cvt_pk_bf16_f32 v103, v62, v63
    s_setprio 3
    s_waitcnt lgkmcnt(0)
    v_mfma_f32_32x32x16_bf16 v[48:63], v[104:107], v[12:15], v[32:47]
    ds_read_b128 v[108:111], v4 offset:17920
    ds_read_b32 v114, v7 offset:17920
    v_exp_f32 v64, v64
    v_exp_f32 v65, v65
    v_exp_f32 v66, v66
    v_exp_f32 v67, v67
    v_exp_f32 v68, v68
    s_setprio 2
    v_mfma_f32_32x32x16_bf16 v[80:95], v[120:123], v[100:103], v[80:95]
    s_mov_b64 exec, s[60:61]
    ds_read_b128 v[116:119], v10 offset:15360
    ds_read_b128 v[120:123], v10 offset:16000
    s_mov_b64 exec, -1
    v_exp_f32 v69, v69
    v_exp_f32 v70, v70
    v_exp_f32 v71, v71
    v_cvt_pk_bf16_f32 v96, v64, v65
    v_cvt_pk_bf16_f32 v97, v66, v67
    v_cvt_pk_bf16_f32 v98, v68, v69
    v_cvt_pk_bf16_f32 v99, v70, v71
    s_setprio 1
    v_mfma_f32_32x32x8_bf16 v[48:63], v[112:113], v[16:17], v[48:63]
    v_exp_f32 v72, v72
    v_exp_f32 v73, v73
    v_exp_f32 v74, v74
    v_exp_f32 v75, v75
    v_exp_f32 v76, v76
    s_setprio 0
    v_mfma_f32_32x32x16_bf16 v[80:95], v[124:127], v[96:99], v[80:95]
    s_waitcnt vmcnt(0)
    s_and_b32 s51, s2, 63
    s_lshl_b32 s51, s51, 7
    s_add_u32 s51, s51, 19488768
    s_mov_b64 exec, 1
    buffer_atomic_add v243, v255, s[20:23], s51 offen sc1
    s_mov_b64 exec, -1
    v_exp_f32 v77, v77
    v_exp_f32 v78, v78
    v_exp_f32 v79, v79
    v_cvt_pk_bf16_f32 v100, v72, v73
    v_cvt_pk_bf16_f32 v101, v74, v75
    v_cvt_pk_bf16_f32 v102, v76, v77
    v_cvt_pk_bf16_f32 v103, v78, v79
    s_setprio 3
    s_waitcnt lgkmcnt(0)
    v_mfma_f32_32x32x16_bf16 v[64:79], v[108:111], v[12:15], v[32:47]
    ds_read_b128 v[104:107], v4 offset:20480
    ds_read_b32 v112, v7 offset:20480
    v_exp_f32 v48, v48
    v_exp_f32 v49, v49
    v_exp_f32 v50, v50
    v_exp_f32 v51, v51
    v_exp_f32 v52, v52
    s_setprio 2
    v_mfma_f32_32x32x16_bf16 v[80:95], v[128:131], v[100:103], v[80:95]
    s_mov_b64 exec, s[60:61]
    ds_read_b128 v[124:127], v10 offset:17920
    ds_read_b128 v[128:131], v10 offset:18560
    s_mov_b64 exec, -1
    v_exp_f32 v53, v53
    v_exp_f32 v54, v54
    v_exp_f32 v55, v55
    v_cvt_pk_bf16_f32 v96, v48, v49
    v_cvt_pk_bf16_f32 v97, v50, v51
    v_cvt_pk_bf16_f32 v98, v52, v53
    v_cvt_pk_bf16_f32 v99, v54, v55
    s_setprio 1
    v_mfma_f32_32x32x8_bf16 v[64:79], v[114:115], v[16:17], v[64:79]
    v_exp_f32 v56, v56
    v_exp_f32 v57, v57
    v_exp_f32 v58, v58
    v_exp_f32 v59, v59
    v_exp_f32 v60, v60
    s_setprio 0
    v_mfma_f32_32x32x16_bf16 v[80:95], v[116:119], v[96:99], v[80:95]
    v_exp_f32 v61, v61
    v_exp_f32 v62, v62
    v_exp_f32 v63, v63
    v_cvt_pk_bf16_f32 v100, v56, v57
    v_cvt_pk_bf16_f32 v101, v58, v59
    v_cvt_pk_bf16_f32 v102, v60, v61
    v_cvt_pk_bf16_f32 v103, v62, v63
    s_setprio 3
    s_waitcnt lgkmcnt(0)
    v_mfma_f32_32x32x16_bf16 v[48:63], v[104:107], v[12:15], v[32:47]
    ds_read_b128 v[108:111], v4 offset:23040
    ds_read_b32 v114, v7 offset:23040
    v_exp_f32 v64, v64
    v_exp_f32 v65, v65
    v_exp_f32 v66, v66
    v_exp_f32 v67, v67
    v_exp_f32 v68, v68
    s_setprio 2
    v_mfma_f32_32x32x16_bf16 v[80:95], v[120:123], v[100:103], v[80:95]
    s_mov_b64 exec, s[60:61]
    ds_read_b128 v[116:119], v10 offset:20480
    ds_read_b128 v[120:123], v10 offset:21120
    s_mov_b64 exec, -1
    v_exp_f32 v69, v69
    v_exp_f32 v70, v70
    v_exp_f32 v71, v71
    v_cvt_pk_bf16_f32 v96, v64, v65
    v_cvt_pk_bf16_f32 v97, v66, v67
    v_cvt_pk_bf16_f32 v98, v68, v69
    v_cvt_pk_bf16_f32 v99, v70, v71
    s_setprio 1
    v_mfma_f32_32x32x8_bf16 v[48:63], v[112:113], v[16:17], v[48:63]
    v_exp_f32 v72, v72
    v_exp_f32 v73, v73
    v_exp_f32 v74, v74
    v_exp_f32 v75, v75
    v_exp_f32 v76, v76
    s_setprio 0
    v_mfma_f32_32x32x16_bf16 v[80:95], v[124:127], v[96:99], v[80:95]
    v_exp_f32 v77, v77
    v_exp_f32 v78, v78
    v_exp_f32 v79, v79
    v_cvt_pk_bf16_f32 v100, v72, v73
    v_cvt_pk_bf16_f32 v101, v74, v75
    v_cvt_pk_bf16_f32 v102, v76, v77
    v_cvt_pk_bf16_f32 v103, v78, v79
    s_setprio 3
    s_waitcnt lgkmcnt(0)
    v_mfma_f32_32x32x16_bf16 v[64:79], v[108:111], v[12:15], v[32:47]
    ds_read_b128 v[104:107], v4 offset:25600
    ds_read_b32 v112, v7 offset:25600
    v_exp_f32 v48, v48
    v_exp_f32 v49, v49
    v_exp_f32 v50, v50
    v_exp_f32 v51, v51
    v_exp_f32 v52, v52
    s_setprio 2
    v_mfma_f32_32x32x16_bf16 v[80:95], v[128:131], v[100:103], v[80:95]
    s_mov_b64 exec, s[60:61]
    ds_read_b128 v[124:127], v10 offset:23040
    ds_read_b128 v[128:131], v10 offset:23680
    s_mov_b64 exec, -1
    v_exp_f32 v53, v53
    v_exp_f32 v54, v54
    v_exp_f32 v55, v55
    v_cvt_pk_bf16_f32 v96, v48, v49
    v_cvt_pk_bf16_f32 v97, v50, v51
    v_cvt_pk_bf16_f32 v98, v52, v53
    v_cvt_pk_bf16_f32 v99, v54, v55
    s_setprio 1
    v_mfma_f32_32x32x8_bf16 v[64:79], v[114:115], v[16:17], v[64:79]
    v_exp_f32 v56, v56
    v_exp_f32 v57, v57
    v_exp_f32 v58, v58
    v_exp_f32 v59, v59
    v_exp_f32 v60, v60
    s_setprio 0
    v_mfma_f32_32x32x16_bf16 v[80:95], v[116:119], v[96:99], v[80:95]
    v_exp_f32 v61, v61
    v_exp_f32 v62, v62
    v_exp_f32 v63, v63
    v_cvt_pk_bf16_f32 v100, v56, v57
    v_cvt_pk_bf16_f32 v101, v58, v59
    v_cvt_pk_bf16_f32 v102, v60, v61
    v_cvt_pk_bf16_f32 v103, v62, v63
    s_setprio 3
    s_waitcnt lgkmcnt(0)
    v_mfma_f32_32x32x16_bf16 v[48:63], v[104:107], v[12:15], v[32:47]
    ds_read_b128 v[108:111], v4 offset:28160
    ds_read_b32 v114, v7 offset:28160
    v_exp_f32 v64, v64
    v_exp_f32 v65, v65
    v_exp_f32 v66, v66
    v_exp_f32 v67, v67
    v_exp_f32 v68, v68
    s_setprio 2
    v_mfma_f32_32x32x16_bf16 v[80:95], v[120:123], v[100:103], v[80:95]
    s_mov_b64 exec, s[60:61]
    ds_read_b128 v[116:119], v10 offset:25600
    ds_read_b128 v[120:123], v10 offset:26240
    s_mov_b64 exec, -1
    v_exp_f32 v69, v69
    v_exp_f32 v70, v70
    v_exp_f32 v71, v71
    v_cvt_pk_bf16_f32 v96, v64, v65
    v_cvt_pk_bf16_f32 v97, v66, v67
    v_cvt_pk_bf16_f32 v98, v68, v69
    v_cvt_pk_bf16_f32 v99, v70, v71
    s_setprio 1
    v_mfma_f32_32x32x8_bf16 v[48:63], v[112:113], v[16:17], v[48:63]
    v_exp_f32 v72, v72
    v_exp_f32 v73, v73
    v_exp_f32 v74, v74
    v_exp_f32 v75, v75
    v_exp_f32 v76, v76
    s_setprio 0
    v_mfma_f32_32x32x16_bf16 v[80:95], v[124:127], v[96:99], v[80:95]
    v_exp_f32 v77, v77
    v_exp_f32 v78, v78
    v_exp_f32 v79, v79
    v_cvt_pk_bf16_f32 v100, v72, v73
    v_cvt_pk_bf16_f32 v101, v74, v75
    v_cvt_pk_bf16_f32 v102, v76, v77
    v_cvt_pk_bf16_f32 v103, v78, v79
    s_setprio 3
    s_waitcnt lgkmcnt(0)
    v_mfma_f32_32x32x16_bf16 v[64:79], v[108:111], v[12:15], v[32:47]
    ds_read_b128 v[104:107], v4 offset:30720
    ds_read_b32 v112, v7 offset:30720
    v_exp_f32 v48, v48
    v_exp_f32 v49, v49
    v_exp_f32 v50, v50
    v_exp_f32 v51, v51
    v_exp_f32 v52, v52
    s_setprio 2
    v_mfma_f32_32x32x16_bf16 v[80:95], v[128:131], v[100:103], v[80:95]
    s_mov_b64 exec, s[60:61]
    ds_read_b128 v[124:127], v10 offset:28160
    ds_read_b128 v[128:131], v10 offset:28800
    s_mov_b64 exec, -1
    v_exp_f32 v53, v53
    v_exp_f32 v54, v54
    v_exp_f32 v55, v55
    v_cvt_pk_bf16_f32 v96, v48, v49
    v_cvt_pk_bf16_f32 v97, v50, v51
    v_cvt_pk_bf16_f32 v98, v52, v53
    v_cvt_pk_bf16_f32 v99, v54, v55
    s_setprio 1
    v_mfma_f32_32x32x8_bf16 v[64:79], v[114:115], v[16:17], v[64:79]
    v_exp_f32 v56, v56
    v_exp_f32 v57, v57
    v_exp_f32 v58, v58
    v_exp_f32 v59, v59
    v_exp_f32 v60, v60
    s_setprio 0
    v_mfma_f32_32x32x16_bf16 v[80:95], v[116:119], v[96:99], v[80:95]
    v_exp_f32 v61, v61
    v_exp_f32 v62, v62
    v_exp_f32 v63, v63
    v_cvt_pk_bf16_f32 v100, v56, v57
    v_cvt_pk_bf16_f32 v101, v58, v59
    v_cvt_pk_bf16_f32 v102, v60, v61
    v_cvt_pk_bf16_f32 v103, v62, v63
    s_setprio 3
    s_waitcnt lgkmcnt(0)
    v_mfma_f32_32x32x16_bf16 v[48:63], v[104:107], v[12:15], v[32:47]
    ds_read_b128 v[108:111], v4 offset:33280
    ds_read_b32 v114, v7 offset:33280
    v_exp_f32 v64, v64
    v_exp_f32 v65, v65
    v_exp_f32 v66, v66
    v_exp_f32 v67, v67
    v_exp_f32 v68, v68
    s_setprio 2
    v_mfma_f32_32x32x16_bf16 v[80:95], v[120:123], v[100:103], v[80:95]
    s_mov_b64 exec, s[60:61]
    ds_read_b128 v[116:119], v10 offset:30720
    ds_read_b128 v[120:123], v10 offset:31360
    s_mov_b64 exec, -1
    v_exp_f32 v69, v69
    v_exp_f32 v70, v70
    v_exp_f32 v71, v71
    v_cvt_pk_bf16_f32 v96, v64, v65
    v_cvt_pk_bf16_f32 v97, v66, v67
    v_cvt_pk_bf16_f32 v98, v68, v69
    v_cvt_pk_bf16_f32 v99, v70, v71
    s_setprio 1
    v_mfma_f32_32x32x8_bf16 v[48:63], v[112:113], v[16:17], v[48:63]
    v_exp_f32 v72, v72
    v_exp_f32 v73, v73
    v_exp_f32 v74, v74
    v_exp_f32 v75, v75
    v_exp_f32 v76, v76
    s_setprio 0
    v_mfma_f32_32x32x16_bf16 v[80:95], v[124:127], v[96:99], v[80:95]
    v_exp_f32 v77, v77
    v_exp_f32 v78, v78
    v_exp_f32 v79, v79
    v_cvt_pk_bf16_f32 v100, v72, v73
    v_cvt_pk_bf16_f32 v101, v74, v75
    v_cvt_pk_bf16_f32 v102, v76, v77
    v_cvt_pk_bf16_f32 v103, v78, v79
    s_setprio 3
    s_waitcnt lgkmcnt(0)
    v_mfma_f32_32x32x16_bf16 v[64:79], v[108:111], v[12:15], v[32:47]
    ds_read_b128 v[104:107], v4 offset:35840
    ds_read_b32 v112, v7 offset:35840
    v_exp_f32 v48, v48
    v_exp_f32 v49, v49
    v_exp_f32 v50, v50
    v_exp_f32 v51, v51
    v_exp_f32 v52, v52
    s_setprio 2
    v_mfma_f32_32x32x16_bf16 v[80:95], v[128:131], v[100:103], v[80:95]
    s_mov_b64 exec, s[60:61]
    ds_read_b128 v[124:127], v10 offset:33280
    ds_read_b128 v[128:131], v10 offset:33920
    s_mov_b64 exec, -1
    v_exp_f32 v53, v53
    v_exp_f32 v54, v54
    v_exp_f32 v55, v55
    v_cvt_pk_bf16_f32 v96, v48, v49
    v_cvt_pk_bf16_f32 v97, v50, v51
    v_cvt_pk_bf16_f32 v98, v52, v53
    v_cvt_pk_bf16_f32 v99, v54, v55
    s_setprio 1
    v_mfma_f32_32x32x8_bf16 v[64:79], v[114:115], v[16:17], v[64:79]
    v_exp_f32 v56, v56
    v_exp_f32 v57, v57
    v_exp_f32 v58, v58
    v_exp_f32 v59, v59
    v_exp_f32 v60, v60
    s_setprio 0
    v_mfma_f32_32x32x16_bf16 v[80:95], v[116:119], v[96:99], v[80:95]
    v_exp_f32 v61, v61
    v_exp_f32 v62, v62
    v_exp_f32 v63, v63
    v_cvt_pk_bf16_f32 v100, v56, v57
    v_cvt_pk_bf16_f32 v101, v58, v59
    v_cvt_pk_bf16_f32 v102, v60, v61
    v_cvt_pk_bf16_f32 v103, v62, v63
    s_setprio 3
    s_waitcnt lgkmcnt(0)
    v_mfma_f32_32x32x16_bf16 v[48:63], v[104:107], v[12:15], v[32:47]
    ds_read_b128 v[108:111], v4 offset:38400
    ds_read_b32 v114, v7 offset:38400
    v_exp_f32 v64, v64
    v_exp_f32 v65, v65
    v_exp_f32 v66, v66
    v_exp_f32 v67, v67
    v_exp_f32 v68, v68
    s_setprio 2
    v_mfma_f32_32x32x16_bf16 v[80:95], v[120:123], v[100:103], v[80:95]
    s_mov_b64 exec, s[60:61]
    ds_read_b128 v[116:119], v10 offset:35840
    ds_read_b128 v[120:123], v10 offset:36480
    s_mov_b64 exec, -1
    v_exp_f32 v69, v69
    v_exp_f32 v70, v70
    v_exp_f32 v71, v71
    v_cvt_pk_bf16_f32 v96, v64, v65
    v_cvt_pk_bf16_f32 v97, v66, v67
    v_cvt_pk_bf16_f32 v98, v68, v69
    v_cvt_pk_bf16_f32 v99, v70, v71
    s_setprio 1
    v_mfma_f32_32x32x8_bf16 v[48:63], v[112:113], v[16:17], v[48:63]
    v_exp_f32 v72, v72
    v_exp_f32 v73, v73
    v_exp_f32 v74, v74
    v_exp_f32 v75, v75
    v_exp_f32 v76, v76
    s_setprio 0
    v_mfma_f32_32x32x16_bf16 v[80:95], v[124:127], v[96:99], v[80:95]
    v_exp_f32 v77, v77
    v_exp_f32 v78, v78
    v_exp_f32 v79, v79
    v_cvt_pk_bf16_f32 v100, v72, v73
    v_cvt_pk_bf16_f32 v101, v74, v75
    v_cvt_pk_bf16_f32 v102, v76, v77
    v_cvt_pk_bf16_f32 v103, v78, v79
    s_setprio 3
    s_waitcnt lgkmcnt(0)
    v_mfma_f32_32x32x16_bf16 v[64:79], v[108:111], v[12:15], v[32:47]
    ds_read_b128 v[104:107], v4 offset:40960
    ds_read_b32 v112, v7 offset:40960
    v_exp_f32 v48, v48
    v_exp_f32 v49, v49
    v_exp_f32 v50, v50
    v_exp_f32 v51, v51
    v_exp_f32 v52, v52
    s_setprio 2
    v_mfma_f32_32x32x16_bf16 v[80:95], v[128:131], v[100:103], v[80:95]
    s_mov_b64 exec, s[60:61]
    ds_read_b128 v[124:127], v10 offset:38400
    ds_read_b128 v[128:131], v10 offset:39040
    s_mov_b64 exec, -1
    v_exp_f32 v53, v53
    v_exp_f32 v54, v54
    v_exp_f32 v55, v55
    v_cvt_pk_bf16_f32 v96, v48, v49
    v_cvt_pk_bf16_f32 v97, v50, v51
    v_cvt_pk_bf16_f32 v98, v52, v53
    v_cvt_pk_bf16_f32 v99, v54, v55
    s_setprio 1
    v_mfma_f32_32x32x8_bf16 v[64:79], v[114:115], v[16:17], v[64:79]
    v_exp_f32 v56, v56
    v_exp_f32 v57, v57
    v_exp_f32 v58, v58
    v_exp_f32 v59, v59
    v_exp_f32 v60, v60
    s_setprio 0
    v_mfma_f32_32x32x16_bf16 v[80:95], v[116:119], v[96:99], v[80:95]
    s_mov_b32 s62, 19488768
    buffer_load_dword v21, v28, s[20:23], s62 offen sc1
    v_exp_f32 v61, v61
    v_exp_f32 v62, v62
    v_exp_f32 v63, v63
    v_cvt_pk_bf16_f32 v100, v56, v57
    v_cvt_pk_bf16_f32 v101, v58, v59
    v_cvt_pk_bf16_f32 v102, v60, v61
    v_cvt_pk_bf16_f32 v103, v62, v63
    s_setprio 3
    s_waitcnt lgkmcnt(0)
    v_mfma_f32_32x32x16_bf16 v[48:63], v[104:107], v[12:15], v[32:47]
    ds_read_b128 v[108:111], v4 offset:43520
    ds_read_b32 v114, v7 offset:43520
    v_exp_f32 v64, v64
    v_exp_f32 v65, v65
    v_exp_f32 v66, v66
    v_exp_f32 v67, v67
    v_exp_f32 v68, v68
    s_setprio 2
    v_mfma_f32_32x32x16_bf16 v[80:95], v[120:123], v[100:103], v[80:95]
    s_mov_b64 exec, s[60:61]
    ds_read_b128 v[116:119], v10 offset:40960
    ds_read_b128 v[120:123], v10 offset:41600
    s_mov_b64 exec, -1
    v_exp_f32 v69, v69
    v_exp_f32 v70, v70
    v_exp_f32 v71, v71
    v_cvt_pk_bf16_f32 v96, v64, v65
    v_cvt_pk_bf16_f32 v97, v66, v67
    v_cvt_pk_bf16_f32 v98, v68, v69
    v_cvt_pk_bf16_f32 v99, v70, v71
    s_setprio 1
    v_mfma_f32_32x32x8_bf16 v[48:63], v[112:113], v[16:17], v[48:63]
    v_exp_f32 v72, v72
    v_exp_f32 v73, v73
    v_exp_f32 v74, v74
    v_exp_f32 v75, v75
    v_exp_f32 v76, v76
    s_setprio 0
    v_mfma_f32_32x32x16_bf16 v[80:95], v[124:127], v[96:99], v[80:95]
    v_exp_f32 v77, v77
    v_exp_f32 v78, v78
    v_exp_f32 v79, v79
    v_cvt_pk_bf16_f32 v100, v72, v73
    v_cvt_pk_bf16_f32 v101, v74, v75
    v_cvt_pk_bf16_f32 v102, v76, v77
    v_cvt_pk_bf16_f32 v103, v78, v79
    s_setprio 3
    s_waitcnt lgkmcnt(0)
    v_mfma_f32_32x32x16_bf16 v[64:79], v[108:111], v[12:15], v[32:47]
    ds_read_b128 v[104:107], v4 offset:46080
    ds_read_b32 v112, v7 offset:46080
    v_exp_f32 v48, v48
    v_exp_f32 v49, v49
    v_exp_f32 v50, v50
    v_exp_f32 v51, v51
    v_exp_f32 v52, v52
    s_setprio 2
    v_mfma_f32_32x32x16_bf16 v[80:95], v[128:131], v[100:103], v[80:95]
    s_mov_b64 exec, s[60:61]
    ds_read_b128 v[124:127], v10 offset:43520
    ds_read_b128 v[128:131], v10 offset:44160
    s_mov_b64 exec, -1
    v_exp_f32 v53, v53
    v_exp_f32 v54, v54
    v_exp_f32 v55, v55
    v_cvt_pk_bf16_f32 v96, v48, v49
    v_cvt_pk_bf16_f32 v97, v50, v51
    v_cvt_pk_bf16_f32 v98, v52, v53
    v_cvt_pk_bf16_f32 v99, v54, v55
    s_setprio 1
    v_mfma_f32_32x32x8_bf16 v[64:79], v[114:115], v[16:17], v[64:79]
    v_exp_f32 v56, v56
    v_exp_f32 v57, v57
    v_exp_f32 v58, v58
    v_exp_f32 v59, v59
    v_exp_f32 v60, v60
    s_setprio 0
    v_mfma_f32_32x32x16_bf16 v[80:95], v[116:119], v[96:99], v[80:95]
    v_exp_f32 v61, v61
    v_exp_f32 v62, v62
    v_exp_f32 v63, v63
    v_cvt_pk_bf16_f32 v100, v56, v57
    v_cvt_pk_bf16_f32 v101, v58, v59
    v_cvt_pk_bf16_f32 v102, v60, v61
    v_cvt_pk_bf16_f32 v103, v62, v63
    s_waitcnt vmcnt(0)
    s_mov_b32 s51, 32768
    s_movk_i32 s63, 32
K2_PP_13:
    v_cmp_ne_u32 vcc, s63, v21
    s_cbranch_vccz K2_PPD_14
    s_sleep 8
    buffer_load_dword v21, v28, s[20:23], s62 offen sc1
    s_sub_u32 s51, s51, 1
    s_waitcnt vmcnt(0)
    s_cmp_lg_u32 s51, 0
    s_cbranch_scc1 K2_PP_13
K2_PPD_14:
    s_setprio 3
    s_waitcnt lgkmcnt(0)
    v_mfma_f32_32x32x16_bf16 v[48:63], v[104:107], v[12:15], v[32:47]
    ds_read_b128 v[108:111], v4 offset:48640
    ds_read_b32 v114, v7 offset:48640
    v_exp_f32 v64, v64
    v_exp_f32 v65, v65
    v_exp_f32 v66, v66
    v_exp_f32 v67, v67
    v_exp_f32 v68, v68
    s_setprio 2
    v_mfma_f32_32x32x16_bf16 v[80:95], v[120:123], v[100:103], v[80:95]
    s_mov_b64 exec, s[60:61]
    ds_read_b128 v[116:119], v10 offset:46080
    ds_read_b128 v[120:123], v10 offset:46720
    s_mov_b64 exec, -1
    v_exp_f32 v69, v69
    v_exp_f32 v70, v70
    v_exp_f32 v71, v71
    v_cvt_pk_bf16_f32 v96, v64, v65
    v_cvt_pk_bf16_f32 v97, v66, v67
    v_cvt_pk_bf16_f32 v98, v68, v69
    v_cvt_pk_bf16_f32 v99, v70, v71
    s_setprio 1
    v_mfma_f32_32x32x8_bf16 v[48:63], v[112:113], v[16:17], v[48:63]
    v_exp_f32 v72, v72
    v_exp_f32 v73, v73
    v_exp_f32 v74, v74
    v_exp_f32 v75, v75
    v_exp_f32 v76, v76
    s_setprio 0
    v_mfma_f32_32x32x16_bf16 v[80:95], v[124:127], v[96:99], v[80:95]
    s_mul_i32 s56, s42, 7
    s_min_u32 s56, s56, 47
    s_lshl_b32 s56, s56, 7
    s_lshl_b32 s57, s40, 8
    s_add_u32 s56, s56, s57
    s_add_u32 s56, s56, 47188480
    s_add_u32 s58, s57, 512
    s_and_b32 s57, s57, 256
    s_mul_i32 s59, s42, 320
    s_add_u32 s59, s59, s57
    s_add_u32 s59, s59, 47185920
    s_cmp_lt_u32 s40, 4
    s_cselect_b32 s56, s56, s59
    s_cselect_b32 s58, s58, s57
    v_lshrrev_b32 v30, 4, v1
    v_mul_u32_u24 v29, 9472, v30
    v_and_b32 v21, 15, v1
    v_lshl_add_u32 v29, v21, 4, v29
    v_bfe_u32 v22, v1, 4, 1
    v_lshl_add_u32 v22, v22, 1, v19
    v_lshl_add_u32 v30, v21, 2, v22
    v_lshl_add_u32 v30, v30, 2, s58
    buffer_load_dwordx4 v[132:135], v29, s[20:23], s56 offen sc1
    s_add_u32 s56, s56, 37888
    v_exp_f32 v77, v77
    v_exp_f32 v78, v78
    v_exp_f32 v79, v79
    v_cvt_pk_bf16_f32 v100, v72, v73
    v_cvt_pk_bf16_f32 v101, v74, v75
    v_cvt_pk_bf16_f32 v102, v76, v77
    v_cvt_pk_bf16_f32 v103, v78, v79
    s_setprio 3
    s_waitcnt lgkmcnt(0)
    v_mfma_f32_32x32x16_bf16 v[64:79], v[108:111], v[12:15], v[32:47]
    ds_read_b128 v[104:107], v4 offset:51200
    ds_read_b32 v112, v7 offset:51200
    s_mul_i32 s36, s40, 3
    s_add_u32 s36, s36, 0
    s_add_u32 s37, s40, 7
    s_cmp_lt_u32 s40, 4
    s_cselect_b32 s36, s36, s37
    s_cmp_ge_u32 s36, 20
    s_cselect_b32 s37, 20, 0
    s_cselect_b32 s38, 409600, 0
    s_sub_u32 s36, s36, s37
    s_sub_u32 s37, s36, 2
    s_lshr_b32 s37, s37, 2
    s_add_u32 s37, s37, s36
    s_sub_u32 s37, s37, 4
    s_mul_i32 s39, s36, 5
    s_add_u32 s39, s39, 2
    s_cmp_lt_u32 s36, 4
    s_cselect_b32 s36, s39, s37
    s_mul_i32 s36, s36, 20480
    s_add_u32 s36, s36, s38
    s_add_u32 s36, s36, 38158336
    s_add_u32 s37, s36, 4096
    buffer_load_dwordx4 v[152:155], v245, s[20:23], s36 offen offset:0 sc1
    v_exp_f32 v48, v48
    v_exp_f32 v49, v49
    v_exp_f32 v50, v50
    v_exp_f32 v51, v51
    v_exp_f32 v52, v52
    s_setprio 2
    v_mfma_f32_32x32x16_bf16 v[80:95], v[128:131], v[100:103], v[80:95]
    s_mov_b64 exec, s[60:61]
    ds_read_b128 v[124:127], v10 offset:48640
    ds_read_b128 v[128:131], v10 offset:49280
    s_mov_b64 exec, -1
    v_exp_f32 v53, v53
    v_exp_f32 v54, v54
    v_exp_f32 v55, v55
    v_cvt_pk_bf16_f32 v96, v48, v49
    v_cvt_pk_bf16_f32 v97, v50, v51
    v_cvt_pk_bf16_f32 v98, v52, v53
    v_cvt_pk_bf16_f32 v99, v54, v55
    s_setprio 1
    v_mfma_f32_32x32x8_bf16 v[64:79], v[114:115], v[16:17], v[64:79]
    v_exp_f32 v56, v56
    v_exp_f32 v57, v57
    v_exp_f32 v58, v58
    v_exp_f32 v59, v59
    v_exp_f32 v60, v60
    s_setprio 0
    v_mfma_f32_32x32x16_bf16 v[80:95], v[116:119], v[96:99], v[80:95]
    v_exp_f32 v61, v61
    v_exp_f32 v62, v62
    v_exp_f32 v63, v63
    v_cvt_pk_bf16_f32 v100, v56, v57
    v_cvt_pk_bf16_f32 v101, v58, v59
    v_cvt_pk_bf16_f32 v102, v60, v61
    v_cvt_pk_bf16_f32 v103, v62, v63
    s_setprio 3
    s_waitcnt lgkmcnt(0)
    v_mfma_f32_32x32x16_bf16 v[48:63], v[104:107], v[12:15], v[32:47]
    ds_read_b128 v[108:111], v4 offset:53760
    ds_read_b32 v114, v7 offset:53760
    buffer_load_dwordx4 v[156:159], v245, s[20:23], s36 offen offset:1024 sc1
    v_exp_f32 v64, v64
    v_exp_f32 v65, v65
    v_exp_f32 v66, v66
    v_exp_f32 v67, v67
    v_exp_f32 v68, v68
    s_setprio 2
    v_mfma_f32_32x32x16_bf16 v[80:95], v[120:123], v[100:103], v[80:95]
    s_mov_b64 exec, s[60:61]
    ds_read_b128 v[116:119], v10 offset:51200
    ds_read_b128 v[120:123], v10 offset:51840
    s_mov_b64 exec, -1
    v_exp_f32 v69, v69
    v_exp_f32 v70, v70
    v_exp_f32 v71, v71
    v_cvt_pk_bf16_f32 v96, v64, v65
    v_cvt_pk_bf16_f32 v97, v66, v67
    v_cvt_pk_bf16_f32 v98, v68, v69
    v_cvt_pk_bf16_f32 v99, v70, v71
    s_setprio 1
    v_mfma_f32_32x32x8_bf16 v[48:63], v[112:113], v[16:17], v[48:63]
    v_exp_f32 v72, v72
    v_exp_f32 v73, v73
    v_exp_f32 v74, v74
    v_exp_f32 v75, v75
    v_exp_f32 v76, v76
    s_setprio 0
    v_mfma_f32_32x32x16_bf16 v[80:95], v[124:127], v[96:99], v[80:95]
    buffer_load_dwordx4 v[136:139], v29, s[20:23], s56 offen sc1
    s_add_u32 s56, s56, 37888
    v_exp_f32 v77, v77
    v_exp_f32 v78, v78
    v_exp_f32 v79, v79
    v_cvt_pk_bf16_f32 v100, v72, v73
    v_cvt_pk_bf16_f32 v101, v74, v75
    v_cvt_pk_bf16_f32 v102, v76, v77
    v_cvt_pk_bf16_f32 v103, v78, v79
    s_barrier
    v_mov_b32 v21, 0
    v_and_b32 v22, 7, v1
    v_lshlrev_b32 v22, 2, v22
    ds_write_b32 v22, v21 offset:1536
    s_setprio 3
    s_waitcnt lgkmcnt(0)
    v_mfma_f32_32x32x16_bf16 v[64:79], v[108:111], v[12:15], v[32:47]
    ds_read_b128 v[104:107], v4 offset:56320
    ds_read_b32 v112, v7 offset:56320
    buffer_load_dwordx4 v[160:163], v245, s[20:23], s36 offen offset:2048 sc1
    v_exp_f32 v48, v48
    v_exp_f32 v49, v49
    v_exp_f32 v50, v50
    v_exp_f32 v51, v51
    v_exp_f32 v52, v52
    s_setprio 2
    v_mfma_f32_32x32x16_bf16 v[80:95], v[128:131], v[100:103], v[80:95]
    s_mov_b64 exec, s[60:61]
    ds_read_b128 v[124:127], v10 offset:53760
    ds_read_b128 v[128:131], v10 offset:54400
    s_mov_b64 exec, -1
    v_exp_f32 v53, v53
    v_exp_f32 v54, v54
    v_exp_f32 v55, v55
    v_cvt_pk_bf16_f32 v96, v48, v49
    v_cvt_pk_bf16_f32 v97, v50, v51
    v_cvt_pk_bf16_f32 v98, v52, v53
    v_cvt_pk_bf16_f32 v99, v54, v55
    s_setprio 1
    v_mfma_f32_32x32x8_bf16 v[64:79], v[114:115], v[16:17], v[64:79]
    s_add_u32 s52, s40, 0
    s_lshr_b32 s53, s52, 2
    s_add_u32 s53, s53, s52
    s_mul_i32 s53, s53, 5120
    s_add_u32 s53, s53, 2048
    s_mul_i32 s54, s52, 20480
    s_add_u32 s54, s54, 37748736
    s_mov_b32 m0, s53
    s_nop 0
    buffer_load_dwordx4 v245, s[20:23], s54 offen offset:0 sc1 lds
    v_exp_f32 v56, v56
    v_exp_f32 v57, v57
    v_exp_f32 v58, v58
    v_exp_f32 v59, v59
    v_exp_f32 v60, v60
    s_setprio 0
    v_mfma_f32_32x32x16_bf16 v[80:95], v[116:119], v[96:99], v[80:95]
    v_exp_f32 v61, v61
    v_exp_f32 v62, v62
    v_exp_f32 v63, v63
    v_cvt_pk_bf16_f32 v100, v56, v57
    v_cvt_pk_bf16_f32 v101, v58, v59
    v_cvt_pk_bf16_f32 v102, v60, v61
    v_cvt_pk_bf16_f32 v103, v62, v63
    s_setprio 3
    s_waitcnt lgkmcnt(0)
    v_mfma_f32_32x32x16_bf16 v[48:63], v[104:107], v[12:15], v[32:47]
    ds_read_b128 v[108:111], v4 offset:58880
    ds_read_b32 v114, v7 offset:58880
    buffer_load_dwordx4 v[164:167], v245, s[20:23], s36 offen offset:3072 sc1
    v_exp_f32 v64, v64
    v_exp_f32 v65, v65
    v_exp_f32 v66, v66
    v_exp_f32 v67, v67
    v_exp_f32 v68, v68
    s_setprio 2
    v_mfma_f32_32x32x16_bf16 v[80:95], v[120:123], v[100:103], v[80:95]
    s_mov_b64 exec, s[60:61]
    ds_read_b128 v[116:119], v10 offset:56320
    ds_read_b128 v[120:123], v10 offset:56960
    s_mov_b64 exec, -1
    v_exp_f32 v69, v69
    v_exp_f32 v70, v70
    v_exp_f32 v71, v71
    v_cvt_pk_bf16_f32 v96, v64, v65
    v_cvt_pk_bf16_f32 v97, v66, v67
    v_cvt_pk_bf16_f32 v98, v68, v69
    v_cvt_pk_bf16_f32 v99, v70, v71
    s_setprio 1
    v_mfma_f32_32x32x8_bf16 v[48:63], v[112:113], v[16:17], v[48:63]
    s_mov_b32 m0, s53
    s_nop 0
    buffer_load_dwordx4 v245, s[20:23], s54 offen offset:1024 sc1 lds
    v_exp_f32 v72, v72
    v_exp_f32 v73, v73
    v_exp_f32 v74, v74
    v_exp_f32 v75, v75
    v_exp_f32 v76, v76
    s_setprio 0
    v_mfma_f32_32x32x16_bf16 v[80:95], v[124:127], v[96:99], v[80:95]
    buffer_load_dwordx4 v[140:143], v29, s[20:23], s56 offen sc1
    s_add_u32 s56, s56, 37888
    v_exp_f32 v77, v77
    v_exp_f32 v78, v78
    v_exp_f32 v79, v79
    v_cvt_pk_bf16_f32 v100, v72, v73
    v_cvt_pk_bf16_f32 v101, v74, v75
    v_cvt_pk_bf16_f32 v102, v76, v77
    v_cvt_pk_bf16_f32 v103, v78, v79
    s_setprio 3
    s_waitcnt lgkmcnt(0)
    v_mfma_f32_32x32x16_bf16 v[64:79], v[108:111], v[12:15], v[32:47]
    ds_read_b128 v[104:107], v5 offset:0
    ds_read_b32 v112, v8 offset:0
    buffer_load_dwordx4 v[168:171], v245, s[20:23], s37 offen offset:0 sc1
    v_exp_f32 v48, v48
    v_exp_f32 v49, v49
    v_exp_f32 v50, v50
    v_exp_f32 v51, v51
    v_exp_f32 v52, v52
    s_setprio 2
    v_mfma_f32_32x32x16_bf16 v[80:95], v[128:131], v[100:103], v[80:95]
    s_mov_b64 exec, s[60:61]
    ds_read_b128 v[124:127], v10 offset:58880
    ds_read_b128 v[128:131], v10 offset:59520
    s_mov_b64 exec, -1
    v_exp_f32 v53, v53
    v_exp_f32 v54, v54
    v_exp_f32 v55, v55
    v_cvt_pk_bf16_f32 v96, v48, v49
    v_cvt_pk_bf16_f32 v97, v50, v51
    v_cvt_pk_bf16_f32 v98, v52, v53
    v_cvt_pk_bf16_f32 v99, v54, v55
    s_setprio 1
    v_mfma_f32_32x32x8_bf16 v[64:79], v[114:115], v[16:17], v[64:79]
    s_mov_b32 m0, s53
    s_nop 0
    buffer_load_dwordx4 v245, s[20:23], s54 offen offset:2048 sc1 lds
    v_exp_f32 v56, v56
    v_exp_f32 v57, v57
    v_exp_f32 v58, v58
    v_exp_f32 v59, v59
    v_exp_f32 v60, v60
    s_setprio 0
    v_mfma_f32_32x32x16_bf16 v[80:95], v[116:119], v[96:99], v[80:95]
    v_exp_f32 v61, v61
    v_exp_f32 v62, v62
    v_exp_f32 v63, v63
    v_cvt_pk_bf16_f32 v100, v56, v57
    v_cvt_pk_bf16_f32 v101, v58, v59
    v_cvt_pk_bf16_f32 v102, v60, v61
    v_cvt_pk_bf16_f32 v103, v62, v63
    s_setprio 3
    s_waitcnt lgkmcnt(0)
    v_mfma_f32_32x32x16_bf16 v[48:63], v[104:107], v[12:15], v[32:47]
    ds_read_b128 v[108:111], v5 offset:2560
    ds_read_b32 v114, v8 offset:2560
    s_mul_i32 s36, s40, 3
    s_add_u32 s36, s36, 1
    s_add_u32 s37, s40, 11
    s_cmp_lt_u32 s40, 4
    s_cselect_b32 s36, s36, s37
    s_cmp_ge_u32 s36, 20
    s_cselect_b32 s37, 20, 0
    s_cselect_b32 s38, 409600, 0
    s_sub_u32 s36, s36, s37
    s_sub_u32 s37, s36, 2
    s_lshr_b32 s37, s37, 2
    s_add_u32 s37, s37, s36
    s_sub_u32 s37, s37, 4
    s_mul_i32 s39, s36, 5
    s_add_u32 s39, s39, 2
    s_cmp_lt_u32 s36, 4
    s_cselect_b32 s36, s39, s37
    s_mul_i32 s36, s36, 20480
    s_add_u32 s36, s36, s38
    s_add_u32 s36, s36, 38158336
    s_add_u32 s37, s36, 4096
    buffer_load_dwordx4 v[172:175], v245, s[20:23], s36 offen offset:0 sc1
    v_exp_f32 v64, v64
    v_exp_f32 v65, v65
    v_exp_f32 v66, v66
    v_exp_f32 v67, v67
    v_exp_f32 v68, v68
    s_setprio 2
    v_mfma_f32_32x32x16_bf16 v[80:95], v[120:123], v[100:103], v[80:95]
    s_mov_b64 exec, s[60:61]
    ds_read_b128 v[116:119], v11 offset:0
    ds_read_b128 v[120:123], v11 offset:640
    s_mov_b64 exec, -1
    v_exp_f32 v69, v69
    v_exp_f32 v70, v70
    v_exp_f32 v71, v71
    v_cvt_pk_bf16_f32 v96, v64, v65
    v_cvt_pk_bf16_f32 v97, v66, v67
    v_cvt_pk_bf16_f32 v98, v68, v69
    v_cvt_pk_bf16_f32 v99, v70, v71
    s_setprio 1
    v_mfma_f32_32x32x8_bf16 v[48:63], v[112:113], v[16:17], v[48:63]
    s_mov_b32 m0, s53
    s_nop 0
    buffer_load_dwordx4 v245, s[20:23], s54 offen offset:3072 sc1 lds
    v_exp_f32 v72, v72
    v_exp_f32 v73, v73
    v_exp_f32 v74, v74
    v_exp_f32 v75, v75
    v_exp_f32 v76, v76
    s_setprio 0
    v_mfma_f32_32x32x16_bf16 v[80:95], v[124:127], v[96:99], v[80:95]
    buffer_load_dwordx4 v[144:147], v29, s[20:23], s56 offen sc1
    s_add_u32 s56, s56, 37888
    v_exp_f32 v77, v77
    v_exp_f32 v78, v78
    v_exp_f32 v79, v79
    v_cvt_pk_bf16_f32 v100, v72, v73
    v_cvt_pk_bf16_f32 v101, v74, v75
    v_cvt_pk_bf16_f32 v102, v76, v77
    v_cvt_pk_bf16_f32 v103, v78, v79
    s_setprio 3
    s_waitcnt lgkmcnt(0)
    v_mfma_f32_32x32x16_bf16 v[64:79], v[108:111], v[12:15], v[32:47]
    ds_read_b128 v[104:107], v5 offset:5120
    ds_read_b32 v112, v8 offset:5120
    buffer_load_dwordx4 v[176:179], v245, s[20:23], s36 offen offset:1024 sc1
    v_exp_f32 v48, v48
    v_exp_f32 v49, v49
    v_exp_f32 v50, v50
    v_exp_f32 v51, v51
    v_exp_f32 v52, v52
    s_setprio 2
    v_mfma_f32_32x32x16_bf16 v[80:95], v[128:131], v[100:103], v[80:95]
    s_mov_b64 exec, s[60:61]
    ds_read_b128 v[124:127], v11 offset:2560
    ds_read_b128 v[128:131], v11 offset:3200
    s_mov_b64 exec, -1
    v_exp_f32 v53, v53
    v_exp_f32 v54, v54
    v_exp_f32 v55, v55
    v_cvt_pk_bf16_f32 v96, v48, v49
    v_cvt_pk_bf16_f32 v97, v50, v51
    v_cvt_pk_bf16_f32 v98, v52, v53
    v_cvt_pk_bf16_f32 v99, v54, v55
    s_setprio 1
    v_mfma_f32_32x32x8_bf16 v[64:79], v[114:115], v[16:17], v[64:79]
    s_add_u32 m0, s53, 4096
    s_add_u32 s54, s54, 4096
    buffer_load_dwordx4 v245, s[20:23], s54 offen sc1 lds
    v_exp_f32 v56, v56
    v_exp_f32 v57, v57
    v_exp_f32 v58, v58
    v_exp_f32 v59, v59
    v_exp_f32 v60, v60
    s_setprio 0
    v_mfma_f32_32x32x16_bf16 v[80:95], v[116:119], v[96:99], v[80:95]
    v_exp_f32 v61, v61
    v_exp_f32 v62, v62
    v_exp_f32 v63, v63
    v_cvt_pk_bf16_f32 v100, v56, v57
    v_cvt_pk_bf16_f32 v101, v58, v59
    v_cvt_pk_bf16_f32 v102, v60, v61
    v_cvt_pk_bf16_f32 v103, v62, v63
    s_setprio 3
    s_waitcnt lgkmcnt(0)
    v_mfma_f32_32x32x16_bf16 v[48:63], v[104:107], v[12:15], v[32:47]
    ds_read_b128 v[108:111], v5 offset:7680
    ds_read_b32 v114, v8 offset:7680
    buffer_load_dwordx4 v[180:183], v245, s[20:23], s36 offen offset:2048 sc1
    v_exp_f32 v64, v64
    v_exp_f32 v65, v65
    v_exp_f32 v66, v66
    v_exp_f32 v67, v67
    v_exp_f32 v68, v68
    s_setprio 2
    v_mfma_f32_32x32x16_bf16 v[80:95], v[120:123], v[100:103], v[80:95]
    s_mov_b64 exec, s[60:61]
    ds_read_b128 v[116:119], v11 offset:5120
    ds_read_b128 v[120:123], v11 offset:5760
    s_mov_b64 exec, -1
    v_exp_f32 v69, v69
    v_exp_f32 v70, v70
    v_exp_f32 v71, v71
    v_cvt_pk_bf16_f32 v96, v64, v65
    v_cvt_pk_bf16_f32 v97, v66, v67
    v_cvt_pk_bf16_f32 v98, v68, v69
    v_cvt_pk_bf16_f32 v99, v70, v71
    s_setprio 1
    v_mfma_f32_32x32x8_bf16 v[48:63], v[112:113], v[16:17], v[48:63]
    s_add_u32 s52, s40, 8
    s_lshr_b32 s53, s52, 2
    s_add_u32 s53, s53, s52
    s_mul_i32 s53, s53, 5120
    s_add_u32 s53, s53, 2048
    s_mul_i32 s54, s52, 20480
    s_add_u32 s54, s54, 37748736
    s_mov_b32 m0, s53
    s_nop 0
    buffer_load_dwordx4 v245, s[20:23], s54 offen offset:0 sc1 lds
    v_exp_f32 v72, v72
    v_exp_f32 v73, v73
    v_exp_f32 v74, v74
    v_exp_f32 v75, v75
    v_exp_f32 v76, v76
    s_setprio 0
    v_mfma_f32_32x32x16_bf16 v[80:95], v[124:127], v[96:99], v[80:95]
    buffer_load_dwordx4 v[148:151], v29, s[20:23], s56 offen sc1
    s_add_u32 s56, s56, 37888
    v_exp_f32 v77, v77
    v_exp_f32 v78, v78
    v_exp_f32 v79, v79
    v_cvt_pk_bf16_f32 v100, v72, v73
    v_cvt_pk_bf16_f32 v101, v74, v75
    v_cvt_pk_bf16_f32 v102, v76, v77
    v_cvt_pk_bf16_f32 v103, v78, v79
    s_setprio 3
    s_waitcnt lgkmcnt(0)
    v_mfma_f32_32x32x16_bf16 v[64:79], v[108:111], v[12:15], v[32:47]
    ds_read_b128 v[104:107], v5 offset:10240
    ds_read_b32 v112, v8 offset:10240
    buffer_load_dwordx4 v[184:187], v245, s[20:23], s36 offen offset:3072 sc1
    v_exp_f32 v48, v48
    v_exp_f32 v49, v49
    v_exp_f32 v50, v50
    v_exp_f32 v51, v51
    v_exp_f32 v52, v52
    s_setprio 2
    v_mfma_f32_32x32x16_bf16 v[80:95], v[128:131], v[100:103], v[80:95]
    s_mov_b64 exec, s[60:61]
    ds_read_b128 v[124:127], v11 offset:7680
    ds_read_b128 v[128:131], v11 offset:8320
    s_mov_b64 exec, -1
    v_exp_f32 v53, v53
    v_exp_f32 v54, v54
    v_exp_f32 v55, v55
    v_cvt_pk_bf16_f32 v96, v48, v49
    v_cvt_pk_bf16_f32 v97, v50, v51
    v_cvt_pk_bf16_f32 v98, v52, v53
    v_cvt_pk_bf16_f32 v99, v54, v55
    s_setprio 1
    v_mfma_f32_32x32x8_bf16 v[64:79], v[114:115], v[16:17], v[64:79]
    s_mov_b32 m0, s53
    s_nop 0
    buffer_load_dwordx4 v245, s[20:23], s54 offen offset:1024 sc1 lds
    v_exp_f32 v56, v56
    v_exp_f32 v57, v57
    v_exp_f32 v58, v58
    v_exp_f32 v59, v59
    v_exp_f32 v60, v60
    s_setprio 0
    v_mfma_f32_32x32x16_bf16 v[80:95], v[116:119], v[96:99], v[80:95]
    v_exp_f32 v61, v61
    v_exp_f32 v62, v62
    v_exp_f32 v63, v63
    v_cvt_pk_bf16_f32 v100, v56, v57
    v_cvt_pk_bf16_f32 v101, v58, v59
    v_cvt_pk_bf16_f32 v102, v60, v61
    v_cvt_pk_bf16_f32 v103, v62, v63
    s_setprio 3
    s_waitcnt lgkmcnt(0)
    v_mfma_f32_32x32x16_bf16 v[48:63], v[104:107], v[12:15], v[32:47]
    ds_read_b128 v[108:111], v5 offset:12800
    ds_read_b32 v114, v8 offset:12800
    buffer_load_dwordx4 v[188:191], v245, s[20:23], s37 offen offset:0 sc1
    v_exp_f32 v64, v64
    v_exp_f32 v65, v65
    v_exp_f32 v66, v66
    v_exp_f32 v67, v67
    v_exp_f32 v68, v68
    s_setprio 2
    v_mfma_f32_32x32x16_bf16 v[80:95], v[120:123], v[100:103], v[80:95]
    s_mov_b64 exec, s[60:61]
    ds_read_b128 v[116:119], v11 offset:10240
    ds_read_b128 v[120:123], v11 offset:10880
    s_mov_b64 exec, -1
    v_exp_f32 v69, v69
    v_exp_f32 v70, v70
    v_exp_f32 v71, v71
    v_cvt_pk_bf16_f32 v96, v64, v65
    v_cvt_pk_bf16_f32 v97, v66, v67
    v_cvt_pk_bf16_f32 v98, v68, v69
    v_cvt_pk_bf16_f32 v99, v70, v71
    s_setprio 1
    v_mfma_f32_32x32x8_bf16 v[48:63], v[112:113], v[16:17], v[48:63]
    s_mov_b32 m0, s53
    s_nop 0
    buffer_load_dwordx4 v245, s[20:23], s54 offen offset:2048 sc1 lds
    v_exp_f32 v72, v72
    v_exp_f32 v73, v73
    v_exp_f32 v74, v74
    v_exp_f32 v75, v75
    v_exp_f32 v76, v76
    s_setprio 0
    v_mfma_f32_32x32x16_bf16 v[80:95], v[124:127], v[96:99], v[80:95]
    v_exp_f32 v77, v77
    v_exp_f32 v78, v78
    v_exp_f32 v79, v79
    v_cvt_pk_bf16_f32 v100, v72, v73
    v_cvt_pk_bf16_f32 v101, v74, v75
    v_cvt_pk_bf16_f32 v102, v76, v77
    v_cvt_pk_bf16_f32 v103, v78, v79
    s_setprio 3
    s_waitcnt lgkmcnt(0)
    v_mfma_f32_32x32x16_bf16 v[64:79], v[108:111], v[12:15], v[32:47]
    ds_read_b128 v[104:107], v5 offset:15360
    ds_read_b32 v112, v8 offset:15360
    s_mul_i32 s36, s40, 3
    s_add_u32 s36, s36, 2
    s_add_u32 s37, s40, 15
    s_cmp_lt_u32 s40, 4
    s_cselect_b32 s36, s36, s37
    s_cmp_ge_u32 s36, 20
    s_cselect_b32 s37, 20, 0
    s_cselect_b32 s38, 409600, 0
    s_sub_u32 s36, s36, s37
    s_sub_u32 s37, s36, 2
    s_lshr_b32 s37, s37, 2
    s_add_u32 s37, s37, s36
    s_sub_u32 s37, s37, 4
    s_mul_i32 s39, s36, 5
    s_add_u32 s39, s39, 2
    s_cmp_lt_u32 s36, 4
    s_cselect_b32 s36, s39, s37
    s_mul_i32 s36, s36, 20480
    s_add_u32 s36, s36, s38
    s_add_u32 s36, s36, 38158336
    s_add_u32 s37, s36, 4096
    buffer_load_dwordx4 v[192:195], v245, s[20:23], s36 offen offset:0 sc1
    v_exp_f32 v48, v48
    v_exp_f32 v49, v49
    v_exp_f32 v50, v50
    v_exp_f32 v51, v51
    v_exp_f32 v52, v52
    s_setprio 2
    v_mfma_f32_32x32x16_bf16 v[80:95], v[128:131], v[100:103], v[80:95]
    s_mov_b64 exec, s[60:61]
    ds_read_b128 v[124:127], v11 offset:12800
    ds_read_b128 v[128:131], v11 offset:13440
    s_mov_b64 exec, -1
    v_exp_f32 v53, v53
    v_exp_f32 v54, v54
    v_exp_f32 v55, v55
    v_cvt_pk_bf16_f32 v96, v48, v49
    v_cvt_pk_bf16_f32 v97, v50, v51
    v_cvt_pk_bf16_f32 v98, v52, v53
    v_cvt_pk_bf16_f32 v99, v54, v55
    s_setprio 1
    v_mfma_f32_32x32x8_bf16 v[64:79], v[114:115], v[16:17], v[64:79]
    s_mov_b32 m0, s53
    s_nop 0
    buffer_load_dwordx4 v245, s[20:23], s54 offen offset:3072 sc1 lds
    v_exp_f32 v56, v56
    v_exp_f32 v57, v57
    v_exp_f32 v58, v58
    v_exp_f32 v59, v59
    v_exp_f32 v60, v60
    s_setprio 0
    v_mfma_f32_32x32x16_bf16 v[80:95], v[116:119], v[96:99], v[80:95]
    v_exp_f32 v61, v61
    v_exp_f32 v62, v62
    v_exp_f32 v63, v63
    v_cvt_pk_bf16_f32 v100, v56, v57
    v_cvt_pk_bf16_f32 v101, v58, v59
    v_cvt_pk_bf16_f32 v102, v60, v61
    v_cvt_pk_bf16_f32 v103, v62, v63
    s_setprio 3
    s_waitcnt lgkmcnt(0)
    v_mfma_f32_32x32x16_bf16 v[48:63], v[104:107], v[12:15], v[32:47]
    ds_read_b128 v[108:111], v5 offset:17920
    ds_read_b32 v114, v8 offset:17920
    buffer_load_dwordx4 v[196:199], v245, s[20:23], s36 offen offset:1024 sc1
    v_exp_f32 v64, v64
    v_exp_f32 v65, v65
    v_exp_f32 v66, v66
    v_exp_f32 v67, v67
    v_exp_f32 v68, v68
    s_setprio 2
    v_mfma_f32_32x32x16_bf16 v[80:95], v[120:123], v[100:103], v[80:95]
    s_mov_b64 exec, s[60:61]
    ds_read_b128 v[116:119], v11 offset:15360
    ds_read_b128 v[120:123], v11 offset:16000
    s_mov_b64 exec, -1
    v_exp_f32 v69, v69
    v_exp_f32 v70, v70
    v_exp_f32 v71, v71
    v_cvt_pk_bf16_f32 v96, v64, v65
    v_cvt_pk_bf16_f32 v97, v66, v67
    v_cvt_pk_bf16_f32 v98, v68, v69
    v_cvt_pk_bf16_f32 v99, v70, v71
    s_setprio 1
    v_mfma_f32_32x32x8_bf16 v[48:63], v[112:113], v[16:17], v[48:63]
    s_add_u32 m0, s53, 4096
    s_add_u32 s54, s54, 4096
    buffer_load_dwordx4 v245, s[20:23], s54 offen sc1 lds
    v_exp_f32 v72, v72
    v_exp_f32 v73, v73
    v_exp_f32 v74, v74
    v_exp_f32 v75, v75
    v_exp_f32 v76, v76
    s_setprio 0
    v_mfma_f32_32x32x16_bf16 v[80:95], v[124:127], v[96:99], v[80:95]
    v_exp_f32 v77, v77
    v_exp_f32 v78, v78
    v_exp_f32 v79, v79
    v_cvt_pk_bf16_f32 v100, v72, v73
    v_cvt_pk_bf16_f32 v101, v74, v75
    v_cvt_pk_bf16_f32 v102, v76, v77
    v_cvt_pk_bf16_f32 v103, v78, v79
    s_setprio 3
    s_waitcnt lgkmcnt(0)
    v_mfma_f32_32x32x16_bf16 v[64:79], v[108:111], v[12:15], v[32:47]
    ds_read_b128 v[104:107], v5 offset:20480
    ds_read_b32 v112, v8 offset:20480
    buffer_load_dwordx4 v[200:203], v245, s[20:23], s36 offen offset:2048 sc1
    v_exp_f32 v48, v48
    v_exp_f32 v49, v49
    v_exp_f32 v50, v50
    v_exp_f32 v51, v51
    v_exp_f32 v52, v52
    s_setprio 2
    v_mfma_f32_32x32x16_bf16 v[80:95], v[128:131], v[100:103], v[80:95]
    s_mov_b64 exec, s[60:61]
    ds_read_b128 v[124:127], v11 offset:17920
    ds_read_b128 v[128:131], v11 offset:18560
    s_mov_b64 exec, -1
    v_exp_f32 v53, v53
    v_exp_f32 v54, v54
    v_exp_f32 v55, v55
    v_cvt_pk_bf16_f32 v96, v48, v49
    v_cvt_pk_bf16_f32 v97, v50, v51
    v_cvt_pk_bf16_f32 v98, v52, v53
    v_cvt_pk_bf16_f32 v99, v54, v55
    s_setprio 1
    v_mfma_f32_32x32x8_bf16 v[64:79], v[114:115], v[16:17], v[64:79]
    s_add_u32 s52, s40, 16
    s_cmp_lt_u32 s52, 20
    s_cselect_b32 s52, s52, s40
    s_mul_i32 s55, s40, 5
    s_add_u32 s55, s55, 4
    s_lshr_b32 s53, s40, 2
    s_add_u32 s53, s53, s40
    s_cmp_lt_u32 s40, 4
    s_cselect_b32 s53, s55, s53
    s_mul_i32 s53, s53, 5120
    s_add_u32 s53, s53, 2048
    s_mul_i32 s54, s52, 20480
    s_add_u32 s54, s54, 37748736
    s_cmp_ge_u32 s40, 4
    s_cbranch_scc1 K2_WO_15
    s_mov_b32 m0, s53
    s_nop 0
    buffer_load_dwordx4 v245, s[20:23], s54 offen offset:0 sc1 lds
K2_WO_15:
    v_exp_f32 v56, v56
    v_exp_f32 v57, v57
    v_exp_f32 v58, v58
    v_exp_f32 v59, v59
    v_exp_f32 v60, v60
    s_setprio 0
    v_mfma_f32_32x32x16_bf16 v[80:95], v[116:119], v[96:99], v[80:95]
    v_exp_f32 v61, v61
    v_exp_f32 v62, v62
    v_exp_f32 v63, v63
    v_cvt_pk_bf16_f32 v100, v56, v57
    v_cvt_pk_bf16_f32 v101, v58, v59
    v_cvt_pk_bf16_f32 v102, v60, v61
    v_cvt_pk_bf16_f32 v103, v62, v63
    s_setprio 3
    s_waitcnt lgkmcnt(0)
    v_mfma_f32_32x32x16_bf16 v[48:63], v[104:107], v[12:15], v[32:47]
    ds_read_b128 v[108:111], v5 offset:23040
    ds_read_b32 v114, v8 offset:23040
    buffer_load_dwordx4 v[204:207], v245, s[20:23], s36 offen offset:3072 sc1
    v_exp_f32 v64, v64
    v_exp_f32 v65, v65
    v_exp_f32 v66, v66
    v_exp_f32 v67, v67
    v_exp_f32 v68, v68
    s_setprio 2
    v_mfma_f32_32x32x16_bf16 v[80:95], v[120:123], v[100:103], v[80:95]
    s_mov_b64 exec, s[60:61]
    ds_read_b128 v[116:119], v11 offset:20480
    ds_read_b128 v[120:123], v11 offset:21120
    s_mov_b64 exec, -1
    v_exp_f32 v69, v69
    v_exp_f32 v70, v70
    v_exp_f32 v71, v71
    v_cvt_pk_bf16_f32 v96, v64, v65
    v_cvt_pk_bf16_f32 v97, v66, v67
    v_cvt_pk_bf16_f32 v98, v68, v69
    v_cvt_pk_bf16_f32 v99, v70, v71
    s_setprio 1
    v_mfma_f32_32x32x8_bf16 v[48:63], v[112:113], v[16:17], v[48:63]
    s_cmp_ge_u32 s40, 4
    s_cbranch_scc1 K2_WO_16
    s_mov_b32 m0, s53
    s_nop 0
    buffer_load_dwordx4 v245, s[20:23], s54 offen offset:1024 sc1 lds
K2_WO_16:
    v_exp_f32 v72, v72
    v_exp_f32 v73, v73
    v_exp_f32 v74, v74
    v_exp_f32 v75, v75
    v_exp_f32 v76, v76
    s_setprio 0
    v_mfma_f32_32x32x16_bf16 v[80:95], v[124:127], v[96:99], v[80:95]
    s_waitcnt vmcnt(10)
    v_add_f32 v132, v132, v136
    v_add_f32 v133, v133, v137
    v_add_f32 v134, v134, v138
    v_add_f32 v135, v135, v139
    v_add_f32 v132, v132, v140
    v_add_f32 v133, v133, v141
    v_add_f32 v134, v134, v142
    v_add_f32 v135, v135, v143
    v_add_f32 v132, v132, v144
    v_add_f32 v133, v133, v145
    v_add_f32 v134, v134, v146
    v_add_f32 v135, v135, v147
    v_add_f32 v132, v132, v148
    v_add_f32 v133, v133, v149
    v_add_f32 v134, v134, v150
    v_add_f32 v135, v135, v151
    v_exp_f32 v77, v77
    v_exp_f32 v78, v78
    v_exp_f32 v79, v79
    v_cvt_pk_bf16_f32 v100, v72, v73
    v_cvt_pk_bf16_f32 v101, v74, v75
    v_cvt_pk_bf16_f32 v102, v76, v77
    v_cvt_pk_bf16_f32 v103, v78, v79
    s_setprio 3
    s_waitcnt lgkmcnt(0)
    v_mfma_f32_32x32x16_bf16 v[64:79], v[108:111], v[12:15], v[32:47]
    ds_read_b128 v[104:107], v5 offset:25600
    ds_read_b32 v112, v8 offset:25600
    buffer_load_dwordx4 v[208:211], v245, s[20:23], s37 offen offset:0 sc1
    v_exp_f32 v48, v48
    v_exp_f32 v49, v49
    v_exp_f32 v50, v50
    v_exp_f32 v51, v51
    v_exp_f32 v52, v52
    s_setprio 2
    v_mfma_f32_32x32x16_bf16 v[80:95], v[128:131], v[100:103], v[80:95]
    s_mov_b64 exec, s[60:61]
    ds_read_b128 v[124:127], v11 offset:23040
    ds_read_b128 v[128:131], v11 offset:23680
    s_mov_b64 exec, -1
    v_exp_f32 v53, v53
    v_exp_f32 v54, v54
    v_exp_f32 v55, v55
    v_cvt_pk_bf16_f32 v96, v48, v49
    v_cvt_pk_bf16_f32 v97, v50, v51
    v_cvt_pk_bf16_f32 v98, v52, v53
    v_cvt_pk_bf16_f32 v99, v54, v55
    s_setprio 1
    v_mfma_f32_32x32x8_bf16 v[64:79], v[114:115], v[16:17], v[64:79]
    s_cmp_ge_u32 s40, 4
    s_cbranch_scc1 K2_WO_17
    s_mov_b32 m0, s53
    s_nop 0
    buffer_load_dwordx4 v245, s[20:23], s54 offen offset:2048 sc1 lds
K2_WO_17:
    v_exp_f32 v56, v56
    v_exp_f32 v57, v57
    v_exp_f32 v58, v58
    v_exp_f32 v59, v59
    v_exp_f32 v60, v60
    s_setprio 0
    v_mfma_f32_32x32x16_bf16 v[80:95], v[116:119], v[96:99], v[80:95]
    v_permlane32_swap_b32 v132, v133
    v_permlane32_swap_b32 v134, v135
    v_add_f32 v132, v132, v133
    v_add_f32 v134, v134, v135
    s_nop 1
    v_permlane16_swap_b32 v132, v134
    v_add_f32 v132, v132, v134
    ds_write_b32 v30, v132
    v_exp_f32 v61, v61
    v_exp_f32 v62, v62
    v_exp_f32 v63, v63
    v_cvt_pk_bf16_f32 v100, v56, v57
    v_cvt_pk_bf16_f32 v101, v58, v59
    v_cvt_pk_bf16_f32 v102, v60, v61
    v_cvt_pk_bf16_f32 v103, v62, v63
    s_setprio 3
    s_waitcnt lgkmcnt(0)
    v_mfma_f32_32x32x16_bf16 v[48:63], v[104:107], v[12:15], v[32:47]
    ds_read_b128 v[108:111], v5 offset:28160
    ds_read_b32 v114, v8 offset:28160
    s_mul_i32 s36, s40, 3
    s_add_u32 s36, s36, 2
    s_add_u32 s37, s40, 19
    s_cmp_lt_u32 s40, 4
    s_cselect_b32 s36, s36, s37
    s_cmp_ge_u32 s36, 20
    s_cselect_b32 s37, 20, 0
    s_cselect_b32 s38, 409600, 0
    s_sub_u32 s36, s36, s37
    s_sub_u32 s37, s36, 2
    s_lshr_b32 s37, s37, 2
    s_add_u32 s37, s37, s36
    s_sub_u32 s37, s37, 4
    s_mul_i32 s39, s36, 5
    s_add_u32 s39, s39, 2
    s_cmp_lt_u32 s36, 4
    s_cselect_b32 s36, s39, s37
    s_mul_i32 s36, s36, 20480
    s_add_u32 s36, s36, s38
    s_add_u32 s36, s36, 38158336
    s_add_u32 s37, s36, 4096
    s_cmp_lt_u32 s40, 4
    s_cbranch_scc1 K2_WR_18
    buffer_load_dwordx4 v[212:215], v245, s[20:23], s36 offen offset:0 sc1
K2_WR_18:
    v_exp_f32 v64, v64
    v_exp_f32 v65, v65
    v_exp_f32 v66, v66
    v_exp_f32 v67, v67
    v_exp_f32 v68, v68
    s_setprio 2
    v_mfma_f32_32x32x16_bf16 v[80:95], v[120:123], v[100:103], v[80:95]
    s_mov_b64 exec, s[60:61]
    ds_read_b128 v[116:119], v11 offset:25600
    ds_read_b128 v[120:123], v11 offset:26240
    s_mov_b64 exec, -1
    v_exp_f32 v69, v69
    v_exp_f32 v70, v70
    v_exp_f32 v71, v71
    v_cvt_pk_bf16_f32 v96, v64, v65
    v_cvt_pk_bf16_f32 v97, v66, v67
    v_cvt_pk_bf16_f32 v98, v68, v69
    v_cvt_pk_bf16_f32 v99, v70, v71
    s_setprio 1
    v_mfma_f32_32x32x8_bf16 v[48:63], v[112:113], v[16:17], v[48:63]
    s_cmp_ge_u32 s40, 4
    s_cbranch_scc1 K2_WO_19
    s_mov_b32 m0, s53
    s_nop 0
    buffer_load_dwordx4 v245, s[20:23], s54 offen offset:3072 sc1 lds
K2_WO_19:
    v_exp_f32 v72, v72
    v_exp_f32 v73, v73
    v_exp_f32 v74, v74
    v_exp_f32 v75, v75
    v_exp_f32 v76, v76
    s_setprio 0
    v_mfma_f32_32x32x16_bf16 v[80:95], v[124:127], v[96:99], v[80:95]
    v_exp_f32 v77, v77
    v_exp_f32 v78, v78
    v_exp_f32 v79, v79
    v_cvt_pk_bf16_f32 v100, v72, v73
    v_cvt_pk_bf16_f32 v101, v74, v75
    v_cvt_pk_bf16_f32 v102, v76, v77
    v_cvt_pk_bf16_f32 v103, v78, v79
    s_setprio 3
    s_waitcnt lgkmcnt(0)
    v_mfma_f32_32x32x16_bf16 v[64:79], v[108:111], v[12:15], v[32:47]
    ds_read_b128 v[104:107], v5 offset:30720
    ds_read_b32 v112, v8 offset:30720
    s_cmp_lt_u32 s40, 4
    s_cbranch_scc1 K2_WR_20
    buffer_load_dwordx4 v[216:219], v245, s[20:23], s36 offen offset:1024 sc1
K2_WR_20:
    v_exp_f32 v48, v48
    v_exp_f32 v49, v49
    v_exp_f32 v50, v50
    v_exp_f32 v51, v51
    v_exp_f32 v52, v52
    s_setprio 2
    v_mfma_f32_32x32x16_bf16 v[80:95], v[128:131], v[100:103], v[80:95]
    s_mov_b64 exec, s[60:61]
    ds_read_b128 v[124:127], v11 offset:28160
    ds_read_b128 v[128:131], v11 offset:28800
    s_mov_b64 exec, -1
    v_exp_f32 v53, v53
    v_exp_f32 v54, v54
    v_exp_f32 v55, v55
    v_cvt_pk_bf16_f32 v96, v48, v49
    v_cvt_pk_bf16_f32 v97, v50, v51
    v_cvt_pk_bf16_f32 v98, v52, v53
    v_cvt_pk_bf16_f32 v99, v54, v55
    s_setprio 1
    v_mfma_f32_32x32x8_bf16 v[64:79], v[114:115], v[16:17], v[64:79]
    s_cmp_ge_u32 s40, 4
    s_cbranch_scc1 K2_WO_21
    s_add_u32 m0, s53, 4096
    s_add_u32 s54, s54, 4096
    buffer_load_dwordx4 v245, s[20:23], s54 offen sc1 lds
K2_WO_21:
    v_exp_f32 v56, v56
    v_exp_f32 v57, v57
    v_exp_f32 v58, v58
    v_exp_f32 v59, v59
    v_exp_f32 v60, v60
    s_setprio 0
    v_mfma_f32_32x32x16_bf16 v[80:95], v[116:119], v[96:99], v[80:95]
    v_exp_f32 v61, v61
    v_exp_f32 v62, v62
    v_exp_f32 v63, v63
    v_cvt_pk_bf16_f32 v100, v56, v57
    v_cvt_pk_bf16_f32 v101, v58, v59
    v_cvt_pk_bf16_f32 v102, v60, v61
    v_cvt_pk_bf16_f32 v103, v62, v63
    s_setprio 3
    s_waitcnt lgkmcnt(0)
    v_mfma_f32_32x32x16_bf16 v[48:63], v[104:107], v[12:15], v[32:47]
    ds_read_b128 v[108:111], v5 offset:33280
    ds_read_b32 v114, v8 offset:33280
    s_cmp_lt_u32 s40, 4
    s_cbranch_scc1 K2_WR_22
    buffer_load_dwordx4 v[220:223], v245, s[20:23], s36 offen offset:2048 sc1
K2_WR_22:
    v_exp_f32 v64, v64
    v_exp_f32 v65, v65
    v_exp_f32 v66, v66
    v_exp_f32 v67, v67
    v_exp_f32 v68, v68
    s_setprio 2
    v_mfma_f32_32x32x16_bf16 v[80:95], v[120:123], v[100:103], v[80:95]
    s_mov_b64 exec, s[60:61]
    ds_read_b128 v[116:119], v11 offset:30720
    ds_read_b128 v[120:123], v11 offset:31360
    s_mov_b64 exec, -1
    v_exp_f32 v69, v69
    v_exp_f32 v70, v70
    v_exp_f32 v71, v71
    v_cvt_pk_bf16_f32 v96, v64, v65
    v_cvt_pk_bf16_f32 v97, v66, v67
    v_cvt_pk_bf16_f32 v98, v68, v69
    v_cvt_pk_bf16_f32 v99, v70, v71
    s_setprio 1
    v_mfma_f32_32x32x8_bf16 v[48:63], v[112:113], v[16:17], v[48:63]
    v_exp_f32 v72, v72
    v_exp_f32 v73, v73
    v_exp_f32 v74, v74
    v_exp_f32 v75, v75
    v_exp_f32 v76, v76
    s_setprio 0
    v_mfma_f32_32x32x16_bf16 v[80:95], v[124:127], v[96:99], v[80:95]
    v_exp_f32 v77, v77
    v_exp_f32 v78, v78
    v_exp_f32 v79, v79
    v_cvt_pk_bf16_f32 v100, v72, v73
    v_cvt_pk_bf16_f32 v101, v74, v75
    v_cvt_pk_bf16_f32 v102, v76, v77
    v_cvt_pk_bf16_f32 v103, v78, v79
    s_setprio 3
    s_waitcnt lgkmcnt(0)
    v_mfma_f32_32x32x16_bf16 v[64:79], v[108:111], v[12:15], v[32:47]
    ds_read_b128 v[104:107], v5 offset:35840
    ds_read_b32 v112, v8 offset:35840
    s_cmp_lt_u32 s40, 4
    s_cbranch_scc1 K2_WR_23
    buffer_load_dwordx4 v[224:227], v245, s[20:23], s36 offen offset:3072 sc1
K2_WR_23:
    v_exp_f32 v48, v48
    v_exp_f32 v49, v49
    v_exp_f32 v50, v50
    v_exp_f32 v51, v51
    v_exp_f32 v52, v52
    s_setprio 2
    v_mfma_f32_32x32x16_bf16 v[80:95], v[128:131], v[100:103], v[80:95]
    s_mov_b64 exec, s[60:61]
    ds_read_b128 v[124:127], v11 offset:33280
    ds_read_b128 v[128:131], v11 offset:33920
    s_mov_b64 exec, -1
    v_exp_f32 v53, v53
    v_exp_f32 v54, v54
    v_exp_f32 v55, v55
    v_cvt_pk_bf16_f32 v96, v48, v49
    v_cvt_pk_bf16_f32 v97, v50, v51
    v_cvt_pk_bf16_f32 v98, v52, v53
    v_cvt_pk_bf16_f32 v99, v54, v55
    s_setprio 1
    v_mfma_f32_32x32x8_bf16 v[64:79], v[114:115], v[16:17], v[64:79]
    v_exp_f32 v56, v56
    v_exp_f32 v57, v57
    v_exp_f32 v58, v58
    v_exp_f32 v59, v59
    v_exp_f32 v60, v60
    s_setprio 0
    v_mfma_f32_32x32x16_bf16 v[80:95], v[116:119], v[96:99], v[80:95]
    v_exp_f32 v61, v61
    v_exp_f32 v62, v62
    v_exp_f32 v63, v63
    v_cvt_pk_bf16_f32 v100, v56, v57
    v_cvt_pk_bf16_f32 v101, v58, v59
    v_cvt_pk_bf16_f32 v102, v60, v61
    v_cvt_pk_bf16_f32 v103, v62, v63
    s_setprio 3
    s_waitcnt lgkmcnt(0)
    v_mfma_f32_32x32x16_bf16 v[48:63], v[104:107], v[12:15], v[32:47]
    ds_read_b128 v[108:111], v5 offset:38400
    ds_read_b32 v114, v8 offset:38400
    s_cmp_lt_u32 s40, 4
    s_cbranch_scc1 K2_WR_24
    buffer_load_dwordx4 v[228:231], v245, s[20:23], s37 offen offset:0 sc1
K2_WR_24:
    v_exp_f32 v64, v64
    v_exp_f32 v65, v65
    v_exp_f32 v66, v66
    v_exp_f32 v67, v67
    v_exp_f32 v68, v68
    s_setprio 2
    v_mfma_f32_32x32x16_bf16 v[80:95], v[120:123], v[100:103], v[80:95]
    s_mov_b64 exec, s[60:61]
    ds_read_b128 v[116:119], v11 offset:35840
    ds_read_b128 v[120:123], v11 offset:36480
    s_mov_b64 exec, -1
    v_exp_f32 v69, v69
    v_exp_f32 v70, v70
    v_exp_f32 v71, v71
    v_cvt_pk_bf16_f32 v96, v64, v65
    v_cvt_pk_bf16_f32 v97, v66, v67
    v_cvt_pk_bf16_f32 v98, v68, v69
    v_cvt_pk_bf16_f32 v99, v70, v71
    s_setprio 1
    v_mfma_f32_32x32x8_bf16 v[48:63], v[112:113], v[16:17], v[48:63]
    v_exp_f32 v72, v72
    v_exp_f32 v73, v73
    v_exp_f32 v74, v74
    v_exp_f32 v75, v75
    v_exp_f32 v76, v76
    s_setprio 0
    v_mfma_f32_32x32x16_bf16 v[80:95], v[124:127], v[96:99], v[80:95]
    v_exp_f32 v77, v77
    v_exp_f32 v78, v78
    v_exp_f32 v79, v79
    v_cvt_pk_bf16_f32 v100, v72, v73
    v_cvt_pk_bf16_f32 v101, v74, v75
    v_cvt_pk_bf16_f32 v102, v76, v77
    v_cvt_pk_bf16_f32 v103, v78, v79
    s_setprio 3
    s_waitcnt lgkmcnt(0)
    v_mfma_f32_32x32x16_bf16 v[64:79], v[108:111], v[12:15], v[32:47]
    v_exp_f32 v48, v48
    v_exp_f32 v49, v49
    v_exp_f32 v50, v50
    v_exp_f32 v51, v51
    v_exp_f32 v52, v52
    s_setprio 2
    v_mfma_f32_32x32x16_bf16 v[80:95], v[128:131], v[100:103], v[80:95]
    s_mov_b64 exec, s[60:61]
    ds_read_b128 v[124:127], v11 offset:38400
    ds_read_b128 v[128:131], v11 offset:39040
    s_mov_b64 exec, -1
    v_exp_f32 v53, v53
    v_exp_f32 v54, v54
    v_exp_f32 v55, v55
    v_cvt_pk_bf16_f32 v96, v48, v49
    v_cvt_pk_bf16_f32 v97, v50, v51
    v_cvt_pk_bf16_f32 v98, v52, v53
    v_cvt_pk_bf16_f32 v99, v54, v55
    s_setprio 1
    v_mfma_f32_32x32x8_bf16 v[64:79], v[114:115], v[16:17], v[64:79]
    v_exp_f32 v56, v56
    v_exp_f32 v57, v57
    v_exp_f32 v58, v58
    v_exp_f32 v59, v59
    v_exp_f32 v60, v60
    s_setprio 0
    v_mfma_f32_32x32x16_bf16 v[80:95], v[116:119], v[96:99], v[80:95]
    v_exp_f32 v61, v61
    v_exp_f32 v62, v62
    v_exp_f32 v63, v63
    v_cvt_pk_bf16_f32 v100, v56, v57
    v_cvt_pk_bf16_f32 v101, v58, v59
    v_cvt_pk_bf16_f32 v102, v60, v61
    v_cvt_pk_bf16_f32 v103, v62, v63
    s_setprio 3
    s_waitcnt lgkmcnt(0)
    v_exp_f32 v64, v64
    v_exp_f32 v65, v65
    v_exp_f32 v66, v66
    v_exp_f32 v67, v67
    v_exp_f32 v68, v68
    s_setprio 2
    v_mfma_f32_32x32x16_bf16 v[80:95], v[120:123], v[100:103], v[80:95]
    v_exp_f32 v69, v69
    v_exp_f32 v70, v70
    v_exp_f32 v71, v71
    v_cvt_pk_bf16_f32 v96, v64, v65
    v_cvt_pk_bf16_f32 v97, v66, v67
    v_cvt_pk_bf16_f32 v98, v68, v69
    v_cvt_pk_bf16_f32 v99, v70, v71
    s_setprio 1
    v_exp_f32 v72, v72
    v_exp_f32 v73, v73
    v_exp_f32 v74, v74
    v_exp_f32 v75, v75
    v_exp_f32 v76, v76
    s_setprio 0
    v_mfma_f32_32x32x16_bf16 v[80:95], v[124:127], v[96:99], v[80:95]
    v_exp_f32 v77, v77
    v_exp_f32 v78, v78
    v_exp_f32 v79, v79
    v_cvt_pk_bf16_f32 v100, v72, v73
    v_cvt_pk_bf16_f32 v101, v74, v75
    v_cvt_pk_bf16_f32 v102, v76, v77
    v_cvt_pk_bf16_f32 v103, v78, v79
    s_setprio 3
    s_nop 0
    v_mfma_f32_32x32x16_bf16 v[80:95], v[128:131], v[100:103], v[80:95]
    s_mov_b32 s52, 0x4e800000
    v_bfe_u32 v21, v1, 4, 1
    v_lshlrev_b32 v21, 14, v21
    v_lshl_add_u32 v21, v19, 8, v21
    v_and_b32 v22, 15, v1
    v_lshl_add_u32 v21, v22, 4, v21
    s_lshl_b32 s53, s45, 15
    s_lshl_b32 s54, s41, 9
    s_add_u32 s53, s53, s54
    s_add_u32 s53, s53, 10485760
    s_lshl_b32 s54, s41, 14
    s_lshl_b32 s55, s45, 8
    s_add_u32 s54, s54, s55
    s_add_u32 s54, s54, 12582912
    v_cmp_nlt_f32 vcc, v92, s52
    s_cbranch_vccnz K2_FALLBACK
K2_NORM:
    v_rcp_f32 v22, v92
    s_nop 0
    v_pk_mul_f32 v[80:81], v[80:81], v[22:23] op_sel_hi:[1,0]
    v_pk_mul_f32 v[82:83], v[82:83], v[22:23] op_sel_hi:[1,0]
    v_pk_mul_f32 v[84:85], v[84:85], v[22:23] op_sel_hi:[1,0]
    v_pk_mul_f32 v[86:87], v[86:87], v[22:23] op_sel_hi:[1,0]
    v_pk_mul_f32 v[88:89], v[88:89], v[22:23] op_sel_hi:[1,0]
    v_pk_mul_f32 v[90:91], v[90:91], v[22:23] op_sel_hi:[1,0]
    v_cvt_pk_bf16_f32 v96, v80, v81
    v_cvt_pk_bf16_f32 v97, v82, v83
    v_cvt_pk_bf16_f32 v98, v84, v85
    v_cvt_pk_bf16_f32 v99, v86, v87
    v_cvt_pk_bf16_f32 v100, v88, v89
    v_cvt_pk_bf16_f32 v101, v90, v91
    buffer_store_dwordx4 v[96:99], v21, s[20:23], s53 offen sc1
    s_mov_b32 exec_hi, 0
    buffer_store_dwordx2 v[100:101], v20, s[20:23], s54 offen sc1
    s_mov_b64 exec, -1
    s_lshl_b32 s55, s45, 7
    s_add_u32 s55, s55, 19398656
    s_mov_b64 exec, 1
    s_waitcnt vmcnt(0)
    buffer_atomic_add v243, v255, s[20:23], s55 offen sc1
    s_mov_b64 exec, -1
    s_waitcnt lgkmcnt(0)
    s_barrier
    s_cmp_ge_u32 s40, 4
    s_cbranch_scc1 K2_HELPER
    buffer_load_dwordx2 v[24:25], v244, s[28:31], s68 offen offset:0
    buffer_load_dwordx2 v[26:27], v244, s[28:31], s68 offen offset:32
    buffer_load_dwordx2 v[28:29], v244, s[28:31], s68 offen offset:64
    buffer_load_dwordx2 v[30:31], v244, s[28:31], s68 offen offset:96
    buffer_load_dwordx2 v[32:33], v244, s[28:31], s68 offen offset:128
    s_mul_i32 s52, s40, 15360
    s_add_u32 s52, s52, 104448
    v_add_u32 v3, s52, v2
    ds_write_b128 v3, v[152:155] offset:0
    ds_write_b128 v3, v[156:159] offset:1024
    ds_write_b128 v3, v[160:163] offset:2048
    ds_write_b128 v3, v[164:167] offset:3072
    ds_write_b128 v3, v[168:171] offset:4096
    ds_write_b128 v3, v[172:175] offset:5120
    ds_write_b128 v3, v[176:179] offset:6144
    ds_write_b128 v3, v[180:183] offset:7168
    ds_write_b128 v3, v[184:187] offset:8192
    ds_write_b128 v3, v[188:191] offset:9216
    s_cmp_eq_u32 s40, 3
    s_cbranch_scc1 K2_PUTD
    ds_write_b128 v3, v[192:195] offset:10240
    ds_write_b128 v3, v[196:199] offset:11264
    ds_write_b128 v3, v[200:203] offset:12288
    ds_write_b128 v3, v[204:207] offset:13312
    ds_write_b128 v3, v[208:211] offset:14336
K2_PUTD:
    v_add_u32 v247, 2048, v2
    v_add_u32 v248, 67584, v2
    v_add_u32 v249, 133120, v2
    v_and_b32 v250, 3, v1
    v_lshlrev_b32 v250, 2, v250
    s_lshl_b32 s52, s40, 2
    v_mov_b32 v251, s52
    v_lshrrev_b32 v254, 4, v1
    v_lshlrev_b32 v254, 4, v254
    s_and_b32 s43, s42, 1
    s_mul_i32 s44, s67, 24576
    s_mul_i32 s45, s42, 3072
    s_add_u32 s45, s45, s44
    s_lshl_b32 s46, s43, 10
    s_add_u32 s46, s46, s45
    s_xor_b32 s47, s43, 1
    s_lshl_b32 s47, s47, 11
    s_add_u32 s47, s47, s45
    v_and_b32 v22, 15, v1
    v_lshrrev_b32 v23, 4, v1
    v_lshlrev_b32 v21, 3, v22
    v_lshl_add_u32 v21, v23, 15, v21
    v_add_u32 v22, 16384, v21
    s_lshl_b32 s51, s67, 14
    s_lshl_b32 s48, s67, 7
    s_add_u32 s54, s51, 10485760
    s_add_u32 s36, s48, 12582912
    s_add_u32 s55, s51, 10489856
    s_add_u32 s37, s48, 12713984
    s_add_u32 s56, s51, 10493952
    s_add_u32 s38, s48, 12845056
    s_add_u32 s57, s51, 10498048
    s_add_u32 s39, s48, 12976128
    s_lshr_b32 s50, s67, 1
    s_lshl_b32 s50, s50, 7
    s_add_u32 s8, s20, 19423232
    s_addc_u32 s9, s21, 0
    s_mov_b32 s10, 16384
    s_mov_b32 s11, 0x00020000
    s_bitcmp1_b32 s42, 1
    s_cselect_b32 s52, -1, 1
    s_lshl_b32 s52, s52, 7
    v_mul_lo_u32 v228, v1, s52
    v_add_u32 v228, s48, v228
    s_mov_b32 s49, 16
    s_cmp_eq_u32 s67, 0
    s_cselect_b32 s49, 12, s49
    s_cmp_eq_u32 s67, 127
    s_cselect_b32 s49, 12, s49
    s_waitcnt lgkmcnt(0)
    s_barrier
    ds_read_b128 v[196:199], v247 offset:0
    ds_read_b128 v[200:203], v247 offset:1024
    ds_read_b128 v[204:207], v247 offset:2048
    ds_read_b128 v[208:211], v247 offset:3072
    ds_read_b128 v[212:215], v247 offset:4096
    ds_read_b128 v[216:219], v247 offset:5120
    ds_read_b128 v[220:223], v247 offset:6144
    s_mov_b32 s53, 32768
    s_add_u32 s62, s50, 19398656
    s_mov_b64 exec, 1
    v_mov_b32 v229, 0
    buffer_atomic_add v229, v255, s[20:23], s62 offen sc0 sc1
    s_sleep 4
    v_mov_b32 v230, 0
    buffer_atomic_add v230, v255, s[20:23], s62 offen sc0 sc1
K2_HL_25:
    s_waitcnt vmcnt(1)
    v_cmp_gt_u32 vcc, 32, v229
    s_cbranch_vccz K2_HX_26
    v_mov_b32 v229, 0
    buffer_atomic_add v229, v255, s[20:23], s62 offen sc0 sc1
    s_waitcnt vmcnt(1)
    v_cmp_gt_u32 vcc, 32, v230
    s_cbranch_vccz K2_HX_26
    v_mov_b32 v230, 0
    buffer_atomic_add v230, v255, s[20:23], s62 offen sc0 sc1
    s_sub_u32 s53, s53, 1
    s_cmp_lg_u32 s53, 0
    s_cbranch_scc1 K2_HL_25
K2_HX_26:
    s_mov_b64 exec, -1
    buffer_load_dwordx4 v[100:103], v2, s[20:23], s54 offen offset:0 sc1
    buffer_load_dwordx4 v[104:107], v2, s[20:23], s54 offen offset:1024 sc1
    buffer_load_dwordx4 v[108:111], v2, s[20:23], s54 offen offset:2048 sc1
    buffer_load_dwordx4 v[112:115], v2, s[20:23], s54 offen offset:3072 sc1
    buffer_load_dwordx2 v[116:117], v21, s[20:23], s36 offen sc1
    buffer_load_dwordx2 v[118:119], v22, s[20:23], s36 offen sc1
    buffer_load_dwordx4 v[124:127], v2, s[20:23], s55 offen offset:0 sc1
    buffer_load_dwordx4 v[128:131], v2, s[20:23], s55 offen offset:1024 sc1
    buffer_load_dwordx4 v[132:135], v2, s[20:23], s55 offen offset:2048 sc1
    buffer_load_dwordx4 v[136:139], v2, s[20:23], s55 offen offset:3072 sc1
    buffer_load_dwordx2 v[140:141], v21, s[20:23], s37 offen sc1
    buffer_load_dwordx2 v[142:143], v22, s[20:23], s37 offen sc1
    buffer_load_dwordx4 v[148:151], v2, s[20:23], s56 offen offset:0 sc1
    buffer_load_dwordx4 v[152:155], v2, s[20:23], s56 offen offset:1024 sc1
    v_lshlrev_b32 v80, 16, v24
    v_and_b32 v81, 0xffff0000, v24
    v_lshlrev_b32 v82, 16, v25
    v_and_b32 v83, 0xffff0000, v25
    v_lshlrev_b32 v84, 16, v26
    v_and_b32 v85, 0xffff0000, v26
    v_lshlrev_b32 v86, 16, v27
    v_and_b32 v87, 0xffff0000, v27
    v_lshlrev_b32 v88, 16, v28
    v_and_b32 v89, 0xffff0000, v28
    v_lshlrev_b32 v90, 16, v29
    v_and_b32 v91, 0xffff0000, v29
    v_lshlrev_b32 v92, 16, v30
    v_and_b32 v93, 0xffff0000, v30
    v_lshlrev_b32 v94, 16, v31
    v_and_b32 v95, 0xffff0000, v31
    v_lshlrev_b32 v96, 16, v32
    v_and_b32 v97, 0xffff0000, v32
    v_lshlrev_b32 v98, 16, v33
    v_and_b32 v99, 0xffff0000, v33
    s_waitcnt vmcnt(13)
    ds_read_b128 v[224:227], v247 offset:7168
    s_waitcnt lgkmcnt(6)
    v_mfma_f32_16x16x32_bf16 v[80:83], v[196:199], v[100:103], v[80:83]
    ds_read_b128 v[196:199], v247 offset:8192
    v_mfma_f32_16x16x32_bf16 v[84:87], v[200:203], v[100:103], v[84:87]
    ds_read_b128 v[200:203], v247 offset:9216
    s_waitcnt lgkmcnt(6)
    v_mfma_f32_16x16x32_bf16 v[88:91], v[204:207], v[100:103], v[88:91]
    ds_read_b128 v[204:207], v247 offset:10240
    v_mfma_f32_16x16x32_bf16 v[92:95], v[208:211], v[100:103], v[92:95]
    ds_read_b128 v[208:211], v247 offset:11264
    s_waitcnt lgkmcnt(6)
    v_mfma_f32_16x16x32_bf16 v[96:99], v[212:215], v[100:103], v[96:99]
    buffer_load_dwordx4 v[156:159], v2, s[20:23], s56 offen offset:2048 sc1
    buffer_load_dwordx4 v[160:163], v2, s[20:23], s56 offen offset:3072 sc1
    s_waitcnt vmcnt(14)
    ds_read_b128 v[212:215], v247 offset:12288
    v_mfma_f32_16x16x32_bf16 v[80:83], v[216:219], v[104:107], v[80:83]
    ds_read_b128 v[216:219], v247 offset:13312
    s_waitcnt lgkmcnt(6)
    v_mfma_f32_16x16x32_bf16 v[84:87], v[220:223], v[104:107], v[84:87]
    ds_read_b128 v[220:223], v247 offset:14336
    v_mfma_f32_16x16x32_bf16 v[88:91], v[224:227], v[104:107], v[88:91]
    ds_read_b128 v[224:227], v247 offset:15360
    s_waitcnt lgkmcnt(6)
    v_mfma_f32_16x16x32_bf16 v[92:95], v[196:199], v[104:107], v[92:95]
    ds_read_b128 v[196:199], v247 offset:16384
    v_mfma_f32_16x16x32_bf16 v[96:99], v[200:203], v[104:107], v[96:99]
    buffer_load_dwordx2 v[164:165], v21, s[20:23], s38 offen sc1
    buffer_load_dwordx2 v[166:167], v22, s[20:23], s38 offen sc1
    s_waitcnt vmcnt(15)
    ds_read_b128 v[200:203], v247 offset:17408
    s_waitcnt lgkmcnt(6)
    v_mfma_f32_16x16x32_bf16 v[80:83], v[204:207], v[108:111], v[80:83]
    ds_read_b128 v[204:207], v247 offset:18432
    v_mfma_f32_16x16x32_bf16 v[84:87], v[208:211], v[108:111], v[84:87]
    ds_read_b128 v[208:211], v247 offset:19456
    s_waitcnt lgkmcnt(6)
    v_mfma_f32_16x16x32_bf16 v[88:91], v[212:215], v[108:111], v[88:91]
    ds_read_b128 v[212:215], v247 offset:20480
    v_mfma_f32_16x16x32_bf16 v[92:95], v[216:219], v[108:111], v[92:95]
    ds_read_b128 v[216:219], v247 offset:21504
    s_waitcnt lgkmcnt(6)
    v_mfma_f32_16x16x32_bf16 v[96:99], v[220:223], v[108:111], v[96:99]
    buffer_load_dwordx4 v[172:175], v2, s[20:23], s57 offen offset:0 sc1
    buffer_load_dwordx4 v[176:179], v2, s[20:23], s57 offen offset:1024 sc1
    s_waitcnt vmcnt(16)
    ds_read_b128 v[220:223], v247 offset:22528
    v_mfma_f32_16x16x32_bf16 v[80:83], v[224:227], v[112:115], v[80:83]
    ds_read_b128 v[224:227], v247 offset:23552
    s_waitcnt lgkmcnt(6)
    v_mfma_f32_16x16x32_bf16 v[84:87], v[196:199], v[112:115], v[84:87]
    ds_read_b128 v[196:199], v247 offset:24576
    v_mfma_f32_16x16x32_bf16 v[88:91], v[200:203], v[112:115], v[88:91]
    ds_read_b128 v[200:203], v247 offset:25600
    s_waitcnt lgkmcnt(6)
    v_mfma_f32_16x16x32_bf16 v[92:95], v[204:207], v[112:115], v[92:95]
    ds_read_b128 v[204:207], v247 offset:26624
    v_mfma_f32_16x16x32_bf16 v[96:99], v[208:211], v[112:115], v[96:99]
    buffer_load_dwordx4 v[180:183], v2, s[20:23], s57 offen offset:2048 sc1
    buffer_load_dwordx4 v[184:187], v2, s[20:23], s57 offen offset:3072 sc1
    s_waitcnt vmcnt(16)
    ds_read_b128 v[208:211], v247 offset:27648
    s_waitcnt lgkmcnt(6)
    v_mfma_f32_16x16x32_bf16 v[80:83], v[212:215], v[116:119], v[80:83]
    ds_read_b128 v[212:215], v247 offset:28672
    v_mfma_f32_16x16x32_bf16 v[84:87], v[216:219], v[116:119], v[84:87]
    ds_read_b128 v[216:219], v247 offset:29696
    s_waitcnt lgkmcnt(6)
    v_mfma_f32_16x16x32_bf16 v[88:91], v[220:223], v[116:119], v[88:91]
    ds_read_b128 v[220:223], v247 offset:30720
    v_mfma_f32_16x16x32_bf16 v[92:95], v[224:227], v[116:119], v[92:95]
    ds_read_b128 v[224:227], v247 offset:31744
    s_waitcnt lgkmcnt(6)
    v_mfma_f32_16x16x32_bf16 v[96:99], v[196:199], v[116:119], v[96:99]
    buffer_load_dwordx2 v[188:189], v21, s[20:23], s39 offen sc1
    buffer_load_dwordx2 v[190:191], v22, s[20:23], s39 offen sc1
    s_waitcnt vmcnt(17)
    ds_read_b128 v[196:199], v247 offset:32768
    v_mfma_f32_16x16x32_bf16 v[80:83], v[200:203], v[124:127], v[80:83]
    ds_read_b128 v[200:203], v247 offset:33792
    s_waitcnt lgkmcnt(6)
    v_mfma_f32_16x16x32_bf16 v[84:87], v[204:207], v[124:127], v[84:87]
    ds_read_b128 v[204:207], v247 offset:34816
    v_mfma_f32_16x16x32_bf16 v[88:91], v[208:211], v[124:127], v[88:91]
    ds_read_b128 v[208:211], v247 offset:35840
    s_waitcnt lgkmcnt(6)
    v_mfma_f32_16x16x32_bf16 v[92:95], v[212:215], v[124:127], v[92:95]
    ds_read_b128 v[212:215], v247 offset:36864
    v_mfma_f32_16x16x32_bf16 v[96:99], v[216:219], v[124:127], v[96:99]
    s_waitcnt vmcnt(16)
    ds_read_b128 v[216:219], v247 offset:37888
    s_waitcnt lgkmcnt(6)
    v_mfma_f32_16x16x32_bf16 v[80:83], v[220:223], v[128:131], v[80:83]
    ds_read_b128 v[220:223], v247 offset:38912
    v_mfma_f32_16x16x32_bf16 v[84:87], v[224:227], v[128:131], v[84:87]
    ds_read_b128 v[224:227], v247 offset:39936
    s_waitcnt lgkmcnt(6)
    v_mfma_f32_16x16x32_bf16 v[88:91], v[196:199], v[128:131], v[88:91]
    ds_read_b128 v[196:199], v247 offset:40960
    v_mfma_f32_16x16x32_bf16 v[92:95], v[200:203], v[128:131], v[92:95]
    ds_read_b128 v[200:203], v247 offset:41984
    s_waitcnt lgkmcnt(6)
    v_mfma_f32_16x16x32_bf16 v[96:99], v[204:207], v[128:131], v[96:99]
    v_mov_b32 v253, 1
    ds_write_b32 v251, v253 offset:1552
    s_waitcnt vmcnt(15)
    ds_read_b128 v[204:207], v247 offset:43008
    v_mfma_f32_16x16x32_bf16 v[80:83], v[208:211], v[132:135], v[80:83]
    ds_read_b128 v[208:211], v247 offset:44032
    s_waitcnt lgkmcnt(7)
    v_mfma_f32_16x16x32_bf16 v[84:87], v[212:215], v[132:135], v[84:87]
    ds_read_b128 v[212:215], v247 offset:45056
    v_mfma_f32_16x16x32_bf16 v[88:91], v[216:219], v[132:135], v[88:91]
    ds_read_b128 v[216:219], v247 offset:46080
    s_waitcnt lgkmcnt(7)
    v_mfma_f32_16x16x32_bf16 v[92:95], v[220:223], v[132:135], v[92:95]
    ds_read_b128 v[220:223], v247 offset:47104
    v_mfma_f32_16x16x32_bf16 v[96:99], v[224:227], v[132:135], v[96:99]
    s_waitcnt vmcnt(14)
    ds_read_b128 v[224:227], v247 offset:48128
    s_waitcnt lgkmcnt(7)
    v_mfma_f32_16x16x32_bf16 v[80:83], v[196:199], v[136:139], v[80:83]
    ds_read_b128 v[196:199], v247 offset:49152
    v_mfma_f32_16x16x32_bf16 v[84:87], v[200:203], v[136:139], v[84:87]
    ds_read_b128 v[200:203], v247 offset:50176
    s_waitcnt lgkmcnt(6)
    v_mfma_f32_16x16x32_bf16 v[88:91], v[204:207], v[136:139], v[88:91]
    ds_read_b128 v[204:207], v247 offset:51200
    v_mfma_f32_16x16x32_bf16 v[92:95], v[208:211], v[136:139], v[92:95]
    ds_read_b128 v[208:211], v247 offset:52224
    s_waitcnt lgkmcnt(6)
    v_mfma_f32_16x16x32_bf16 v[96:99], v[212:215], v[136:139], v[96:99]
    s_waitcnt vmcnt(12)
    ds_read_b128 v[212:215], v247 offset:53248
    v_mfma_f32_16x16x32_bf16 v[80:83], v[216:219], v[140:143], v[80:83]
    ds_read_b128 v[216:219], v247 offset:54272
    s_waitcnt lgkmcnt(6)
    v_mfma_f32_16x16x32_bf16 v[84:87], v[220:223], v[140:143], v[84:87]
    ds_read_b128 v[220:223], v247 offset:55296
    v_mfma_f32_16x16x32_bf16 v[88:91], v[224:227], v[140:143], v[88:91]
    ds_read_b128 v[224:227], v247 offset:56320
    s_waitcnt lgkmcnt(6)
    v_mfma_f32_16x16x32_bf16 v[92:95], v[196:199], v[140:143], v[92:95]
    ds_read_b128 v[196:199], v247 offset:57344
    v_mfma_f32_16x16x32_bf16 v[96:99], v[200:203], v[140:143], v[96:99]
    s_waitcnt vmcnt(11)
    ds_read_b128 v[200:203], v247 offset:58368
    s_waitcnt lgkmcnt(6)
    v_mfma_f32_16x16x32_bf16 v[80:83], v[204:207], v[148:151], v[80:83]
    ds_read_b128 v[204:207], v247 offset:59392
    v_mfma_f32_16x16x32_bf16 v[84:87], v[208:211], v[148:151], v[84:87]
    ds_read_b128 v[208:211], v247 offset:60416
    s_waitcnt lgkmcnt(6)
    v_mfma_f32_16x16x32_bf16 v[88:91], v[212:215], v[148:151], v[88:91]
    ds_read_b128 v[212:215], v247 offset:61440
    v_mfma_f32_16x16x32_bf16 v[92:95], v[216:219], v[148:151], v[92:95]
    ds_read_b128 v[216:219], v247 offset:62464
    s_waitcnt lgkmcnt(6)
    v_mfma_f32_16x16x32_bf16 v[96:99], v[220:223], v[148:151], v[96:99]
    s_waitcnt vmcnt(10)
    ds_read_b128 v[220:223], v247 offset:63488
    v_mfma_f32_16x16x32_bf16 v[80:83], v[224:227], v[152:155], v[80:83]
    ds_read_b128 v[224:227], v247 offset:64512
    s_waitcnt lgkmcnt(6)
    v_mfma_f32_16x16x32_bf16 v[84:87], v[196:199], v[152:155], v[84:87]
    ds_read_b128 v[196:199], v248 offset:0
    v_mfma_f32_16x16x32_bf16 v[88:91], v[200:203], v[152:155], v[88:91]
    ds_read_b128 v[200:203], v248 offset:1024
    s_waitcnt lgkmcnt(6)
    v_mfma_f32_16x16x32_bf16 v[92:95], v[204:207], v[152:155], v[92:95]
    ds_read_b128 v[204:207], v248 offset:2048
    v_mfma_f32_16x16x32_bf16 v[96:99], v[208:211], v[152:155], v[96:99]
    s_waitcnt vmcnt(9)
    ds_read_b128 v[208:211], v248 offset:3072
    s_waitcnt lgkmcnt(6)
    v_mfma_f32_16x16x32_bf16 v[80:83], v[212:215], v[156:159], v[80:83]
    ds_read_b128 v[212:215], v248 offset:4096
    v_mfma_f32_16x16x32_bf16 v[84:87], v[216:219], v[156:159], v[84:87]
    ds_read_b128 v[216:219], v248 offset:5120
    s_waitcnt lgkmcnt(6)
    v_mfma_f32_16x16x32_bf16 v[88:91], v[220:223], v[156:159], v[88:91]
    ds_read_b128 v[220:223], v248 offset:6144
    v_mfma_f32_16x16x32_bf16 v[92:95], v[224:227], v[156:159], v[92:95]
    ds_read_b128 v[224:227], v248 offset:7168
    s_waitcnt lgkmcnt(6)
    v_mfma_f32_16x16x32_bf16 v[96:99], v[196:199], v[156:159], v[96:99]
    s_waitcnt vmcnt(8)
    ds_read_b128 v[196:199], v248 offset:8192
    v_mfma_f32_16x16x32_bf16 v[80:83], v[200:203], v[160:163], v[80:83]
    ds_read_b128 v[200:203], v248 offset:9216
    s_waitcnt lgkmcnt(6)
    v_mfma_f32_16x16x32_bf16 v[84:87], v[204:207], v[160:163], v[84:87]
    ds_read_b128 v[204:207], v248 offset:10240
    v_mfma_f32_16x16x32_bf16 v[88:91], v[208:211], v[160:163], v[88:91]
    ds_read_b128 v[208:211], v248 offset:11264
    s_waitcnt lgkmcnt(6)
    v_mfma_f32_16x16x32_bf16 v[92:95], v[212:215], v[160:163], v[92:95]
    ds_read_b128 v[212:215], v248 offset:12288
    v_mfma_f32_16x16x32_bf16 v[96:99], v[216:219], v[160:163], v[96:99]
    s_waitcnt vmcnt(6)
    ds_read_b128 v[216:219], v248 offset:13312
    s_waitcnt lgkmcnt(6)
    v_mfma_f32_16x16x32_bf16 v[80:83], v[220:223], v[164:167], v[80:83]
    ds_read_b128 v[220:223], v248 offset:14336
    v_mfma_f32_16x16x32_bf16 v[84:87], v[224:227], v[164:167], v[84:87]
    ds_read_b128 v[224:227], v248 offset:15360
    s_waitcnt lgkmcnt(6)
    v_mfma_f32_16x16x32_bf16 v[88:91], v[196:199], v[164:167], v[88:91]
    ds_read_b128 v[196:199], v248 offset:16384
    v_mfma_f32_16x16x32_bf16 v[92:95], v[200:203], v[164:167], v[92:95]
    ds_read_b128 v[200:203], v248 offset:17408
    s_waitcnt lgkmcnt(6)
    v_mfma_f32_16x16x32_bf16 v[96:99], v[204:207], v[164:167], v[96:99]
    s_waitcnt vmcnt(5)
    ds_read_b128 v[204:207], v248 offset:18432
    v_mfma_f32_16x16x32_bf16 v[80:83], v[208:211], v[172:175], v[80:83]
    ds_read_b128 v[208:211], v248 offset:19456
    s_waitcnt lgkmcnt(6)
    v_mfma_f32_16x16x32_bf16 v[84:87], v[212:215], v[172:175], v[84:87]
    ds_read_b128 v[212:215], v248 offset:20480
    v_mfma_f32_16x16x32_bf16 v[88:91], v[216:219], v[172:175], v[88:91]
    ds_read_b128 v[216:219], v248 offset:21504
    s_waitcnt lgkmcnt(6)
    v_mfma_f32_16x16x32_bf16 v[92:95], v[220:223], v[172:175], v[92:95]
    ds_read_b128 v[220:223], v248 offset:22528
    v_mfma_f32_16x16x32_bf16 v[96:99], v[224:227], v[172:175], v[96:99]
    s_waitcnt vmcnt(4)
    ds_read_b128 v[224:227], v248 offset:23552
    s_waitcnt lgkmcnt(6)
    v_mfma_f32_16x16x32_bf16 v[80:83], v[196:199], v[176:179], v[80:83]
    ds_read_b128 v[196:199], v248 offset:24576
    v_mfma_f32_16x16x32_bf16 v[84:87], v[200:203], v[176:179], v[84:87]
    ds_read_b128 v[200:203], v248 offset:25600
    s_waitcnt lgkmcnt(6)
    v_mfma_f32_16x16x32_bf16 v[88:91], v[204:207], v[176:179], v[88:91]
    ds_read_b128 v[204:207], v248 offset:26624
    v_mfma_f32_16x16x32_bf16 v[92:95], v[208:211], v[176:179], v[92:95]
    ds_read_b128 v[208:211], v248 offset:27648
    s_waitcnt lgkmcnt(6)
    v_mfma_f32_16x16x32_bf16 v[96:99], v[212:215], v[176:179], v[96:99]
    s_waitcnt vmcnt(3)
    ds_read_b128 v[212:215], v248 offset:28672
    v_mfma_f32_16x16x32_bf16 v[80:83], v[216:219], v[180:183], v[80:83]
    ds_read_b128 v[216:219], v248 offset:29696
    s_waitcnt lgkmcnt(6)
    v_mfma_f32_16x16x32_bf16 v[84:87], v[220:223], v[180:183], v[84:87]
    ds_read_b128 v[220:223], v248 offset:30720
    v_mfma_f32_16x16x32_bf16 v[88:91], v[224:227], v[180:183], v[88:91]
    ds_read_b128 v[224:227], v248 offset:31744
    s_waitcnt lgkmcnt(6)
    v_mfma_f32_16x16x32_bf16 v[92:95], v[196:199], v[180:183], v[92:95]
    ds_read_b128 v[196:199], v248 offset:32768
    v_mfma_f32_16x16x32_bf16 v[96:99], v[200:203], v[180:183], v[96:99]
    s_waitcnt vmcnt(2)
    ds_read_b128 v[200:203], v248 offset:33792
    s_waitcnt lgkmcnt(6)
    v_mfma_f32_16x16x32_bf16 v[80:83], v[204:207], v[184:187], v[80:83]
    ds_read_b128 v[204:207], v248 offset:34816
    v_mfma_f32_16x16x32_bf16 v[84:87], v[208:211], v[184:187], v[84:87]
    ds_read_b128 v[208:211], v248 offset:35840
    s_waitcnt lgkmcnt(6)
    v_mfma_f32_16x16x32_bf16 v[88:91], v[212:215], v[184:187], v[88:91]
    v_mfma_f32_16x16x32_bf16 v[92:95], v[216:219], v[184:187], v[92:95]
    s_waitcnt lgkmcnt(4)
    v_mfma_f32_16x16x32_bf16 v[96:99], v[220:223], v[184:187], v[96:99]
    s_waitcnt vmcnt(0)
    v_mfma_f32_16x16x32_bf16 v[80:83], v[224:227], v[188:191], v[80:83]
    s_waitcnt lgkmcnt(2)
    v_mfma_f32_16x16x32_bf16 v[84:87], v[196:199], v[188:191], v[84:87]
    v_mfma_f32_16x16x32_bf16 v[88:91], v[200:203], v[188:191], v[88:91]
    s_waitcnt lgkmcnt(0)
    v_mfma_f32_16x16x32_bf16 v[92:95], v[204:207], v[188:191], v[92:95]
    v_mfma_f32_16x16x32_bf16 v[96:99], v[208:211], v[188:191], v[96:99]
    v_mov_b32 v253, 2
    ds_write_b32 v251, v253 offset:1552
    s_nop 6
    s_add_u32 s52, s46, 13107200
    s_add_u32 s53, s47, 13107200
    v_cvt_pk_bf16_f32 v100, v80, v81
    v_cvt_pk_bf16_f32 v101, v82, v83
    v_cvt_pk_bf16_f32 v102, v84, v85
    v_cvt_pk_bf16_f32 v103, v86, v87
    v_cvt_pk_bf16_f32 v104, v88, v89
    v_cvt_pk_bf16_f32 v105, v90, v91
    v_cvt_pk_bf16_f32 v106, v92, v93
    v_cvt_pk_bf16_f32 v107, v94, v95
    buffer_store_dwordx4 v[100:103], v2, s[20:23], s52 offen sc1
    buffer_store_dwordx4 v[104:107], v2, s[20:23], s52 offen offset:1024 sc1
    v_cvt_pk_bf16_f32 v110, v96, v97
    v_cvt_pk_bf16_f32 v111, v98, v99
    v_pk_add_f32 v[112:113], v[80:81], v[82:83]
    v_pk_mul_f32 v[114:115], v[80:81], v[80:81]
    v_pk_fma_f32 v[114:115], v[82:83], v[82:83], v[114:115]
    v_pk_add_f32 v[112:113], v[112:113], v[84:85]
    v_pk_fma_f32 v[114:115], v[84:85], v[84:85], v[114:115]
    v_pk_add_f32 v[112:113], v[112:113], v[86:87]
    v_pk_fma_f32 v[114:115], v[86:87], v[86:87], v[114:115]
    v_pk_add_f32 v[112:113], v[112:113], v[88:89]
    v_pk_fma_f32 v[114:115], v[88:89], v[88:89], v[114:115]
    v_pk_add_f32 v[112:113], v[112:113], v[90:91]
    v_pk_fma_f32 v[114:115], v[90:91], v[90:91], v[114:115]
    v_pk_add_f32 v[112:113], v[112:113], v[92:93]
    v_pk_fma_f32 v[114:115], v[92:93], v[92:93], v[114:115]
    v_pk_add_f32 v[112:113], v[112:113], v[94:95]
    v_pk_fma_f32 v[114:115], v[94:95], v[94:95], v[114:115]
    v_pk_add_f32 v[112:113], v[112:113], v[96:97]
    v_pk_fma_f32 v[114:115], v[96:97], v[96:97], v[114:115]
    v_pk_add_f32 v[112:113], v[112:113], v[98:99]
    v_pk_fma_f32 v[114:115], v[98:99], v[98:99], v[114:115]
    v_add_f32 v108, v112, v113
    v_add_f32 v109, v114, v115
    v_mov_b32 v112, v108
    v_mov_b32 v113, v109
    s_cmp_eq_u32 s43, 1
    s_cbranch_scc1 K2_SO_27
    buffer_store_dwordx4 v[108:111], v2, s[20:23], s53 offen sc1
    s_branch K2_SD_28
K2_SO_27:
    buffer_store_dwordx4 v[110:113], v2, s[20:23], s53 offen sc1
K2_SD_28:
    s_add_u32 s54, s44, 13107200
    s_add_u32 s55, s44, 13111296
    s_add_u32 s56, s44, 13115392
    s_add_u32 s57, s44, 13119488
    s_add_u32 s58, s44, 13123584
    s_add_u32 s59, s44, 13127680
    ds_read_b128 v[44:47], v254 offset:0
    ds_read_b128 v[48:51], v254 offset:64
    ds_read_b128 v[52:55], v254 offset:128
    ds_read_b128 v[56:59], v254 offset:192
    ds_read_b128 v[60:63], v254 offset:256
    s_waitcnt vmcnt(0)
    s_add_u32 s52, s48, 19406848
    s_mov_b64 exec, 1
    buffer_atomic_add v243, v255, s[20:23], s52 offen sc1
    s_mov_b64 exec, -1
    s_mov_b32 s53, 32768
    s_add_u32 s62, s48, 19406848
    s_mov_b64 exec, 1
    v_mov_b32 v229, 0
    buffer_atomic_add v229, v255, s[20:23], s62 offen sc0 sc1
    s_sleep 4
    v_mov_b32 v230, 0
    buffer_atomic_add v230, v255, s[20:23], s62 offen sc0 sc1
K2_HL_29:
    s_waitcnt vmcnt(1)
    v_cmp_gt_u32 vcc, 8, v229
    s_cbranch_vccz K2_HX_30
    v_mov_b32 v229, 0
    buffer_atomic_add v229, v255, s[20:23], s62 offen sc0 sc1
    s_waitcnt vmcnt(1)
    v_cmp_gt_u32 vcc, 8, v230
    s_cbranch_vccz K2_HX_30
    v_mov_b32 v230, 0
    buffer_atomic_add v230, v255, s[20:23], s62 offen sc0 sc1
    s_sub_u32 s53, s53, 1
    s_cmp_lg_u32 s53, 0
    s_cbranch_scc1 K2_HL_29
K2_HX_30:
    s_mov_b64 exec, -1
    buffer_load_dwordx4 v[108:111], v2, s[20:23], s54 offen offset:2048 sc1
    buffer_load_dwordx4 v[112:115], v2, s[20:23], s54 offen offset:3072 sc1
    buffer_load_dwordx4 v[132:135], v2, s[20:23], s56 offen offset:0 sc1
    buffer_load_dwordx4 v[136:139], v2, s[20:23], s56 offen offset:1024 sc1
    buffer_load_dwordx4 v[156:159], v2, s[20:23], s57 offen offset:2048 sc1
    buffer_load_dwordx4 v[160:163], v2, s[20:23], s57 offen offset:3072 sc1
    buffer_load_dwordx4 v[180:183], v2, s[20:23], s59 offen offset:0 sc1
    buffer_load_dwordx4 v[184:187], v2, s[20:23], s59 offen offset:1024 sc1
    buffer_load_dwordx4 v[100:103], v2, s[20:23], s54 offen offset:0 sc1
    buffer_load_dwordx4 v[104:107], v2, s[20:23], s54 offen offset:1024 sc1
    buffer_load_dwordx4 v[116:119], v2, s[20:23], s55 offen offset:0 sc1
    buffer_load_dwordx4 v[120:123], v2, s[20:23], s55 offen offset:1024 sc1
    buffer_load_dwordx4 v[124:127], v2, s[20:23], s55 offen offset:2048 sc1
    buffer_load_dwordx4 v[128:131], v2, s[20:23], s55 offen offset:3072 sc1
    ds_read_b128 v[212:215], v248 offset:36864
    ds_read_b128 v[216:219], v248 offset:37888
    ds_read_b128 v[220:223], v248 offset:38912
    ds_read_b128 v[224:227], v248 offset:39936
    ds_read_b128 v[196:199], v248 offset:40960
    ds_read_b128 v[200:203], v248 offset:41984
    ds_read_b128 v[204:207], v248 offset:43008
    s_waitcnt vmcnt(12)
    ds_read_b128 v[208:211], v248 offset:44032
    s_waitcnt lgkmcnt(6)
    v_mfma_f32_16x16x32_bf16 v[24:27], v[212:215], v[110:113], 0
    v_add_f32 v232, v108, v114
    ds_read_b128 v[212:215], v248 offset:45056
    v_mfma_f32_16x16x32_bf16 v[28:31], v[216:219], v[110:113], 0
    ds_read_b128 v[216:219], v248 offset:46080
    s_waitcnt lgkmcnt(6)
    v_mfma_f32_16x16x32_bf16 v[32:35], v[220:223], v[110:113], 0
    v_add_f32 v233, v109, v115
    ds_read_b128 v[220:223], v248 offset:47104
    v_mfma_f32_16x16x32_bf16 v[36:39], v[224:227], v[110:113], 0
    ds_read_b128 v[224:227], v248 offset:48128
    s_waitcnt lgkmcnt(6)
    v_mfma_f32_16x16x32_bf16 v[40:43], v[196:199], v[110:113], 0
    buffer_load_dwordx4 v[140:143], v2, s[20:23], s56 offen offset:2048 sc1
    buffer_load_dwordx4 v[144:147], v2, s[20:23], s56 offen offset:3072 sc1
    s_waitcnt vmcnt(12)
    ds_read_b128 v[196:199], v248 offset:49152
    v_mfma_f32_16x16x32_bf16 v[24:27], v[200:203], v[134:137], v[24:27]
    ds_read_b128 v[200:203], v248 offset:50176
    s_waitcnt lgkmcnt(6)
    v_mfma_f32_16x16x32_bf16 v[28:31], v[204:207], v[134:137], v[28:31]
    v_add_f32 v232, v232, v132
    ds_read_b128 v[204:207], v248 offset:51200
    v_mfma_f32_16x16x32_bf16 v[32:35], v[208:211], v[134:137], v[32:35]
    ds_read_b128 v[208:211], v248 offset:52224
    s_waitcnt lgkmcnt(6)
    v_mfma_f32_16x16x32_bf16 v[36:39], v[212:215], v[134:137], v[36:39]
    v_add_f32 v233, v233, v133
    ds_read_b128 v[212:215], v248 offset:53248
    v_mfma_f32_16x16x32_bf16 v[40:43], v[216:219], v[134:137], v[40:43]
    buffer_load_dwordx4 v[148:151], v2, s[20:23], s57 offen offset:0 sc1
    buffer_load_dwordx4 v[152:155], v2, s[20:23], s57 offen offset:1024 sc1
    s_waitcnt vmcnt(12)
    ds_read_b128 v[216:219], v248 offset:54272
    s_waitcnt lgkmcnt(6)
    v_mfma_f32_16x16x32_bf16 v[24:27], v[220:223], v[158:161], v[24:27]
    v_add_f32 v232, v232, v138
    ds_read_b128 v[220:223], v248 offset:55296
    v_mfma_f32_16x16x32_bf16 v[28:31], v[224:227], v[158:161], v[28:31]
    ds_read_b128 v[224:227], v248 offset:56320
    s_waitcnt lgkmcnt(6)
    v_mfma_f32_16x16x32_bf16 v[32:35], v[196:199], v[158:161], v[32:35]
    v_add_f32 v233, v233, v139
    ds_read_b128 v[196:199], v248 offset:57344
    v_mfma_f32_16x16x32_bf16 v[36:39], v[200:203], v[158:161], v[36:39]
    ds_read_b128 v[200:203], v248 offset:58368
    s_waitcnt lgkmcnt(6)
    v_mfma_f32_16x16x32_bf16 v[40:43], v[204:207], v[158:161], v[40:43]
    v_add_f32 v232, v232, v156
    buffer_load_dwordx4 v[164:167], v2, s[20:23], s58 offen offset:0 sc1
    buffer_load_dwordx4 v[168:171], v2, s[20:23], s58 offen offset:1024 sc1
    s_waitcnt vmcnt(12)
    ds_read_b128 v[204:207], v248 offset:59392
    v_mfma_f32_16x16x32_bf16 v[24:27], v[208:211], v[182:185], v[24:27]
    ds_read_b128 v[208:211], v248 offset:60416
    s_waitcnt lgkmcnt(6)
    v_mfma_f32_16x16x32_bf16 v[28:31], v[212:215], v[182:185], v[28:31]
    v_add_f32 v233, v233, v157
    ds_read_b128 v[212:215], v248 offset:61440
    v_mfma_f32_16x16x32_bf16 v[32:35], v[216:219], v[182:185], v[32:35]
    ds_read_b128 v[216:219], v248 offset:62464
    s_waitcnt lgkmcnt(6)
    v_mfma_f32_16x16x32_bf16 v[36:39], v[220:223], v[182:185], v[36:39]
    v_add_f32 v232, v232, v162
    ds_read_b128 v[220:223], v248 offset:63488
    v_mfma_f32_16x16x32_bf16 v[40:43], v[224:227], v[182:185], v[40:43]
    buffer_load_dwordx4 v[172:175], v2, s[20:23], s58 offen offset:2048 sc1
    buffer_load_dwordx4 v[176:179], v2, s[20:23], s58 offen offset:3072 sc1
    s_waitcnt vmcnt(13)
    ds_read_b128 v[224:227], v248 offset:64512
    s_waitcnt lgkmcnt(6)
    v_mfma_f32_16x16x32_bf16 v[24:27], v[196:199], v[100:103], v[24:27]
    v_add_f32 v233, v233, v163
    ds_read_b128 v[196:199], v249 offset:0
    v_mfma_f32_16x16x32_bf16 v[28:31], v[200:203], v[100:103], v[28:31]
    ds_read_b128 v[200:203], v249 offset:1024
    s_waitcnt lgkmcnt(6)
    v_mfma_f32_16x16x32_bf16 v[32:35], v[204:207], v[100:103], v[32:35]
    v_add_f32 v232, v232, v180
    ds_read_b128 v[204:207], v249 offset:2048
    v_mfma_f32_16x16x32_bf16 v[36:39], v[208:211], v[100:103], v[36:39]
    ds_read_b128 v[208:211], v249 offset:3072
    s_waitcnt lgkmcnt(6)
    v_mfma_f32_16x16x32_bf16 v[40:43], v[212:215], v[100:103], v[40:43]
    v_add_f32 v233, v233, v181
    buffer_load_dwordx4 v[188:191], v2, s[20:23], s59 offen offset:2048 sc1
    buffer_load_dwordx4 v[192:195], v2, s[20:23], s59 offen offset:3072 sc1
    s_waitcnt vmcnt(14)
    ds_read_b128 v[212:215], v249 offset:4096
    v_mfma_f32_16x16x32_bf16 v[24:27], v[216:219], v[104:107], v[24:27]
    ds_read_b128 v[216:219], v249 offset:5120
    s_waitcnt lgkmcnt(6)
    v_mfma_f32_16x16x32_bf16 v[28:31], v[220:223], v[104:107], v[28:31]
    v_add_f32 v232, v232, v186
    ds_read_b128 v[220:223], v249 offset:6144
    v_mfma_f32_16x16x32_bf16 v[32:35], v[224:227], v[104:107], v[32:35]
    ds_read_b128 v[224:227], v249 offset:7168
    s_waitcnt lgkmcnt(6)
    v_mfma_f32_16x16x32_bf16 v[36:39], v[196:199], v[104:107], v[36:39]
    v_add_f32 v233, v233, v187
    ds_read_b128 v[196:199], v249 offset:8192
    v_mfma_f32_16x16x32_bf16 v[40:43], v[200:203], v[104:107], v[40:43]
    s_waitcnt vmcnt(13)
    ds_read_b128 v[200:203], v249 offset:9216
    s_waitcnt lgkmcnt(6)
    v_mfma_f32_16x16x32_bf16 v[24:27], v[204:207], v[116:119], v[24:27]
    v_mov_b32 v234, v232
    ds_read_b128 v[204:207], v249 offset:10240
    v_mfma_f32_16x16x32_bf16 v[28:31], v[208:211], v[116:119], v[28:31]
    ds_read_b128 v[208:211], v249 offset:11264
    s_waitcnt lgkmcnt(6)
    v_mfma_f32_16x16x32_bf16 v[32:35], v[212:215], v[116:119], v[32:35]
    v_mov_b32 v235, v233
    ds_read_b128 v[212:215], v249 offset:12288
    v_mfma_f32_16x16x32_bf16 v[36:39], v[216:219], v[116:119], v[36:39]
    ds_read_b128 v[216:219], v249 offset:13312
    s_waitcnt lgkmcnt(6)
    v_mfma_f32_16x16x32_bf16 v[40:43], v[220:223], v[116:119], v[40:43]
    v_mov_b32 v253, 3
    ds_write_b32 v251, v253 offset:1552
    v_permlane32_swap_b32 v232, v234
    s_waitcnt vmcnt(12)
    ds_read_b128 v[220:223], v249 offset:14336
    v_mfma_f32_16x16x32_bf16 v[24:27], v[224:227], v[120:123], v[24:27]
    ds_read_b128 v[224:227], v249 offset:15360
    s_waitcnt lgkmcnt(7)
    v_mfma_f32_16x16x32_bf16 v[28:31], v[196:199], v[120:123], v[28:31]
    v_permlane32_swap_b32 v233, v235
    ds_read_b128 v[196:199], v249 offset:16384
    v_mfma_f32_16x16x32_bf16 v[32:35], v[200:203], v[120:123], v[32:35]
    ds_read_b128 v[200:203], v249 offset:17408
    s_waitcnt lgkmcnt(7)
    v_mfma_f32_16x16x32_bf16 v[36:39], v[204:207], v[120:123], v[36:39]
    v_add_f32 v232, v232, v234
    ds_read_b128 v[204:207], v249 offset:18432
    v_mfma_f32_16x16x32_bf16 v[40:43], v[208:211], v[120:123], v[40:43]
    s_waitcnt vmcnt(11)
    ds_read_b128 v[208:211], v249 offset:19456
    s_waitcnt lgkmcnt(7)
    v_mfma_f32_16x16x32_bf16 v[24:27], v[212:215], v[124:127], v[24:27]
    v_add_f32 v233, v233, v235
    ds_read_b128 v[212:215], v249 offset:20480
    v_mfma_f32_16x16x32_bf16 v[28:31], v[216:219], v[124:127], v[28:31]
    ds_read_b128 v[216:219], v249 offset:21504
    s_waitcnt lgkmcnt(6)
    v_mfma_f32_16x16x32_bf16 v[32:35], v[220:223], v[124:127], v[32:35]
    v_mov_b32 v234, v232
    ds_read_b128 v[220:223], v249 offset:22528
    v_mfma_f32_16x16x32_bf16 v[36:39], v[224:227], v[124:127], v[36:39]
    ds_read_b128 v[224:227], v249 offset:23552
    ds_read_b32 v252, v250 offset:1536
    s_waitcnt lgkmcnt(7)
    v_mfma_f32_16x16x32_bf16 v[40:43], v[196:199], v[124:127], v[40:43]
    v_mov_b32 v235, v233
    s_waitcnt vmcnt(10)
    ds_read_b128 v[196:199], v249 offset:24576
    v_mfma_f32_16x16x32_bf16 v[24:27], v[200:203], v[128:131], v[24:27]
    ds_read_b128 v[200:203], v249 offset:25600
    s_waitcnt lgkmcnt(7)
    v_mfma_f32_16x16x32_bf16 v[28:31], v[204:207], v[128:131], v[28:31]
    v_permlane16_swap_b32 v232, v234
    ds_read_b128 v[204:207], v249 offset:26624
    v_mfma_f32_16x16x32_bf16 v[32:35], v[208:211], v[128:131], v[32:35]
    s_waitcnt lgkmcnt(3)
    v_cmp_gt_u32 vcc, 3, v252
    s_cbranch_vccnz K2_FW_31
K2_FB_32:
    ds_read_b128 v[208:211], v249 offset:27648
    v_mfma_f32_16x16x32_bf16 v[36:39], v[212:215], v[128:131], v[36:39]
    v_permlane16_swap_b32 v233, v235
    ds_read_b128 v[212:215], v249 offset:28672
    v_mfma_f32_16x16x32_bf16 v[40:43], v[216:219], v[128:131], v[40:43]
    s_waitcnt vmcnt(9)
    ds_read_b128 v[216:219], v249 offset:29696
    v_mfma_f32_16x16x32_bf16 v[24:27], v[220:223], v[140:143], v[24:27]
    v_add_f32 v232, v232, v234
    ds_read_b128 v[220:223], v247 offset:0
    v_mfma_f32_16x16x32_bf16 v[28:31], v[224:227], v[140:143], v[28:31]
    ds_read_b128 v[224:227], v247 offset:1024
    s_waitcnt lgkmcnt(6)
    v_mfma_f32_16x16x32_bf16 v[32:35], v[196:199], v[140:143], v[32:35]
    v_add_f32 v233, v233, v235
    ds_read_b128 v[196:199], v247 offset:2048
    v_mfma_f32_16x16x32_bf16 v[36:39], v[200:203], v[140:143], v[36:39]
    ds_read_b128 v[200:203], v247 offset:3072
    s_waitcnt lgkmcnt(6)
    v_mfma_f32_16x16x32_bf16 v[40:43], v[204:207], v[140:143], v[40:43]
    v_mul_f32 v236, 0xbacccccd, v232
    s_waitcnt vmcnt(8)
    ds_read_b128 v[204:207], v247 offset:4096
    v_mfma_f32_16x16x32_bf16 v[24:27], v[208:211], v[144:147], v[24:27]
    ds_read_b128 v[208:211], v247 offset:5120
    s_waitcnt lgkmcnt(6)
    v_mfma_f32_16x16x32_bf16 v[28:31], v[212:215], v[144:147], v[28:31]
    v_mul_f32 v233, 0x3acccccd, v233
    ds_read_b128 v[212:215], v247 offset:6144
    v_mfma_f32_16x16x32_bf16 v[32:35], v[216:219], v[144:147], v[32:35]
    ds_read_b128 v[216:219], v247 offset:7168
    s_waitcnt lgkmcnt(6)
    v_mfma_f32_16x16x32_bf16 v[36:39], v[220:223], v[144:147], v[36:39]
    v_fma_f32 v233, -v236, v236, v233
    ds_read_b128 v[220:223], v247 offset:8192
    v_mfma_f32_16x16x32_bf16 v[40:43], v[224:227], v[144:147], v[40:43]
    s_waitcnt vmcnt(7)
    ds_read_b128 v[224:227], v247 offset:9216
    s_waitcnt lgkmcnt(6)
    v_mfma_f32_16x16x32_bf16 v[24:27], v[196:199], v[148:151], v[24:27]
    v_max_f32 v233, 0, v233
    ds_read_b128 v[196:199], v247 offset:10240
    v_mfma_f32_16x16x32_bf16 v[28:31], v[200:203], v[148:151], v[28:31]
    ds_read_b128 v[200:203], v247 offset:11264
    s_waitcnt lgkmcnt(6)
    v_mfma_f32_16x16x32_bf16 v[32:35], v[204:207], v[148:151], v[32:35]
    v_add_f32 v232, 0x3727c5ac, v233
    ds_read_b128 v[204:207], v247 offset:12288
    v_mfma_f32_16x16x32_bf16 v[36:39], v[208:211], v[148:151], v[36:39]
    ds_read_b128 v[208:211], v247 offset:13312
    s_waitcnt lgkmcnt(6)
    v_mfma_f32_16x16x32_bf16 v[40:43], v[212:215], v[148:151], v[40:43]
    v_rsq_f32 v238, v232
    s_waitcnt vmcnt(6)
    ds_read_b128 v[212:215], v247 offset:14336
    v_mfma_f32_16x16x32_bf16 v[24:27], v[216:219], v[152:155], v[24:27]
    ds_read_b128 v[216:219], v247 offset:15360
    s_waitcnt lgkmcnt(6)
    v_mfma_f32_16x16x32_bf16 v[28:31], v[220:223], v[152:155], v[28:31]
    v_mul_f32 v232, v238, v238
    ds_read_b128 v[220:223], v247 offset:16384
    v_mfma_f32_16x16x32_bf16 v[32:35], v[224:227], v[152:155], v[32:35]
    ds_read_b128 v[224:227], v247 offset:17408
    s_waitcnt lgkmcnt(6)
    v_mfma_f32_16x16x32_bf16 v[36:39], v[196:199], v[152:155], v[36:39]
    v_fmaak_f32 v232, v232, v233, 0x3727c5ac
    ds_read_b128 v[196:199], v247 offset:18432
    v_mfma_f32_16x16x32_bf16 v[40:43], v[200:203], v[152:155], v[40:43]
    s_waitcnt vmcnt(5)
    ds_read_b128 v[200:203], v247 offset:19456
    s_waitcnt lgkmcnt(6)
    v_mfma_f32_16x16x32_bf16 v[24:27], v[204:207], v[164:167], v[24:27]
    v_rsq_f32 v232, v232
    ds_read_b128 v[204:207], v247 offset:20480
    v_mfma_f32_16x16x32_bf16 v[28:31], v[208:211], v[164:167], v[28:31]
    ds_read_b128 v[208:211], v247 offset:21504
    s_waitcnt lgkmcnt(6)
    v_mfma_f32_16x16x32_bf16 v[32:35], v[212:215], v[164:167], v[32:35]
    v_mul_f32 v232, v232, v238
    ds_read_b128 v[212:215], v247 offset:22528
    v_mfma_f32_16x16x32_bf16 v[36:39], v[216:219], v[164:167], v[36:39]
    ds_read_b128 v[216:219], v247 offset:23552
    s_waitcnt lgkmcnt(6)
    v_mfma_f32_16x16x32_bf16 v[40:43], v[220:223], v[164:167], v[40:43]
    v_rcp_f32 v234, v232
    s_waitcnt vmcnt(4)
    ds_read_b128 v[220:223], v247 offset:24576
    v_mfma_f32_16x16x32_bf16 v[24:27], v[224:227], v[168:171], v[24:27]
    ds_read_b128 v[224:227], v247 offset:25600
    s_waitcnt lgkmcnt(6)
    v_mfma_f32_16x16x32_bf16 v[28:31], v[196:199], v[168:171], v[28:31]
    v_mul_f32 v240, 0xc0135761, v232
    ds_read_b128 v[196:199], v247 offset:26624
    v_mfma_f32_16x16x32_bf16 v[32:35], v[200:203], v[168:171], v[32:35]
    ds_read_b128 v[200:203], v247 offset:27648
    s_waitcnt lgkmcnt(6)
    v_mfma_f32_16x16x32_bf16 v[36:39], v[204:207], v[168:171], v[36:39]
    v_mul_f32 v233, v232, v232
    ds_read_b128 v[204:207], v247 offset:28672
    v_mfma_f32_16x16x32_bf16 v[40:43], v[208:211], v[168:171], v[40:43]
    s_waitcnt vmcnt(3)
    ds_read_b128 v[208:211], v247 offset:29696
    s_waitcnt lgkmcnt(6)
    v_mfma_f32_16x16x32_bf16 v[24:27], v[212:215], v[172:175], v[24:27]
    v_mul_f32 v233, v233, v232
    ds_read_b128 v[212:215], v247 offset:30720
    v_mfma_f32_16x16x32_bf16 v[28:31], v[216:219], v[172:175], v[28:31]
    ds_read_b128 v[216:219], v247 offset:31744
    s_waitcnt lgkmcnt(6)
    v_mfma_f32_16x16x32_bf16 v[32:35], v[220:223], v[172:175], v[32:35]
    v_mul_f32 v242, 0xbdd2d3e8, v233
    ds_read_b128 v[220:223], v247 offset:32768
    v_mfma_f32_16x16x32_bf16 v[36:39], v[224:227], v[172:175], v[36:39]
    ds_read_b128 v[224:227], v247 offset:33792
    s_waitcnt lgkmcnt(6)
    v_mfma_f32_16x16x32_bf16 v[40:43], v[196:199], v[172:175], v[40:43]
    s_waitcnt vmcnt(2)
    ds_read_b128 v[196:199], v247 offset:34816
    v_mfma_f32_16x16x32_bf16 v[24:27], v[200:203], v[176:179], v[24:27]
    ds_read_b128 v[200:203], v247 offset:35840
    s_waitcnt lgkmcnt(6)
    v_mfma_f32_16x16x32_bf16 v[28:31], v[204:207], v[176:179], v[28:31]
    ds_read_b128 v[204:207], v247 offset:36864
    v_mfma_f32_16x16x32_bf16 v[32:35], v[208:211], v[176:179], v[32:35]
    ds_read_b128 v[208:211], v247 offset:37888
    s_waitcnt lgkmcnt(6)
    v_mfma_f32_16x16x32_bf16 v[36:39], v[212:215], v[176:179], v[36:39]
    ds_read_b128 v[212:215], v247 offset:38912
    v_mfma_f32_16x16x32_bf16 v[40:43], v[216:219], v[176:179], v[40:43]
    s_waitcnt vmcnt(1)
    ds_read_b128 v[216:219], v247 offset:39936
    s_waitcnt lgkmcnt(6)
    v_mfma_f32_16x16x32_bf16 v[24:27], v[220:223], v[188:191], v[24:27]
    ds_read_b128 v[220:223], v247 offset:40960
    v_mfma_f32_16x16x32_bf16 v[28:31], v[224:227], v[188:191], v[28:31]
    ds_read_b128 v[224:227], v247 offset:41984
    s_waitcnt lgkmcnt(6)
    v_mfma_f32_16x16x32_bf16 v[32:35], v[196:199], v[188:191], v[32:35]
    v_mfma_f32_16x16x32_bf16 v[36:39], v[200:203], v[188:191], v[36:39]
    s_waitcnt lgkmcnt(4)
    v_mfma_f32_16x16x32_bf16 v[40:43], v[204:207], v[188:191], v[40:43]
    s_waitcnt vmcnt(0)
    v_mfma_f32_16x16x32_bf16 v[24:27], v[208:211], v[192:195], v[24:27]
    s_waitcnt lgkmcnt(2)
    v_mfma_f32_16x16x32_bf16 v[28:31], v[212:215], v[192:195], v[28:31]
    v_mfma_f32_16x16x32_bf16 v[32:35], v[216:219], v[192:195], v[32:35]
    s_waitcnt lgkmcnt(0)
    v_mfma_f32_16x16x32_bf16 v[36:39], v[220:223], v[192:195], v[36:39]
    v_mfma_f32_16x16x32_bf16 v[40:43], v[224:227], v[192:195], v[40:43]
    v_mov_b32 v253, 4
    ds_write_b32 v251, v253 offset:1552
    s_nop 2
    v_pk_fma_f32 v[24:25], v[44:45], v[236:237], v[24:25] op_sel_hi:[1,0,1]
    v_pk_fma_f32 v[26:27], v[46:47], v[236:237], v[26:27] op_sel_hi:[1,0,1]
    v_pk_fma_f32 v[28:29], v[48:49], v[236:237], v[28:29] op_sel_hi:[1,0,1]
    v_pk_fma_f32 v[30:31], v[50:51], v[236:237], v[30:31] op_sel_hi:[1,0,1]
    v_pk_fma_f32 v[32:33], v[52:53], v[236:237], v[32:33] op_sel_hi:[1,0,1]
    v_pk_fma_f32 v[34:35], v[54:55], v[236:237], v[34:35] op_sel_hi:[1,0,1]
    v_pk_fma_f32 v[36:37], v[56:57], v[236:237], v[36:37] op_sel_hi:[1,0,1]
    v_pk_fma_f32 v[38:39], v[58:59], v[236:237], v[38:39] op_sel_hi:[1,0,1]
    v_pk_fma_f32 v[40:41], v[60:61], v[236:237], v[40:41] op_sel_hi:[1,0,1]
    v_pk_fma_f32 v[42:43], v[62:63], v[236:237], v[42:43] op_sel_hi:[1,0,1]
    v_pk_mul_f32 v[100:101], v[24:25], v[24:25]
    v_pk_mul_f32 v[102:103], v[26:27], v[26:27]
    v_pk_mul_f32 v[104:105], v[28:29], v[28:29]
    v_pk_mul_f32 v[106:107], v[30:31], v[30:31]
    v_pk_mul_f32 v[108:109], v[32:33], v[32:33]
    v_pk_mul_f32 v[110:111], v[34:35], v[34:35]
    v_pk_mul_f32 v[112:113], v[36:37], v[36:37]
    v_pk_mul_f32 v[114:115], v[38:39], v[38:39]
    v_pk_mul_f32 v[116:117], v[40:41], v[40:41]
    v_pk_mul_f32 v[118:119], v[42:43], v[42:43]
    v_pk_fma_f32 v[100:101], v[100:101], v[242:243], v[240:241] op_sel_hi:[1,0,0]
    v_pk_fma_f32 v[102:103], v[102:103], v[242:243], v[240:241] op_sel_hi:[1,0,0]
    v_pk_fma_f32 v[104:105], v[104:105], v[242:243], v[240:241] op_sel_hi:[1,0,0]
    v_pk_fma_f32 v[106:107], v[106:107], v[242:243], v[240:241] op_sel_hi:[1,0,0]
    v_pk_fma_f32 v[108:109], v[108:109], v[242:243], v[240:241] op_sel_hi:[1,0,0]
    v_pk_fma_f32 v[110:111], v[110:111], v[242:243], v[240:241] op_sel_hi:[1,0,0]
    v_pk_fma_f32 v[112:113], v[112:113], v[242:243], v[240:241] op_sel_hi:[1,0,0]
    v_pk_fma_f32 v[114:115], v[114:115], v[242:243], v[240:241] op_sel_hi:[1,0,0]
    v_pk_fma_f32 v[116:117], v[116:117], v[242:243], v[240:241] op_sel_hi:[1,0,0]
    v_pk_fma_f32 v[118:119], v[118:119], v[242:243], v[240:241] op_sel_hi:[1,0,0]
    v_pk_mul_f32 v[100:101], v[100:101], v[24:25]
    v_pk_mul_f32 v[102:103], v[102:103], v[26:27]
    v_pk_mul_f32 v[104:105], v[104:105], v[28:29]
    v_pk_mul_f32 v[106:107], v[106:107], v[30:31]
    v_pk_mul_f32 v[108:109], v[108:109], v[32:33]
    v_pk_mul_f32 v[110:111], v[110:111], v[34:35]
    v_pk_mul_f32 v[112:113], v[112:113], v[36:37]
    v_pk_mul_f32 v[114:115], v[114:115], v[38:39]
    v_pk_mul_f32 v[116:117], v[116:117], v[40:41]
    v_pk_mul_f32 v[118:119], v[118:119], v[42:43]
    v_exp_f32 v100, v100
    v_exp_f32 v101, v101
    v_exp_f32 v102, v102
    v_exp_f32 v103, v103
    v_exp_f32 v104, v104
    v_exp_f32 v105, v105
    v_exp_f32 v106, v106
    v_exp_f32 v107, v107
    v_exp_f32 v108, v108
    v_exp_f32 v109, v109
    v_exp_f32 v110, v110
    v_exp_f32 v111, v111
    v_exp_f32 v112, v112
    v_exp_f32 v113, v113
    v_exp_f32 v114, v114
    v_exp_f32 v115, v115
    v_exp_f32 v116, v116
    v_exp_f32 v117, v117
    v_exp_f32 v118, v118
    v_exp_f32 v119, v119
    v_pk_fma_f32 v[100:101], v[100:101], v[234:235], v[234:235] op_sel_hi:[1,0,0]
    v_pk_fma_f32 v[102:103], v[102:103], v[234:235], v[234:235] op_sel_hi:[1,0,0]
    v_pk_fma_f32 v[104:105], v[104:105], v[234:235], v[234:235] op_sel_hi:[1,0,0]
    v_pk_fma_f32 v[106:107], v[106:107], v[234:235], v[234:235] op_sel_hi:[1,0,0]
    v_pk_fma_f32 v[108:109], v[108:109], v[234:235], v[234:235] op_sel_hi:[1,0,0]
    v_pk_fma_f32 v[110:111], v[110:111], v[234:235], v[234:235] op_sel_hi:[1,0,0]
    v_pk_fma_f32 v[112:113], v[112:113], v[234:235], v[234:235] op_sel_hi:[1,0,0]
    v_pk_fma_f32 v[114:115], v[114:115], v[234:235], v[234:235] op_sel_hi:[1,0,0]
    v_pk_fma_f32 v[116:117], v[116:117], v[234:235], v[234:235] op_sel_hi:[1,0,0]
    v_pk_fma_f32 v[118:119], v[118:119], v[234:235], v[234:235] op_sel_hi:[1,0,0]
    v_rcp_f32 v100, v100
    v_rcp_f32 v101, v101
    v_rcp_f32 v102, v102
    v_rcp_f32 v103, v103
    v_rcp_f32 v104, v104
    v_rcp_f32 v105, v105
    v_rcp_f32 v106, v106
    v_rcp_f32 v107, v107
    v_rcp_f32 v108, v108
    v_rcp_f32 v109, v109
    v_rcp_f32 v110, v110
    v_rcp_f32 v111, v111
    v_rcp_f32 v112, v112
    v_rcp_f32 v113, v113
    v_rcp_f32 v114, v114
    v_rcp_f32 v115, v115
    v_rcp_f32 v116, v116
    v_rcp_f32 v117, v117
    v_rcp_f32 v118, v118
    v_rcp_f32 v119, v119
    v_pk_mul_f32 v[24:25], v[24:25], v[100:101]
    v_pk_mul_f32 v[26:27], v[26:27], v[102:103]
    v_pk_mul_f32 v[28:29], v[28:29], v[104:105]
    v_pk_mul_f32 v[30:31], v[30:31], v[106:107]
    v_pk_mul_f32 v[32:33], v[32:33], v[108:109]
    v_pk_mul_f32 v[34:35], v[34:35], v[110:111]
    v_pk_mul_f32 v[36:37], v[36:37], v[112:113]
    v_pk_mul_f32 v[38:39], v[38:39], v[114:115]
    v_pk_mul_f32 v[40:41], v[40:41], v[116:117]
    v_pk_mul_f32 v[42:43], v[42:43], v[118:119]
    s_add_u32 s52, s46, 16252928
    s_add_u32 s53, s47, 16252928
    v_cvt_pk_bf16_f32 v132, v24, v25
    v_cvt_pk_bf16_f32 v133, v26, v27
    v_cvt_pk_bf16_f32 v134, v28, v29
    v_cvt_pk_bf16_f32 v135, v30, v31
    v_cvt_pk_bf16_f32 v136, v32, v33
    v_cvt_pk_bf16_f32 v137, v34, v35
    v_cvt_pk_bf16_f32 v138, v36, v37
    v_cvt_pk_bf16_f32 v139, v38, v39
    buffer_store_dwordx4 v[132:135], v2, s[20:23], s52 offen sc1
    buffer_store_dwordx4 v[136:139], v2, s[20:23], s52 offen offset:1024 sc1
    v_cvt_pk_bf16_f32 v142, v40, v41
    v_cvt_pk_bf16_f32 v143, v42, v43
    s_cmp_eq_u32 s43, 1
    s_cbranch_scc1 K2_SO_33
    buffer_store_dwordx4 v[140:143], v2, s[20:23], s53 offen sc1
    s_branch K2_SD_34
K2_SO_33:
    buffer_store_dwordx4 v[142:145], v2, s[20:23], s53 offen sc1
K2_SD_34:
    v_mul_f32 v232, v236, v238
    v_pk_fma_f32 v[4:5], v[80:81], v[238:239], v[232:233] op_sel_hi:[1,0,0]
    v_pk_fma_f32 v[6:7], v[82:83], v[238:239], v[232:233] op_sel_hi:[1,0,0]
    v_pk_fma_f32 v[8:9], v[84:85], v[238:239], v[232:233] op_sel_hi:[1,0,0]
    v_pk_fma_f32 v[10:11], v[86:87], v[238:239], v[232:233] op_sel_hi:[1,0,0]
    v_pk_fma_f32 v[12:13], v[88:89], v[238:239], v[232:233] op_sel_hi:[1,0,0]
    v_pk_fma_f32 v[14:15], v[90:91], v[238:239], v[232:233] op_sel_hi:[1,0,0]
    v_pk_fma_f32 v[16:17], v[92:93], v[238:239], v[232:233] op_sel_hi:[1,0,0]
    v_pk_fma_f32 v[18:19], v[94:95], v[238:239], v[232:233] op_sel_hi:[1,0,0]
    v_pk_fma_f32 v[20:21], v[96:97], v[238:239], v[232:233] op_sel_hi:[1,0,0]
    v_pk_fma_f32 v[22:23], v[98:99], v[238:239], v[232:233] op_sel_hi:[1,0,0]
    s_add_u32 s36, s20, 16252928
    s_addc_u32 s37, s21, 0
    s_mov_b32 s38, 3145728
    s_mov_b32 s39, 0x00020000
    v_and_b32 v44, 15, v1
    v_lshrrev_b32 v45, 4, v1
    s_lshl_b32 s52, s67, 4
    v_add_u32 v44, s52, v44
    s_mov_b32 s53, 24576
    v_add_u32 v46, -1, v44
    v_ashrrev_i32 v47, 4, v46
    v_and_b32 v46, 15, v46
    v_mul_lo_u32 v47, v47, s53
    v_lshl_add_u32 v47, v46, 4, v47
    v_lshl_add_u32 v48, v45, 8, v47
    v_add_u32 v46, 1, v44
    v_ashrrev_i32 v47, 4, v46
    v_and_b32 v46, 15, v46
    v_mul_lo_u32 v47, v47, s53
    v_lshl_add_u32 v47, v46, 4, v47
    v_lshl_add_u32 v49, v45, 8, v47
    v_add_u32 v46, -2, v44
    v_ashrrev_i32 v47, 4, v46
    v_and_b32 v46, 15, v46
    v_mul_lo_u32 v47, v47, s53
    v_lshl_add_u32 v47, v46, 4, v47
    v_lshl_add_u32 v50, v45, 8, v47
    v_add_u32 v46, 2, v44
    v_ashrrev_i32 v47, 4, v46
    v_and_b32 v46, 15, v46
    v_mul_lo_u32 v47, v47, s53
    v_lshl_add_u32 v47, v46, 4, v47
    v_lshl_add_u32 v51, v45, 8, v47
    s_mov_b32 s54, 0
    s_mov_b32 s55, 4096
    s_mov_b32 s56, 8192
    s_mov_b32 s57, 12288
    s_mov_b32 s58, 16384
    s_mov_b32 s59, 20480
    s_waitcnt vmcnt(0)
    s_mov_b32 s52, 0
    s_mov_b64 exec, 3
    buffer_atomic_add v243, v228, s[8:11], s52 offen sc1
    s_mov_b64 exec, -1
    s_mov_b32 s53, 32768
    s_add_u32 s62, s48, 19423232
    s_mov_b64 exec, 1
    v_mov_b32 v229, 0
    buffer_atomic_add v229, v255, s[20:23], s62 offen sc0 sc1
    s_sleep 4
    v_mov_b32 v230, 0
    buffer_atomic_add v230, v255, s[20:23], s62 offen sc0 sc1
K2_HL_35:
    s_waitcnt vmcnt(1)
    v_cmp_gt_u32 vcc, s49, v229
    s_cbranch_vccz K2_HX_36
    v_mov_b32 v229, 0
    buffer_atomic_add v229, v255, s[20:23], s62 offen sc0 sc1
    s_waitcnt vmcnt(1)
    v_cmp_gt_u32 vcc, s49, v230
    s_cbranch_vccz K2_HX_36
    v_mov_b32 v230, 0
    buffer_atomic_add v230, v255, s[20:23], s62 offen sc0 sc1
    s_sub_u32 s53, s53, 1
    s_cmp_lg_u32 s53, 0
    s_cbranch_scc1 K2_HL_35
K2_HX_36:
    s_mov_b64 exec, -1
    ds_read_b32 v252, v250 offset:1536
    buffer_load_dwordx4 v[108:111], v48, s[36:39], s54 offen offset:2048 sc1
    buffer_load_dwordx4 v[112:115], v48, s[36:39], s54 offen offset:3072 sc1
    buffer_load_dwordx4 v[132:135], v49, s[36:39], s56 offen offset:0 sc1
    buffer_load_dwordx4 v[136:139], v49, s[36:39], s56 offen offset:1024 sc1
    buffer_load_dwordx4 v[156:159], v50, s[36:39], s57 offen offset:2048 sc1
    buffer_load_dwordx4 v[160:163], v50, s[36:39], s57 offen offset:3072 sc1
    buffer_load_dwordx4 v[180:183], v51, s[36:39], s59 offen offset:0 sc1
    buffer_load_dwordx4 v[184:187], v51, s[36:39], s59 offen offset:1024 sc1
    buffer_load_dwordx4 v[100:103], v48, s[36:39], s54 offen offset:0 sc1
    buffer_load_dwordx4 v[104:107], v48, s[36:39], s54 offen offset:1024 sc1
    buffer_load_dwordx4 v[116:119], v48, s[36:39], s55 offen offset:0 sc1
    buffer_load_dwordx4 v[120:123], v48, s[36:39], s55 offen offset:1024 sc1
    buffer_load_dwordx4 v[124:127], v49, s[36:39], s55 offen offset:2048 sc1
    buffer_load_dwordx4 v[128:131], v49, s[36:39], s55 offen offset:3072 sc1
    s_waitcnt lgkmcnt(0)
    v_cmp_gt_u32 vcc, 4, v252
    s_cbranch_vccnz K2_FW_37
K2_FB_38:
    ds_read_b128 v[196:199], v247 offset:43008
    ds_read_b128 v[200:203], v247 offset:44032
    ds_read_b128 v[204:207], v247 offset:45056
    ds_read_b128 v[208:211], v247 offset:46080
    ds_read_b128 v[212:215], v247 offset:47104
    ds_read_b128 v[216:219], v247 offset:48128
    ds_read_b128 v[220:223], v247 offset:49152
    s_waitcnt vmcnt(12)
    ds_read_b128 v[224:227], v247 offset:50176
    s_waitcnt lgkmcnt(6)
    v_mfma_f32_16x16x32_bf16 v[4:7], v[196:199], v[110:113], v[4:7]
    ds_read_b128 v[196:199], v247 offset:51200
    v_mfma_f32_16x16x32_bf16 v[8:11], v[200:203], v[110:113], v[8:11]
    ds_read_b128 v[200:203], v247 offset:52224
    s_waitcnt lgkmcnt(6)
    v_mfma_f32_16x16x32_bf16 v[12:15], v[204:207], v[110:113], v[12:15]
    ds_read_b128 v[204:207], v247 offset:53248
    v_mfma_f32_16x16x32_bf16 v[16:19], v[208:211], v[110:113], v[16:19]
    ds_read_b128 v[208:211], v247 offset:54272
    s_waitcnt lgkmcnt(6)
    v_mfma_f32_16x16x32_bf16 v[20:23], v[212:215], v[110:113], v[20:23]
    buffer_load_dwordx4 v[140:143], v49, s[36:39], s56 offen offset:2048 sc1
    buffer_load_dwordx4 v[144:147], v49, s[36:39], s56 offen offset:3072 sc1
    s_waitcnt vmcnt(12)
    ds_read_b128 v[212:215], v247 offset:55296
    v_mfma_f32_16x16x32_bf16 v[4:7], v[216:219], v[134:137], v[4:7]
    ds_read_b128 v[216:219], v247 offset:56320
    s_waitcnt lgkmcnt(6)
    v_mfma_f32_16x16x32_bf16 v[8:11], v[220:223], v[134:137], v[8:11]
    ds_read_b128 v[220:223], v247 offset:57344
    v_mfma_f32_16x16x32_bf16 v[12:15], v[224:227], v[134:137], v[12:15]
    ds_read_b128 v[224:227], v247 offset:58368
    s_waitcnt lgkmcnt(6)
    v_mfma_f32_16x16x32_bf16 v[16:19], v[196:199], v[134:137], v[16:19]
    ds_read_b128 v[196:199], v247 offset:59392
    v_mfma_f32_16x16x32_bf16 v[20:23], v[200:203], v[134:137], v[20:23]
    buffer_load_dwordx4 v[148:151], v50, s[36:39], s57 offen offset:0 sc1
    buffer_load_dwordx4 v[152:155], v50, s[36:39], s57 offen offset:1024 sc1
    s_waitcnt vmcnt(12)
    ds_read_b128 v[200:203], v247 offset:60416
    s_waitcnt lgkmcnt(6)
    v_mfma_f32_16x16x32_bf16 v[4:7], v[204:207], v[158:161], v[4:7]
    ds_read_b128 v[204:207], v247 offset:61440
    v_mfma_f32_16x16x32_bf16 v[8:11], v[208:211], v[158:161], v[8:11]
    ds_read_b128 v[208:211], v247 offset:62464
    s_waitcnt lgkmcnt(6)
    v_mfma_f32_16x16x32_bf16 v[12:15], v[212:215], v[158:161], v[12:15]
    ds_read_b128 v[212:215], v247 offset:63488
    v_mfma_f32_16x16x32_bf16 v[16:19], v[216:219], v[158:161], v[16:19]
    ds_read_b128 v[216:219], v247 offset:64512
    s_waitcnt lgkmcnt(6)
    v_mfma_f32_16x16x32_bf16 v[20:23], v[220:223], v[158:161], v[20:23]
    buffer_load_dwordx4 v[164:167], v50, s[36:39], s58 offen offset:0 sc1
    buffer_load_dwordx4 v[168:171], v50, s[36:39], s58 offen offset:1024 sc1
    s_waitcnt vmcnt(12)
    ds_read_b128 v[220:223], v248 offset:0
    v_mfma_f32_16x16x32_bf16 v[4:7], v[224:227], v[182:185], v[4:7]
    ds_read_b128 v[224:227], v248 offset:1024
    s_waitcnt lgkmcnt(6)
    v_mfma_f32_16x16x32_bf16 v[8:11], v[196:199], v[182:185], v[8:11]
    ds_read_b128 v[196:199], v248 offset:2048
    v_mfma_f32_16x16x32_bf16 v[12:15], v[200:203], v[182:185], v[12:15]
    ds_read_b128 v[200:203], v248 offset:3072
    s_waitcnt lgkmcnt(6)
    v_mfma_f32_16x16x32_bf16 v[16:19], v[204:207], v[182:185], v[16:19]
    ds_read_b128 v[204:207], v248 offset:4096
    v_mfma_f32_16x16x32_bf16 v[20:23], v[208:211], v[182:185], v[20:23]
    buffer_load_dwordx4 v[172:175], v51, s[36:39], s58 offen offset:2048 sc1
    buffer_load_dwordx4 v[176:179], v51, s[36:39], s58 offen offset:3072 sc1
    s_waitcnt vmcnt(13)
    ds_read_b128 v[208:211], v248 offset:5120
    s_waitcnt lgkmcnt(6)
    v_mfma_f32_16x16x32_bf16 v[4:7], v[212:215], v[100:103], v[4:7]
    ds_read_b128 v[212:215], v248 offset:6144
    v_mfma_f32_16x16x32_bf16 v[8:11], v[216:219], v[100:103], v[8:11]
    ds_read_b128 v[216:219], v248 offset:7168
    s_waitcnt lgkmcnt(6)
    v_mfma_f32_16x16x32_bf16 v[12:15], v[220:223], v[100:103], v[12:15]
    ds_read_b128 v[220:223], v248 offset:8192
    v_mfma_f32_16x16x32_bf16 v[16:19], v[224:227], v[100:103], v[16:19]
    ds_read_b128 v[224:227], v248 offset:9216
    s_waitcnt lgkmcnt(6)
    v_mfma_f32_16x16x32_bf16 v[20:23], v[196:199], v[100:103], v[20:23]
    buffer_load_dwordx4 v[188:191], v51, s[36:39], s59 offen offset:2048 sc1
    buffer_load_dwordx4 v[192:195], v51, s[36:39], s59 offen offset:3072 sc1
    s_waitcnt vmcnt(14)
    ds_read_b128 v[196:199], v248 offset:10240
    v_mfma_f32_16x16x32_bf16 v[4:7], v[200:203], v[104:107], v[4:7]
    ds_read_b128 v[200:203], v248 offset:11264
    s_waitcnt lgkmcnt(6)
    v_mfma_f32_16x16x32_bf16 v[8:11], v[204:207], v[104:107], v[8:11]
    ds_read_b128 v[204:207], v248 offset:12288
    v_mfma_f32_16x16x32_bf16 v[12:15], v[208:211], v[104:107], v[12:15]
    ds_read_b128 v[208:211], v248 offset:13312
    s_waitcnt lgkmcnt(6)
    v_mfma_f32_16x16x32_bf16 v[16:19], v[212:215], v[104:107], v[16:19]
    ds_read_b128 v[212:215], v248 offset:14336
    v_mfma_f32_16x16x32_bf16 v[20:23], v[216:219], v[104:107], v[20:23]
    s_waitcnt vmcnt(13)
    ds_read_b128 v[216:219], v248 offset:15360
    s_waitcnt lgkmcnt(6)
    v_mfma_f32_16x16x32_bf16 v[4:7], v[220:223], v[116:119], v[4:7]
    ds_read_b128 v[220:223], v248 offset:16384
    v_mfma_f32_16x16x32_bf16 v[8:11], v[224:227], v[116:119], v[8:11]
    ds_read_b128 v[224:227], v248 offset:17408
    s_waitcnt lgkmcnt(6)
    v_mfma_f32_16x16x32_bf16 v[12:15], v[196:199], v[116:119], v[12:15]
    ds_read_b128 v[196:199], v248 offset:18432
    v_mfma_f32_16x16x32_bf16 v[16:19], v[200:203], v[116:119], v[16:19]
    ds_read_b128 v[200:203], v248 offset:19456
    s_waitcnt lgkmcnt(6)
    v_mfma_f32_16x16x32_bf16 v[20:23], v[204:207], v[116:119], v[20:23]
    v_mov_b32 v253, 5
    ds_write_b32 v251, v253 offset:1552
    s_waitcnt vmcnt(12)
    ds_read_b128 v[204:207], v248 offset:20480
    v_mfma_f32_16x16x32_bf16 v[4:7], v[208:211], v[120:123], v[4:7]
    ds_read_b128 v[208:211], v248 offset:21504
    s_waitcnt lgkmcnt(7)
    v_mfma_f32_16x16x32_bf16 v[8:11], v[212:215], v[120:123], v[8:11]
    ds_read_b128 v[212:215], v248 offset:22528
    v_mfma_f32_16x16x32_bf16 v[12:15], v[216:219], v[120:123], v[12:15]
    ds_read_b128 v[216:219], v248 offset:23552
    s_waitcnt lgkmcnt(7)
    v_mfma_f32_16x16x32_bf16 v[16:19], v[220:223], v[120:123], v[16:19]
    ds_read_b128 v[220:223], v248 offset:24576
    v_mfma_f32_16x16x32_bf16 v[20:23], v[224:227], v[120:123], v[20:23]
    s_waitcnt vmcnt(11)
    ds_read_b128 v[224:227], v248 offset:25600
    s_waitcnt lgkmcnt(7)
    v_mfma_f32_16x16x32_bf16 v[4:7], v[196:199], v[124:127], v[4:7]
    ds_read_b128 v[196:199], v248 offset:26624
    v_mfma_f32_16x16x32_bf16 v[8:11], v[200:203], v[124:127], v[8:11]
    ds_read_b128 v[200:203], v248 offset:27648
    s_waitcnt lgkmcnt(6)
    v_mfma_f32_16x16x32_bf16 v[12:15], v[204:207], v[124:127], v[12:15]
    ds_read_b128 v[204:207], v248 offset:28672
    v_mfma_f32_16x16x32_bf16 v[16:19], v[208:211], v[124:127], v[16:19]
    ds_read_b128 v[208:211], v248 offset:29696
    s_waitcnt lgkmcnt(6)
    v_mfma_f32_16x16x32_bf16 v[20:23], v[212:215], v[124:127], v[20:23]
    s_waitcnt vmcnt(10)
    ds_read_b128 v[212:215], v248 offset:30720
    v_mfma_f32_16x16x32_bf16 v[4:7], v[216:219], v[128:131], v[4:7]
    ds_read_b128 v[216:219], v248 offset:31744
    s_waitcnt lgkmcnt(6)
    v_mfma_f32_16x16x32_bf16 v[8:11], v[220:223], v[128:131], v[8:11]
    ds_read_b128 v[220:223], v248 offset:32768
    ds_read_b32 v252, v250 offset:1536
    v_mfma_f32_16x16x32_bf16 v[12:15], v[224:227], v[128:131], v[12:15]
    ds_read_b128 v[224:227], v248 offset:33792
    s_waitcnt lgkmcnt(7)
    v_mfma_f32_16x16x32_bf16 v[16:19], v[196:199], v[128:131], v[16:19]
    ds_read_b128 v[196:199], v248 offset:34816
    v_mfma_f32_16x16x32_bf16 v[20:23], v[200:203], v[128:131], v[20:23]
    s_waitcnt vmcnt(9)
    ds_read_b128 v[200:203], v248 offset:35840
    s_waitcnt lgkmcnt(7)
    v_mfma_f32_16x16x32_bf16 v[4:7], v[204:207], v[140:143], v[4:7]
    s_waitcnt lgkmcnt(3)
    v_cmp_gt_u32 vcc, 5, v252
    s_cbranch_vccnz K2_FW_39
K2_FB_40:
    ds_read_b128 v[204:207], v248 offset:36864
    v_mfma_f32_16x16x32_bf16 v[8:11], v[208:211], v[140:143], v[8:11]
    ds_read_b128 v[208:211], v248 offset:37888
    v_mfma_f32_16x16x32_bf16 v[12:15], v[212:215], v[140:143], v[12:15]
    ds_read_b128 v[212:215], v248 offset:38912
    v_mfma_f32_16x16x32_bf16 v[16:19], v[216:219], v[140:143], v[16:19]
    ds_read_b128 v[216:219], v248 offset:39936
    s_waitcnt lgkmcnt(6)
    v_mfma_f32_16x16x32_bf16 v[20:23], v[220:223], v[140:143], v[20:23]
    s_waitcnt vmcnt(8)
    ds_read_b128 v[220:223], v248 offset:40960
    v_mfma_f32_16x16x32_bf16 v[4:7], v[224:227], v[144:147], v[4:7]
    ds_read_b128 v[224:227], v248 offset:41984
    s_waitcnt lgkmcnt(6)
    v_mfma_f32_16x16x32_bf16 v[8:11], v[196:199], v[144:147], v[8:11]
    ds_read_b128 v[196:199], v248 offset:43008
    v_mfma_f32_16x16x32_bf16 v[12:15], v[200:203], v[144:147], v[12:15]
    ds_read_b128 v[200:203], v248 offset:44032
    s_waitcnt lgkmcnt(6)
    v_mfma_f32_16x16x32_bf16 v[16:19], v[204:207], v[144:147], v[16:19]
    ds_read_b128 v[204:207], v248 offset:45056
    v_mfma_f32_16x16x32_bf16 v[20:23], v[208:211], v[144:147], v[20:23]
    s_waitcnt vmcnt(7)
    ds_read_b128 v[208:211], v248 offset:46080
    s_waitcnt lgkmcnt(6)
    v_mfma_f32_16x16x32_bf16 v[4:7], v[212:215], v[148:151], v[4:7]
    ds_read_b128 v[212:215], v248 offset:47104
    v_mfma_f32_16x16x32_bf16 v[8:11], v[216:219], v[148:151], v[8:11]
    ds_read_b128 v[216:219], v248 offset:48128
    s_waitcnt lgkmcnt(6)
    v_mfma_f32_16x16x32_bf16 v[12:15], v[220:223], v[148:151], v[12:15]
    ds_read_b128 v[220:223], v248 offset:49152
    v_mfma_f32_16x16x32_bf16 v[16:19], v[224:227], v[148:151], v[16:19]
    ds_read_b128 v[224:227], v248 offset:50176
    s_waitcnt lgkmcnt(6)
    v_mfma_f32_16x16x32_bf16 v[20:23], v[196:199], v[148:151], v[20:23]
    s_waitcnt vmcnt(6)
    ds_read_b128 v[196:199], v248 offset:51200
    v_mfma_f32_16x16x32_bf16 v[4:7], v[200:203], v[152:155], v[4:7]
    ds_read_b128 v[200:203], v248 offset:52224
    s_waitcnt lgkmcnt(6)
    v_mfma_f32_16x16x32_bf16 v[8:11], v[204:207], v[152:155], v[8:11]
    ds_read_b128 v[204:207], v248 offset:53248
    v_mfma_f32_16x16x32_bf16 v[12:15], v[208:211], v[152:155], v[12:15]
    ds_read_b128 v[208:211], v248 offset:54272
    s_waitcnt lgkmcnt(6)
    v_mfma_f32_16x16x32_bf16 v[16:19], v[212:215], v[152:155], v[16:19]
    ds_read_b128 v[212:215], v248 offset:55296
    v_mfma_f32_16x16x32_bf16 v[20:23], v[216:219], v[152:155], v[20:23]
    s_waitcnt vmcnt(5)
    ds_read_b128 v[216:219], v248 offset:56320
    s_waitcnt lgkmcnt(6)
    v_mfma_f32_16x16x32_bf16 v[4:7], v[220:223], v[164:167], v[4:7]
    ds_read_b128 v[220:223], v248 offset:57344
    v_mfma_f32_16x16x32_bf16 v[8:11], v[224:227], v[164:167], v[8:11]
    ds_read_b128 v[224:227], v248 offset:58368
    s_waitcnt lgkmcnt(6)
    v_mfma_f32_16x16x32_bf16 v[12:15], v[196:199], v[164:167], v[12:15]
    ds_read_b128 v[196:199], v248 offset:59392
    v_mfma_f32_16x16x32_bf16 v[16:19], v[200:203], v[164:167], v[16:19]
    ds_read_b128 v[200:203], v248 offset:60416
    s_waitcnt lgkmcnt(6)
    v_mfma_f32_16x16x32_bf16 v[20:23], v[204:207], v[164:167], v[20:23]
    s_waitcnt vmcnt(4)
    ds_read_b128 v[204:207], v248 offset:61440
    v_mfma_f32_16x16x32_bf16 v[4:7], v[208:211], v[168:171], v[4:7]
    ds_read_b128 v[208:211], v248 offset:62464
    s_waitcnt lgkmcnt(6)
    v_mfma_f32_16x16x32_bf16 v[8:11], v[212:215], v[168:171], v[8:11]
    ds_read_b128 v[212:215], v248 offset:63488
    v_mfma_f32_16x16x32_bf16 v[12:15], v[216:219], v[168:171], v[12:15]
    ds_read_b128 v[216:219], v248 offset:64512
    s_waitcnt lgkmcnt(6)
    v_mfma_f32_16x16x32_bf16 v[16:19], v[220:223], v[168:171], v[16:19]
    ds_read_b128 v[220:223], v249 offset:0
    v_mfma_f32_16x16x32_bf16 v[20:23], v[224:227], v[168:171], v[20:23]
    s_waitcnt vmcnt(3)
    ds_read_b128 v[224:227], v249 offset:1024
    s_waitcnt lgkmcnt(6)
    v_mfma_f32_16x16x32_bf16 v[4:7], v[196:199], v[172:175], v[4:7]
    ds_read_b128 v[196:199], v249 offset:2048
    v_mfma_f32_16x16x32_bf16 v[8:11], v[200:203], v[172:175], v[8:11]
    ds_read_b128 v[200:203], v249 offset:3072
    s_waitcnt lgkmcnt(6)
    v_mfma_f32_16x16x32_bf16 v[12:15], v[204:207], v[172:175], v[12:15]
    ds_read_b128 v[204:207], v249 offset:4096
    v_mfma_f32_16x16x32_bf16 v[16:19], v[208:211], v[172:175], v[16:19]
    ds_read_b128 v[208:211], v249 offset:5120
    s_waitcnt lgkmcnt(6)
    v_mfma_f32_16x16x32_bf16 v[20:23], v[212:215], v[172:175], v[20:23]
    s_waitcnt vmcnt(2)
    ds_read_b128 v[212:215], v249 offset:6144
    v_mfma_f32_16x16x32_bf16 v[4:7], v[216:219], v[176:179], v[4:7]
    ds_read_b128 v[216:219], v249 offset:7168
    s_waitcnt lgkmcnt(6)
    v_mfma_f32_16x16x32_bf16 v[8:11], v[220:223], v[176:179], v[8:11]
    ds_read_b128 v[220:223], v249 offset:8192
    v_mfma_f32_16x16x32_bf16 v[12:15], v[224:227], v[176:179], v[12:15]
    ds_read_b128 v[224:227], v249 offset:9216
    s_waitcnt lgkmcnt(6)
    v_mfma_f32_16x16x32_bf16 v[16:19], v[196:199], v[176:179], v[16:19]
    ds_read_b128 v[196:199], v249 offset:10240
    v_mfma_f32_16x16x32_bf16 v[20:23], v[200:203], v[176:179], v[20:23]
    s_waitcnt vmcnt(1)
    ds_read_b128 v[200:203], v249 offset:11264
    s_waitcnt lgkmcnt(6)
    v_mfma_f32_16x16x32_bf16 v[4:7], v[204:207], v[188:191], v[4:7]
    ds_read_b128 v[204:207], v249 offset:12288
    v_mfma_f32_16x16x32_bf16 v[8:11], v[208:211], v[188:191], v[8:11]
    ds_read_b128 v[208:211], v249 offset:13312
    s_waitcnt lgkmcnt(6)
    v_mfma_f32_16x16x32_bf16 v[12:15], v[212:215], v[188:191], v[12:15]
    v_mfma_f32_16x16x32_bf16 v[16:19], v[216:219], v[188:191], v[16:19]
    s_waitcnt lgkmcnt(4)
    v_mfma_f32_16x16x32_bf16 v[20:23], v[220:223], v[188:191], v[20:23]
    s_waitcnt vmcnt(0)
    v_mfma_f32_16x16x32_bf16 v[4:7], v[224:227], v[192:195], v[4:7]
    s_waitcnt lgkmcnt(2)
    v_mfma_f32_16x16x32_bf16 v[8:11], v[196:199], v[192:195], v[8:11]
    v_mfma_f32_16x16x32_bf16 v[12:15], v[200:203], v[192:195], v[12:15]
    s_waitcnt lgkmcnt(0)
    v_mfma_f32_16x16x32_bf16 v[16:19], v[204:207], v[192:195], v[16:19]
    v_mfma_f32_16x16x32_bf16 v[20:23], v[208:211], v[192:195], v[20:23]
    v_mov_b32 v253, 6
    ds_write_b32 v251, v253 offset:1552
    s_nop 6
    s_add_u32 s52, s46, 19529728
    s_add_u32 s53, s47, 19529728
    v_cvt_pk_bf16_f32 v100, v4, v5
    v_cvt_pk_bf16_f32 v101, v6, v7
    v_cvt_pk_bf16_f32 v102, v8, v9
    v_cvt_pk_bf16_f32 v103, v10, v11
    v_cvt_pk_bf16_f32 v104, v12, v13
    v_cvt_pk_bf16_f32 v105, v14, v15
    v_cvt_pk_bf16_f32 v106, v16, v17
    v_cvt_pk_bf16_f32 v107, v18, v19
    buffer_store_dwordx4 v[100:103], v2, s[20:23], s52 offen sc1
    buffer_store_dwordx4 v[104:107], v2, s[20:23], s52 offen offset:1024 sc1
    v_cvt_pk_bf16_f32 v110, v20, v21
    v_cvt_pk_bf16_f32 v111, v22, v23
    v_pk_add_f32 v[112:113], v[4:5], v[6:7]
    v_pk_mul_f32 v[114:115], v[4:5], v[4:5]
    v_pk_fma_f32 v[114:115], v[6:7], v[6:7], v[114:115]
    v_pk_add_f32 v[112:113], v[112:113], v[8:9]
    v_pk_fma_f32 v[114:115], v[8:9], v[8:9], v[114:115]
    v_pk_add_f32 v[112:113], v[112:113], v[10:11]
    v_pk_fma_f32 v[114:115], v[10:11], v[10:11], v[114:115]
    v_pk_add_f32 v[112:113], v[112:113], v[12:13]
    v_pk_fma_f32 v[114:115], v[12:13], v[12:13], v[114:115]
    v_pk_add_f32 v[112:113], v[112:113], v[14:15]
    v_pk_fma_f32 v[114:115], v[14:15], v[14:15], v[114:115]
    v_pk_add_f32 v[112:113], v[112:113], v[16:17]
    v_pk_fma_f32 v[114:115], v[16:17], v[16:17], v[114:115]
    v_pk_add_f32 v[112:113], v[112:113], v[18:19]
    v_pk_fma_f32 v[114:115], v[18:19], v[18:19], v[114:115]
    v_pk_add_f32 v[112:113], v[112:113], v[20:21]
    v_pk_fma_f32 v[114:115], v[20:21], v[20:21], v[114:115]
    v_pk_add_f32 v[112:113], v[112:113], v[22:23]
    v_pk_fma_f32 v[114:115], v[22:23], v[22:23], v[114:115]
    v_add_f32 v108, v112, v113
    v_add_f32 v109, v114, v115
    v_mov_b32 v112, v108
    v_mov_b32 v113, v109
    s_cmp_eq_u32 s43, 1
    s_cbranch_scc1 K2_SO_41
    buffer_store_dwordx4 v[108:111], v2, s[20:23], s53 offen sc1
    s_branch K2_SD_42
K2_SO_41:
    buffer_store_dwordx4 v[110:113], v2, s[20:23], s53 offen sc1
K2_SD_42:
    v_pk_add_f32 v[80:81], v[80:81], v[4:5]
    v_pk_add_f32 v[82:83], v[82:83], v[6:7]
    v_pk_add_f32 v[84:85], v[84:85], v[8:9]
    v_pk_add_f32 v[86:87], v[86:87], v[10:11]
    v_pk_add_f32 v[88:89], v[88:89], v[12:13]
    v_pk_add_f32 v[90:91], v[90:91], v[14:15]
    v_pk_add_f32 v[92:93], v[92:93], v[16:17]
    v_pk_add_f32 v[94:95], v[94:95], v[18:19]
    v_pk_add_f32 v[96:97], v[96:97], v[20:21]
    v_pk_add_f32 v[98:99], v[98:99], v[22:23]
    s_mul_i32 s51, s67, 55296
    s_add_u32 s51, s51, 22675456
    s_lshl_b32 s50, s42, 12
    s_add_u32 s50, s50, s51
    s_mul_i32 s36, s42, 3072
    s_add_u32 s36, s36, 32768
    s_min_u32 s36, s36, 52224
    s_add_u32 s37, s36, 1024
    s_cmp_eq_u32 s42, 6
    s_cselect_b32 s37, 28672, s37
    s_add_u32 s36, s36, s51
    s_add_u32 s37, s37, s51
    s_add_u32 s54, s44, 19529728
    s_add_u32 s55, s44, 19533824
    s_add_u32 s56, s44, 19537920
    s_add_u32 s57, s44, 19542016
    s_add_u32 s58, s44, 19546112
    s_add_u32 s59, s44, 19550208
    s_waitcnt vmcnt(0)
    s_add_u32 s52, s48, 19439616
    s_mov_b64 exec, 1
    buffer_atomic_add v243, v255, s[20:23], s52 offen sc1
    s_mov_b64 exec, -1
    s_mov_b32 s53, 32768
    s_add_u32 s62, s48, 19439616
    s_mov_b64 exec, 1
    v_mov_b32 v229, 0
    buffer_atomic_add v229, v255, s[20:23], s62 offen sc0 sc1
    s_sleep 4
    v_mov_b32 v230, 0
    buffer_atomic_add v230, v255, s[20:23], s62 offen sc0 sc1
K2_HL_43:
    s_waitcnt vmcnt(1)
    v_cmp_gt_u32 vcc, 8, v229
    s_cbranch_vccz K2_HX_44
    v_mov_b32 v229, 0
    buffer_atomic_add v229, v255, s[20:23], s62 offen sc0 sc1
    s_waitcnt vmcnt(1)
    v_cmp_gt_u32 vcc, 8, v230
    s_cbranch_vccz K2_HX_44
    v_mov_b32 v230, 0
    buffer_atomic_add v230, v255, s[20:23], s62 offen sc0 sc1
    s_sub_u32 s53, s53, 1
    s_cmp_lg_u32 s53, 0
    s_cbranch_scc1 K2_HL_43
K2_HX_44:
    s_mov_b64 exec, -1
    ds_read_b32 v252, v250 offset:1536
    buffer_load_dwordx4 v[108:111], v2, s[20:23], s54 offen offset:2048 sc1
    buffer_load_dwordx4 v[112:115], v2, s[20:23], s54 offen offset:3072 sc1
    buffer_load_dwordx4 v[132:135], v2, s[20:23], s56 offen offset:0 sc1
    buffer_load_dwordx4 v[136:139], v2, s[20:23], s56 offen offset:1024 sc1
    buffer_load_dwordx4 v[156:159], v2, s[20:23], s57 offen offset:2048 sc1
    buffer_load_dwordx4 v[160:163], v2, s[20:23], s57 offen offset:3072 sc1
    buffer_load_dwordx4 v[180:183], v2, s[20:23], s59 offen offset:0 sc1
    buffer_load_dwordx4 v[184:187], v2, s[20:23], s59 offen offset:1024 sc1
    buffer_load_dwordx4 v[100:103], v2, s[20:23], s54 offen offset:0 sc1
    buffer_load_dwordx4 v[104:107], v2, s[20:23], s54 offen offset:1024 sc1
    buffer_load_dwordx4 v[116:119], v2, s[20:23], s55 offen offset:0 sc1
    buffer_load_dwordx4 v[120:123], v2, s[20:23], s55 offen offset:1024 sc1
    buffer_load_dwordx4 v[124:127], v2, s[20:23], s55 offen offset:2048 sc1
    buffer_load_dwordx4 v[128:131], v2, s[20:23], s55 offen offset:3072 sc1
    s_waitcnt lgkmcnt(0)
    v_cmp_gt_u32 vcc, 6, v252
    s_cbranch_vccnz K2_FW_45
K2_FB_46:
    ds_read_b128 v[212:215], v249 offset:14336
    ds_read_b128 v[216:219], v249 offset:15360
    ds_read_b128 v[220:223], v249 offset:16384
    ds_read_b128 v[224:227], v249 offset:17408
    ds_read_b128 v[196:199], v249 offset:18432
    ds_read_b128 v[200:203], v249 offset:19456
    ds_read_b128 v[204:207], v249 offset:20480
    s_waitcnt vmcnt(12)
    ds_read_b128 v[208:211], v249 offset:21504
    s_waitcnt lgkmcnt(6)
    v_mfma_f32_16x16x32_bf16 v[24:27], v[212:215], v[110:113], 0
    v_add_f32 v232, v108, v114
    ds_read_b128 v[212:215], v249 offset:22528
    v_mfma_f32_16x16x32_bf16 v[28:31], v[216:219], v[110:113], 0
    ds_read_b128 v[216:219], v249 offset:23552
    s_waitcnt lgkmcnt(6)
    v_mfma_f32_16x16x32_bf16 v[32:35], v[220:223], v[110:113], 0
    v_add_f32 v233, v109, v115
    ds_read_b128 v[220:223], v249 offset:24576
    v_mfma_f32_16x16x32_bf16 v[36:39], v[224:227], v[110:113], 0
    ds_read_b128 v[224:227], v249 offset:25600
    s_waitcnt lgkmcnt(6)
    v_mfma_f32_16x16x32_bf16 v[40:43], v[196:199], v[110:113], 0
    ds_read_b128 v[196:199], v249 offset:26624
    v_mfma_f32_16x16x32_bf16 v[44:47], v[200:203], v[110:113], 0
    ds_read_b128 v[200:203], v249 offset:27648
    s_waitcnt lgkmcnt(6)
    v_mfma_f32_16x16x32_bf16 v[48:51], v[204:207], v[110:113], 0
    ds_read_b128 v[204:207], v249 offset:28672
    v_mfma_f32_16x16x32_bf16 v[52:55], v[208:211], v[110:113], 0
    buffer_load_dwordx4 v[140:143], v2, s[20:23], s56 offen offset:2048 sc1
    buffer_load_dwordx4 v[144:147], v2, s[20:23], s56 offen offset:3072 sc1
    s_waitcnt vmcnt(12)
    ds_read_b128 v[208:211], v249 offset:29696
    s_waitcnt lgkmcnt(6)
    v_mfma_f32_16x16x32_bf16 v[24:27], v[212:215], v[134:137], v[24:27]
    v_add_f32 v232, v232, v132
    ds_read_b128 v[212:215], v247 offset:0
    v_mfma_f32_16x16x32_bf16 v[28:31], v[216:219], v[134:137], v[28:31]
    ds_read_b128 v[216:219], v247 offset:1024
    s_waitcnt lgkmcnt(6)
    v_mfma_f32_16x16x32_bf16 v[32:35], v[220:223], v[134:137], v[32:35]
    v_add_f32 v233, v233, v133
    ds_read_b128 v[220:223], v247 offset:2048
    v_mfma_f32_16x16x32_bf16 v[36:39], v[224:227], v[134:137], v[36:39]
    ds_read_b128 v[224:227], v247 offset:3072
    s_waitcnt lgkmcnt(6)
    v_mfma_f32_16x16x32_bf16 v[40:43], v[196:199], v[134:137], v[40:43]
    v_add_f32 v232, v232, v138
    ds_read_b128 v[196:199], v247 offset:4096
    v_mfma_f32_16x16x32_bf16 v[44:47], v[200:203], v[134:137], v[44:47]
    ds_read_b128 v[200:203], v247 offset:5120
    s_waitcnt lgkmcnt(6)
    v_mfma_f32_16x16x32_bf16 v[48:51], v[204:207], v[134:137], v[48:51]
    v_add_f32 v233, v233, v139
    ds_read_b128 v[204:207], v247 offset:6144
    v_mfma_f32_16x16x32_bf16 v[52:55], v[208:211], v[134:137], v[52:55]
    buffer_load_dwordx4 v[148:151], v2, s[20:23], s57 offen offset:0 sc1
    buffer_load_dwordx4 v[152:155], v2, s[20:23], s57 offen offset:1024 sc1
    s_waitcnt vmcnt(12)
    ds_read_b128 v[208:211], v247 offset:7168
    s_waitcnt lgkmcnt(6)
    v_mfma_f32_16x16x32_bf16 v[24:27], v[212:215], v[158:161], v[24:27]
    v_add_f32 v232, v232, v156
    ds_read_b128 v[212:215], v247 offset:8192
    v_mfma_f32_16x16x32_bf16 v[28:31], v[216:219], v[158:161], v[28:31]
    ds_read_b128 v[216:219], v247 offset:9216
    s_waitcnt lgkmcnt(6)
    v_mfma_f32_16x16x32_bf16 v[32:35], v[220:223], v[158:161], v[32:35]
    v_add_f32 v233, v233, v157
    ds_read_b128 v[220:223], v247 offset:10240
    v_mfma_f32_16x16x32_bf16 v[36:39], v[224:227], v[158:161], v[36:39]
    ds_read_b128 v[224:227], v247 offset:11264
    s_waitcnt lgkmcnt(6)
    v_mfma_f32_16x16x32_bf16 v[40:43], v[196:199], v[158:161], v[40:43]
    v_add_f32 v232, v232, v162
    ds_read_b128 v[196:199], v247 offset:12288
    v_mfma_f32_16x16x32_bf16 v[44:47], v[200:203], v[158:161], v[44:47]
    ds_read_b128 v[200:203], v247 offset:13312
    s_waitcnt lgkmcnt(6)
    v_mfma_f32_16x16x32_bf16 v[48:51], v[204:207], v[158:161], v[48:51]
    v_add_f32 v233, v233, v163
    ds_read_b128 v[204:207], v247 offset:14336
    v_mfma_f32_16x16x32_bf16 v[52:55], v[208:211], v[158:161], v[52:55]
    buffer_load_dwordx4 v[164:167], v2, s[20:23], s58 offen offset:0 sc1
    buffer_load_dwordx4 v[168:171], v2, s[20:23], s58 offen offset:1024 sc1
    s_waitcnt vmcnt(12)
    ds_read_b128 v[208:211], v247 offset:15360
    s_waitcnt lgkmcnt(6)
    v_mfma_f32_16x16x32_bf16 v[24:27], v[212:215], v[182:185], v[24:27]
    v_add_f32 v232, v232, v180
    ds_read_b128 v[212:215], v247 offset:16384
    v_mfma_f32_16x16x32_bf16 v[28:31], v[216:219], v[182:185], v[28:31]
    ds_read_b128 v[216:219], v247 offset:17408
    s_waitcnt lgkmcnt(6)
    v_mfma_f32_16x16x32_bf16 v[32:35], v[220:223], v[182:185], v[32:35]
    v_add_f32 v233, v233, v181
    ds_read_b128 v[220:223], v247 offset:18432
    v_mfma_f32_16x16x32_bf16 v[36:39], v[224:227], v[182:185], v[36:39]
    ds_read_b128 v[224:227], v247 offset:19456
    s_waitcnt lgkmcnt(6)
    v_mfma_f32_16x16x32_bf16 v[40:43], v[196:199], v[182:185], v[40:43]
    v_add_f32 v232, v232, v186
    ds_read_b128 v[196:199], v247 offset:20480
    v_mfma_f32_16x16x32_bf16 v[44:47], v[200:203], v[182:185], v[44:47]
    ds_read_b128 v[200:203], v247 offset:21504
    s_waitcnt lgkmcnt(6)
    v_mfma_f32_16x16x32_bf16 v[48:51], v[204:207], v[182:185], v[48:51]
    v_add_f32 v233, v233, v187
    ds_read_b128 v[204:207], v247 offset:22528
    v_mfma_f32_16x16x32_bf16 v[52:55], v[208:211], v[182:185], v[52:55]
    v_mov_b32 v253, 7
    ds_write_b32 v251, v253 offset:1552
    buffer_load_dwordx4 v[172:175], v2, s[20:23], s58 offen offset:2048 sc1
    buffer_load_dwordx4 v[176:179], v2, s[20:23], s58 offen offset:3072 sc1
    s_waitcnt vmcnt(13)
    ds_read_b128 v[208:211], v247 offset:23552
    s_waitcnt lgkmcnt(7)
    v_mfma_f32_16x16x32_bf16 v[24:27], v[212:215], v[100:103], v[24:27]
    ds_read_b128 v[212:215], v247 offset:24576
    v_mfma_f32_16x16x32_bf16 v[28:31], v[216:219], v[100:103], v[28:31]
    ds_read_b128 v[216:219], v247 offset:25600
    s_waitcnt lgkmcnt(7)
    v_mfma_f32_16x16x32_bf16 v[32:35], v[220:223], v[100:103], v[32:35]
    ds_read_b128 v[220:223], v247 offset:26624
    v_mfma_f32_16x16x32_bf16 v[36:39], v[224:227], v[100:103], v[36:39]
    ds_read_b128 v[224:227], v247 offset:27648
    s_waitcnt lgkmcnt(7)
    v_mfma_f32_16x16x32_bf16 v[40:43], v[196:199], v[100:103], v[40:43]
    ds_read_b128 v[196:199], v247 offset:28672
    v_mfma_f32_16x16x32_bf16 v[44:47], v[200:203], v[100:103], v[44:47]
    ds_read_b128 v[200:203], v247 offset:29696
    s_waitcnt lgkmcnt(6)
    v_mfma_f32_16x16x32_bf16 v[48:51], v[204:207], v[100:103], v[48:51]
    ds_read_b128 v[204:207], v247 offset:30720
    v_mfma_f32_16x16x32_bf16 v[52:55], v[208:211], v[100:103], v[52:55]
    buffer_load_dwordx4 v[188:191], v2, s[20:23], s59 offen offset:2048 sc1
    buffer_load_dwordx4 v[192:195], v2, s[20:23], s59 offen offset:3072 sc1
    s_waitcnt vmcnt(14)
    ds_read_b128 v[208:211], v247 offset:31744
    s_waitcnt lgkmcnt(6)
    v_mfma_f32_16x16x32_bf16 v[24:27], v[212:215], v[104:107], v[24:27]
    ds_read_b128 v[212:215], v247 offset:32768
    v_mfma_f32_16x16x32_bf16 v[28:31], v[216:219], v[104:107], v[28:31]
    ds_read_b128 v[216:219], v247 offset:33792
    s_waitcnt lgkmcnt(6)
    v_mfma_f32_16x16x32_bf16 v[32:35], v[220:223], v[104:107], v[32:35]
    ds_read_b128 v[220:223], v247 offset:34816
    v_mfma_f32_16x16x32_bf16 v[36:39], v[224:227], v[104:107], v[36:39]
    ds_read_b128 v[224:227], v247 offset:35840
    s_waitcnt lgkmcnt(6)
    v_mfma_f32_16x16x32_bf16 v[40:43], v[196:199], v[104:107], v[40:43]
    ds_read_b128 v[196:199], v247 offset:36864
    v_mfma_f32_16x16x32_bf16 v[44:47], v[200:203], v[104:107], v[44:47]
    ds_read_b128 v[200:203], v247 offset:37888
    s_waitcnt lgkmcnt(6)
    v_mfma_f32_16x16x32_bf16 v[48:51], v[204:207], v[104:107], v[48:51]
    ds_read_b128 v[204:207], v247 offset:38912
    ds_read_b32 v252, v250 offset:1536
    v_mfma_f32_16x16x32_bf16 v[52:55], v[208:211], v[104:107], v[52:55]
    s_waitcnt vmcnt(13)
    ds_read_b128 v[208:211], v247 offset:39936
    s_waitcnt lgkmcnt(7)
    v_mfma_f32_16x16x32_bf16 v[24:27], v[212:215], v[116:119], v[24:27]
    v_mov_b32 v234, v232
    ds_read_b128 v[212:215], v247 offset:40960
    v_mfma_f32_16x16x32_bf16 v[28:31], v[216:219], v[116:119], v[28:31]
    ds_read_b128 v[216:219], v247 offset:41984
    s_waitcnt lgkmcnt(7)
    v_mfma_f32_16x16x32_bf16 v[32:35], v[220:223], v[116:119], v[32:35]
    v_mov_b32 v235, v233
    s_waitcnt lgkmcnt(3)
    v_cmp_gt_u32 vcc, 7, v252
    s_cbranch_vccnz K2_FW_47
K2_FB_48:
    ds_read_b128 v[220:223], v247 offset:43008
    v_mfma_f32_16x16x32_bf16 v[36:39], v[224:227], v[116:119], v[36:39]
    ds_read_b128 v[224:227], v247 offset:44032
    v_mfma_f32_16x16x32_bf16 v[40:43], v[196:199], v[116:119], v[40:43]
    v_permlane32_swap_b32 v232, v234
    ds_read_b128 v[196:199], v247 offset:45056
    v_mfma_f32_16x16x32_bf16 v[44:47], v[200:203], v[116:119], v[44:47]
    ds_read_b128 v[200:203], v247 offset:46080
    s_waitcnt lgkmcnt(6)
    v_mfma_f32_16x16x32_bf16 v[48:51], v[204:207], v[116:119], v[48:51]
    v_permlane32_swap_b32 v233, v235
    ds_read_b128 v[204:207], v247 offset:47104
    v_mfma_f32_16x16x32_bf16 v[52:55], v[208:211], v[116:119], v[52:55]
    s_waitcnt vmcnt(12)
    ds_read_b128 v[208:211], v247 offset:48128
    s_waitcnt lgkmcnt(6)
    v_mfma_f32_16x16x32_bf16 v[24:27], v[212:215], v[120:123], v[24:27]
    v_add_f32 v232, v232, v234
    ds_read_b128 v[212:215], v247 offset:49152
    v_mfma_f32_16x16x32_bf16 v[28:31], v[216:219], v[120:123], v[28:31]
    ds_read_b128 v[216:219], v247 offset:50176
    s_waitcnt lgkmcnt(6)
    v_mfma_f32_16x16x32_bf16 v[32:35], v[220:223], v[120:123], v[32:35]
    v_add_f32 v233, v233, v235
    ds_read_b128 v[220:223], v247 offset:51200
    v_mfma_f32_16x16x32_bf16 v[36:39], v[224:227], v[120:123], v[36:39]
    ds_read_b128 v[224:227], v247 offset:52224
    s_waitcnt lgkmcnt(6)
    v_mfma_f32_16x16x32_bf16 v[40:43], v[196:199], v[120:123], v[40:43]
    v_mov_b32 v234, v232
    ds_read_b128 v[196:199], v247 offset:53248
    v_mfma_f32_16x16x32_bf16 v[44:47], v[200:203], v[120:123], v[44:47]
    ds_read_b128 v[200:203], v247 offset:54272
    s_waitcnt lgkmcnt(6)
    v_mfma_f32_16x16x32_bf16 v[48:51], v[204:207], v[120:123], v[48:51]
    v_mov_b32 v235, v233
    ds_read_b128 v[204:207], v247 offset:55296
    v_mfma_f32_16x16x32_bf16 v[52:55], v[208:211], v[120:123], v[52:55]
    v_mov_b32 v253, 8
    ds_write_b32 v251, v253 offset:1552
    s_waitcnt vmcnt(11)
    ds_read_b128 v[208:211], v247 offset:56320
    s_waitcnt lgkmcnt(7)
    v_mfma_f32_16x16x32_bf16 v[24:27], v[212:215], v[124:127], v[24:27]
    v_permlane16_swap_b32 v232, v234
    ds_read_b128 v[212:215], v247 offset:57344
    v_mfma_f32_16x16x32_bf16 v[28:31], v[216:219], v[124:127], v[28:31]
    ds_read_b128 v[216:219], v247 offset:58368
    s_waitcnt lgkmcnt(7)
    v_mfma_f32_16x16x32_bf16 v[32:35], v[220:223], v[124:127], v[32:35]
    v_permlane16_swap_b32 v233, v235
    ds_read_b128 v[220:223], v247 offset:59392
    v_mfma_f32_16x16x32_bf16 v[36:39], v[224:227], v[124:127], v[36:39]
    ds_read_b128 v[224:227], v247 offset:60416
    s_waitcnt lgkmcnt(7)
    v_mfma_f32_16x16x32_bf16 v[40:43], v[196:199], v[124:127], v[40:43]
    v_add_f32 v232, v232, v234
    ds_read_b128 v[196:199], v247 offset:61440
    v_mfma_f32_16x16x32_bf16 v[44:47], v[200:203], v[124:127], v[44:47]
    ds_read_b128 v[200:203], v247 offset:62464
    s_waitcnt lgkmcnt(6)
    v_mfma_f32_16x16x32_bf16 v[48:51], v[204:207], v[124:127], v[48:51]
    v_add_f32 v233, v233, v235
    ds_read_b128 v[204:207], v247 offset:63488
    v_mfma_f32_16x16x32_bf16 v[52:55], v[208:211], v[124:127], v[52:55]
    s_waitcnt vmcnt(10)
    ds_read_b128 v[208:211], v247 offset:64512
    s_waitcnt lgkmcnt(6)
    v_mfma_f32_16x16x32_bf16 v[24:27], v[212:215], v[128:131], v[24:27]
    v_mul_f32 v236, 0xbacccccd, v232
    ds_read_b128 v[212:215], v248 offset:0
    v_mfma_f32_16x16x32_bf16 v[28:31], v[216:219], v[128:131], v[28:31]
    ds_read_b128 v[216:219], v248 offset:1024
    s_waitcnt lgkmcnt(6)
    v_mfma_f32_16x16x32_bf16 v[32:35], v[220:223], v[128:131], v[32:35]
    v_mul_f32 v233, 0x3acccccd, v233
    ds_read_b128 v[220:223], v248 offset:2048
    v_mfma_f32_16x16x32_bf16 v[36:39], v[224:227], v[128:131], v[36:39]
    ds_read_b128 v[224:227], v248 offset:3072
    s_waitcnt lgkmcnt(6)
    v_mfma_f32_16x16x32_bf16 v[40:43], v[196:199], v[128:131], v[40:43]
    v_fma_f32 v233, -v236, v236, v233
    ds_read_b128 v[196:199], v248 offset:4096
    v_mfma_f32_16x16x32_bf16 v[44:47], v[200:203], v[128:131], v[44:47]
    ds_read_b128 v[200:203], v248 offset:5120
    s_waitcnt lgkmcnt(6)
    v_mfma_f32_16x16x32_bf16 v[48:51], v[204:207], v[128:131], v[48:51]
    v_max_f32 v233, 0, v233
    ds_read_b128 v[204:207], v248 offset:6144
    v_mfma_f32_16x16x32_bf16 v[52:55], v[208:211], v[128:131], v[52:55]
    s_waitcnt vmcnt(9)
    ds_read_b128 v[208:211], v248 offset:7168
    s_waitcnt lgkmcnt(6)
    v_mfma_f32_16x16x32_bf16 v[24:27], v[212:215], v[140:143], v[24:27]
    v_add_f32 v232, 0x3727c5ac, v233
    ds_read_b128 v[212:215], v248 offset:8192
    v_mfma_f32_16x16x32_bf16 v[28:31], v[216:219], v[140:143], v[28:31]
    ds_read_b128 v[216:219], v248 offset:9216
    s_waitcnt lgkmcnt(6)
    v_mfma_f32_16x16x32_bf16 v[32:35], v[220:223], v[140:143], v[32:35]
    v_rsq_f32 v238, v232
    ds_read_b128 v[220:223], v248 offset:10240
    v_mfma_f32_16x16x32_bf16 v[36:39], v[224:227], v[140:143], v[36:39]
    ds_read_b128 v[224:227], v248 offset:11264
    s_waitcnt lgkmcnt(6)
    v_mfma_f32_16x16x32_bf16 v[40:43], v[196:199], v[140:143], v[40:43]
    v_mov_b32 v232, v238
    ds_read_b128 v[196:199], v248 offset:12288
    v_mfma_f32_16x16x32_bf16 v[44:47], v[200:203], v[140:143], v[44:47]
    ds_read_b128 v[200:203], v248 offset:13312
    s_waitcnt lgkmcnt(6)
    v_mfma_f32_16x16x32_bf16 v[48:51], v[204:207], v[140:143], v[48:51]
    v_rcp_f32 v234, v232
    ds_read_b128 v[204:207], v248 offset:14336
    v_mfma_f32_16x16x32_bf16 v[52:55], v[208:211], v[140:143], v[52:55]
    s_waitcnt vmcnt(8)
    ds_read_b128 v[208:211], v248 offset:15360
    s_waitcnt lgkmcnt(6)
    v_mfma_f32_16x16x32_bf16 v[24:27], v[212:215], v[144:147], v[24:27]
    v_mul_f32 v240, 0xc0135761, v232
    ds_read_b128 v[212:215], v248 offset:16384
    v_mfma_f32_16x16x32_bf16 v[28:31], v[216:219], v[144:147], v[28:31]
    ds_read_b128 v[216:219], v248 offset:17408
    s_waitcnt lgkmcnt(6)
    v_mfma_f32_16x16x32_bf16 v[32:35], v[220:223], v[144:147], v[32:35]
    v_mul_f32 v233, v232, v232
    ds_read_b128 v[220:223], v248 offset:18432
    v_mfma_f32_16x16x32_bf16 v[36:39], v[224:227], v[144:147], v[36:39]
    ds_read_b128 v[224:227], v248 offset:19456
    s_waitcnt lgkmcnt(6)
    v_mfma_f32_16x16x32_bf16 v[40:43], v[196:199], v[144:147], v[40:43]
    v_mul_f32 v233, v233, v232
    ds_read_b128 v[196:199], v248 offset:20480
    v_mfma_f32_16x16x32_bf16 v[44:47], v[200:203], v[144:147], v[44:47]
    ds_read_b128 v[200:203], v248 offset:21504
    s_waitcnt lgkmcnt(6)
    v_mfma_f32_16x16x32_bf16 v[48:51], v[204:207], v[144:147], v[48:51]
    v_mul_f32 v242, 0xbdd2d3e8, v233
    ds_read_b128 v[204:207], v248 offset:22528
    v_mfma_f32_16x16x32_bf16 v[52:55], v[208:211], v[144:147], v[52:55]
    v_mov_b32 v253, 9
    ds_write_b32 v251, v253 offset:1552
    s_waitcnt vmcnt(7)
    ds_read_b128 v[208:211], v248 offset:23552
    s_waitcnt lgkmcnt(7)
    v_mfma_f32_16x16x32_bf16 v[24:27], v[212:215], v[148:151], v[24:27]
    ds_read_b128 v[212:215], v248 offset:24576
    v_mfma_f32_16x16x32_bf16 v[28:31], v[216:219], v[148:151], v[28:31]
    ds_read_b128 v[216:219], v248 offset:25600
    s_waitcnt lgkmcnt(7)
    v_mfma_f32_16x16x32_bf16 v[32:35], v[220:223], v[148:151], v[32:35]
    ds_read_b128 v[220:223], v248 offset:26624
    v_mfma_f32_16x16x32_bf16 v[36:39], v[224:227], v[148:151], v[36:39]
    ds_read_b128 v[224:227], v248 offset:27648
    s_waitcnt lgkmcnt(7)
    v_mfma_f32_16x16x32_bf16 v[40:43], v[196:199], v[148:151], v[40:43]
    ds_read_b128 v[196:199], v248 offset:28672
    v_mfma_f32_16x16x32_bf16 v[44:47], v[200:203], v[148:151], v[44:47]
    ds_read_b128 v[200:203], v248 offset:29696
    s_waitcnt lgkmcnt(6)
    v_mfma_f32_16x16x32_bf16 v[48:51], v[204:207], v[148:151], v[48:51]
    ds_read_b128 v[204:207], v248 offset:30720
    v_mfma_f32_16x16x32_bf16 v[52:55], v[208:211], v[148:151], v[52:55]
    s_waitcnt vmcnt(6)
    ds_read_b128 v[208:211], v248 offset:31744
    s_waitcnt lgkmcnt(6)
    v_mfma_f32_16x16x32_bf16 v[24:27], v[212:215], v[152:155], v[24:27]
    ds_read_b128 v[212:215], v248 offset:32768
    v_mfma_f32_16x16x32_bf16 v[28:31], v[216:219], v[152:155], v[28:31]
    ds_read_b128 v[216:219], v248 offset:33792
    s_waitcnt lgkmcnt(6)
    v_mfma_f32_16x16x32_bf16 v[32:35], v[220:223], v[152:155], v[32:35]
    ds_read_b128 v[220:223], v248 offset:34816
    v_mfma_f32_16x16x32_bf16 v[36:39], v[224:227], v[152:155], v[36:39]
    ds_read_b128 v[224:227], v248 offset:35840
    s_waitcnt lgkmcnt(6)
    v_mfma_f32_16x16x32_bf16 v[40:43], v[196:199], v[152:155], v[40:43]
    ds_read_b128 v[196:199], v248 offset:36864
    v_mfma_f32_16x16x32_bf16 v[44:47], v[200:203], v[152:155], v[44:47]
    ds_read_b128 v[200:203], v248 offset:37888
    s_waitcnt lgkmcnt(6)
    v_mfma_f32_16x16x32_bf16 v[48:51], v[204:207], v[152:155], v[48:51]
    ds_read_b128 v[204:207], v248 offset:38912
    v_mfma_f32_16x16x32_bf16 v[52:55], v[208:211], v[152:155], v[52:55]
    s_waitcnt vmcnt(5)
    ds_read_b128 v[208:211], v248 offset:39936
    s_waitcnt lgkmcnt(6)
    v_mfma_f32_16x16x32_bf16 v[24:27], v[212:215], v[164:167], v[24:27]
    ds_read_b128 v[212:215], v248 offset:40960
    v_mfma_f32_16x16x32_bf16 v[28:31], v[216:219], v[164:167], v[28:31]
    ds_read_b128 v[216:219], v248 offset:41984
    s_waitcnt lgkmcnt(6)
    v_mfma_f32_16x16x32_bf16 v[32:35], v[220:223], v[164:167], v[32:35]
    ds_read_b128 v[220:223], v248 offset:43008
    v_mfma_f32_16x16x32_bf16 v[36:39], v[224:227], v[164:167], v[36:39]
    ds_read_b128 v[224:227], v248 offset:44032
    s_waitcnt lgkmcnt(6)
    v_mfma_f32_16x16x32_bf16 v[40:43], v[196:199], v[164:167], v[40:43]
    ds_read_b128 v[196:199], v248 offset:45056
    v_mfma_f32_16x16x32_bf16 v[44:47], v[200:203], v[164:167], v[44:47]
    ds_read_b128 v[200:203], v248 offset:46080
    s_waitcnt lgkmcnt(6)
    v_mfma_f32_16x16x32_bf16 v[48:51], v[204:207], v[164:167], v[48:51]
    ds_read_b128 v[204:207], v248 offset:47104
    v_mfma_f32_16x16x32_bf16 v[52:55], v[208:211], v[164:167], v[52:55]
    s_waitcnt vmcnt(4)
    ds_read_b128 v[208:211], v248 offset:48128
    s_waitcnt lgkmcnt(6)
    v_mfma_f32_16x16x32_bf16 v[24:27], v[212:215], v[168:171], v[24:27]
    ds_read_b128 v[212:215], v248 offset:49152
    v_mfma_f32_16x16x32_bf16 v[28:31], v[216:219], v[168:171], v[28:31]
    ds_read_b128 v[216:219], v248 offset:50176
    s_waitcnt lgkmcnt(6)
    v_mfma_f32_16x16x32_bf16 v[32:35], v[220:223], v[168:171], v[32:35]
    ds_read_b128 v[220:223], v248 offset:51200
    v_mfma_f32_16x16x32_bf16 v[36:39], v[224:227], v[168:171], v[36:39]
    ds_read_b128 v[224:227], v248 offset:52224
    s_waitcnt lgkmcnt(6)
    v_mfma_f32_16x16x32_bf16 v[40:43], v[196:199], v[168:171], v[40:43]
    ds_read_b128 v[196:199], v248 offset:53248
    v_mfma_f32_16x16x32_bf16 v[44:47], v[200:203], v[168:171], v[44:47]
    ds_read_b128 v[200:203], v248 offset:54272
    s_waitcnt lgkmcnt(6)
    v_mfma_f32_16x16x32_bf16 v[48:51], v[204:207], v[168:171], v[48:51]
    ds_read_b128 v[204:207], v248 offset:55296
    v_mfma_f32_16x16x32_bf16 v[52:55], v[208:211], v[168:171], v[52:55]
    v_mov_b32 v253, 10
    ds_write_b32 v251, v253 offset:1552
    s_waitcnt vmcnt(3)
    ds_read_b128 v[208:211], v248 offset:56320
    s_waitcnt lgkmcnt(7)
    v_mfma_f32_16x16x32_bf16 v[24:27], v[212:215], v[172:175], v[24:27]
    ds_read_b128 v[212:215], v248 offset:57344
    v_mfma_f32_16x16x32_bf16 v[28:31], v[216:219], v[172:175], v[28:31]
    ds_read_b128 v[216:219], v248 offset:58368
    s_waitcnt lgkmcnt(7)
    v_mfma_f32_16x16x32_bf16 v[32:35], v[220:223], v[172:175], v[32:35]
    ds_read_b128 v[220:223], v248 offset:59392
    v_mfma_f32_16x16x32_bf16 v[36:39], v[224:227], v[172:175], v[36:39]
    ds_read_b128 v[224:227], v248 offset:60416
    s_waitcnt lgkmcnt(7)
    v_mfma_f32_16x16x32_bf16 v[40:43], v[196:199], v[172:175], v[40:43]
    ds_read_b128 v[196:199], v248 offset:61440
    v_mfma_f32_16x16x32_bf16 v[44:47], v[200:203], v[172:175], v[44:47]
    ds_read_b128 v[200:203], v248 offset:62464
    s_waitcnt lgkmcnt(6)
    v_mfma_f32_16x16x32_bf16 v[48:51], v[204:207], v[172:175], v[48:51]
    ds_read_b128 v[204:207], v248 offset:63488
    v_mfma_f32_16x16x32_bf16 v[52:55], v[208:211], v[172:175], v[52:55]
    s_waitcnt vmcnt(2)
    ds_read_b128 v[208:211], v248 offset:64512
    s_waitcnt lgkmcnt(6)
    v_mfma_f32_16x16x32_bf16 v[24:27], v[212:215], v[176:179], v[24:27]
    ds_read_b128 v[212:215], v249 offset:0
    v_mfma_f32_16x16x32_bf16 v[28:31], v[216:219], v[176:179], v[28:31]
    ds_read_b128 v[216:219], v249 offset:1024
    s_waitcnt lgkmcnt(6)
    v_mfma_f32_16x16x32_bf16 v[32:35], v[220:223], v[176:179], v[32:35]
    ds_read_b128 v[220:223], v249 offset:2048
    v_mfma_f32_16x16x32_bf16 v[36:39], v[224:227], v[176:179], v[36:39]
    ds_read_b128 v[224:227], v249 offset:3072
    s_waitcnt lgkmcnt(6)
    v_mfma_f32_16x16x32_bf16 v[40:43], v[196:199], v[176:179], v[40:43]
    ds_read_b128 v[196:199], v249 offset:4096
    v_mfma_f32_16x16x32_bf16 v[44:47], v[200:203], v[176:179], v[44:47]
    ds_read_b128 v[200:203], v249 offset:5120
    s_waitcnt lgkmcnt(6)
    v_mfma_f32_16x16x32_bf16 v[48:51], v[204:207], v[176:179], v[48:51]
    ds_read_b128 v[204:207], v249 offset:6144
    v_mfma_f32_16x16x32_bf16 v[52:55], v[208:211], v[176:179], v[52:55]
    s_waitcnt vmcnt(1)
    ds_read_b128 v[208:211], v249 offset:7168
    s_waitcnt lgkmcnt(6)
    v_mfma_f32_16x16x32_bf16 v[24:27], v[212:215], v[188:191], v[24:27]
    ds_read_b128 v[212:215], v249 offset:8192
    v_mfma_f32_16x16x32_bf16 v[28:31], v[216:219], v[188:191], v[28:31]
    ds_read_b128 v[216:219], v249 offset:9216
    s_waitcnt lgkmcnt(6)
    v_mfma_f32_16x16x32_bf16 v[32:35], v[220:223], v[188:191], v[32:35]
    ds_read_b128 v[220:223], v249 offset:10240
    ds_read_b32 v252, v250 offset:1536
    v_mfma_f32_16x16x32_bf16 v[36:39], v[224:227], v[188:191], v[36:39]
    ds_read_b128 v[224:227], v249 offset:11264
    s_waitcnt lgkmcnt(7)
    v_mfma_f32_16x16x32_bf16 v[40:43], v[196:199], v[188:191], v[40:43]
    ds_read_b128 v[196:199], v249 offset:12288
    v_mfma_f32_16x16x32_bf16 v[44:47], v[200:203], v[188:191], v[44:47]
    ds_read_b128 v[200:203], v249 offset:13312
    s_waitcnt lgkmcnt(7)
    v_mfma_f32_16x16x32_bf16 v[48:51], v[204:207], v[188:191], v[48:51]
    s_waitcnt lgkmcnt(3)
    v_cmp_gt_u32 vcc, 8, v252
    s_cbranch_vccnz K2_FW_49
K2_FB_50:
    ds_read_b128 v[204:207], v249 offset:14336
    v_mfma_f32_16x16x32_bf16 v[52:55], v[208:211], v[188:191], v[52:55]
    s_waitcnt vmcnt(0)
    ds_read_b128 v[208:211], v249 offset:15360
    v_mfma_f32_16x16x32_bf16 v[24:27], v[212:215], v[192:195], v[24:27]
    v_mfma_f32_16x16x32_bf16 v[28:31], v[216:219], v[192:195], v[28:31]
    s_waitcnt lgkmcnt(4)
    v_mfma_f32_16x16x32_bf16 v[32:35], v[220:223], v[192:195], v[32:35]
    v_mfma_f32_16x16x32_bf16 v[36:39], v[224:227], v[192:195], v[36:39]
    s_waitcnt lgkmcnt(2)
    v_mfma_f32_16x16x32_bf16 v[40:43], v[196:199], v[192:195], v[40:43]
    v_mfma_f32_16x16x32_bf16 v[44:47], v[200:203], v[192:195], v[44:47]
    s_waitcnt lgkmcnt(0)
    v_mfma_f32_16x16x32_bf16 v[48:51], v[204:207], v[192:195], v[48:51]
    v_mfma_f32_16x16x32_bf16 v[52:55], v[208:211], v[192:195], v[52:55]
    v_mov_b32 v253, 11
    ds_write_b32 v251, v253 offset:1552
    ds_read_b128 v[196:199], v254 offset:512
    ds_read_b128 v[200:203], v254 offset:576
    ds_read_b128 v[204:207], v254 offset:640
    ds_read_b128 v[208:211], v254 offset:704
    ds_read_b128 v[212:215], v254 offset:768
    ds_read_b128 v[216:219], v254 offset:832
    ds_read_b128 v[220:223], v254 offset:896
    ds_read_b128 v[224:227], v254 offset:960
    s_waitcnt lgkmcnt(4)
    s_nop 3
    v_pk_fma_f32 v[24:25], v[196:197], v[236:237], v[24:25] op_sel_hi:[1,0,1]
    v_pk_fma_f32 v[26:27], v[198:199], v[236:237], v[26:27] op_sel_hi:[1,0,1]
    v_pk_fma_f32 v[28:29], v[200:201], v[236:237], v[28:29] op_sel_hi:[1,0,1]
    v_pk_fma_f32 v[30:31], v[202:203], v[236:237], v[30:31] op_sel_hi:[1,0,1]
    v_pk_fma_f32 v[32:33], v[204:205], v[236:237], v[32:33] op_sel_hi:[1,0,1]
    v_pk_fma_f32 v[34:35], v[206:207], v[236:237], v[34:35] op_sel_hi:[1,0,1]
    v_pk_fma_f32 v[36:37], v[208:209], v[236:237], v[36:37] op_sel_hi:[1,0,1]
    v_pk_fma_f32 v[38:39], v[210:211], v[236:237], v[38:39] op_sel_hi:[1,0,1]
    v_pk_mul_f32 v[56:57], v[24:25], v[24:25]
    v_pk_mul_f32 v[58:59], v[26:27], v[26:27]
    v_pk_mul_f32 v[60:61], v[28:29], v[28:29]
    v_pk_mul_f32 v[62:63], v[30:31], v[30:31]
    v_pk_mul_f32 v[64:65], v[32:33], v[32:33]
    v_pk_mul_f32 v[66:67], v[34:35], v[34:35]
    v_pk_mul_f32 v[68:69], v[36:37], v[36:37]
    v_pk_mul_f32 v[70:71], v[38:39], v[38:39]
    v_pk_fma_f32 v[56:57], v[56:57], v[242:243], v[240:241] op_sel_hi:[1,0,0]
    v_pk_fma_f32 v[58:59], v[58:59], v[242:243], v[240:241] op_sel_hi:[1,0,0]
    v_pk_fma_f32 v[60:61], v[60:61], v[242:243], v[240:241] op_sel_hi:[1,0,0]
    v_pk_fma_f32 v[62:63], v[62:63], v[242:243], v[240:241] op_sel_hi:[1,0,0]
    v_pk_fma_f32 v[64:65], v[64:65], v[242:243], v[240:241] op_sel_hi:[1,0,0]
    v_pk_fma_f32 v[66:67], v[66:67], v[242:243], v[240:241] op_sel_hi:[1,0,0]
    v_pk_fma_f32 v[68:69], v[68:69], v[242:243], v[240:241] op_sel_hi:[1,0,0]
    v_pk_fma_f32 v[70:71], v[70:71], v[242:243], v[240:241] op_sel_hi:[1,0,0]
    v_pk_mul_f32 v[56:57], v[56:57], v[24:25]
    v_pk_mul_f32 v[58:59], v[58:59], v[26:27]
    v_pk_mul_f32 v[60:61], v[60:61], v[28:29]
    v_pk_mul_f32 v[62:63], v[62:63], v[30:31]
    v_pk_mul_f32 v[64:65], v[64:65], v[32:33]
    v_pk_mul_f32 v[66:67], v[66:67], v[34:35]
    v_pk_mul_f32 v[68:69], v[68:69], v[36:37]
    v_pk_mul_f32 v[70:71], v[70:71], v[38:39]
    v_exp_f32 v56, v56
    v_exp_f32 v57, v57
    v_exp_f32 v58, v58
    v_exp_f32 v59, v59
    v_exp_f32 v60, v60
    v_exp_f32 v61, v61
    v_exp_f32 v62, v62
    v_exp_f32 v63, v63
    v_exp_f32 v64, v64
    v_exp_f32 v65, v65
    v_exp_f32 v66, v66
    v_exp_f32 v67, v67
    v_exp_f32 v68, v68
    v_exp_f32 v69, v69
    v_exp_f32 v70, v70
    v_exp_f32 v71, v71
    v_pk_fma_f32 v[56:57], v[56:57], v[234:235], v[234:235] op_sel_hi:[1,0,0]
    v_pk_fma_f32 v[58:59], v[58:59], v[234:235], v[234:235] op_sel_hi:[1,0,0]
    v_pk_fma_f32 v[60:61], v[60:61], v[234:235], v[234:235] op_sel_hi:[1,0,0]
    v_pk_fma_f32 v[62:63], v[62:63], v[234:235], v[234:235] op_sel_hi:[1,0,0]
    v_pk_fma_f32 v[64:65], v[64:65], v[234:235], v[234:235] op_sel_hi:[1,0,0]
    v_pk_fma_f32 v[66:67], v[66:67], v[234:235], v[234:235] op_sel_hi:[1,0,0]
    v_pk_fma_f32 v[68:69], v[68:69], v[234:235], v[234:235] op_sel_hi:[1,0,0]
    v_pk_fma_f32 v[70:71], v[70:71], v[234:235], v[234:235] op_sel_hi:[1,0,0]
    v_rcp_f32 v56, v56
    v_rcp_f32 v57, v57
    v_rcp_f32 v58, v58
    v_rcp_f32 v59, v59
    v_rcp_f32 v60, v60
    v_rcp_f32 v61, v61
    v_rcp_f32 v62, v62
    v_rcp_f32 v63, v63
    v_rcp_f32 v64, v64
    v_rcp_f32 v65, v65
    v_rcp_f32 v66, v66
    v_rcp_f32 v67, v67
    v_rcp_f32 v68, v68
    v_rcp_f32 v69, v69
    v_rcp_f32 v70, v70
    v_rcp_f32 v71, v71
    v_pk_mul_f32 v[24:25], v[24:25], v[56:57]
    v_pk_mul_f32 v[26:27], v[26:27], v[58:59]
    v_pk_mul_f32 v[28:29], v[28:29], v[60:61]
    v_pk_mul_f32 v[30:31], v[30:31], v[62:63]
    v_pk_mul_f32 v[32:33], v[32:33], v[64:65]
    v_pk_mul_f32 v[34:35], v[34:35], v[66:67]
    v_pk_mul_f32 v[36:37], v[36:37], v[68:69]
    v_pk_mul_f32 v[38:39], v[38:39], v[70:71]
    v_cvt_pk_bf16_f32 v4, v24, v25
    v_cvt_pk_bf16_f32 v5, v26, v27
    v_cvt_pk_bf16_f32 v6, v28, v29
    v_cvt_pk_bf16_f32 v7, v30, v31
    buffer_store_dwordx4 v[4:7], v2, s[20:23], s50 offen offset:0 sc1
    v_cvt_pk_bf16_f32 v8, v32, v33
    v_cvt_pk_bf16_f32 v9, v34, v35
    v_cvt_pk_bf16_f32 v10, v36, v37
    v_cvt_pk_bf16_f32 v11, v38, v39
    buffer_store_dwordx4 v[8:11], v2, s[20:23], s50 offen offset:1024 sc1
    s_waitcnt lgkmcnt(0)
    ds_read_b32 v252, v250 offset:1536
    v_pk_fma_f32 v[40:41], v[212:213], v[236:237], v[40:41] op_sel_hi:[1,0,1]
    v_pk_fma_f32 v[42:43], v[214:215], v[236:237], v[42:43] op_sel_hi:[1,0,1]
    v_pk_fma_f32 v[44:45], v[216:217], v[236:237], v[44:45] op_sel_hi:[1,0,1]
    v_pk_fma_f32 v[46:47], v[218:219], v[236:237], v[46:47] op_sel_hi:[1,0,1]
    v_pk_fma_f32 v[48:49], v[220:221], v[236:237], v[48:49] op_sel_hi:[1,0,1]
    v_pk_fma_f32 v[50:51], v[222:223], v[236:237], v[50:51] op_sel_hi:[1,0,1]
    v_pk_fma_f32 v[52:53], v[224:225], v[236:237], v[52:53] op_sel_hi:[1,0,1]
    v_pk_fma_f32 v[54:55], v[226:227], v[236:237], v[54:55] op_sel_hi:[1,0,1]
    v_pk_mul_f32 v[56:57], v[40:41], v[40:41]
    v_pk_mul_f32 v[58:59], v[42:43], v[42:43]
    v_pk_mul_f32 v[60:61], v[44:45], v[44:45]
    v_pk_mul_f32 v[62:63], v[46:47], v[46:47]
    v_pk_mul_f32 v[64:65], v[48:49], v[48:49]
    v_pk_mul_f32 v[66:67], v[50:51], v[50:51]
    v_pk_mul_f32 v[68:69], v[52:53], v[52:53]
    v_pk_mul_f32 v[70:71], v[54:55], v[54:55]
    v_pk_fma_f32 v[56:57], v[56:57], v[242:243], v[240:241] op_sel_hi:[1,0,0]
    v_pk_fma_f32 v[58:59], v[58:59], v[242:243], v[240:241] op_sel_hi:[1,0,0]
    v_pk_fma_f32 v[60:61], v[60:61], v[242:243], v[240:241] op_sel_hi:[1,0,0]
    v_pk_fma_f32 v[62:63], v[62:63], v[242:243], v[240:241] op_sel_hi:[1,0,0]
    v_pk_fma_f32 v[64:65], v[64:65], v[242:243], v[240:241] op_sel_hi:[1,0,0]
    v_pk_fma_f32 v[66:67], v[66:67], v[242:243], v[240:241] op_sel_hi:[1,0,0]
    v_pk_fma_f32 v[68:69], v[68:69], v[242:243], v[240:241] op_sel_hi:[1,0,0]
    v_pk_fma_f32 v[70:71], v[70:71], v[242:243], v[240:241] op_sel_hi:[1,0,0]
    v_pk_mul_f32 v[56:57], v[56:57], v[40:41]
    v_pk_mul_f32 v[58:59], v[58:59], v[42:43]
    v_pk_mul_f32 v[60:61], v[60:61], v[44:45]
    v_pk_mul_f32 v[62:63], v[62:63], v[46:47]
    v_pk_mul_f32 v[64:65], v[64:65], v[48:49]
    v_pk_mul_f32 v[66:67], v[66:67], v[50:51]
    v_pk_mul_f32 v[68:69], v[68:69], v[52:53]
    v_pk_mul_f32 v[70:71], v[70:71], v[54:55]
    v_exp_f32 v56, v56
    v_exp_f32 v57, v57
    v_exp_f32 v58, v58
    v_exp_f32 v59, v59
    v_exp_f32 v60, v60
    v_exp_f32 v61, v61
    v_exp_f32 v62, v62
    v_exp_f32 v63, v63
    v_exp_f32 v64, v64
    v_exp_f32 v65, v65
    v_exp_f32 v66, v66
    v_exp_f32 v67, v67
    v_exp_f32 v68, v68
    v_exp_f32 v69, v69
    v_exp_f32 v70, v70
    v_exp_f32 v71, v71
    v_pk_fma_f32 v[56:57], v[56:57], v[234:235], v[234:235] op_sel_hi:[1,0,0]
    v_pk_fma_f32 v[58:59], v[58:59], v[234:235], v[234:235] op_sel_hi:[1,0,0]
    v_pk_fma_f32 v[60:61], v[60:61], v[234:235], v[234:235] op_sel_hi:[1,0,0]
    v_pk_fma_f32 v[62:63], v[62:63], v[234:235], v[234:235] op_sel_hi:[1,0,0]
    v_pk_fma_f32 v[64:65], v[64:65], v[234:235], v[234:235] op_sel_hi:[1,0,0]
    v_pk_fma_f32 v[66:67], v[66:67], v[234:235], v[234:235] op_sel_hi:[1,0,0]
    v_pk_fma_f32 v[68:69], v[68:69], v[234:235], v[234:235] op_sel_hi:[1,0,0]
    v_pk_fma_f32 v[70:71], v[70:71], v[234:235], v[234:235] op_sel_hi:[1,0,0]
    v_rcp_f32 v56, v56
    v_rcp_f32 v57, v57
    v_rcp_f32 v58, v58
    v_rcp_f32 v59, v59
    v_rcp_f32 v60, v60
    v_rcp_f32 v61, v61
    v_rcp_f32 v62, v62
    v_rcp_f32 v63, v63
    v_rcp_f32 v64, v64
    v_rcp_f32 v65, v65
    v_rcp_f32 v66, v66
    v_rcp_f32 v67, v67
    v_rcp_f32 v68, v68
    v_rcp_f32 v69, v69
    v_rcp_f32 v70, v70
    v_rcp_f32 v71, v71
    v_pk_mul_f32 v[40:41], v[40:41], v[56:57]
    v_pk_mul_f32 v[42:43], v[42:43], v[58:59]
    v_pk_mul_f32 v[44:45], v[44:45], v[60:61]
    v_pk_mul_f32 v[46:47], v[46:47], v[62:63]
    v_pk_mul_f32 v[48:49], v[48:49], v[64:65]
    v_pk_mul_f32 v[50:51], v[50:51], v[66:67]
    v_pk_mul_f32 v[52:53], v[52:53], v[68:69]
    v_pk_mul_f32 v[54:55], v[54:55], v[70:71]
    v_cvt_pk_bf16_f32 v12, v40, v41
    v_cvt_pk_bf16_f32 v13, v42, v43
    v_cvt_pk_bf16_f32 v14, v44, v45
    v_cvt_pk_bf16_f32 v15, v46, v47
    buffer_store_dwordx4 v[12:15], v2, s[20:23], s50 offen offset:2048 sc1
    v_cvt_pk_bf16_f32 v16, v48, v49
    v_cvt_pk_bf16_f32 v17, v50, v51
    v_cvt_pk_bf16_f32 v18, v52, v53
    v_cvt_pk_bf16_f32 v19, v54, v55
    buffer_store_dwordx4 v[16:19], v2, s[20:23], s50 offen offset:3072 sc1
    s_waitcnt lgkmcnt(0)
    v_cmp_gt_u32 vcc, 9, v252
    s_cbranch_vccnz K2_FW_51
K2_FB_52:
    ds_read_b128 v[212:215], v249 offset:16384
    ds_read_b128 v[216:219], v249 offset:17408
    ds_read_b128 v[220:223], v249 offset:18432
    ds_read_b128 v[224:227], v249 offset:19456
    ds_read_b128 v[196:199], v249 offset:20480
    ds_read_b128 v[200:203], v249 offset:21504
    ds_read_b128 v[204:207], v249 offset:22528
    ds_read_b128 v[208:211], v249 offset:23552
    s_waitcnt lgkmcnt(6)
    v_mfma_f32_16x16x32_bf16 v[56:59], v[212:215], v[110:113], 0
    ds_read_b128 v[212:215], v249 offset:24576
    v_mfma_f32_16x16x32_bf16 v[60:63], v[216:219], v[110:113], 0
    ds_read_b128 v[216:219], v249 offset:25600
    s_waitcnt lgkmcnt(6)
    v_mfma_f32_16x16x32_bf16 v[64:67], v[220:223], v[110:113], 0
    ds_read_b128 v[220:223], v249 offset:26624
    v_mfma_f32_16x16x32_bf16 v[68:71], v[224:227], v[110:113], 0
    ds_read_b128 v[224:227], v249 offset:27648
    s_waitcnt lgkmcnt(6)
    v_mfma_f32_16x16x32_bf16 v[72:75], v[196:199], v[110:113], 0
    ds_read_b128 v[196:199], v249 offset:28672
    v_mfma_f32_16x16x32_bf16 v[76:79], v[200:203], v[110:113], 0
    ds_read_b128 v[200:203], v249 offset:29696
    s_waitcnt lgkmcnt(6)
    v_mfma_f32_16x16x32_bf16 v[56:59], v[204:207], v[134:137], v[56:59]
    ds_read_b128 v[204:207], v247 offset:0
    v_mfma_f32_16x16x32_bf16 v[60:63], v[208:211], v[134:137], v[60:63]
    ds_read_b128 v[208:211], v247 offset:1024
    s_waitcnt lgkmcnt(6)
    v_mfma_f32_16x16x32_bf16 v[64:67], v[212:215], v[134:137], v[64:67]
    ds_read_b128 v[212:215], v247 offset:2048
    v_mfma_f32_16x16x32_bf16 v[68:71], v[216:219], v[134:137], v[68:71]
    ds_read_b128 v[216:219], v247 offset:3072
    s_waitcnt lgkmcnt(6)
    v_mfma_f32_16x16x32_bf16 v[72:75], v[220:223], v[134:137], v[72:75]
    ds_read_b128 v[220:223], v247 offset:4096
    v_mfma_f32_16x16x32_bf16 v[76:79], v[224:227], v[134:137], v[76:79]
    ds_read_b128 v[224:227], v247 offset:5120
    s_waitcnt lgkmcnt(6)
    v_mfma_f32_16x16x32_bf16 v[56:59], v[196:199], v[158:161], v[56:59]
    ds_read_b128 v[196:199], v247 offset:6144
    v_mfma_f32_16x16x32_bf16 v[60:63], v[200:203], v[158:161], v[60:63]
    ds_read_b128 v[200:203], v247 offset:7168
    s_waitcnt lgkmcnt(6)
    v_mfma_f32_16x16x32_bf16 v[64:67], v[204:207], v[158:161], v[64:67]
    ds_read_b128 v[204:207], v247 offset:8192
    v_mfma_f32_16x16x32_bf16 v[68:71], v[208:211], v[158:161], v[68:71]
    ds_read_b128 v[208:211], v247 offset:9216
    s_waitcnt lgkmcnt(6)
    v_mfma_f32_16x16x32_bf16 v[72:75], v[212:215], v[158:161], v[72:75]
    ds_read_b128 v[212:215], v247 offset:10240
    v_mfma_f32_16x16x32_bf16 v[76:79], v[216:219], v[158:161], v[76:79]
    ds_read_b128 v[216:219], v247 offset:11264
    s_waitcnt lgkmcnt(6)
    v_mfma_f32_16x16x32_bf16 v[56:59], v[220:223], v[182:185], v[56:59]
    ds_read_b128 v[220:223], v247 offset:12288
    v_mfma_f32_16x16x32_bf16 v[60:63], v[224:227], v[182:185], v[60:63]
    ds_read_b128 v[224:227], v247 offset:13312
    s_waitcnt lgkmcnt(6)
    v_mfma_f32_16x16x32_bf16 v[64:67], v[196:199], v[182:185], v[64:67]
    ds_read_b128 v[196:199], v247 offset:14336
    v_mfma_f32_16x16x32_bf16 v[68:71], v[200:203], v[182:185], v[68:71]
    ds_read_b128 v[200:203], v247 offset:15360
    s_waitcnt lgkmcnt(6)
    v_mfma_f32_16x16x32_bf16 v[72:75], v[204:207], v[182:185], v[72:75]
    ds_read_b128 v[204:207], v247 offset:16384
    v_mfma_f32_16x16x32_bf16 v[76:79], v[208:211], v[182:185], v[76:79]
    ds_read_b128 v[208:211], v247 offset:17408
    s_waitcnt lgkmcnt(6)
    v_mfma_f32_16x16x32_bf16 v[56:59], v[212:215], v[100:103], v[56:59]
    ds_read_b128 v[212:215], v247 offset:18432
    v_mfma_f32_16x16x32_bf16 v[60:63], v[216:219], v[100:103], v[60:63]
    ds_read_b128 v[216:219], v247 offset:19456
    s_waitcnt lgkmcnt(6)
    v_mfma_f32_16x16x32_bf16 v[64:67], v[220:223], v[100:103], v[64:67]
    ds_read_b128 v[220:223], v247 offset:20480
    v_mfma_f32_16x16x32_bf16 v[68:71], v[224:227], v[100:103], v[68:71]
    ds_read_b128 v[224:227], v247 offset:21504
    s_waitcnt lgkmcnt(6)
    v_mfma_f32_16x16x32_bf16 v[72:75], v[196:199], v[100:103], v[72:75]
    ds_read_b128 v[196:199], v247 offset:22528
    v_mfma_f32_16x16x32_bf16 v[76:79], v[200:203], v[100:103], v[76:79]
    v_mov_b32 v253, 12
    ds_write_b32 v251, v253 offset:1552
    ds_read_b128 v[200:203], v247 offset:23552
    s_waitcnt lgkmcnt(7)
    v_mfma_f32_16x16x32_bf16 v[56:59], v[204:207], v[104:107], v[56:59]
    ds_read_b128 v[204:207], v247 offset:24576
    v_mfma_f32_16x16x32_bf16 v[60:63], v[208:211], v[104:107], v[60:63]
    ds_read_b128 v[208:211], v247 offset:25600
    s_waitcnt lgkmcnt(7)
    v_mfma_f32_16x16x32_bf16 v[64:67], v[212:215], v[104:107], v[64:67]
    ds_read_b128 v[212:215], v247 offset:26624
    v_mfma_f32_16x16x32_bf16 v[68:71], v[216:219], v[104:107], v[68:71]
    ds_read_b128 v[216:219], v247 offset:27648
    s_waitcnt lgkmcnt(7)
    v_mfma_f32_16x16x32_bf16 v[72:75], v[220:223], v[104:107], v[72:75]
    ds_read_b128 v[220:223], v247 offset:28672
    v_mfma_f32_16x16x32_bf16 v[76:79], v[224:227], v[104:107], v[76:79]
    ds_read_b128 v[224:227], v247 offset:29696
    s_waitcnt lgkmcnt(6)
    v_mfma_f32_16x16x32_bf16 v[56:59], v[196:199], v[116:119], v[56:59]
    ds_read_b128 v[196:199], v247 offset:30720
    v_mfma_f32_16x16x32_bf16 v[60:63], v[200:203], v[116:119], v[60:63]
    ds_read_b128 v[200:203], v247 offset:31744
    s_waitcnt lgkmcnt(6)
    v_mfma_f32_16x16x32_bf16 v[64:67], v[204:207], v[116:119], v[64:67]
    ds_read_b128 v[204:207], v247 offset:32768
    v_mfma_f32_16x16x32_bf16 v[68:71], v[208:211], v[116:119], v[68:71]
    ds_read_b128 v[208:211], v247 offset:33792
    s_waitcnt lgkmcnt(6)
    v_mfma_f32_16x16x32_bf16 v[72:75], v[212:215], v[116:119], v[72:75]
    ds_read_b128 v[212:215], v247 offset:34816
    v_mfma_f32_16x16x32_bf16 v[76:79], v[216:219], v[116:119], v[76:79]
    s_waitcnt vmcnt(0)
    s_add_u32 s52, s48, 19456000
    s_mov_b64 exec, 1
    buffer_atomic_add v243, v255, s[20:23], s52 offen sc1
    s_mov_b64 exec, -1
    ds_read_b128 v[216:219], v247 offset:35840
    s_waitcnt lgkmcnt(6)
    v_mfma_f32_16x16x32_bf16 v[56:59], v[220:223], v[120:123], v[56:59]
    ds_read_b128 v[220:223], v247 offset:36864
    v_mfma_f32_16x16x32_bf16 v[60:63], v[224:227], v[120:123], v[60:63]
    ds_read_b128 v[224:227], v247 offset:37888
    s_waitcnt lgkmcnt(6)
    v_mfma_f32_16x16x32_bf16 v[64:67], v[196:199], v[120:123], v[64:67]
    ds_read_b128 v[196:199], v247 offset:38912
    v_mfma_f32_16x16x32_bf16 v[68:71], v[200:203], v[120:123], v[68:71]
    ds_read_b128 v[200:203], v247 offset:39936
    s_waitcnt lgkmcnt(6)
    v_mfma_f32_16x16x32_bf16 v[72:75], v[204:207], v[120:123], v[72:75]
    ds_read_b128 v[204:207], v247 offset:40960
    v_mfma_f32_16x16x32_bf16 v[76:79], v[208:211], v[120:123], v[76:79]
    ds_read_b128 v[208:211], v247 offset:41984
    s_waitcnt lgkmcnt(6)
    v_mfma_f32_16x16x32_bf16 v[56:59], v[212:215], v[124:127], v[56:59]
    ds_read_b128 v[212:215], v247 offset:43008
    v_mfma_f32_16x16x32_bf16 v[60:63], v[216:219], v[124:127], v[60:63]
    ds_read_b128 v[216:219], v247 offset:44032
    s_waitcnt lgkmcnt(6)
    v_mfma_f32_16x16x32_bf16 v[64:67], v[220:223], v[124:127], v[64:67]
    ds_read_b128 v[220:223], v247 offset:45056
    ds_read_b32 v252, v250 offset:1536
    v_mfma_f32_16x16x32_bf16 v[68:71], v[224:227], v[124:127], v[68:71]
    ds_read_b128 v[224:227], v247 offset:46080
    s_waitcnt lgkmcnt(7)
    v_mfma_f32_16x16x32_bf16 v[72:75], v[196:199], v[124:127], v[72:75]
    ds_read_b128 v[196:199], v247 offset:47104
    v_mfma_f32_16x16x32_bf16 v[76:79], v[200:203], v[124:127], v[76:79]
    ds_read_b128 v[200:203], v247 offset:48128
    s_waitcnt lgkmcnt(7)
    v_mfma_f32_16x16x32_bf16 v[56:59], v[204:207], v[128:131], v[56:59]
    s_waitcnt lgkmcnt(3)
    v_cmp_gt_u32 vcc, 10, v252
    s_cbranch_vccnz K2_FW_53
K2_FB_54:
    ds_read_b128 v[204:207], v247 offset:49152
    v_mfma_f32_16x16x32_bf16 v[60:63], v[208:211], v[128:131], v[60:63]
    ds_read_b128 v[208:211], v247 offset:50176
    v_mfma_f32_16x16x32_bf16 v[64:67], v[212:215], v[128:131], v[64:67]
    ds_read_b128 v[212:215], v247 offset:51200
    v_mfma_f32_16x16x32_bf16 v[68:71], v[216:219], v[128:131], v[68:71]
    ds_read_b128 v[216:219], v247 offset:52224
    s_waitcnt lgkmcnt(6)
    v_mfma_f32_16x16x32_bf16 v[72:75], v[220:223], v[128:131], v[72:75]
    ds_read_b128 v[220:223], v247 offset:53248
    v_mfma_f32_16x16x32_bf16 v[76:79], v[224:227], v[128:131], v[76:79]
    v_mov_b32 v253, 13
    ds_write_b32 v251, v253 offset:1552
    ds_read_b128 v[224:227], v247 offset:54272
    s_waitcnt lgkmcnt(7)
    v_mfma_f32_16x16x32_bf16 v[56:59], v[196:199], v[140:143], v[56:59]
    ds_read_b128 v[196:199], v247 offset:55296
    v_mfma_f32_16x16x32_bf16 v[60:63], v[200:203], v[140:143], v[60:63]
    ds_read_b128 v[200:203], v247 offset:56320
    s_waitcnt lgkmcnt(7)
    v_mfma_f32_16x16x32_bf16 v[64:67], v[204:207], v[140:143], v[64:67]
    ds_read_b128 v[204:207], v247 offset:57344
    v_mfma_f32_16x16x32_bf16 v[68:71], v[208:211], v[140:143], v[68:71]
    ds_read_b128 v[208:211], v247 offset:58368
    s_waitcnt lgkmcnt(7)
    v_mfma_f32_16x16x32_bf16 v[72:75], v[212:215], v[140:143], v[72:75]
    ds_read_b128 v[212:215], v247 offset:59392
    v_mfma_f32_16x16x32_bf16 v[76:79], v[216:219], v[140:143], v[76:79]
    ds_read_b128 v[216:219], v247 offset:60416
    s_waitcnt lgkmcnt(6)
    v_mfma_f32_16x16x32_bf16 v[56:59], v[220:223], v[144:147], v[56:59]
    ds_read_b128 v[220:223], v247 offset:61440
    v_mfma_f32_16x16x32_bf16 v[60:63], v[224:227], v[144:147], v[60:63]
    ds_read_b128 v[224:227], v247 offset:62464
    s_waitcnt lgkmcnt(6)
    v_mfma_f32_16x16x32_bf16 v[64:67], v[196:199], v[144:147], v[64:67]
    ds_read_b128 v[196:199], v247 offset:63488
    v_mfma_f32_16x16x32_bf16 v[68:71], v[200:203], v[144:147], v[68:71]
    ds_read_b128 v[200:203], v247 offset:64512
    s_waitcnt lgkmcnt(6)
    v_mfma_f32_16x16x32_bf16 v[72:75], v[204:207], v[144:147], v[72:75]
    ds_read_b128 v[204:207], v248 offset:0
    v_mfma_f32_16x16x32_bf16 v[76:79], v[208:211], v[144:147], v[76:79]
    ds_read_b128 v[208:211], v248 offset:1024
    s_waitcnt lgkmcnt(6)
    v_mfma_f32_16x16x32_bf16 v[56:59], v[212:215], v[148:151], v[56:59]
    ds_read_b128 v[212:215], v248 offset:2048
    v_mfma_f32_16x16x32_bf16 v[60:63], v[216:219], v[148:151], v[60:63]
    ds_read_b128 v[216:219], v248 offset:3072
    s_waitcnt lgkmcnt(6)
    v_mfma_f32_16x16x32_bf16 v[64:67], v[220:223], v[148:151], v[64:67]
    ds_read_b128 v[220:223], v248 offset:4096
    v_mfma_f32_16x16x32_bf16 v[68:71], v[224:227], v[148:151], v[68:71]
    ds_read_b128 v[224:227], v248 offset:5120
    s_waitcnt lgkmcnt(6)
    v_mfma_f32_16x16x32_bf16 v[72:75], v[196:199], v[148:151], v[72:75]
    ds_read_b128 v[196:199], v248 offset:6144
    v_mfma_f32_16x16x32_bf16 v[76:79], v[200:203], v[148:151], v[76:79]
    ds_read_b128 v[200:203], v248 offset:7168
    s_waitcnt lgkmcnt(6)
    v_mfma_f32_16x16x32_bf16 v[56:59], v[204:207], v[152:155], v[56:59]
    ds_read_b128 v[204:207], v248 offset:8192
    v_mfma_f32_16x16x32_bf16 v[60:63], v[208:211], v[152:155], v[60:63]
    ds_read_b128 v[208:211], v248 offset:9216
    s_waitcnt lgkmcnt(6)
    v_mfma_f32_16x16x32_bf16 v[64:67], v[212:215], v[152:155], v[64:67]
    ds_read_b128 v[212:215], v248 offset:10240
    v_mfma_f32_16x16x32_bf16 v[68:71], v[216:219], v[152:155], v[68:71]
    ds_read_b128 v[216:219], v248 offset:11264
    s_waitcnt lgkmcnt(6)
    v_mfma_f32_16x16x32_bf16 v[72:75], v[220:223], v[152:155], v[72:75]
    ds_read_b128 v[220:223], v248 offset:12288
    ds_read_b32 v252, v250 offset:1536
    v_mfma_f32_16x16x32_bf16 v[76:79], v[224:227], v[152:155], v[76:79]
    ds_read_b128 v[224:227], v248 offset:13312
    s_waitcnt lgkmcnt(7)
    v_mfma_f32_16x16x32_bf16 v[56:59], v[196:199], v[164:167], v[56:59]
    ds_read_b128 v[196:199], v248 offset:14336
    v_mfma_f32_16x16x32_bf16 v[60:63], v[200:203], v[164:167], v[60:63]
    ds_read_b128 v[200:203], v248 offset:15360
    s_waitcnt lgkmcnt(7)
    v_mfma_f32_16x16x32_bf16 v[64:67], v[204:207], v[164:167], v[64:67]
    s_waitcnt lgkmcnt(3)
    v_cmp_gt_u32 vcc, 11, v252
    s_cbranch_vccnz K2_FW_55
K2_FB_56:
    ds_read_b128 v[204:207], v248 offset:16384
    v_mfma_f32_16x16x32_bf16 v[68:71], v[208:211], v[164:167], v[68:71]
    ds_read_b128 v[208:211], v248 offset:17408
    v_mfma_f32_16x16x32_bf16 v[72:75], v[212:215], v[164:167], v[72:75]
    ds_read_b128 v[212:215], v248 offset:18432
    v_mfma_f32_16x16x32_bf16 v[76:79], v[216:219], v[164:167], v[76:79]
    v_mov_b32 v253, 14
    ds_write_b32 v251, v253 offset:1552
    ds_read_b128 v[216:219], v248 offset:19456
    s_waitcnt lgkmcnt(7)
    v_mfma_f32_16x16x32_bf16 v[56:59], v[220:223], v[168:171], v[56:59]
    ds_read_b128 v[220:223], v248 offset:20480
    v_mfma_f32_16x16x32_bf16 v[60:63], v[224:227], v[168:171], v[60:63]
    ds_read_b128 v[224:227], v248 offset:21504
    s_waitcnt lgkmcnt(7)
    v_mfma_f32_16x16x32_bf16 v[64:67], v[196:199], v[168:171], v[64:67]
    ds_read_b128 v[196:199], v248 offset:22528
    v_mfma_f32_16x16x32_bf16 v[68:71], v[200:203], v[168:171], v[68:71]
    ds_read_b128 v[200:203], v248 offset:23552
    s_waitcnt lgkmcnt(7)
    v_mfma_f32_16x16x32_bf16 v[72:75], v[204:207], v[168:171], v[72:75]
    ds_read_b128 v[204:207], v248 offset:24576
    v_mfma_f32_16x16x32_bf16 v[76:79], v[208:211], v[168:171], v[76:79]
    s_add_u32 s62, s48, 19456000
    s_mov_b64 exec, 1
    v_mov_b32 v231, 0
    buffer_atomic_add v231, v255, s[20:23], s62 offen sc0 sc1
    s_mov_b64 exec, -1
    ds_read_b128 v[208:211], v248 offset:25600
    s_waitcnt lgkmcnt(6)
    v_mfma_f32_16x16x32_bf16 v[56:59], v[212:215], v[172:175], v[56:59]
    ds_read_b128 v[212:215], v248 offset:26624
    v_mfma_f32_16x16x32_bf16 v[60:63], v[216:219], v[172:175], v[60:63]
    ds_read_b128 v[216:219], v248 offset:27648
    s_waitcnt lgkmcnt(6)
    v_mfma_f32_16x16x32_bf16 v[64:67], v[220:223], v[172:175], v[64:67]
    ds_read_b128 v[220:223], v248 offset:28672
    v_mfma_f32_16x16x32_bf16 v[68:71], v[224:227], v[172:175], v[68:71]
    ds_read_b128 v[224:227], v248 offset:29696
    s_waitcnt lgkmcnt(6)
    v_mfma_f32_16x16x32_bf16 v[72:75], v[196:199], v[172:175], v[72:75]
    ds_read_b128 v[196:199], v248 offset:30720
    v_mfma_f32_16x16x32_bf16 v[76:79], v[200:203], v[172:175], v[76:79]
    ds_read_b128 v[200:203], v248 offset:31744
    s_waitcnt lgkmcnt(6)
    v_mfma_f32_16x16x32_bf16 v[56:59], v[204:207], v[176:179], v[56:59]
    ds_read_b128 v[204:207], v248 offset:32768
    v_mfma_f32_16x16x32_bf16 v[60:63], v[208:211], v[176:179], v[60:63]
    ds_read_b128 v[208:211], v248 offset:33792
    s_waitcnt lgkmcnt(6)
    v_mfma_f32_16x16x32_bf16 v[64:67], v[212:215], v[176:179], v[64:67]
    ds_read_b128 v[212:215], v248 offset:34816
    v_mfma_f32_16x16x32_bf16 v[68:71], v[216:219], v[176:179], v[68:71]
    ds_read_b128 v[216:219], v248 offset:35840
    s_waitcnt lgkmcnt(6)
    v_mfma_f32_16x16x32_bf16 v[72:75], v[220:223], v[176:179], v[72:75]
    ds_read_b128 v[220:223], v248 offset:36864
    v_mfma_f32_16x16x32_bf16 v[76:79], v[224:227], v[176:179], v[76:79]
    ds_read_b128 v[224:227], v248 offset:37888
    s_waitcnt lgkmcnt(6)
    v_mfma_f32_16x16x32_bf16 v[56:59], v[196:199], v[188:191], v[56:59]
    ds_read_b128 v[196:199], v248 offset:38912
    v_mfma_f32_16x16x32_bf16 v[60:63], v[200:203], v[188:191], v[60:63]
    ds_read_b128 v[200:203], v248 offset:39936
    s_waitcnt lgkmcnt(6)
    v_mfma_f32_16x16x32_bf16 v[64:67], v[204:207], v[188:191], v[64:67]
    ds_read_b128 v[204:207], v248 offset:40960
    v_mfma_f32_16x16x32_bf16 v[68:71], v[208:211], v[188:191], v[68:71]
    ds_read_b128 v[208:211], v248 offset:41984
    s_waitcnt lgkmcnt(6)
    v_mfma_f32_16x16x32_bf16 v[72:75], v[212:215], v[188:191], v[72:75]
    v_mfma_f32_16x16x32_bf16 v[76:79], v[216:219], v[188:191], v[76:79]
    s_waitcnt lgkmcnt(4)
    v_mfma_f32_16x16x32_bf16 v[56:59], v[220:223], v[192:195], v[56:59]
    v_mfma_f32_16x16x32_bf16 v[60:63], v[224:227], v[192:195], v[60:63]
    s_waitcnt lgkmcnt(2)
    v_mfma_f32_16x16x32_bf16 v[64:67], v[196:199], v[192:195], v[64:67]
    v_mfma_f32_16x16x32_bf16 v[68:71], v[200:203], v[192:195], v[68:71]
    s_waitcnt lgkmcnt(0)
    v_mfma_f32_16x16x32_bf16 v[72:75], v[204:207], v[192:195], v[72:75]
    v_mfma_f32_16x16x32_bf16 v[76:79], v[208:211], v[192:195], v[76:79]
    v_mov_b32 v253, 15
    ds_write_b32 v251, v253 offset:1552
    s_waitcnt vmcnt(0)
    v_readfirstlane_b32 s52, v231
    s_cmp_lt_u32 s52, 8
    s_cbranch_scc1 K2_G2_57
K2_G2B_58:
    s_mov_b32 s57, s51
    s_mov_b32 s61, s51
    s_mov_b32 s56, s51
    s_mov_b32 s60, s51
    s_add_u32 s54, s51, 0
    s_add_u32 s58, s51, 4096
    buffer_load_dwordx4 v[100:103], v2, s[20:23], s54 offen offset:0 sc1
    buffer_load_dwordx4 v[104:107], v2, s[20:23], s54 offen offset:1024 sc1
    buffer_load_dwordx4 v[108:111], v2, s[20:23], s54 offen offset:2048 sc1
    buffer_load_dwordx4 v[112:115], v2, s[20:23], s54 offen offset:3072 sc1
    buffer_load_dwordx4 v[116:119], v2, s[20:23], s58 offen offset:0 sc1
    buffer_load_dwordx4 v[120:123], v2, s[20:23], s58 offen offset:1024 sc1
    s_add_u32 s55, s51, 6144
    s_add_u32 s59, s51, 10240
    buffer_load_dwordx4 v[124:127], v2, s[20:23], s55 offen offset:0 sc1
    buffer_load_dwordx4 v[128:131], v2, s[20:23], s55 offen offset:1024 sc1
    buffer_load_dwordx4 v[132:135], v2, s[20:23], s55 offen offset:2048 sc1
    buffer_load_dwordx4 v[136:139], v2, s[20:23], s55 offen offset:3072 sc1
    buffer_load_dwordx4 v[140:143], v2, s[20:23], s59 offen offset:0 sc1
    buffer_load_dwordx4 v[144:147], v2, s[20:23], s59 offen offset:1024 sc1
    ds_read_b128 v[196:199], v254 offset:1024
    ds_read_b128 v[200:203], v254 offset:1088
    ds_read_b128 v[204:207], v254 offset:1152
    ds_read_b128 v[208:211], v254 offset:1216
    ds_read_b128 v[212:215], v254 offset:1280
    ds_read_b128 v[216:219], v254 offset:1344
    s_waitcnt lgkmcnt(0)
    s_nop 3
    ds_read_b32 v252, v250 offset:1536
    v_pk_fma_f32 v[56:57], v[196:197], v[236:237], v[56:57] op_sel_hi:[1,0,1]
    v_pk_fma_f32 v[58:59], v[198:199], v[236:237], v[58:59] op_sel_hi:[1,0,1]
    v_pk_fma_f32 v[60:61], v[200:201], v[236:237], v[60:61] op_sel_hi:[1,0,1]
    v_pk_fma_f32 v[62:63], v[202:203], v[236:237], v[62:63] op_sel_hi:[1,0,1]
    v_pk_fma_f32 v[64:65], v[204:205], v[236:237], v[64:65] op_sel_hi:[1,0,1]
    v_pk_fma_f32 v[66:67], v[206:207], v[236:237], v[66:67] op_sel_hi:[1,0,1]
    v_pk_fma_f32 v[68:69], v[208:209], v[236:237], v[68:69] op_sel_hi:[1,0,1]
    v_pk_fma_f32 v[70:71], v[210:211], v[236:237], v[70:71] op_sel_hi:[1,0,1]
    v_pk_fma_f32 v[72:73], v[212:213], v[236:237], v[72:73] op_sel_hi:[1,0,1]
    v_pk_fma_f32 v[74:75], v[214:215], v[236:237], v[74:75] op_sel_hi:[1,0,1]
    v_pk_fma_f32 v[76:77], v[216:217], v[236:237], v[76:77] op_sel_hi:[1,0,1]
    v_pk_fma_f32 v[78:79], v[218:219], v[236:237], v[78:79] op_sel_hi:[1,0,1]
    v_pk_mul_f32 v[24:25], v[56:57], v[56:57]
    v_pk_mul_f32 v[26:27], v[58:59], v[58:59]
    v_pk_mul_f32 v[28:29], v[60:61], v[60:61]
    v_pk_mul_f32 v[30:31], v[62:63], v[62:63]
    v_pk_mul_f32 v[32:33], v[64:65], v[64:65]
    v_pk_mul_f32 v[34:35], v[66:67], v[66:67]
    v_pk_mul_f32 v[36:37], v[68:69], v[68:69]
    v_pk_mul_f32 v[38:39], v[70:71], v[70:71]
    v_pk_mul_f32 v[40:41], v[72:73], v[72:73]
    v_pk_mul_f32 v[42:43], v[74:75], v[74:75]
    v_pk_mul_f32 v[44:45], v[76:77], v[76:77]
    v_pk_mul_f32 v[46:47], v[78:79], v[78:79]
    v_pk_fma_f32 v[24:25], v[24:25], v[242:243], v[240:241] op_sel_hi:[1,0,0]
    v_pk_fma_f32 v[26:27], v[26:27], v[242:243], v[240:241] op_sel_hi:[1,0,0]
    v_pk_fma_f32 v[28:29], v[28:29], v[242:243], v[240:241] op_sel_hi:[1,0,0]
    v_pk_fma_f32 v[30:31], v[30:31], v[242:243], v[240:241] op_sel_hi:[1,0,0]
    v_pk_fma_f32 v[32:33], v[32:33], v[242:243], v[240:241] op_sel_hi:[1,0,0]
    v_pk_fma_f32 v[34:35], v[34:35], v[242:243], v[240:241] op_sel_hi:[1,0,0]
    v_pk_fma_f32 v[36:37], v[36:37], v[242:243], v[240:241] op_sel_hi:[1,0,0]
    v_pk_fma_f32 v[38:39], v[38:39], v[242:243], v[240:241] op_sel_hi:[1,0,0]
    v_pk_fma_f32 v[40:41], v[40:41], v[242:243], v[240:241] op_sel_hi:[1,0,0]
    v_pk_fma_f32 v[42:43], v[42:43], v[242:243], v[240:241] op_sel_hi:[1,0,0]
    v_pk_fma_f32 v[44:45], v[44:45], v[242:243], v[240:241] op_sel_hi:[1,0,0]
    v_pk_fma_f32 v[46:47], v[46:47], v[242:243], v[240:241] op_sel_hi:[1,0,0]
    v_pk_mul_f32 v[24:25], v[24:25], v[56:57]
    v_pk_mul_f32 v[26:27], v[26:27], v[58:59]
    v_pk_mul_f32 v[28:29], v[28:29], v[60:61]
    v_pk_mul_f32 v[30:31], v[30:31], v[62:63]
    v_pk_mul_f32 v[32:33], v[32:33], v[64:65]
    v_pk_mul_f32 v[34:35], v[34:35], v[66:67]
    v_pk_mul_f32 v[36:37], v[36:37], v[68:69]
    v_pk_mul_f32 v[38:39], v[38:39], v[70:71]
    v_pk_mul_f32 v[40:41], v[40:41], v[72:73]
    v_pk_mul_f32 v[42:43], v[42:43], v[74:75]
    v_pk_mul_f32 v[44:45], v[44:45], v[76:77]
    v_pk_mul_f32 v[46:47], v[46:47], v[78:79]
    v_exp_f32 v24, v24
    v_exp_f32 v25, v25
    v_exp_f32 v26, v26
    v_exp_f32 v27, v27
    v_exp_f32 v28, v28
    v_exp_f32 v29, v29
    v_exp_f32 v30, v30
    v_exp_f32 v31, v31
    v_exp_f32 v32, v32
    v_exp_f32 v33, v33
    v_exp_f32 v34, v34
    v_exp_f32 v35, v35
    v_exp_f32 v36, v36
    v_exp_f32 v37, v37
    v_exp_f32 v38, v38
    v_exp_f32 v39, v39
    v_exp_f32 v40, v40
    v_exp_f32 v41, v41
    v_exp_f32 v42, v42
    v_exp_f32 v43, v43
    v_exp_f32 v44, v44
    v_exp_f32 v45, v45
    v_exp_f32 v46, v46
    v_exp_f32 v47, v47
    v_pk_fma_f32 v[24:25], v[24:25], v[234:235], v[234:235] op_sel_hi:[1,0,0]
    v_pk_fma_f32 v[26:27], v[26:27], v[234:235], v[234:235] op_sel_hi:[1,0,0]
    v_pk_fma_f32 v[28:29], v[28:29], v[234:235], v[234:235] op_sel_hi:[1,0,0]
    v_pk_fma_f32 v[30:31], v[30:31], v[234:235], v[234:235] op_sel_hi:[1,0,0]
    v_pk_fma_f32 v[32:33], v[32:33], v[234:235], v[234:235] op_sel_hi:[1,0,0]
    v_pk_fma_f32 v[34:35], v[34:35], v[234:235], v[234:235] op_sel_hi:[1,0,0]
    v_pk_fma_f32 v[36:37], v[36:37], v[234:235], v[234:235] op_sel_hi:[1,0,0]
    v_pk_fma_f32 v[38:39], v[38:39], v[234:235], v[234:235] op_sel_hi:[1,0,0]
    v_pk_fma_f32 v[40:41], v[40:41], v[234:235], v[234:235] op_sel_hi:[1,0,0]
    v_pk_fma_f32 v[42:43], v[42:43], v[234:235], v[234:235] op_sel_hi:[1,0,0]
    v_pk_fma_f32 v[44:45], v[44:45], v[234:235], v[234:235] op_sel_hi:[1,0,0]
    v_pk_fma_f32 v[46:47], v[46:47], v[234:235], v[234:235] op_sel_hi:[1,0,0]
    v_rcp_f32 v24, v24
    v_rcp_f32 v25, v25
    v_rcp_f32 v26, v26
    v_rcp_f32 v27, v27
    v_rcp_f32 v28, v28
    v_rcp_f32 v29, v29
    v_rcp_f32 v30, v30
    v_rcp_f32 v31, v31
    v_rcp_f32 v32, v32
    v_rcp_f32 v33, v33
    v_rcp_f32 v34, v34
    v_rcp_f32 v35, v35
    v_rcp_f32 v36, v36
    v_rcp_f32 v37, v37
    v_rcp_f32 v38, v38
    v_rcp_f32 v39, v39
    v_rcp_f32 v40, v40
    v_rcp_f32 v41, v41
    v_rcp_f32 v42, v42
    v_rcp_f32 v43, v43
    v_rcp_f32 v44, v44
    v_rcp_f32 v45, v45
    v_rcp_f32 v46, v46
    v_rcp_f32 v47, v47
    v_pk_mul_f32 v[56:57], v[56:57], v[24:25]
    v_pk_mul_f32 v[58:59], v[58:59], v[26:27]
    v_pk_mul_f32 v[60:61], v[60:61], v[28:29]
    v_pk_mul_f32 v[62:63], v[62:63], v[30:31]
    v_pk_mul_f32 v[64:65], v[64:65], v[32:33]
    v_pk_mul_f32 v[66:67], v[66:67], v[34:35]
    v_pk_mul_f32 v[68:69], v[68:69], v[36:37]
    v_pk_mul_f32 v[70:71], v[70:71], v[38:39]
    v_pk_mul_f32 v[72:73], v[72:73], v[40:41]
    v_pk_mul_f32 v[74:75], v[74:75], v[42:43]
    v_pk_mul_f32 v[76:77], v[76:77], v[44:45]
    v_pk_mul_f32 v[78:79], v[78:79], v[46:47]
    v_cvt_pk_bf16_f32 v4, v56, v57
    v_cvt_pk_bf16_f32 v5, v58, v59
    v_cvt_pk_bf16_f32 v6, v60, v61
    v_cvt_pk_bf16_f32 v7, v62, v63
    buffer_store_dwordx4 v[4:7], v2, s[20:23], s36 offen sc1
    v_cvt_pk_bf16_f32 v8, v64, v65
    v_cvt_pk_bf16_f32 v9, v66, v67
    v_cvt_pk_bf16_f32 v10, v68, v69
    v_cvt_pk_bf16_f32 v11, v70, v71
    buffer_store_dwordx4 v[8:11], v2, s[20:23], s37 offen sc1
    v_cvt_pk_bf16_f32 v12, v72, v73
    v_cvt_pk_bf16_f32 v13, v74, v75
    v_cvt_pk_bf16_f32 v14, v76, v77
    v_cvt_pk_bf16_f32 v15, v78, v79
    buffer_store_dwordx4 v[12:15], v2, s[20:23], s37 offen offset:1024 sc1
    s_waitcnt lgkmcnt(0)
    v_cmp_gt_u32 vcc, 13, v252
    s_cbranch_vccnz K2_FW_59
K2_FB_60:
    ds_read_b128 v[212:215], v248 offset:43008
    ds_read_b128 v[216:219], v248 offset:44032
    ds_read_b128 v[220:223], v248 offset:45056
    ds_read_b128 v[224:227], v248 offset:46080
    ds_read_b128 v[196:199], v248 offset:47104
    ds_read_b128 v[200:203], v248 offset:48128
    ds_read_b128 v[204:207], v248 offset:49152
    v_bfe_u32 v3, v1, 4, 1
    v_mul_u32_u24 v3, 24, v3
    v_add_u32 v3, v3, v244
    s_waitcnt vmcnt(14)
    ds_read_b128 v[208:211], v248 offset:50176
    s_waitcnt lgkmcnt(6)
    v_mfma_f32_16x16x32_bf16 v[80:83], v[212:215], v[100:103], v[80:83]
    ds_read_b128 v[212:215], v248 offset:51200
    v_mfma_f32_16x16x32_bf16 v[84:87], v[216:219], v[100:103], v[84:87]
    ds_read_b128 v[216:219], v248 offset:52224
    s_waitcnt lgkmcnt(6)
    v_mfma_f32_16x16x32_bf16 v[88:91], v[220:223], v[100:103], v[88:91]
    ds_read_b128 v[220:223], v248 offset:53248
    v_mfma_f32_16x16x32_bf16 v[92:95], v[224:227], v[100:103], v[92:95]
    ds_read_b128 v[224:227], v248 offset:54272
    s_waitcnt lgkmcnt(6)
    v_mfma_f32_16x16x32_bf16 v[96:99], v[196:199], v[100:103], v[96:99]
    s_add_u32 s56, s51, 12288
    s_add_u32 s60, s51, 16384
    buffer_load_dwordx4 v[148:151], v2, s[20:23], s56 offen offset:0 sc1
    s_waitcnt vmcnt(14)
    ds_read_b128 v[196:199], v248 offset:55296
    v_mfma_f32_16x16x32_bf16 v[80:83], v[200:203], v[104:107], v[80:83]
    ds_read_b128 v[200:203], v248 offset:56320
    s_waitcnt lgkmcnt(6)
    v_mfma_f32_16x16x32_bf16 v[84:87], v[204:207], v[104:107], v[84:87]
    ds_read_b128 v[204:207], v248 offset:57344
    v_mfma_f32_16x16x32_bf16 v[88:91], v[208:211], v[104:107], v[88:91]
    ds_read_b128 v[208:211], v248 offset:58368
    s_waitcnt lgkmcnt(6)
    v_mfma_f32_16x16x32_bf16 v[92:95], v[212:215], v[104:107], v[92:95]
    ds_read_b128 v[212:215], v248 offset:59392
    v_mfma_f32_16x16x32_bf16 v[96:99], v[216:219], v[104:107], v[96:99]
    buffer_load_dwordx4 v[152:155], v2, s[20:23], s56 offen offset:1024 sc1
    s_waitcnt vmcnt(14)
    ds_read_b128 v[216:219], v248 offset:60416
    s_waitcnt lgkmcnt(6)
    v_mfma_f32_16x16x32_bf16 v[80:83], v[220:223], v[108:111], v[80:83]
    ds_read_b128 v[220:223], v248 offset:61440
    v_mfma_f32_16x16x32_bf16 v[84:87], v[224:227], v[108:111], v[84:87]
    ds_read_b128 v[224:227], v248 offset:62464
    s_waitcnt lgkmcnt(6)
    v_mfma_f32_16x16x32_bf16 v[88:91], v[196:199], v[108:111], v[88:91]
    ds_read_b128 v[196:199], v248 offset:63488
    v_mfma_f32_16x16x32_bf16 v[92:95], v[200:203], v[108:111], v[92:95]
    ds_read_b128 v[200:203], v248 offset:64512
    s_waitcnt lgkmcnt(6)
    v_mfma_f32_16x16x32_bf16 v[96:99], v[204:207], v[108:111], v[96:99]
    buffer_load_dwordx4 v[156:159], v2, s[20:23], s56 offen offset:2048 sc1
    s_waitcnt vmcnt(14)
    ds_read_b128 v[204:207], v249 offset:0
    v_mfma_f32_16x16x32_bf16 v[80:83], v[208:211], v[112:115], v[80:83]
    ds_read_b128 v[208:211], v249 offset:1024
    s_waitcnt lgkmcnt(6)
    v_mfma_f32_16x16x32_bf16 v[84:87], v[212:215], v[112:115], v[84:87]
    ds_read_b128 v[212:215], v249 offset:2048
    v_mfma_f32_16x16x32_bf16 v[88:91], v[216:219], v[112:115], v[88:91]
    ds_read_b128 v[216:219], v249 offset:3072
    s_waitcnt lgkmcnt(6)
    v_mfma_f32_16x16x32_bf16 v[92:95], v[220:223], v[112:115], v[92:95]
    ds_read_b128 v[220:223], v249 offset:4096
    v_mfma_f32_16x16x32_bf16 v[96:99], v[224:227], v[112:115], v[96:99]
    buffer_load_dwordx4 v[160:163], v2, s[20:23], s56 offen offset:3072 sc1
    s_waitcnt vmcnt(14)
    ds_read_b128 v[224:227], v249 offset:5120
    s_waitcnt lgkmcnt(6)
    v_mfma_f32_16x16x32_bf16 v[80:83], v[196:199], v[116:119], v[80:83]
    ds_read_b128 v[196:199], v249 offset:6144
    v_mfma_f32_16x16x32_bf16 v[84:87], v[200:203], v[116:119], v[84:87]
    ds_read_b128 v[200:203], v249 offset:7168
    s_waitcnt lgkmcnt(6)
    v_mfma_f32_16x16x32_bf16 v[88:91], v[204:207], v[116:119], v[88:91]
    ds_read_b128 v[204:207], v249 offset:8192
    v_mfma_f32_16x16x32_bf16 v[92:95], v[208:211], v[116:119], v[92:95]
    ds_read_b128 v[208:211], v249 offset:9216
    s_waitcnt lgkmcnt(6)
    v_mfma_f32_16x16x32_bf16 v[96:99], v[212:215], v[116:119], v[96:99]
    buffer_load_dwordx4 v[164:167], v2, s[20:23], s60 offen offset:0 sc1
    s_waitcnt vmcnt(14)
    ds_read_b128 v[212:215], v249 offset:10240
    v_mfma_f32_16x16x32_bf16 v[80:83], v[216:219], v[120:123], v[80:83]
    ds_read_b128 v[216:219], v249 offset:11264
    s_waitcnt lgkmcnt(6)
    v_mfma_f32_16x16x32_bf16 v[84:87], v[220:223], v[120:123], v[84:87]
    ds_read_b128 v[220:223], v249 offset:12288
    v_mfma_f32_16x16x32_bf16 v[88:91], v[224:227], v[120:123], v[88:91]
    ds_read_b128 v[224:227], v249 offset:13312
    s_waitcnt lgkmcnt(6)
    v_mfma_f32_16x16x32_bf16 v[92:95], v[196:199], v[120:123], v[92:95]
    ds_read_b128 v[196:199], v249 offset:14336
    v_mfma_f32_16x16x32_bf16 v[96:99], v[200:203], v[120:123], v[96:99]
    v_mov_b32 v253, 16
    ds_write_b32 v251, v253 offset:1552
    buffer_load_dwordx4 v[168:171], v2, s[20:23], s60 offen offset:1024 sc1
    s_waitcnt vmcnt(14)
    ds_read_b128 v[200:203], v249 offset:15360
    s_waitcnt lgkmcnt(7)
    v_mfma_f32_16x16x32_bf16 v[80:83], v[204:207], v[124:127], v[80:83]
    ds_read_b128 v[204:207], v249 offset:16384
    v_mfma_f32_16x16x32_bf16 v[84:87], v[208:211], v[124:127], v[84:87]
    ds_read_b128 v[208:211], v249 offset:17408
    s_waitcnt lgkmcnt(7)
    v_mfma_f32_16x16x32_bf16 v[88:91], v[212:215], v[124:127], v[88:91]
    ds_read_b128 v[212:215], v249 offset:18432
    v_mfma_f32_16x16x32_bf16 v[92:95], v[216:219], v[124:127], v[92:95]
    ds_read_b128 v[216:219], v249 offset:19456
    s_waitcnt lgkmcnt(7)
    v_mfma_f32_16x16x32_bf16 v[96:99], v[220:223], v[124:127], v[96:99]
    s_waitcnt vmcnt(6)
    s_add_u32 s52, s48, 19472384
    s_mov_b64 exec, 1
    buffer_atomic_add v243, v255, s[20:23], s52 offen sc1
    s_mov_b64 exec, -1
    s_add_u32 s57, s51, 18432
    s_add_u32 s61, s51, 22528
    buffer_load_dwordx4 v[172:175], v2, s[20:23], s57 offen offset:0 sc1
    ds_read_b128 v[220:223], v249 offset:20480
    v_mfma_f32_16x16x32_bf16 v[80:83], v[224:227], v[128:131], v[80:83]
    ds_read_b128 v[224:227], v249 offset:21504
    s_waitcnt lgkmcnt(6)
    v_mfma_f32_16x16x32_bf16 v[84:87], v[196:199], v[128:131], v[84:87]
    ds_read_b128 v[196:199], v249 offset:22528
    v_mfma_f32_16x16x32_bf16 v[88:91], v[200:203], v[128:131], v[88:91]
    ds_read_b128 v[200:203], v249 offset:23552
    s_waitcnt lgkmcnt(6)
    v_mfma_f32_16x16x32_bf16 v[92:95], v[204:207], v[128:131], v[92:95]
    ds_read_b128 v[204:207], v249 offset:24576
    v_mfma_f32_16x16x32_bf16 v[96:99], v[208:211], v[128:131], v[96:99]
    buffer_load_dwordx4 v[176:179], v2, s[20:23], s57 offen offset:1024 sc1
    ds_read_b128 v[208:211], v249 offset:25600
    s_waitcnt lgkmcnt(6)
    v_mfma_f32_16x16x32_bf16 v[80:83], v[212:215], v[132:135], v[80:83]
    ds_read_b128 v[212:215], v249 offset:26624
    v_mfma_f32_16x16x32_bf16 v[84:87], v[216:219], v[132:135], v[84:87]
    ds_read_b128 v[216:219], v249 offset:27648
    s_waitcnt lgkmcnt(6)
    v_mfma_f32_16x16x32_bf16 v[88:91], v[220:223], v[132:135], v[88:91]
    ds_read_b128 v[220:223], v249 offset:28672
    v_mfma_f32_16x16x32_bf16 v[92:95], v[224:227], v[132:135], v[92:95]
    ds_read_b128 v[224:227], v249 offset:29696
    s_waitcnt lgkmcnt(6)
    v_mfma_f32_16x16x32_bf16 v[96:99], v[196:199], v[132:135], v[96:99]
    buffer_load_dwordx4 v[180:183], v2, s[20:23], s57 offen offset:2048 sc1
    ds_read_b128 v[196:199], v247 offset:0
    v_mfma_f32_16x16x32_bf16 v[80:83], v[200:203], v[136:139], v[80:83]
    ds_read_b128 v[200:203], v247 offset:1024
    s_waitcnt lgkmcnt(6)
    v_mfma_f32_16x16x32_bf16 v[84:87], v[204:207], v[136:139], v[84:87]
    ds_read_b128 v[204:207], v247 offset:2048
    v_mfma_f32_16x16x32_bf16 v[88:91], v[208:211], v[136:139], v[88:91]
    ds_read_b128 v[208:211], v247 offset:3072
    s_waitcnt lgkmcnt(6)
    v_mfma_f32_16x16x32_bf16 v[92:95], v[212:215], v[136:139], v[92:95]
    ds_read_b128 v[212:215], v247 offset:4096
    v_mfma_f32_16x16x32_bf16 v[96:99], v[216:219], v[136:139], v[96:99]
    buffer_load_dwordx4 v[184:187], v2, s[20:23], s57 offen offset:3072 sc1
    ds_read_b128 v[216:219], v247 offset:5120
    s_waitcnt lgkmcnt(6)
    v_mfma_f32_16x16x32_bf16 v[80:83], v[220:223], v[140:143], v[80:83]
    ds_read_b128 v[220:223], v247 offset:6144
    v_mfma_f32_16x16x32_bf16 v[84:87], v[224:227], v[140:143], v[84:87]
    ds_read_b128 v[224:227], v247 offset:7168
    s_waitcnt lgkmcnt(6)
    v_mfma_f32_16x16x32_bf16 v[88:91], v[196:199], v[140:143], v[88:91]
    ds_read_b128 v[196:199], v247 offset:8192
    v_mfma_f32_16x16x32_bf16 v[92:95], v[200:203], v[140:143], v[92:95]
    ds_read_b128 v[200:203], v247 offset:9216
    s_waitcnt lgkmcnt(6)
    v_mfma_f32_16x16x32_bf16 v[96:99], v[204:207], v[140:143], v[96:99]
    buffer_load_dwordx4 v[188:191], v2, s[20:23], s61 offen offset:0 sc1
    ds_read_b128 v[204:207], v247 offset:10240
    v_mfma_f32_16x16x32_bf16 v[80:83], v[208:211], v[144:147], v[80:83]
    ds_read_b128 v[208:211], v247 offset:11264
    s_waitcnt lgkmcnt(6)
    v_mfma_f32_16x16x32_bf16 v[84:87], v[212:215], v[144:147], v[84:87]
    ds_read_b128 v[212:215], v247 offset:12288
    ds_read_b32 v252, v250 offset:1536
    v_mfma_f32_16x16x32_bf16 v[88:91], v[216:219], v[144:147], v[88:91]
    ds_read_b128 v[216:219], v247 offset:13312
    s_waitcnt lgkmcnt(7)
    v_mfma_f32_16x16x32_bf16 v[92:95], v[220:223], v[144:147], v[92:95]
    ds_read_b128 v[220:223], v247 offset:14336
    v_mfma_f32_16x16x32_bf16 v[96:99], v[224:227], v[144:147], v[96:99]
    v_mov_b32 v253, 17
    ds_write_b32 v251, v253 offset:1552
    buffer_load_dwordx4 v[192:195], v2, s[20:23], s61 offen offset:1024 sc1
    s_waitcnt vmcnt(12)
    ds_read_b128 v[224:227], v247 offset:15360
    s_waitcnt lgkmcnt(8)
    v_mfma_f32_16x16x32_bf16 v[80:83], v[196:199], v[148:151], v[80:83]
    s_waitcnt lgkmcnt(4)
    v_cmp_gt_u32 vcc, 14, v252
    s_cbranch_vccnz K2_FW_61
K2_FB_62:
    ds_read_b128 v[196:199], v247 offset:16384
    v_mfma_f32_16x16x32_bf16 v[84:87], v[200:203], v[148:151], v[84:87]
    ds_read_b128 v[200:203], v247 offset:17408
    v_mfma_f32_16x16x32_bf16 v[88:91], v[204:207], v[148:151], v[88:91]
    ds_read_b128 v[204:207], v247 offset:18432
    v_mfma_f32_16x16x32_bf16 v[92:95], v[208:211], v[148:151], v[92:95]
    ds_read_b128 v[208:211], v247 offset:19456
    s_waitcnt lgkmcnt(7)
    v_mfma_f32_16x16x32_bf16 v[96:99], v[212:215], v[148:151], v[96:99]
    s_add_u32 s54, s51, 24576
    s_add_u32 s58, s51, 28672
    buffer_load_dwordx4 v[100:103], v2, s[20:23], s54 offen offset:0 sc1
    s_waitcnt vmcnt(12)
    ds_read_b128 v[212:215], v247 offset:20480
    v_mfma_f32_16x16x32_bf16 v[80:83], v[216:219], v[152:155], v[80:83]
    ds_read_b128 v[216:219], v247 offset:21504
    s_waitcnt lgkmcnt(6)
    v_mfma_f32_16x16x32_bf16 v[84:87], v[220:223], v[152:155], v[84:87]
    ds_read_b128 v[220:223], v247 offset:22528
    v_mfma_f32_16x16x32_bf16 v[88:91], v[224:227], v[152:155], v[88:91]
    ds_read_b128 v[224:227], v247 offset:23552
    s_waitcnt lgkmcnt(6)
    v_mfma_f32_16x16x32_bf16 v[92:95], v[196:199], v[152:155], v[92:95]
    ds_read_b128 v[196:199], v247 offset:24576
    v_mfma_f32_16x16x32_bf16 v[96:99], v[200:203], v[152:155], v[96:99]
    buffer_load_dwordx4 v[104:107], v2, s[20:23], s54 offen offset:1024 sc1
    s_waitcnt vmcnt(12)
    ds_read_b128 v[200:203], v247 offset:25600
    s_waitcnt lgkmcnt(6)
    v_mfma_f32_16x16x32_bf16 v[80:83], v[204:207], v[156:159], v[80:83]
    ds_read_b128 v[204:207], v247 offset:26624
    v_mfma_f32_16x16x32_bf16 v[84:87], v[208:211], v[156:159], v[84:87]
    ds_read_b128 v[208:211], v247 offset:27648
    s_waitcnt lgkmcnt(6)
    v_mfma_f32_16x16x32_bf16 v[88:91], v[212:215], v[156:159], v[88:91]
    ds_read_b128 v[212:215], v247 offset:28672
    v_mfma_f32_16x16x32_bf16 v[92:95], v[216:219], v[156:159], v[92:95]
    ds_read_b128 v[216:219], v247 offset:29696
    s_waitcnt lgkmcnt(6)
    v_mfma_f32_16x16x32_bf16 v[96:99], v[220:223], v[156:159], v[96:99]
    s_add_u32 s62, s48, 19472384
    s_mov_b64 exec, 1
    v_mov_b32 v231, 0
    buffer_atomic_add v231, v255, s[20:23], s62 offen sc0 sc1
    s_mov_b64 exec, -1
    buffer_load_dwordx4 v[108:111], v2, s[20:23], s54 offen offset:2048 sc1
    s_waitcnt vmcnt(13)
    ds_read_b128 v[220:223], v247 offset:30720
    v_mfma_f32_16x16x32_bf16 v[80:83], v[224:227], v[160:163], v[80:83]
    ds_read_b128 v[224:227], v247 offset:31744
    s_waitcnt lgkmcnt(6)
    v_mfma_f32_16x16x32_bf16 v[84:87], v[196:199], v[160:163], v[84:87]
    ds_read_b128 v[196:199], v247 offset:32768
    v_mfma_f32_16x16x32_bf16 v[88:91], v[200:203], v[160:163], v[88:91]
    ds_read_b128 v[200:203], v247 offset:33792
    s_waitcnt lgkmcnt(6)
    v_mfma_f32_16x16x32_bf16 v[92:95], v[204:207], v[160:163], v[92:95]
    ds_read_b128 v[204:207], v247 offset:34816
    v_mfma_f32_16x16x32_bf16 v[96:99], v[208:211], v[160:163], v[96:99]
    buffer_load_dwordx4 v[112:115], v2, s[20:23], s54 offen offset:3072 sc1
    s_waitcnt vmcnt(13)
    ds_read_b128 v[208:211], v247 offset:35840
    s_waitcnt lgkmcnt(6)
    v_mfma_f32_16x16x32_bf16 v[80:83], v[212:215], v[164:167], v[80:83]
    ds_read_b128 v[212:215], v247 offset:36864
    v_mfma_f32_16x16x32_bf16 v[84:87], v[216:219], v[164:167], v[84:87]
    ds_read_b128 v[216:219], v247 offset:37888
    s_waitcnt lgkmcnt(6)
    v_mfma_f32_16x16x32_bf16 v[88:91], v[220:223], v[164:167], v[88:91]
    ds_read_b128 v[220:223], v247 offset:38912
    v_mfma_f32_16x16x32_bf16 v[92:95], v[224:227], v[164:167], v[92:95]
    ds_read_b128 v[224:227], v247 offset:39936
    s_waitcnt lgkmcnt(6)
    v_mfma_f32_16x16x32_bf16 v[96:99], v[196:199], v[164:167], v[96:99]
    buffer_load_dwordx4 v[116:119], v2, s[20:23], s58 offen offset:0 sc1
    s_waitcnt vmcnt(13)
    ds_read_b128 v[196:199], v247 offset:40960
    v_mfma_f32_16x16x32_bf16 v[80:83], v[200:203], v[168:171], v[80:83]
    ds_read_b128 v[200:203], v247 offset:41984
    s_waitcnt lgkmcnt(6)
    v_mfma_f32_16x16x32_bf16 v[84:87], v[204:207], v[168:171], v[84:87]
    ds_read_b128 v[204:207], v247 offset:43008
    ds_read_b32 v252, v250 offset:1536
    v_mfma_f32_16x16x32_bf16 v[88:91], v[208:211], v[168:171], v[88:91]
    ds_read_b128 v[208:211], v247 offset:44032
    s_waitcnt lgkmcnt(7)
    v_mfma_f32_16x16x32_bf16 v[92:95], v[212:215], v[168:171], v[92:95]
    ds_read_b128 v[212:215], v247 offset:45056
    v_mfma_f32_16x16x32_bf16 v[96:99], v[216:219], v[168:171], v[96:99]
    v_mov_b32 v253, 18
    ds_write_b32 v251, v253 offset:1552
    buffer_load_dwordx4 v[120:123], v2, s[20:23], s58 offen offset:1024 sc1
    s_waitcnt vmcnt(12)
    ds_read_b128 v[216:219], v247 offset:46080
    s_waitcnt lgkmcnt(8)
    v_mfma_f32_16x16x32_bf16 v[80:83], v[220:223], v[172:175], v[80:83]
    s_waitcnt lgkmcnt(4)
    v_cmp_gt_u32 vcc, 15, v252
    s_cbranch_vccnz K2_FW_63
K2_FB_64:
    ds_read_b128 v[220:223], v247 offset:47104
    v_mfma_f32_16x16x32_bf16 v[84:87], v[224:227], v[172:175], v[84:87]
    ds_read_b128 v[224:227], v247 offset:48128
    v_mfma_f32_16x16x32_bf16 v[88:91], v[196:199], v[172:175], v[88:91]
    ds_read_b128 v[196:199], v247 offset:49152
    v_mfma_f32_16x16x32_bf16 v[92:95], v[200:203], v[172:175], v[92:95]
    ds_read_b128 v[200:203], v247 offset:50176
    s_waitcnt lgkmcnt(7)
    v_mfma_f32_16x16x32_bf16 v[96:99], v[204:207], v[172:175], v[96:99]
    s_add_u32 s55, s51, 30720
    s_add_u32 s59, s51, 34816
    buffer_load_dwordx4 v[124:127], v2, s[20:23], s55 offen offset:0 sc1
    s_waitcnt vmcnt(12)
    ds_read_b128 v[204:207], v247 offset:51200
    v_mfma_f32_16x16x32_bf16 v[80:83], v[208:211], v[176:179], v[80:83]
    ds_read_b128 v[208:211], v247 offset:52224
    s_waitcnt lgkmcnt(6)
    v_mfma_f32_16x16x32_bf16 v[84:87], v[212:215], v[176:179], v[84:87]
    ds_read_b128 v[212:215], v247 offset:53248
    v_mfma_f32_16x16x32_bf16 v[88:91], v[216:219], v[176:179], v[88:91]
    ds_read_b128 v[216:219], v247 offset:54272
    s_waitcnt lgkmcnt(6)
    v_mfma_f32_16x16x32_bf16 v[92:95], v[220:223], v[176:179], v[92:95]
    ds_read_b128 v[220:223], v247 offset:55296
    v_mfma_f32_16x16x32_bf16 v[96:99], v[224:227], v[176:179], v[96:99]
    buffer_load_dwordx4 v[128:131], v2, s[20:23], s55 offen offset:1024 sc1
    s_waitcnt vmcnt(12)
    ds_read_b128 v[224:227], v247 offset:56320
    s_waitcnt lgkmcnt(6)
    v_mfma_f32_16x16x32_bf16 v[80:83], v[196:199], v[180:183], v[80:83]
    ds_read_b128 v[196:199], v247 offset:57344
    v_mfma_f32_16x16x32_bf16 v[84:87], v[200:203], v[180:183], v[84:87]
    ds_read_b128 v[200:203], v247 offset:58368
    s_waitcnt lgkmcnt(6)
    v_mfma_f32_16x16x32_bf16 v[88:91], v[204:207], v[180:183], v[88:91]
    ds_read_b128 v[204:207], v247 offset:59392
    v_mfma_f32_16x16x32_bf16 v[92:95], v[208:211], v[180:183], v[92:95]
    ds_read_b128 v[208:211], v247 offset:60416
    s_waitcnt lgkmcnt(6)
    v_mfma_f32_16x16x32_bf16 v[96:99], v[212:215], v[180:183], v[96:99]
    s_waitcnt vmcnt(6)
    v_readfirstlane_b32 s52, v231
    s_cmp_lt_u32 s52, 8
    s_cbranch_scc1 K2_G2_65
K2_G2B_66:
    buffer_load_dwordx4 v[132:135], v2, s[20:23], s55 offen offset:2048 sc1
    ds_read_b128 v[212:215], v247 offset:61440
    v_mfma_f32_16x16x32_bf16 v[80:83], v[216:219], v[184:187], v[80:83]
    ds_read_b128 v[216:219], v247 offset:62464
    s_waitcnt lgkmcnt(6)
    v_mfma_f32_16x16x32_bf16 v[84:87], v[220:223], v[184:187], v[84:87]
    ds_read_b128 v[220:223], v247 offset:63488
    v_mfma_f32_16x16x32_bf16 v[88:91], v[224:227], v[184:187], v[88:91]
    ds_read_b128 v[224:227], v247 offset:64512
    s_waitcnt lgkmcnt(6)
    v_mfma_f32_16x16x32_bf16 v[92:95], v[196:199], v[184:187], v[92:95]
    ds_read_b128 v[196:199], v248 offset:0
    v_mfma_f32_16x16x32_bf16 v[96:99], v[200:203], v[184:187], v[96:99]
    buffer_load_dwordx4 v[136:139], v2, s[20:23], s55 offen offset:3072 sc1
    ds_read_b128 v[200:203], v248 offset:1024
    s_waitcnt lgkmcnt(6)
    v_mfma_f32_16x16x32_bf16 v[80:83], v[204:207], v[188:191], v[80:83]
    ds_read_b128 v[204:207], v248 offset:2048
    v_mfma_f32_16x16x32_bf16 v[84:87], v[208:211], v[188:191], v[84:87]
    ds_read_b128 v[208:211], v248 offset:3072
    s_waitcnt lgkmcnt(6)
    v_mfma_f32_16x16x32_bf16 v[88:91], v[212:215], v[188:191], v[88:91]
    ds_read_b128 v[212:215], v248 offset:4096
    v_mfma_f32_16x16x32_bf16 v[92:95], v[216:219], v[188:191], v[92:95]
    ds_read_b128 v[216:219], v248 offset:5120
    s_waitcnt lgkmcnt(6)
    v_mfma_f32_16x16x32_bf16 v[96:99], v[220:223], v[188:191], v[96:99]
    buffer_load_dwordx4 v[140:143], v2, s[20:23], s59 offen offset:0 sc1
    ds_read_b128 v[220:223], v248 offset:6144
    v_mfma_f32_16x16x32_bf16 v[80:83], v[224:227], v[192:195], v[80:83]
    ds_read_b128 v[224:227], v248 offset:7168
    s_waitcnt lgkmcnt(6)
    v_mfma_f32_16x16x32_bf16 v[84:87], v[196:199], v[192:195], v[84:87]
    ds_read_b128 v[196:199], v248 offset:8192
    ds_read_b32 v252, v250 offset:1536
    v_mfma_f32_16x16x32_bf16 v[88:91], v[200:203], v[192:195], v[88:91]
    ds_read_b128 v[200:203], v248 offset:9216
    s_waitcnt lgkmcnt(7)
    v_mfma_f32_16x16x32_bf16 v[92:95], v[204:207], v[192:195], v[92:95]
    ds_read_b128 v[204:207], v248 offset:10240
    v_mfma_f32_16x16x32_bf16 v[96:99], v[208:211], v[192:195], v[96:99]
    v_mov_b32 v253, 19
    ds_write_b32 v251, v253 offset:1552
    buffer_load_dwordx4 v[144:147], v2, s[20:23], s59 offen offset:1024 sc1
    ds_read_b128 v[208:211], v248 offset:11264
    s_waitcnt lgkmcnt(8)
    v_mfma_f32_16x16x32_bf16 v[80:83], v[212:215], v[100:103], v[80:83]
    s_waitcnt lgkmcnt(4)
    v_cmp_gt_u32 vcc, 16, v252
    s_cbranch_vccnz K2_FW_67
K2_FB_68:
    ds_read_b128 v[212:215], v248 offset:12288
    v_mfma_f32_16x16x32_bf16 v[84:87], v[216:219], v[100:103], v[84:87]
    ds_read_b128 v[216:219], v248 offset:13312
    v_mfma_f32_16x16x32_bf16 v[88:91], v[220:223], v[100:103], v[88:91]
    ds_read_b128 v[220:223], v248 offset:14336
    v_mfma_f32_16x16x32_bf16 v[92:95], v[224:227], v[100:103], v[92:95]
    ds_read_b128 v[224:227], v248 offset:15360
    s_waitcnt lgkmcnt(7)
    v_mfma_f32_16x16x32_bf16 v[96:99], v[196:199], v[100:103], v[96:99]
    s_add_u32 s56, s51, 36864
    s_add_u32 s60, s51, 40960
    buffer_load_dwordx4 v[148:151], v2, s[20:23], s56 offen offset:0 sc1
    ds_read_b128 v[196:199], v248 offset:16384
    v_mfma_f32_16x16x32_bf16 v[80:83], v[200:203], v[104:107], v[80:83]
    ds_read_b128 v[200:203], v248 offset:17408
    s_waitcnt lgkmcnt(6)
    v_mfma_f32_16x16x32_bf16 v[84:87], v[204:207], v[104:107], v[84:87]
    ds_read_b128 v[204:207], v248 offset:18432
    v_mfma_f32_16x16x32_bf16 v[88:91], v[208:211], v[104:107], v[88:91]
    ds_read_b128 v[208:211], v248 offset:19456
    s_waitcnt lgkmcnt(6)
    v_mfma_f32_16x16x32_bf16 v[92:95], v[212:215], v[104:107], v[92:95]
    ds_read_b128 v[212:215], v248 offset:20480
    v_mfma_f32_16x16x32_bf16 v[96:99], v[216:219], v[104:107], v[96:99]
    buffer_load_dwordx4 v[152:155], v2, s[20:23], s56 offen offset:1024 sc1
    s_waitcnt vmcnt(11)
    ds_read_b128 v[216:219], v248 offset:21504
    s_waitcnt lgkmcnt(6)
    v_mfma_f32_16x16x32_bf16 v[80:83], v[220:223], v[108:111], v[80:83]
    ds_read_b128 v[220:223], v248 offset:22528
    v_mfma_f32_16x16x32_bf16 v[84:87], v[224:227], v[108:111], v[84:87]
    ds_read_b128 v[224:227], v248 offset:23552
    s_waitcnt lgkmcnt(6)
    v_mfma_f32_16x16x32_bf16 v[88:91], v[196:199], v[108:111], v[88:91]
    ds_read_b128 v[196:199], v248 offset:24576
    v_mfma_f32_16x16x32_bf16 v[92:95], v[200:203], v[108:111], v[92:95]
    ds_read_b128 v[200:203], v248 offset:25600
    s_waitcnt lgkmcnt(6)
    v_mfma_f32_16x16x32_bf16 v[96:99], v[204:207], v[108:111], v[96:99]
    buffer_load_dwordx4 v[156:159], v2, s[20:23], s56 offen offset:2048 sc1
    s_waitcnt vmcnt(11)
    ds_read_b128 v[204:207], v248 offset:26624
    v_mfma_f32_16x16x32_bf16 v[80:83], v[208:211], v[112:115], v[80:83]
    ds_read_b128 v[208:211], v248 offset:27648
    s_waitcnt lgkmcnt(6)
    v_mfma_f32_16x16x32_bf16 v[84:87], v[212:215], v[112:115], v[84:87]
    ds_read_b128 v[212:215], v248 offset:28672
    v_mfma_f32_16x16x32_bf16 v[88:91], v[216:219], v[112:115], v[88:91]
    ds_read_b128 v[216:219], v248 offset:29696
    s_waitcnt lgkmcnt(6)
    v_mfma_f32_16x16x32_bf16 v[92:95], v[220:223], v[112:115], v[92:95]
    ds_read_b128 v[220:223], v248 offset:30720
    v_mfma_f32_16x16x32_bf16 v[96:99], v[224:227], v[112:115], v[96:99]
    buffer_load_dwordx4 v[160:163], v2, s[20:23], s56 offen offset:3072 sc1
    s_waitcnt vmcnt(11)
    ds_read_b128 v[224:227], v248 offset:31744
    s_waitcnt lgkmcnt(6)
    v_mfma_f32_16x16x32_bf16 v[80:83], v[196:199], v[116:119], v[80:83]
    ds_read_b128 v[196:199], v248 offset:32768
    v_mfma_f32_16x16x32_bf16 v[84:87], v[200:203], v[116:119], v[84:87]
    ds_read_b128 v[200:203], v248 offset:33792
    s_waitcnt lgkmcnt(6)
    v_mfma_f32_16x16x32_bf16 v[88:91], v[204:207], v[116:119], v[88:91]
    ds_read_b128 v[204:207], v248 offset:34816
    v_mfma_f32_16x16x32_bf16 v[92:95], v[208:211], v[116:119], v[92:95]
    ds_read_b128 v[208:211], v248 offset:35840
    s_waitcnt lgkmcnt(6)
    v_mfma_f32_16x16x32_bf16 v[96:99], v[212:215], v[116:119], v[96:99]
    buffer_load_dwordx4 v[164:167], v2, s[20:23], s60 offen offset:0 sc1
    s_waitcnt vmcnt(11)
    ds_read_b128 v[212:215], v248 offset:36864
    v_mfma_f32_16x16x32_bf16 v[80:83], v[216:219], v[120:123], v[80:83]
    ds_read_b128 v[216:219], v248 offset:37888
    s_waitcnt lgkmcnt(6)
    v_mfma_f32_16x16x32_bf16 v[84:87], v[220:223], v[120:123], v[84:87]
    ds_read_b128 v[220:223], v248 offset:38912
    ds_read_b32 v252, v250 offset:1536
    v_mfma_f32_16x16x32_bf16 v[88:91], v[224:227], v[120:123], v[88:91]
    ds_read_b128 v[224:227], v248 offset:39936
    s_waitcnt lgkmcnt(7)
    v_mfma_f32_16x16x32_bf16 v[92:95], v[196:199], v[120:123], v[92:95]
    ds_read_b128 v[196:199], v248 offset:40960
    v_mfma_f32_16x16x32_bf16 v[96:99], v[200:203], v[120:123], v[96:99]
    buffer_load_dwordx4 v[168:171], v2, s[20:23], s60 offen offset:1024 sc1
    s_waitcnt vmcnt(11)
    ds_read_b128 v[200:203], v248 offset:41984
    s_waitcnt lgkmcnt(7)
    v_mfma_f32_16x16x32_bf16 v[80:83], v[204:207], v[124:127], v[80:83]
    s_waitcnt lgkmcnt(3)
    v_cmp_gt_u32 vcc, 17, v252
    s_cbranch_vccnz K2_FW_69
K2_FB_70:
    ds_read_b128 v[204:207], v248 offset:43008
    v_mfma_f32_16x16x32_bf16 v[84:87], v[208:211], v[124:127], v[84:87]
    ds_read_b128 v[208:211], v248 offset:44032
    v_mfma_f32_16x16x32_bf16 v[88:91], v[212:215], v[124:127], v[88:91]
    ds_read_b128 v[212:215], v248 offset:45056
    v_mfma_f32_16x16x32_bf16 v[92:95], v[216:219], v[124:127], v[92:95]
    ds_read_b128 v[216:219], v248 offset:46080
    s_waitcnt lgkmcnt(6)
    v_mfma_f32_16x16x32_bf16 v[96:99], v[220:223], v[124:127], v[96:99]
    s_add_u32 s57, s51, 43008
    s_add_u32 s61, s51, 47104
    buffer_load_dwordx4 v[172:175], v2, s[20:23], s57 offen offset:0 sc1
    s_waitcnt vmcnt(11)
    ds_read_b128 v[220:223], v248 offset:47104
    v_mfma_f32_16x16x32_bf16 v[80:83], v[224:227], v[128:131], v[80:83]
    ds_read_b128 v[224:227], v248 offset:48128
    s_waitcnt lgkmcnt(6)
    v_mfma_f32_16x16x32_bf16 v[84:87], v[196:199], v[128:131], v[84:87]
    ds_read_b128 v[196:199], v248 offset:49152
    v_mfma_f32_16x16x32_bf16 v[88:91], v[200:203], v[128:131], v[88:91]
    ds_read_b128 v[200:203], v248 offset:50176
    s_waitcnt lgkmcnt(6)
    v_mfma_f32_16x16x32_bf16 v[92:95], v[204:207], v[128:131], v[92:95]
    ds_read_b128 v[204:207], v248 offset:51200
    v_mfma_f32_16x16x32_bf16 v[96:99], v[208:211], v[128:131], v[96:99]
    buffer_load_dwordx4 v[176:179], v2, s[20:23], s57 offen offset:1024 sc1
    s_waitcnt vmcnt(11)
    ds_read_b128 v[208:211], v248 offset:52224
    s_waitcnt lgkmcnt(6)
    v_mfma_f32_16x16x32_bf16 v[80:83], v[212:215], v[132:135], v[80:83]
    ds_read_b128 v[212:215], v248 offset:53248
    v_mfma_f32_16x16x32_bf16 v[84:87], v[216:219], v[132:135], v[84:87]
    ds_read_b128 v[216:219], v248 offset:54272
    s_waitcnt lgkmcnt(6)
    v_mfma_f32_16x16x32_bf16 v[88:91], v[220:223], v[132:135], v[88:91]
    ds_read_b128 v[220:223], v248 offset:55296
    v_mfma_f32_16x16x32_bf16 v[92:95], v[224:227], v[132:135], v[92:95]
    ds_read_b128 v[224:227], v248 offset:56320
    s_waitcnt lgkmcnt(6)
    v_mfma_f32_16x16x32_bf16 v[96:99], v[196:199], v[132:135], v[96:99]
    buffer_load_dwordx4 v[180:183], v2, s[20:23], s57 offen offset:2048 sc1
    s_waitcnt vmcnt(11)
    ds_read_b128 v[196:199], v248 offset:57344
    v_mfma_f32_16x16x32_bf16 v[80:83], v[200:203], v[136:139], v[80:83]
    ds_read_b128 v[200:203], v248 offset:58368
    s_waitcnt lgkmcnt(6)
    v_mfma_f32_16x16x32_bf16 v[84:87], v[204:207], v[136:139], v[84:87]
    ds_read_b128 v[204:207], v248 offset:59392
    v_mfma_f32_16x16x32_bf16 v[88:91], v[208:211], v[136:139], v[88:91]
    ds_read_b128 v[208:211], v248 offset:60416
    s_waitcnt lgkmcnt(6)
    v_mfma_f32_16x16x32_bf16 v[92:95], v[212:215], v[136:139], v[92:95]
    ds_read_b128 v[212:215], v248 offset:61440
    v_mfma_f32_16x16x32_bf16 v[96:99], v[216:219], v[136:139], v[96:99]
    buffer_load_dwordx4 v[184:187], v2, s[20:23], s57 offen offset:3072 sc1
    s_waitcnt vmcnt(11)
    ds_read_b128 v[216:219], v248 offset:62464
    s_waitcnt lgkmcnt(6)
    v_mfma_f32_16x16x32_bf16 v[80:83], v[220:223], v[140:143], v[80:83]
    ds_read_b128 v[220:223], v248 offset:63488
    v_mfma_f32_16x16x32_bf16 v[84:87], v[224:227], v[140:143], v[84:87]
    ds_read_b128 v[224:227], v248 offset:64512
    s_waitcnt lgkmcnt(6)
    v_mfma_f32_16x16x32_bf16 v[88:91], v[196:199], v[140:143], v[88:91]
    ds_read_b128 v[196:199], v249 offset:0
    v_mfma_f32_16x16x32_bf16 v[92:95], v[200:203], v[140:143], v[92:95]
    ds_read_b128 v[200:203], v249 offset:1024
    s_waitcnt lgkmcnt(6)
    v_mfma_f32_16x16x32_bf16 v[96:99], v[204:207], v[140:143], v[96:99]
    buffer_load_dwordx4 v[188:191], v2, s[20:23], s61 offen offset:0 sc1
    s_waitcnt vmcnt(11)
    ds_read_b128 v[204:207], v249 offset:2048
    v_mfma_f32_16x16x32_bf16 v[80:83], v[208:211], v[144:147], v[80:83]
    ds_read_b128 v[208:211], v249 offset:3072
    s_waitcnt lgkmcnt(6)
    v_mfma_f32_16x16x32_bf16 v[84:87], v[212:215], v[144:147], v[84:87]
    ds_read_b128 v[212:215], v249 offset:4096
    ds_read_b32 v252, v250 offset:1536
    v_mfma_f32_16x16x32_bf16 v[88:91], v[216:219], v[144:147], v[88:91]
    ds_read_b128 v[216:219], v249 offset:5120
    s_waitcnt lgkmcnt(7)
    v_mfma_f32_16x16x32_bf16 v[92:95], v[220:223], v[144:147], v[92:95]
    ds_read_b128 v[220:223], v249 offset:6144
    v_mfma_f32_16x16x32_bf16 v[96:99], v[224:227], v[144:147], v[96:99]
    buffer_load_dwordx4 v[192:195], v2, s[20:23], s61 offen offset:1024 sc1
    s_waitcnt vmcnt(11)
    ds_read_b128 v[224:227], v249 offset:7168
    s_waitcnt lgkmcnt(7)
    v_mfma_f32_16x16x32_bf16 v[80:83], v[196:199], v[148:151], v[80:83]
    s_waitcnt lgkmcnt(3)
    v_cmp_gt_u32 vcc, 18, v252
    s_cbranch_vccnz K2_FW_71
K2_FB_72:
    ds_read_b128 v[196:199], v249 offset:8192
    v_mfma_f32_16x16x32_bf16 v[84:87], v[200:203], v[148:151], v[84:87]
    ds_read_b128 v[200:203], v249 offset:9216
    v_mfma_f32_16x16x32_bf16 v[88:91], v[204:207], v[148:151], v[88:91]
    ds_read_b128 v[204:207], v249 offset:10240
    v_mfma_f32_16x16x32_bf16 v[92:95], v[208:211], v[148:151], v[92:95]
    ds_read_b128 v[208:211], v249 offset:11264
    s_waitcnt lgkmcnt(6)
    v_mfma_f32_16x16x32_bf16 v[96:99], v[212:215], v[148:151], v[96:99]
    s_add_u32 s54, s51, 49152
    s_add_u32 s58, s51, 53248
    buffer_load_dwordx4 v[100:103], v2, s[20:23], s54 offen offset:0 sc1
    s_waitcnt vmcnt(11)
    ds_read_b128 v[212:215], v249 offset:12288
    v_mfma_f32_16x16x32_bf16 v[80:83], v[216:219], v[152:155], v[80:83]
    ds_read_b128 v[216:219], v249 offset:13312
    s_waitcnt lgkmcnt(6)
    v_mfma_f32_16x16x32_bf16 v[84:87], v[220:223], v[152:155], v[84:87]
    ds_read_b128 v[220:223], v249 offset:14336
    v_mfma_f32_16x16x32_bf16 v[88:91], v[224:227], v[152:155], v[88:91]
    ds_read_b128 v[224:227], v249 offset:15360
    s_waitcnt lgkmcnt(6)
    v_mfma_f32_16x16x32_bf16 v[92:95], v[196:199], v[152:155], v[92:95]
    ds_read_b128 v[196:199], v249 offset:16384
    v_mfma_f32_16x16x32_bf16 v[96:99], v[200:203], v[152:155], v[96:99]
    buffer_load_dwordx4 v[104:107], v2, s[20:23], s54 offen offset:1024 sc1
    s_waitcnt vmcnt(11)
    ds_read_b128 v[200:203], v249 offset:17408
    s_waitcnt lgkmcnt(6)
    v_mfma_f32_16x16x32_bf16 v[80:83], v[204:207], v[156:159], v[80:83]
    ds_read_b128 v[204:207], v249 offset:18432
    v_mfma_f32_16x16x32_bf16 v[84:87], v[208:211], v[156:159], v[84:87]
    ds_read_b128 v[208:211], v249 offset:19456
    s_waitcnt lgkmcnt(6)
    v_mfma_f32_16x16x32_bf16 v[88:91], v[212:215], v[156:159], v[88:91]
    ds_read_b128 v[212:215], v249 offset:20480
    v_mfma_f32_16x16x32_bf16 v[92:95], v[216:219], v[156:159], v[92:95]
    ds_read_b128 v[216:219], v249 offset:21504
    s_waitcnt lgkmcnt(6)
    v_mfma_f32_16x16x32_bf16 v[96:99], v[220:223], v[156:159], v[96:99]
    buffer_load_dwordx4 v[108:111], v2, s[20:23], s54 offen offset:2048 sc1
    s_waitcnt vmcnt(11)
    ds_read_b128 v[220:223], v249 offset:22528
    v_mfma_f32_16x16x32_bf16 v[80:83], v[224:227], v[160:163], v[80:83]
    ds_read_b128 v[224:227], v249 offset:23552
    s_waitcnt lgkmcnt(6)
    v_mfma_f32_16x16x32_bf16 v[84:87], v[196:199], v[160:163], v[84:87]
    ds_read_b128 v[196:199], v249 offset:24576
    v_mfma_f32_16x16x32_bf16 v[88:91], v[200:203], v[160:163], v[88:91]
    ds_read_b128 v[200:203], v249 offset:25600
    s_waitcnt lgkmcnt(6)
    v_mfma_f32_16x16x32_bf16 v[92:95], v[204:207], v[160:163], v[92:95]
    ds_read_b128 v[204:207], v249 offset:26624
    v_mfma_f32_16x16x32_bf16 v[96:99], v[208:211], v[160:163], v[96:99]
    buffer_load_dwordx4 v[112:115], v2, s[20:23], s54 offen offset:3072 sc1
    s_waitcnt vmcnt(11)
    ds_read_b128 v[208:211], v249 offset:27648
    s_waitcnt lgkmcnt(6)
    v_mfma_f32_16x16x32_bf16 v[80:83], v[212:215], v[164:167], v[80:83]
    ds_read_b128 v[212:215], v249 offset:28672
    v_mfma_f32_16x16x32_bf16 v[84:87], v[216:219], v[164:167], v[84:87]
    ds_read_b128 v[216:219], v249 offset:29696
    s_waitcnt lgkmcnt(6)
    v_mfma_f32_16x16x32_bf16 v[88:91], v[220:223], v[164:167], v[88:91]
    ds_read_b128 v[220:223], v247 offset:0
    v_mfma_f32_16x16x32_bf16 v[92:95], v[224:227], v[164:167], v[92:95]
    ds_read_b128 v[224:227], v247 offset:1024
    s_waitcnt lgkmcnt(6)
    v_mfma_f32_16x16x32_bf16 v[96:99], v[196:199], v[164:167], v[96:99]
    buffer_load_dwordx4 v[116:119], v2, s[20:23], s58 offen offset:0 sc1
    s_waitcnt vmcnt(11)
    ds_read_b128 v[196:199], v247 offset:2048
    v_mfma_f32_16x16x32_bf16 v[80:83], v[200:203], v[168:171], v[80:83]
    ds_read_b128 v[200:203], v247 offset:3072
    s_waitcnt lgkmcnt(6)
    v_mfma_f32_16x16x32_bf16 v[84:87], v[204:207], v[168:171], v[84:87]
    ds_read_b128 v[204:207], v247 offset:4096
    ds_read_b32 v252, v250 offset:1536
    v_mfma_f32_16x16x32_bf16 v[88:91], v[208:211], v[168:171], v[88:91]
    ds_read_b128 v[208:211], v247 offset:5120
    s_waitcnt lgkmcnt(7)
    v_mfma_f32_16x16x32_bf16 v[92:95], v[212:215], v[168:171], v[92:95]
    ds_read_b128 v[212:215], v247 offset:6144
    v_mfma_f32_16x16x32_bf16 v[96:99], v[216:219], v[168:171], v[96:99]
    buffer_load_dwordx4 v[120:123], v2, s[20:23], s58 offen offset:1024 sc1
    s_waitcnt vmcnt(11)
    ds_read_b128 v[216:219], v247 offset:7168
    s_waitcnt lgkmcnt(7)
    v_mfma_f32_16x16x32_bf16 v[80:83], v[220:223], v[172:175], v[80:83]
    s_waitcnt lgkmcnt(3)
    v_cmp_gt_u32 vcc, 19, v252
    s_cbranch_vccnz K2_FW_73
K2_FB_74:
    ds_read_b128 v[220:223], v247 offset:8192
    v_mfma_f32_16x16x32_bf16 v[84:87], v[224:227], v[172:175], v[84:87]
    ds_read_b128 v[224:227], v247 offset:9216
    v_mfma_f32_16x16x32_bf16 v[88:91], v[196:199], v[172:175], v[88:91]
    ds_read_b128 v[196:199], v247 offset:10240
    v_mfma_f32_16x16x32_bf16 v[92:95], v[200:203], v[172:175], v[92:95]
    ds_read_b128 v[200:203], v247 offset:11264
    s_waitcnt lgkmcnt(6)
    v_mfma_f32_16x16x32_bf16 v[96:99], v[204:207], v[172:175], v[96:99]
    s_waitcnt vmcnt(10)
    ds_read_b128 v[204:207], v247 offset:12288
    v_mfma_f32_16x16x32_bf16 v[80:83], v[208:211], v[176:179], v[80:83]
    ds_read_b128 v[208:211], v247 offset:13312
    s_waitcnt lgkmcnt(6)
    v_mfma_f32_16x16x32_bf16 v[84:87], v[212:215], v[176:179], v[84:87]
    ds_read_b128 v[212:215], v247 offset:14336
    v_mfma_f32_16x16x32_bf16 v[88:91], v[216:219], v[176:179], v[88:91]
    ds_read_b128 v[216:219], v247 offset:15360
    s_waitcnt lgkmcnt(6)
    v_mfma_f32_16x16x32_bf16 v[92:95], v[220:223], v[176:179], v[92:95]
    ds_read_b128 v[220:223], v247 offset:16384
    v_mfma_f32_16x16x32_bf16 v[96:99], v[224:227], v[176:179], v[96:99]
    s_waitcnt vmcnt(9)
    ds_read_b128 v[224:227], v247 offset:17408
    s_waitcnt lgkmcnt(6)
    v_mfma_f32_16x16x32_bf16 v[80:83], v[196:199], v[180:183], v[80:83]
    ds_read_b128 v[196:199], v247 offset:18432
    v_mfma_f32_16x16x32_bf16 v[84:87], v[200:203], v[180:183], v[84:87]
    ds_read_b128 v[200:203], v247 offset:19456
    s_waitcnt lgkmcnt(6)
    v_mfma_f32_16x16x32_bf16 v[88:91], v[204:207], v[180:183], v[88:91]
    ds_read_b128 v[204:207], v247 offset:20480
    v_mfma_f32_16x16x32_bf16 v[92:95], v[208:211], v[180:183], v[92:95]
    ds_read_b128 v[208:211], v247 offset:21504
    s_waitcnt lgkmcnt(6)
    v_mfma_f32_16x16x32_bf16 v[96:99], v[212:215], v[180:183], v[96:99]
    s_waitcnt vmcnt(8)
    ds_read_b128 v[212:215], v247 offset:22528
    v_mfma_f32_16x16x32_bf16 v[80:83], v[216:219], v[184:187], v[80:83]
    ds_read_b128 v[216:219], v247 offset:23552
    s_waitcnt lgkmcnt(6)
    v_mfma_f32_16x16x32_bf16 v[84:87], v[220:223], v[184:187], v[84:87]
    ds_read_b128 v[220:223], v247 offset:24576
    v_mfma_f32_16x16x32_bf16 v[88:91], v[224:227], v[184:187], v[88:91]
    ds_read_b128 v[224:227], v247 offset:25600
    s_waitcnt lgkmcnt(6)
    v_mfma_f32_16x16x32_bf16 v[92:95], v[196:199], v[184:187], v[92:95]
    ds_read_b128 v[196:199], v247 offset:26624
    v_mfma_f32_16x16x32_bf16 v[96:99], v[200:203], v[184:187], v[96:99]
    s_waitcnt vmcnt(7)
    ds_read_b128 v[200:203], v247 offset:27648
    s_waitcnt lgkmcnt(6)
    v_mfma_f32_16x16x32_bf16 v[80:83], v[204:207], v[188:191], v[80:83]
    ds_read_b128 v[204:207], v247 offset:28672
    v_mfma_f32_16x16x32_bf16 v[84:87], v[208:211], v[188:191], v[84:87]
    ds_read_b128 v[208:211], v247 offset:29696
    s_waitcnt lgkmcnt(6)
    v_mfma_f32_16x16x32_bf16 v[88:91], v[212:215], v[188:191], v[88:91]
    ds_read_b128 v[212:215], v247 offset:30720
    v_mfma_f32_16x16x32_bf16 v[92:95], v[216:219], v[188:191], v[92:95]
    ds_read_b128 v[216:219], v247 offset:31744
    s_waitcnt lgkmcnt(6)
    v_mfma_f32_16x16x32_bf16 v[96:99], v[220:223], v[188:191], v[96:99]
    s_waitcnt vmcnt(6)
    ds_read_b128 v[220:223], v247 offset:32768
    v_mfma_f32_16x16x32_bf16 v[80:83], v[224:227], v[192:195], v[80:83]
    ds_read_b128 v[224:227], v247 offset:33792
    s_waitcnt lgkmcnt(6)
    v_mfma_f32_16x16x32_bf16 v[84:87], v[196:199], v[192:195], v[84:87]
    ds_read_b128 v[196:199], v247 offset:34816
    ds_read_b32 v252, v250 offset:1536
    v_mfma_f32_16x16x32_bf16 v[88:91], v[200:203], v[192:195], v[88:91]
    ds_read_b128 v[200:203], v247 offset:35840
    s_waitcnt lgkmcnt(7)
    v_mfma_f32_16x16x32_bf16 v[92:95], v[204:207], v[192:195], v[92:95]
    ds_read_b128 v[204:207], v247 offset:36864
    v_mfma_f32_16x16x32_bf16 v[96:99], v[208:211], v[192:195], v[96:99]
    s_waitcnt vmcnt(5)
    ds_read_b128 v[208:211], v247 offset:37888
    s_waitcnt lgkmcnt(7)
    v_mfma_f32_16x16x32_bf16 v[80:83], v[212:215], v[100:103], v[80:83]
    s_waitcnt lgkmcnt(3)
    v_cmp_gt_u32 vcc, 20, v252
    s_cbranch_vccnz K2_FW_75
K2_FB_76:
    ds_read_b128 v[212:215], v247 offset:38912
    v_mfma_f32_16x16x32_bf16 v[84:87], v[216:219], v[100:103], v[84:87]
    ds_read_b128 v[216:219], v247 offset:39936
    v_mfma_f32_16x16x32_bf16 v[88:91], v[220:223], v[100:103], v[88:91]
    ds_read_b128 v[220:223], v247 offset:40960
    v_mfma_f32_16x16x32_bf16 v[92:95], v[224:227], v[100:103], v[92:95]
    ds_read_b128 v[224:227], v247 offset:41984
    s_waitcnt lgkmcnt(6)
    v_mfma_f32_16x16x32_bf16 v[96:99], v[196:199], v[100:103], v[96:99]
    s_waitcnt vmcnt(4)
    ds_read_b128 v[196:199], v247 offset:43008
    v_mfma_f32_16x16x32_bf16 v[80:83], v[200:203], v[104:107], v[80:83]
    ds_read_b128 v[200:203], v247 offset:44032
    s_waitcnt lgkmcnt(6)
    v_mfma_f32_16x16x32_bf16 v[84:87], v[204:207], v[104:107], v[84:87]
    ds_read_b128 v[204:207], v247 offset:45056
    v_mfma_f32_16x16x32_bf16 v[88:91], v[208:211], v[104:107], v[88:91]
    ds_read_b128 v[208:211], v247 offset:46080
    s_waitcnt lgkmcnt(6)
    v_mfma_f32_16x16x32_bf16 v[92:95], v[212:215], v[104:107], v[92:95]
    ds_read_b128 v[212:215], v247 offset:47104
    v_mfma_f32_16x16x32_bf16 v[96:99], v[216:219], v[104:107], v[96:99]
    s_waitcnt vmcnt(3)
    ds_read_b128 v[216:219], v247 offset:48128
    s_waitcnt lgkmcnt(6)
    v_mfma_f32_16x16x32_bf16 v[80:83], v[220:223], v[108:111], v[80:83]
    ds_read_b128 v[220:223], v247 offset:49152
    v_mfma_f32_16x16x32_bf16 v[84:87], v[224:227], v[108:111], v[84:87]
    ds_read_b128 v[224:227], v247 offset:50176
    s_waitcnt lgkmcnt(6)
    v_mfma_f32_16x16x32_bf16 v[88:91], v[196:199], v[108:111], v[88:91]
    ds_read_b128 v[196:199], v247 offset:51200
    v_mfma_f32_16x16x32_bf16 v[92:95], v[200:203], v[108:111], v[92:95]
    ds_read_b128 v[200:203], v247 offset:52224
    s_waitcnt lgkmcnt(6)
    v_mfma_f32_16x16x32_bf16 v[96:99], v[204:207], v[108:111], v[96:99]
    s_waitcnt vmcnt(2)
    ds_read_b128 v[204:207], v247 offset:53248
    v_mfma_f32_16x16x32_bf16 v[80:83], v[208:211], v[112:115], v[80:83]
    ds_read_b128 v[208:211], v247 offset:54272
    s_waitcnt lgkmcnt(6)
    v_mfma_f32_16x16x32_bf16 v[84:87], v[212:215], v[112:115], v[84:87]
    ds_read_b128 v[212:215], v247 offset:55296
    v_mfma_f32_16x16x32_bf16 v[88:91], v[216:219], v[112:115], v[88:91]
    ds_read_b128 v[216:219], v247 offset:56320
    s_waitcnt lgkmcnt(6)
    v_mfma_f32_16x16x32_bf16 v[92:95], v[220:223], v[112:115], v[92:95]
    ds_read_b128 v[220:223], v247 offset:57344
    v_mfma_f32_16x16x32_bf16 v[96:99], v[224:227], v[112:115], v[96:99]
    s_waitcnt vmcnt(1)
    ds_read_b128 v[224:227], v247 offset:58368
    s_waitcnt lgkmcnt(6)
    v_mfma_f32_16x16x32_bf16 v[80:83], v[196:199], v[116:119], v[80:83]
    ds_read_b128 v[196:199], v247 offset:59392
    v_mfma_f32_16x16x32_bf16 v[84:87], v[200:203], v[116:119], v[84:87]
    ds_read_b128 v[200:203], v247 offset:60416
    s_waitcnt lgkmcnt(6)
    v_mfma_f32_16x16x32_bf16 v[88:91], v[204:207], v[116:119], v[88:91]
    v_mfma_f32_16x16x32_bf16 v[92:95], v[208:211], v[116:119], v[92:95]
    s_waitcnt lgkmcnt(4)
    v_mfma_f32_16x16x32_bf16 v[96:99], v[212:215], v[116:119], v[96:99]
    s_waitcnt vmcnt(0)
    v_mfma_f32_16x16x32_bf16 v[80:83], v[216:219], v[120:123], v[80:83]
    s_waitcnt lgkmcnt(2)
    v_mfma_f32_16x16x32_bf16 v[84:87], v[220:223], v[120:123], v[84:87]
    v_mfma_f32_16x16x32_bf16 v[88:91], v[224:227], v[120:123], v[88:91]
    s_waitcnt lgkmcnt(0)
    v_mfma_f32_16x16x32_bf16 v[92:95], v[196:199], v[120:123], v[92:95]
    v_mfma_f32_16x16x32_bf16 v[96:99], v[200:203], v[120:123], v[96:99]
    s_nop 6
    v_cvt_pk_bf16_f32 v100, v80, v81
    v_cvt_pk_bf16_f32 v101, v82, v83
    v_cvt_pk_bf16_f32 v102, v84, v85
    v_cvt_pk_bf16_f32 v103, v86, v87
    v_cvt_pk_bf16_f32 v104, v88, v89
    v_cvt_pk_bf16_f32 v105, v90, v91
    v_cvt_pk_bf16_f32 v106, v92, v93
    v_cvt_pk_bf16_f32 v107, v94, v95
    v_cvt_pk_bf16_f32 v108, v96, v97
    v_cvt_pk_bf16_f32 v109, v98, v99
    buffer_store_dwordx2 v[108:109], v244, s[32:35], s68 offen offset:128
    v_permlane16_swap_b32 v100, v102
    v_permlane16_swap_b32 v101, v103
    buffer_store_dwordx4 v[100:103], v3, s[32:35], s68 offen offset:0
    v_permlane16_swap_b32 v104, v106
    v_permlane16_swap_b32 v105, v107
    buffer_store_dwordx4 v[104:107], v3, s[32:35], s68 offen offset:64
    s_endpgm
K2_FW_31:
    s_mov_b32 s53, 32768
K2_FW_31_l:

    ds_read_b32 v252, v250 offset:1536
    s_sub_u32 s53, s53, 1
    s_cmp_eq_u32 s53, 0
    s_cbranch_scc1 K2_FB_32
    s_waitcnt lgkmcnt(0)
    v_cmp_gt_u32 vcc, 3, v252
    s_cbranch_vccnz K2_FW_31_l
    s_branch K2_FB_32
K2_FW_37:
    s_mov_b32 s53, 32768
K2_FW_37_l:

    ds_read_b32 v252, v250 offset:1536
    s_sub_u32 s53, s53, 1
    s_cmp_eq_u32 s53, 0
    s_cbranch_scc1 K2_FB_38
    s_waitcnt lgkmcnt(0)
    v_cmp_gt_u32 vcc, 4, v252
    s_cbranch_vccnz K2_FW_37_l
    s_branch K2_FB_38
K2_FW_39:
    s_mov_b32 s53, 32768
K2_FW_39_l:

    ds_read_b32 v252, v250 offset:1536
    s_sub_u32 s53, s53, 1
    s_cmp_eq_u32 s53, 0
    s_cbranch_scc1 K2_FB_40
    s_waitcnt lgkmcnt(0)
    v_cmp_gt_u32 vcc, 5, v252
    s_cbranch_vccnz K2_FW_39_l
    s_branch K2_FB_40
K2_FW_45:
    s_mov_b32 s53, 32768
K2_FW_45_l:

    ds_read_b32 v252, v250 offset:1536
    s_sub_u32 s53, s53, 1
    s_cmp_eq_u32 s53, 0
    s_cbranch_scc1 K2_FB_46
    s_waitcnt lgkmcnt(0)
    v_cmp_gt_u32 vcc, 6, v252
    s_cbranch_vccnz K2_FW_45_l
    s_branch K2_FB_46
K2_FW_47:
    s_mov_b32 s53, 32768
K2_FW_47_l:

    ds_read_b32 v252, v250 offset:1536
    s_sub_u32 s53, s53, 1
    s_cmp_eq_u32 s53, 0
    s_cbranch_scc1 K2_FB_48
    s_waitcnt lgkmcnt(0)
    v_cmp_gt_u32 vcc, 7, v252
    s_cbranch_vccnz K2_FW_47_l
    s_branch K2_FB_48
K2_FW_49:
    s_mov_b32 s53, 32768
K2_FW_49_l:

    ds_read_b32 v252, v250 offset:1536
    s_sub_u32 s53, s53, 1
    s_cmp_eq_u32 s53, 0
    s_cbranch_scc1 K2_FB_50
    s_waitcnt lgkmcnt(0)
    v_cmp_gt_u32 vcc, 8, v252
    s_cbranch_vccnz K2_FW_49_l
    s_branch K2_FB_50
K2_FW_51:
    s_mov_b32 s53, 32768
K2_FW_51_l:

    ds_read_b32 v252, v250 offset:1536
    s_sub_u32 s53, s53, 1
    s_cmp_eq_u32 s53, 0
    s_cbranch_scc1 K2_FB_52
    s_waitcnt lgkmcnt(0)
    v_cmp_gt_u32 vcc, 9, v252
    s_cbranch_vccnz K2_FW_51_l
    s_branch K2_FB_52
K2_FW_53:
    s_mov_b32 s53, 32768
K2_FW_53_l:

    ds_read_b32 v252, v250 offset:1536
    s_sub_u32 s53, s53, 1
    s_cmp_eq_u32 s53, 0
    s_cbranch_scc1 K2_FB_54
    s_waitcnt lgkmcnt(0)
    v_cmp_gt_u32 vcc, 10, v252
    s_cbranch_vccnz K2_FW_53_l
    s_branch K2_FB_54
K2_FW_55:
    s_mov_b32 s53, 32768
K2_FW_55_l:

    ds_read_b32 v252, v250 offset:1536
    s_sub_u32 s53, s53, 1
    s_cmp_eq_u32 s53, 0
    s_cbranch_scc1 K2_FB_56
    s_waitcnt lgkmcnt(0)
    v_cmp_gt_u32 vcc, 11, v252
    s_cbranch_vccnz K2_FW_55_l
    s_branch K2_FB_56
K2_G2_57:
    s_mov_b32 s53, 32768
    s_mov_b64 exec, 1
K2_G2_57_l:

    v_mov_b32 v231, 0
    buffer_atomic_add v231, v255, s[20:23], s62 offen sc0 sc1
    s_sub_u32 s53, s53, 1
    s_cmp_eq_u32 s53, 0
    s_cbranch_scc1 K2_G2_57_x
    s_waitcnt vmcnt(0)
    v_cmp_gt_u32 vcc, 8, v231
    s_cbranch_vccnz K2_G2_57_l
K2_G2_57_x:
    s_mov_b64 exec, -1
    s_branch K2_G2B_58
K2_FW_59:
    s_mov_b32 s53, 32768
K2_FW_59_l:

    ds_read_b32 v252, v250 offset:1536
    s_sub_u32 s53, s53, 1
    s_cmp_eq_u32 s53, 0
    s_cbranch_scc1 K2_FB_60
    s_waitcnt lgkmcnt(0)
    v_cmp_gt_u32 vcc, 13, v252
    s_cbranch_vccnz K2_FW_59_l
    s_branch K2_FB_60
K2_FW_61:
    s_mov_b32 s53, 32768
K2_FW_61_l:

    ds_read_b32 v252, v250 offset:1536
    s_sub_u32 s53, s53, 1
    s_cmp_eq_u32 s53, 0
    s_cbranch_scc1 K2_FB_62
    s_waitcnt lgkmcnt(0)
    v_cmp_gt_u32 vcc, 14, v252
    s_cbranch_vccnz K2_FW_61_l
    s_branch K2_FB_62
K2_FW_63:
    s_mov_b32 s53, 32768
K2_FW_63_l:

    ds_read_b32 v252, v250 offset:1536
    s_sub_u32 s53, s53, 1
    s_cmp_eq_u32 s53, 0
    s_cbranch_scc1 K2_FB_64
    s_waitcnt lgkmcnt(0)
    v_cmp_gt_u32 vcc, 15, v252
    s_cbranch_vccnz K2_FW_63_l
    s_branch K2_FB_64
K2_G2_65:
    s_mov_b32 s53, 32768
    s_mov_b64 exec, 1
K2_G2_65_l:

    v_mov_b32 v231, 0
    buffer_atomic_add v231, v255, s[20:23], s62 offen sc0 sc1
    s_sub_u32 s53, s53, 1
    s_cmp_eq_u32 s53, 0
    s_cbranch_scc1 K2_G2_65_x
    s_waitcnt vmcnt(0)
    v_cmp_gt_u32 vcc, 8, v231
    s_cbranch_vccnz K2_G2_65_l
K2_G2_65_x:
    s_mov_b64 exec, -1
    s_branch K2_G2B_66
K2_FW_67:
    s_mov_b32 s53, 32768
K2_FW_67_l:

    ds_read_b32 v252, v250 offset:1536
    s_sub_u32 s53, s53, 1
    s_cmp_eq_u32 s53, 0
    s_cbranch_scc1 K2_FB_68
    s_waitcnt lgkmcnt(0)
    v_cmp_gt_u32 vcc, 16, v252
    s_cbranch_vccnz K2_FW_67_l
    s_branch K2_FB_68
K2_FW_69:
    s_mov_b32 s53, 32768
K2_FW_69_l:

    ds_read_b32 v252, v250 offset:1536
    s_sub_u32 s53, s53, 1
    s_cmp_eq_u32 s53, 0
    s_cbranch_scc1 K2_FB_70
    s_waitcnt lgkmcnt(0)
    v_cmp_gt_u32 vcc, 17, v252
    s_cbranch_vccnz K2_FW_69_l
    s_branch K2_FB_70
K2_FW_71:
    s_mov_b32 s53, 32768
K2_FW_71_l:

    ds_read_b32 v252, v250 offset:1536
    s_sub_u32 s53, s53, 1
    s_cmp_eq_u32 s53, 0
    s_cbranch_scc1 K2_FB_72
    s_waitcnt lgkmcnt(0)
    v_cmp_gt_u32 vcc, 18, v252
    s_cbranch_vccnz K2_FW_71_l
    s_branch K2_FB_72
K2_FW_73:
    s_mov_b32 s53, 32768
K2_FW_73_l:

    ds_read_b32 v252, v250 offset:1536
    s_sub_u32 s53, s53, 1
    s_cmp_eq_u32 s53, 0
    s_cbranch_scc1 K2_FB_74
    s_waitcnt lgkmcnt(0)
    v_cmp_gt_u32 vcc, 19, v252
    s_cbranch_vccnz K2_FW_73_l
    s_branch K2_FB_74
K2_FW_75:
    s_mov_b32 s53, 32768
K2_FW_75_l:

    ds_read_b32 v252, v250 offset:1536
    s_sub_u32 s53, s53, 1
    s_cmp_eq_u32 s53, 0
    s_cbranch_scc1 K2_FB_76
    s_waitcnt lgkmcnt(0)
    v_cmp_gt_u32 vcc, 20, v252
    s_cbranch_vccnz K2_FW_75_l
    s_branch K2_FB_76
K2_HELPER:
    s_setprio 0
    s_mov_b32 s24, s20
    s_mov_b32 s25, s21
    s_add_u32 s26, s3, 41230336
    s_mov_b32 s27, 0x00020000
    s_mul_i32 s50, s42, 7
    s_min_u32 s50, s50, 47
    s_lshl_b32 s51, s50, 11
    s_cmp_ge_u32 s42, 4
    s_cselect_b32 s52, 3612672, 0
    s_add_u32 s51, s51, s52
    v_add_u32 v246, s51, v2
    v_and_b32 v3, 255, v0
    v_lshlrev_b32 v3, 2, v3
    v_and_b32 v6, 3, v1
    v_lshlrev_b32 v6, 2, v6
    s_and_b32 s51, s40, 3
    s_lshl_b32 s51, s51, 2
    v_mov_b32 v7, s51
    v_mov_b32 v10, v28
    s_mul_i32 s45, s67, 24576
    s_mul_i32 s51, s42, 3072
    s_add_u32 s45, s45, s51
    v_add_u32 v12, 2048, v2
    v_add_u32 v13, 67584, v2
    v_add_u32 v14, 133120, v2
    s_barrier
    s_cmp_eq_u32 s40, 5
    s_cbranch_scc1 K2_H1
    s_cmp_eq_u32 s40, 6
    s_cbranch_scc1 K2_H2
    s_cmp_eq_u32 s40, 7
    s_cbranch_scc1 K2_H3
    s_mov_b32 s54, 38649856
    buffer_load_dwordx4 v[16:19], v245, s[20:23], s54 offen offset:0 sc1
    buffer_load_dwordx4 v[20:23], v245, s[20:23], s54 offen offset:1024 sc1
    s_mov_b32 s54, 38670336
    buffer_load_dwordx4 v[24:27], v245, s[20:23], s54 offen offset:3072 sc1
    s_mov_b32 s54, 38674432
    buffer_load_dwordx4 v[28:31], v245, s[20:23], s54 offen offset:0 sc1
    s_mov_b32 s54, 38731776
    buffer_load_dwordx4 v[32:35], v245, s[20:23], s54 offen offset:1024 sc1
    buffer_load_dwordx4 v[36:39], v245, s[20:23], s54 offen offset:2048 sc1
    s_mov_b32 s54, 38756352
    buffer_load_dwordx4 v[40:43], v245, s[20:23], s54 offen offset:0 sc1
    s_mov_b32 s54, 38772736
    buffer_load_dwordx4 v[44:47], v245, s[20:23], s54 offen offset:0 sc1
    s_mov_b32 s54, 38793216
    buffer_load_dwordx4 v[48:51], v245, s[20:23], s54 offen offset:2048 sc1
    buffer_load_dwordx4 v[52:55], v245, s[20:23], s54 offen offset:3072 sc1
    s_mov_b32 s54, 38854656
    buffer_load_dwordx4 v[56:59], v245, s[20:23], s54 offen offset:0 sc1
    buffer_load_dwordx4 v[60:63], v245, s[20:23], s54 offen offset:1024 sc1
    s_mov_b32 s54, 38875136
    buffer_load_dwordx4 v[64:67], v245, s[20:23], s54 offen offset:3072 sc1
    s_mov_b32 s54, 38879232
    buffer_load_dwordx4 v[68:71], v245, s[20:23], s54 offen offset:0 sc1
    s_mov_b32 s54, 38936576
    buffer_load_dwordx4 v[72:75], v245, s[20:23], s54 offen offset:1024 sc1
    buffer_load_dwordx4 v[76:79], v245, s[20:23], s54 offen offset:2048 sc1
    s_mov_b32 s54, 38961152
    buffer_load_dwordx4 v[80:83], v245, s[20:23], s54 offen offset:0 sc1
    s_mov_b32 s54, 39092224
    buffer_load_dwordx4 v[84:87], v246, s[20:23], s54 offen offset:0 sc1
    s_mov_b32 s54, 39096320
    buffer_load_dwordx4 v[88:91], v246, s[20:23], s54 offen offset:3072 sc1
    s_mov_b32 s54, 39378944
    buffer_load_dwordx4 v[92:95], v246, s[20:23], s54 offen offset:0 sc1
    s_mov_b32 s54, 39383040
    buffer_load_dwordx4 v[96:99], v246, s[20:23], s54 offen offset:3072 sc1
    s_mov_b32 s54, 39665664
    buffer_load_dwordx4 v[100:103], v246, s[20:23], s54 offen offset:0 sc1
    s_mov_b32 s54, 39669760
    buffer_load_dwordx4 v[104:107], v246, s[20:23], s54 offen offset:3072 sc1
    s_mov_b32 s54, 39952384
    buffer_load_dwordx4 v[108:111], v246, s[20:23], s54 offen offset:0 sc1
    s_mov_b32 s54, 39956480
    buffer_load_dwordx4 v[112:115], v246, s[20:23], s54 offen offset:3072 sc1
    s_mov_b32 s54, 38977536
    buffer_load_dwordx4 v[116:119], v246, s[20:23], s54 offen offset:0 sc1
    s_mov_b32 s54, 38981632
    buffer_load_dwordx4 v[120:123], v246, s[20:23], s54 offen offset:3072 sc1
    s_mov_b32 s54, 39034880
    buffer_load_dwordx4 v[124:127], v246, s[20:23], s54 offen offset:0 sc1
    s_mov_b32 s54, 39038976
    buffer_load_dwordx4 v[128:131], v246, s[20:23], s54 offen offset:3072 sc1
    s_mov_b32 s54, 39149568
    buffer_load_dwordx4 v[132:135], v246, s[20:23], s54 offen offset:0 sc1
    s_mov_b32 s54, 39153664
    buffer_load_dwordx4 v[136:139], v246, s[20:23], s54 offen offset:3072 sc1
    s_mov_b32 s54, 39206912
    buffer_load_dwordx4 v[140:143], v246, s[20:23], s54 offen offset:0 sc1
    s_mov_b32 s55, 131072
K2_HP_77:
    ds_read_b32 v9, v6 offset:1552
    s_sub_u32 s55, s55, 1
    s_cmp_eq_u32 s55, 0
    s_cbranch_scc1 K2_HD_78
    s_waitcnt lgkmcnt(0)
    v_cmp_gt_u32 vcc, 2, v9
    s_cbranch_vccz K2_HD_78
    s_sleep 1
    s_branch K2_HP_77
K2_HD_78:
    ds_write_b128 v14, v[152:155] offset:27648
    ds_write_b128 v14, v[156:159] offset:28672
    ds_write_b128 v14, v[160:163] offset:29696
    ds_write_b128 v12, v[164:167] offset:0
    ds_write_b128 v12, v[168:171] offset:1024
    ds_write_b128 v12, v[172:175] offset:17408
    ds_write_b128 v12, v[176:179] offset:18432
    ds_write_b128 v12, v[180:183] offset:19456
    ds_write_b128 v12, v[184:187] offset:20480
    ds_write_b128 v12, v[188:191] offset:21504
    ds_write_b128 v12, v[192:195] offset:37888
    ds_write_b128 v12, v[196:199] offset:38912
    ds_write_b128 v12, v[200:203] offset:39936
    ds_write_b128 v12, v[204:207] offset:40960
    ds_write_b128 v12, v[208:211] offset:41984
    v_mov_b32 v8, 3
    ds_write_b32 v7, v8 offset:1536
    ds_write_b128 v12, v[212:215] offset:58368
    ds_write_b128 v12, v[216:219] offset:59392
    ds_write_b128 v12, v[220:223] offset:60416
    ds_write_b128 v12, v[224:227] offset:61440
    ds_write_b128 v12, v[228:231] offset:62464
    s_waitcnt vmcnt(31)
    ds_write_b128 v13, v[16:19] offset:13312
    s_waitcnt vmcnt(30)
    ds_write_b128 v13, v[20:23] offset:14336
    s_waitcnt vmcnt(29)
    ds_write_b128 v13, v[24:27] offset:21504
    s_waitcnt vmcnt(28)
    ds_write_b128 v13, v[28:31] offset:22528
    s_waitcnt vmcnt(27)
    ds_write_b128 v13, v[32:35] offset:29696
    s_waitcnt vmcnt(26)
    ds_write_b128 v13, v[36:39] offset:30720
    v_mov_b32 v8, 4
    ds_write_b32 v7, v8 offset:1536
    s_mov_b32 s55, 131072
K2_HP_79:
    ds_read_b32 v9, v6 offset:1552
    s_sub_u32 s55, s55, 1
    s_cmp_eq_u32 s55, 0
    s_cbranch_scc1 K2_HD_80
    s_waitcnt lgkmcnt(0)
    v_cmp_gt_u32 vcc, 3, v9
    s_cbranch_vccz K2_HD_80
    s_sleep 1
    s_branch K2_HP_79
K2_HD_80:
    s_mov_b32 s54, 39211008
    buffer_load_dwordx4 v[144:147], v246, s[20:23], s54 offen offset:3072 sc1
    s_mov_b32 s54, 39264256
    buffer_load_dwordx4 v[152:155], v246, s[20:23], s54 offen offset:0 sc1
    s_mov_b32 s54, 39268352
    buffer_load_dwordx4 v[156:159], v246, s[20:23], s54 offen offset:3072 sc1
    s_mov_b32 s54, 39321600
    buffer_load_dwordx4 v[160:163], v246, s[20:23], s54 offen offset:0 sc1
    s_mov_b32 s54, 39325696
    buffer_load_dwordx4 v[164:167], v246, s[20:23], s54 offen offset:3072 sc1
    s_mov_b32 s54, 39436288
    buffer_load_dwordx4 v[168:171], v246, s[20:23], s54 offen offset:0 sc1
    s_mov_b32 s54, 39440384
    buffer_load_dwordx4 v[172:175], v246, s[20:23], s54 offen offset:3072 sc1
    s_mov_b32 s54, 39493632
    buffer_load_dwordx4 v[176:179], v246, s[20:23], s54 offen offset:0 sc1
    s_mov_b32 s54, 39497728
    buffer_load_dwordx4 v[180:183], v246, s[20:23], s54 offen offset:3072 sc1
    s_mov_b32 s54, 39550976
    buffer_load_dwordx4 v[184:187], v246, s[20:23], s54 offen offset:0 sc1
    s_mov_b32 s54, 39555072
    buffer_load_dwordx4 v[188:191], v246, s[20:23], s54 offen offset:3072 sc1
    s_mov_b32 s54, 39608320
    buffer_load_dwordx4 v[192:195], v246, s[20:23], s54 offen offset:0 sc1
    s_mov_b32 s54, 39612416
    buffer_load_dwordx4 v[196:199], v246, s[20:23], s54 offen offset:3072 sc1
    s_mov_b32 s54, 39723008
    buffer_load_dwordx4 v[200:203], v246, s[20:23], s54 offen offset:0 sc1
    s_mov_b32 s54, 39727104
    buffer_load_dwordx4 v[204:207], v246, s[20:23], s54 offen offset:3072 sc1
    s_mov_b32 s54, 39780352
    buffer_load_dwordx4 v[208:211], v246, s[20:23], s54 offen offset:0 sc1
    s_mov_b32 s54, 39784448
    buffer_load_dwordx4 v[212:215], v246, s[20:23], s54 offen offset:3072 sc1
    s_mov_b32 s54, 39837696
    buffer_load_dwordx4 v[216:219], v246, s[20:23], s54 offen offset:0 sc1
    s_mov_b32 s54, 39841792
    buffer_load_dwordx4 v[220:223], v246, s[20:23], s54 offen offset:3072 sc1
    s_mov_b32 s54, 39895040
    buffer_load_dwordx4 v[224:227], v246, s[20:23], s54 offen offset:0 sc1
    s_mov_b32 s54, 39899136
    buffer_load_dwordx4 v[228:231], v246, s[20:23], s54 offen offset:3072 sc1
    s_mov_b32 s54, 40009728
    buffer_load_dwordx4 v[16:19], v246, s[20:23], s54 offen offset:0 sc1
    s_mov_b32 s54, 40013824
    buffer_load_dwordx4 v[20:23], v246, s[20:23], s54 offen offset:3072 sc1
    s_mov_b32 s54, 40067072
    buffer_load_dwordx4 v[24:27], v246, s[20:23], s54 offen offset:0 sc1
    s_mov_b32 s55, 131072
K2_HP_81:
    ds_read_b32 v9, v6 offset:1552
    s_sub_u32 s55, s55, 1
    s_cmp_eq_u32 s55, 0
    s_cbranch_scc1 K2_HD_82
    s_waitcnt lgkmcnt(0)
    v_cmp_gt_u32 vcc, 4, v9
    s_cbranch_vccz K2_HD_82
    s_sleep 1
    s_branch K2_HP_81
K2_HD_82:
    s_waitcnt vmcnt(49)
    ds_write_b128 v13, v[40:43] offset:37888
    s_waitcnt vmcnt(48)
    ds_write_b128 v13, v[44:47] offset:38912
    s_waitcnt vmcnt(47)
    ds_write_b128 v13, v[48:51] offset:46080
    s_waitcnt vmcnt(46)
    ds_write_b128 v13, v[52:55] offset:47104
    s_waitcnt vmcnt(45)
    ds_write_b128 v13, v[56:59] offset:54272
    s_waitcnt vmcnt(44)
    ds_write_b128 v13, v[60:63] offset:55296
    s_waitcnt vmcnt(43)
    ds_write_b128 v13, v[64:67] offset:62464
    s_waitcnt vmcnt(42)
    ds_write_b128 v13, v[68:71] offset:63488
    s_waitcnt vmcnt(41)
    ds_write_b128 v14, v[72:75] offset:5120
    s_waitcnt vmcnt(40)
    ds_write_b128 v14, v[76:79] offset:6144
    s_waitcnt vmcnt(39)
    ds_write_b128 v14, v[80:83] offset:13312
    v_mov_b32 v8, 5
    ds_write_b32 v7, v8 offset:1536
    s_waitcnt vmcnt(38)
    ds_write_b128 v14, v[84:87] offset:14336
    s_waitcnt vmcnt(37)
    ds_write_b128 v14, v[88:91] offset:21504
    s_waitcnt vmcnt(36)
    ds_write_b128 v14, v[92:95] offset:22528
    s_waitcnt vmcnt(35)
    ds_write_b128 v14, v[96:99] offset:29696
    s_waitcnt vmcnt(34)
    ds_write_b128 v12, v[100:103] offset:0
    s_waitcnt vmcnt(33)
    ds_write_b128 v12, v[104:107] offset:7168
    s_waitcnt vmcnt(32)
    ds_write_b128 v12, v[108:111] offset:8192
    s_waitcnt vmcnt(31)
    ds_write_b128 v12, v[112:115] offset:15360
    s_waitcnt vmcnt(30)
    ds_write_b128 v12, v[116:119] offset:16384
    s_waitcnt vmcnt(29)
    ds_write_b128 v12, v[120:123] offset:23552
    s_waitcnt vmcnt(28)
    ds_write_b128 v12, v[124:127] offset:24576
    s_waitcnt vmcnt(27)
    ds_write_b128 v12, v[128:131] offset:31744
    s_waitcnt vmcnt(26)
    ds_write_b128 v12, v[132:135] offset:32768
    s_waitcnt vmcnt(25)
    ds_write_b128 v12, v[136:139] offset:39936
    s_waitcnt vmcnt(24)
    ds_write_b128 v12, v[140:143] offset:40960
    v_mov_b32 v8, 6
    ds_write_b32 v7, v8 offset:1536
    s_mov_b32 s55, 131072
K2_HP_83:
    ds_read_b32 v9, v6 offset:1552
    s_sub_u32 s55, s55, 1
    s_cmp_eq_u32 s55, 0
    s_cbranch_scc1 K2_HD_84
    s_waitcnt lgkmcnt(0)
    v_cmp_gt_u32 vcc, 6, v9
    s_cbranch_vccz K2_HD_84
    s_sleep 1
    s_branch K2_HP_83
K2_HD_84:
    s_waitcnt vmcnt(23)
    ds_write_b128 v12, v[144:147] offset:48128
    s_waitcnt vmcnt(22)
    ds_write_b128 v12, v[152:155] offset:49152
    s_waitcnt vmcnt(21)
    ds_write_b128 v12, v[156:159] offset:56320
    s_waitcnt vmcnt(20)
    ds_write_b128 v12, v[160:163] offset:57344
    s_waitcnt vmcnt(19)
    ds_write_b128 v12, v[164:167] offset:64512
    s_waitcnt vmcnt(18)
    ds_write_b128 v13, v[168:171] offset:0
    s_waitcnt vmcnt(17)
    ds_write_b128 v13, v[172:175] offset:7168
    s_waitcnt vmcnt(16)
    ds_write_b128 v13, v[176:179] offset:8192
    s_waitcnt vmcnt(15)
    ds_write_b128 v13, v[180:183] offset:15360
    s_waitcnt vmcnt(14)
    ds_write_b128 v13, v[184:187] offset:16384
    s_waitcnt vmcnt(13)
    ds_write_b128 v13, v[188:191] offset:23552
    s_waitcnt vmcnt(12)
    ds_write_b128 v13, v[192:195] offset:24576
    s_waitcnt vmcnt(11)
    ds_write_b128 v13, v[196:199] offset:31744
    s_waitcnt vmcnt(10)
    ds_write_b128 v13, v[200:203] offset:32768
    s_waitcnt vmcnt(9)
    ds_write_b128 v13, v[204:207] offset:39936
    s_waitcnt vmcnt(8)
    ds_write_b128 v13, v[208:211] offset:40960
    s_waitcnt vmcnt(7)
    ds_write_b128 v13, v[212:215] offset:48128
    s_waitcnt vmcnt(6)
    ds_write_b128 v13, v[216:219] offset:49152
    s_waitcnt vmcnt(5)
    ds_write_b128 v13, v[220:223] offset:56320
    s_waitcnt vmcnt(4)
    ds_write_b128 v13, v[224:227] offset:57344
    s_waitcnt vmcnt(3)
    ds_write_b128 v13, v[228:231] offset:64512
    s_waitcnt vmcnt(2)
    ds_write_b128 v14, v[16:19] offset:0
    s_waitcnt vmcnt(1)
    ds_write_b128 v14, v[20:23] offset:7168
    s_waitcnt vmcnt(0)
    ds_write_b128 v14, v[24:27] offset:8192
    v_mov_b32 v8, 7
    ds_write_b32 v7, v8 offset:1536
    ds_read_b32 v9, v6 offset:1552
    s_waitcnt lgkmcnt(0)
    v_cmp_gt_u32 vcc, 7, v9
    s_cbranch_vccz K2_HD_86
    s_mov_b32 s55, 131072
K2_HP_85:
    ds_read_b32 v9, v6 offset:1552
    s_sub_u32 s55, s55, 1
    s_cmp_eq_u32 s55, 0
    s_cbranch_scc1 K2_HD_86
    s_waitcnt lgkmcnt(0)
    v_cmp_gt_u32 vcc, 7, v9
    s_cbranch_vccz K2_HD_86
    s_sleep 1
    s_branch K2_HP_85
K2_HD_86:
    s_mov_b32 m0, 147456
    s_mov_b32 s54, 40073216
    buffer_load_dwordx4 v246, s[20:23], s54 offen offset:0 sc1 lds
    buffer_load_dwordx4 v246, s[20:23], s54 offen offset:1024 sc1 lds
    s_mov_b32 m0, 159744
    s_mov_b32 s54, 39391232
    buffer_load_dwordx4 v246, s[20:23], s54 offen offset:0 sc1 lds
    buffer_load_dwordx4 v246, s[20:23], s54 offen offset:1024 sc1 lds
    s_mov_b32 m0, 2048
    s_mov_b32 s54, 39675904
    buffer_load_dwordx4 v246, s[20:23], s54 offen offset:0 sc1 lds
    buffer_load_dwordx4 v246, s[20:23], s54 offen offset:1024 sc1 lds
    buffer_load_dwordx4 v246, s[20:23], s54 offen offset:2048 sc1 lds
    buffer_load_dwordx4 v246, s[20:23], s54 offen offset:3072 sc1 lds
    ds_read_b32 v9, v6 offset:1552
    s_waitcnt lgkmcnt(0)
    v_cmp_gt_u32 vcc, 8, v9
    s_cbranch_vccz K2_HD_88
    s_waitcnt vmcnt(0)
    v_mov_b32 v8, 8
    ds_write_b32 v7, v8 offset:1536
    s_mov_b32 s55, 131072
K2_HP_87:
    ds_read_b32 v9, v6 offset:1552
    s_sub_u32 s55, s55, 1
    s_cmp_eq_u32 s55, 0
    s_cbranch_scc1 K2_HD_88
    s_waitcnt lgkmcnt(0)
    v_cmp_gt_u32 vcc, 8, v9
    s_cbranch_vccz K2_HD_88
    s_sleep 1
    s_branch K2_HP_87
K2_HD_88:
    s_mov_b32 m0, 18432
    s_mov_b32 s54, 39043072
    buffer_load_dwordx4 v246, s[20:23], s54 offen offset:0 sc1 lds
    buffer_load_dwordx4 v246, s[20:23], s54 offen offset:1024 sc1 lds
    buffer_load_dwordx4 v246, s[20:23], s54 offen offset:2048 sc1 lds
    buffer_load_dwordx4 v246, s[20:23], s54 offen offset:3072 sc1 lds
    s_mov_b32 m0, 36864
    s_mov_b32 s54, 39272448
    buffer_load_dwordx4 v246, s[20:23], s54 offen offset:0 sc1 lds
    buffer_load_dwordx4 v246, s[20:23], s54 offen offset:1024 sc1 lds
    buffer_load_dwordx4 v246, s[20:23], s54 offen offset:2048 sc1 lds
    buffer_load_dwordx4 v246, s[20:23], s54 offen offset:3072 sc1 lds
    s_waitcnt vmcnt(8)
    v_mov_b32 v8, 8
    ds_write_b32 v7, v8 offset:1536
    ds_read_b32 v9, v6 offset:1552
    s_waitcnt lgkmcnt(0)
    v_cmp_gt_u32 vcc, 9, v9
    s_cbranch_vccz K2_HD_90
    s_waitcnt vmcnt(0)
    v_mov_b32 v8, 9
    ds_write_b32 v7, v8 offset:1536
    s_mov_b32 s55, 131072
K2_HP_89:
    ds_read_b32 v9, v6 offset:1552
    s_sub_u32 s55, s55, 1
    s_cmp_eq_u32 s55, 0
    s_cbranch_scc1 K2_HD_90
    s_waitcnt lgkmcnt(0)
    v_cmp_gt_u32 vcc, 9, v9
    s_cbranch_vccz K2_HD_90
    s_sleep 1
    s_branch K2_HP_89
K2_HD_90:
    s_mov_b32 m0, 51200
    s_mov_b32 s54, 39446528
    buffer_load_dwordx4 v246, s[20:23], s54 offen offset:0 sc1 lds
    buffer_load_dwordx4 v246, s[20:23], s54 offen offset:1024 sc1 lds
    buffer_load_dwordx4 v246, s[20:23], s54 offen offset:2048 sc1 lds
    buffer_load_dwordx4 v246, s[20:23], s54 offen offset:3072 sc1 lds
    s_mov_b32 m0, 67584
    s_mov_b32 s54, 39616512
    buffer_load_dwordx4 v246, s[20:23], s54 offen offset:0 sc1 lds
    buffer_load_dwordx4 v246, s[20:23], s54 offen offset:1024 sc1 lds
    buffer_load_dwordx4 v246, s[20:23], s54 offen offset:2048 sc1 lds
    buffer_load_dwordx4 v246, s[20:23], s54 offen offset:3072 sc1 lds
    s_waitcnt vmcnt(8)
    v_mov_b32 v8, 9
    ds_write_b32 v7, v8 offset:1536
    ds_read_b32 v9, v6 offset:1552
    s_waitcnt lgkmcnt(0)
    v_cmp_gt_u32 vcc, 10, v9
    s_cbranch_vccz K2_HD_92
    s_waitcnt vmcnt(0)
    v_mov_b32 v8, 10
    ds_write_b32 v7, v8 offset:1536
    s_mov_b32 s55, 131072
K2_HP_91:
    ds_read_b32 v9, v6 offset:1552
    s_sub_u32 s55, s55, 1
    s_cmp_eq_u32 s55, 0
    s_cbranch_scc1 K2_HD_92
    s_waitcnt lgkmcnt(0)
    v_cmp_gt_u32 vcc, 10, v9
    s_cbranch_vccz K2_HD_92
    s_sleep 1
    s_branch K2_HP_91
K2_HD_92:
    s_mov_b32 m0, 86016
    s_mov_b32 s54, 39845888
    buffer_load_dwordx4 v246, s[20:23], s54 offen offset:0 sc1 lds
    buffer_load_dwordx4 v246, s[20:23], s54 offen offset:1024 sc1 lds
    buffer_load_dwordx4 v246, s[20:23], s54 offen offset:2048 sc1 lds
    buffer_load_dwordx4 v246, s[20:23], s54 offen offset:3072 sc1 lds
    s_mov_b32 m0, 102400
    s_mov_b32 s54, 40022016
    buffer_load_dwordx4 v246, s[20:23], s54 offen offset:0 sc1 lds
    buffer_load_dwordx4 v246, s[20:23], s54 offen offset:1024 sc1 lds
    s_mov_b32 m0, 110592
    s_mov_b32 s54, 40124416
    buffer_load_dwordx4 v245, s[20:23], s54 offen offset:0 sc1 lds
    buffer_load_dwordx4 v245, s[20:23], s54 offen offset:1024 sc1 lds
    buffer_load_dwordx4 v245, s[20:23], s54 offen offset:2048 sc1 lds
    buffer_load_dwordx4 v245, s[20:23], s54 offen offset:3072 sc1 lds
    s_waitcnt vmcnt(10)
    v_mov_b32 v8, 10
    ds_write_b32 v7, v8 offset:1536
    ds_read_b32 v9, v6 offset:1552
    s_waitcnt lgkmcnt(0)
    v_cmp_gt_u32 vcc, 11, v9
    s_cbranch_vccz K2_HD_94
    s_waitcnt vmcnt(0)
    v_mov_b32 v8, 11
    ds_write_b32 v7, v8 offset:1536
    s_mov_b32 s55, 131072
K2_HP_93:
    ds_read_b32 v9, v6 offset:1552
    s_sub_u32 s55, s55, 1
    s_cmp_eq_u32 s55, 0
    s_cbranch_scc1 K2_HD_94
    s_waitcnt lgkmcnt(0)
    v_cmp_gt_u32 vcc, 11, v9
    s_cbranch_vccz K2_HD_94
    s_sleep 1
    s_branch K2_HP_93
K2_HD_94:
    s_mov_b32 m0, 130048
    s_mov_b32 s54, 40189952
    buffer_load_dwordx4 v245, s[20:23], s54 offen offset:0 sc1 lds
    s_mov_b32 m0, 131072
    s_mov_b32 s54, 40267776
    buffer_load_dwordx4 v245, s[20:23], s54 offen offset:0 sc1 lds
    buffer_load_dwordx4 v245, s[20:23], s54 offen offset:1024 sc1 lds
    buffer_load_dwordx4 v245, s[20:23], s54 offen offset:2048 sc1 lds
    buffer_load_dwordx4 v245, s[20:23], s54 offen offset:3072 sc1 lds
    s_waitcnt vmcnt(5)
    v_mov_b32 v8, 11
    ds_write_b32 v7, v8 offset:1536
    ds_read_b32 v9, v6 offset:1552
    s_waitcnt lgkmcnt(0)
    v_cmp_gt_u32 vcc, 12, v9
    s_cbranch_vccz K2_HD_96
    s_waitcnt vmcnt(0)
    v_mov_b32 v8, 12
    ds_write_b32 v7, v8 offset:1536
    s_mov_b32 s55, 131072
K2_HP_95:
    ds_read_b32 v9, v6 offset:1552
    s_sub_u32 s55, s55, 1
    s_cmp_eq_u32 s55, 0
    s_cbranch_scc1 K2_HD_96
    s_waitcnt lgkmcnt(0)
    v_cmp_gt_u32 vcc, 12, v9
    s_cbranch_vccz K2_HD_96
    s_sleep 1
    s_branch K2_HP_95
K2_HD_96:
    s_mov_b32 m0, 149504
    s_mov_b32 s54, 40332288
    buffer_load_dwordx4 v245, s[20:23], s54 offen offset:0 sc1 lds
    buffer_load_dwordx4 v245, s[20:23], s54 offen offset:1024 sc1 lds
    s_mov_b32 m0, 155648
    s_mov_b32 s54, 40415232
    buffer_load_dwordx4 v245, s[20:23], s54 offen offset:0 sc1 lds
    s_mov_b32 m0, 161792
    s_mov_b32 s54, 40452096
    buffer_load_dwordx4 v245, s[20:23], s54 offen offset:0 sc1 lds
    buffer_load_dwordx4 v245, s[20:23], s54 offen offset:1024 sc1 lds
    s_mov_b32 m0, 9216
    s_mov_b32 s54, 40476672
    buffer_load_dwordx4 v245, s[20:23], s54 offen offset:0 sc1 lds
    s_mov_b32 m0, 10240
    s_mov_b32 s54, 40554496
    buffer_load_dwordx4 v245, s[20:23], s54 offen offset:0 sc1 lds
    buffer_load_dwordx4 v245, s[20:23], s54 offen offset:1024 sc1 lds
    buffer_load_dwordx4 v245, s[20:23], s54 offen offset:2048 sc1 lds
    buffer_load_dwordx4 v245, s[20:23], s54 offen offset:3072 sc1 lds
    s_waitcnt vmcnt(10)
    v_mov_b32 v8, 12
    ds_write_b32 v7, v8 offset:1536
    ds_read_b32 v9, v6 offset:1552
    s_waitcnt lgkmcnt(0)
    v_cmp_gt_u32 vcc, 13, v9
    s_cbranch_vccz K2_HD_98
    s_waitcnt vmcnt(0)
    v_mov_b32 v8, 13
    ds_write_b32 v7, v8 offset:1536
    s_mov_b32 s55, 131072
K2_HP_97:
    ds_read_b32 v9, v6 offset:1552
    s_sub_u32 s55, s55, 1
    s_cmp_eq_u32 s55, 0
    s_cbranch_scc1 K2_HD_98
    s_waitcnt lgkmcnt(0)
    v_cmp_gt_u32 vcc, 13, v9
    s_cbranch_vccz K2_HD_98
    s_sleep 1
    s_branch K2_HP_97
K2_HD_98:
    s_mov_b32 m0, 29696
    s_mov_b32 s54, 40620032
    buffer_load_dwordx4 v245, s[20:23], s54 offen offset:0 sc1 lds
    s_mov_b32 m0, 34816
    s_mov_b32 s54, 40701952
    buffer_load_dwordx4 v245, s[20:23], s54 offen offset:0 sc1 lds
    s_mov_b32 m0, 35840
    s_mov_b32 s54, 40718336
    buffer_load_dwordx4 v245, s[20:23], s54 offen offset:0 sc1 lds
    buffer_load_dwordx4 v245, s[20:23], s54 offen offset:1024 sc1 lds
    buffer_load_dwordx4 v245, s[20:23], s54 offen offset:2048 sc1 lds
    buffer_load_dwordx4 v245, s[20:23], s54 offen offset:3072 sc1 lds
    s_waitcnt vmcnt(6)
    v_mov_b32 v8, 13
    ds_write_b32 v7, v8 offset:1536
    ds_read_b32 v9, v6 offset:1552
    s_waitcnt lgkmcnt(0)
    v_cmp_gt_u32 vcc, 14, v9
    s_cbranch_vccz K2_HD_100
    s_waitcnt vmcnt(0)
    v_mov_b32 v8, 14
    ds_write_b32 v7, v8 offset:1536
    s_mov_b32 s55, 131072
K2_HP_99:
    ds_read_b32 v9, v6 offset:1552
    s_sub_u32 s55, s55, 1
    s_cmp_eq_u32 s55, 0
    s_cbranch_scc1 K2_HD_100
    s_waitcnt lgkmcnt(0)
    v_cmp_gt_u32 vcc, 14, v9
    s_cbranch_vccz K2_HD_100
    s_sleep 1
    s_branch K2_HP_99
K2_HD_100:
    s_mov_b32 m0, 51200
    s_mov_b32 s54, 40841216
    buffer_load_dwordx4 v245, s[20:23], s54 offen offset:0 sc1 lds
    buffer_load_dwordx4 v245, s[20:23], s54 offen offset:1024 sc1 lds
    buffer_load_dwordx4 v245, s[20:23], s54 offen offset:2048 sc1 lds
    buffer_load_dwordx4 v245, s[20:23], s54 offen offset:3072 sc1 lds
    s_mov_b32 m0, 70656
    s_mov_b32 s54, 40906752
    buffer_load_dwordx4 v245, s[20:23], s54 offen offset:0 sc1 lds
    s_mov_b32 m0, 71680
    s_mov_b32 s54, 40984576
    buffer_load_dwordx4 v245, s[20:23], s54 offen offset:0 sc1 lds
    buffer_load_dwordx4 v245, s[20:23], s54 offen offset:1024 sc1 lds
    buffer_load_dwordx4 v245, s[20:23], s54 offen offset:2048 sc1 lds
    buffer_load_dwordx4 v245, s[20:23], s54 offen offset:3072 sc1 lds
    s_waitcnt vmcnt(9)
    v_mov_b32 v8, 14
    ds_write_b32 v7, v8 offset:1536
    ds_read_b32 v9, v6 offset:1552
    s_waitcnt lgkmcnt(0)
    v_cmp_gt_u32 vcc, 15, v9
    s_cbranch_vccz K2_HD_102
    s_waitcnt vmcnt(0)
    v_mov_b32 v8, 15
    ds_write_b32 v7, v8 offset:1536
    s_mov_b32 s55, 131072
K2_HP_101:
    ds_read_b32 v9, v6 offset:1552
    s_sub_u32 s55, s55, 1
    s_cmp_eq_u32 s55, 0
    s_cbranch_scc1 K2_HD_102
    s_waitcnt lgkmcnt(0)
    v_cmp_gt_u32 vcc, 15, v9
    s_cbranch_vccz K2_HD_102
    s_sleep 1
    s_branch K2_HP_101
K2_HD_102:
    s_mov_b32 m0, 91136
    s_mov_b32 s54, 41050112
    buffer_load_dwordx4 v245, s[20:23], s54 offen offset:0 sc1 lds
    s_mov_b32 m0, 96256
    s_mov_b32 s54, 41091072
    buffer_load_dwordx4 v245, s[20:23], s54 offen offset:0 sc1 lds
    s_mov_b32 m0, 97280
    s_mov_b32 s54, 41107456
    buffer_load_dwordx4 v245, s[20:23], s54 offen offset:0 sc1 lds
    buffer_load_dwordx4 v245, s[20:23], s54 offen offset:1024 sc1 lds
    buffer_load_dwordx4 v245, s[20:23], s54 offen offset:2048 sc1 lds
    buffer_load_dwordx4 v245, s[20:23], s54 offen offset:3072 sc1 lds
    s_waitcnt vmcnt(6)
    v_mov_b32 v8, 15
    ds_write_b32 v7, v8 offset:1536
    ds_read_b32 v9, v6 offset:1552
    s_waitcnt lgkmcnt(0)
    v_cmp_gt_u32 vcc, 16, v9
    s_cbranch_vccz K2_HD_104
    s_waitcnt vmcnt(0)
    v_mov_b32 v8, 16
    ds_write_b32 v7, v8 offset:1536
    s_mov_b32 s55, 131072
K2_HP_103:
    ds_read_b32 v9, v6 offset:1552
    s_sub_u32 s55, s55, 1
    s_cmp_eq_u32 s55, 0
    s_cbranch_scc1 K2_HD_104
    s_waitcnt lgkmcnt(0)
    v_cmp_gt_u32 vcc, 16, v9
    s_cbranch_vccz K2_HD_104
    s_sleep 1
    s_branch K2_HP_103
K2_HD_104:
    s_mov_b32 m0, 112640
    s_mov_b32 s54, 40206336
    buffer_load_dwordx4 v245, s[20:23], s54 offen offset:0 sc1 lds
    buffer_load_dwordx4 v245, s[20:23], s54 offen offset:1024 sc1 lds
    buffer_load_dwordx4 v245, s[20:23], s54 offen offset:2048 sc1 lds
    buffer_load_dwordx4 v245, s[20:23], s54 offen offset:3072 sc1 lds
    s_mov_b32 m0, 132096
    s_mov_b32 s54, 40353792
    buffer_load_dwordx4 v245, s[20:23], s54 offen offset:0 sc1 lds
    s_mov_b32 m0, 133120
    s_mov_b32 s54, 40370176
    buffer_load_dwordx4 v245, s[20:23], s54 offen offset:0 sc1 lds
    buffer_load_dwordx4 v245, s[20:23], s54 offen offset:1024 sc1 lds
    buffer_load_dwordx4 v245, s[20:23], s54 offen offset:2048 sc1 lds
    buffer_load_dwordx4 v245, s[20:23], s54 offen offset:3072 sc1 lds
    s_waitcnt vmcnt(9)
    v_mov_b32 v8, 16
    ds_write_b32 v7, v8 offset:1536
    ds_read_b32 v9, v6 offset:1552
    s_waitcnt lgkmcnt(0)
    v_cmp_gt_u32 vcc, 17, v9
    s_cbranch_vccz K2_HD_106
    s_waitcnt vmcnt(0)
    v_mov_b32 v8, 17
    ds_write_b32 v7, v8 offset:1536
    s_mov_b32 s55, 131072
K2_HP_105:
    ds_read_b32 v9, v6 offset:1552
    s_sub_u32 s55, s55, 1
    s_cmp_eq_u32 s55, 0
    s_cbranch_scc1 K2_HD_106
    s_waitcnt lgkmcnt(0)
    v_cmp_gt_u32 vcc, 17, v9
    s_cbranch_vccz K2_HD_106
    s_sleep 1
    s_branch K2_HP_105
K2_HD_106:
    s_mov_b32 m0, 152576
    s_mov_b32 s54, 40517632
    buffer_load_dwordx4 v245, s[20:23], s54 offen offset:0 sc1 lds
    s_mov_b32 m0, 157696
    s_mov_b32 s54, 40538112
    buffer_load_dwordx4 v245, s[20:23], s54 offen offset:0 sc1 lds
    s_mov_b32 m0, 158720
    s_mov_b32 s54, 40636416
    buffer_load_dwordx4 v245, s[20:23], s54 offen offset:0 sc1 lds
    buffer_load_dwordx4 v245, s[20:23], s54 offen offset:1024 sc1 lds
    buffer_load_dwordx4 v245, s[20:23], s54 offen offset:2048 sc1 lds
    buffer_load_dwordx4 v245, s[20:23], s54 offen offset:3072 sc1 lds
    s_waitcnt vmcnt(6)
    v_mov_b32 v8, 17
    ds_write_b32 v7, v8 offset:1536
    ds_read_b32 v9, v6 offset:1552
    s_waitcnt lgkmcnt(0)
    v_cmp_gt_u32 vcc, 18, v9
    s_cbranch_vccz K2_HD_108
    s_waitcnt vmcnt(0)
    v_mov_b32 v8, 18
    ds_write_b32 v7, v8 offset:1536
    s_mov_b32 s55, 131072
K2_HP_107:
    ds_read_b32 v9, v6 offset:1552
    s_sub_u32 s55, s55, 1
    s_cmp_eq_u32 s55, 0
    s_cbranch_scc1 K2_HD_108
    s_waitcnt lgkmcnt(0)
    v_cmp_gt_u32 vcc, 18, v9
    s_cbranch_vccz K2_HD_108
    s_sleep 1
    s_branch K2_HP_107
K2_HD_108:
    s_mov_b32 m0, 12288
    s_mov_b32 s54, 40779776
    buffer_load_dwordx4 v245, s[20:23], s54 offen offset:0 sc1 lds
    buffer_load_dwordx4 v245, s[20:23], s54 offen offset:1024 sc1 lds
    buffer_load_dwordx4 v245, s[20:23], s54 offen offset:2048 sc1 lds
    buffer_load_dwordx4 v245, s[20:23], s54 offen offset:3072 sc1 lds
    s_mov_b32 m0, 31744
    s_mov_b32 s54, 40927232
    buffer_load_dwordx4 v245, s[20:23], s54 offen offset:0 sc1 lds
    s_mov_b32 m0, 32768
    s_mov_b32 s54, 40943616
    buffer_load_dwordx4 v245, s[20:23], s54 offen offset:0 sc1 lds
    buffer_load_dwordx4 v245, s[20:23], s54 offen offset:1024 sc1 lds
    buffer_load_dwordx4 v245, s[20:23], s54 offen offset:2048 sc1 lds
    buffer_load_dwordx4 v245, s[20:23], s54 offen offset:3072 sc1 lds
    s_waitcnt vmcnt(9)
    v_mov_b32 v8, 18
    ds_write_b32 v7, v8 offset:1536
    ds_read_b32 v9, v6 offset:1552
    s_waitcnt lgkmcnt(0)
    v_cmp_gt_u32 vcc, 19, v9
    s_cbranch_vccz K2_HD_110
    s_waitcnt vmcnt(0)
    v_mov_b32 v8, 19
    ds_write_b32 v7, v8 offset:1536
    s_mov_b32 s55, 131072
K2_HP_109:
    ds_read_b32 v9, v6 offset:1552
    s_sub_u32 s55, s55, 1
    s_cmp_eq_u32 s55, 0
    s_cbranch_scc1 K2_HD_110
    s_waitcnt lgkmcnt(0)
    v_cmp_gt_u32 vcc, 19, v9
    s_cbranch_vccz K2_HD_110
    s_sleep 1
    s_branch K2_HP_109
K2_HD_110:
    s_mov_b32 m0, 52224
    s_mov_b32 s54, 41172992
    buffer_load_dwordx4 v245, s[20:23], s54 offen offset:0 sc1 lds
    s_mov_b32 m0, 57344
    s_mov_b32 s54, 41193472
    buffer_load_dwordx4 v245, s[20:23], s54 offen offset:0 sc1 lds
    s_mov_b32 m0, 58368
    s_mov_b32 s54, 41209856
    buffer_load_dwordx4 v245, s[20:23], s54 offen offset:0 sc1 lds
    buffer_load_dwordx4 v245, s[20:23], s54 offen offset:1024 sc1 lds
    buffer_load_dwordx4 v245, s[20:23], s54 offen offset:2048 sc1 lds
    buffer_load_dwordx4 v245, s[20:23], s54 offen offset:3072 sc1 lds
    s_waitcnt vmcnt(6)
    v_mov_b32 v8, 19
    ds_write_b32 v7, v8 offset:1536
    s_waitcnt vmcnt(0)
    v_mov_b32 v8, 20
    ds_write_b32 v7, v8 offset:1536
    s_endpgm
K2_H1:
    s_mov_b32 s54, 38649856
    buffer_load_dwordx4 v[16:19], v245, s[20:23], s54 offen offset:2048 sc1
    buffer_load_dwordx4 v[20:23], v245, s[20:23], s54 offen offset:3072 sc1
    s_mov_b32 s54, 38690816
    buffer_load_dwordx4 v[24:27], v245, s[20:23], s54 offen offset:0 sc1
    buffer_load_dwordx4 v[28:31], v245, s[20:23], s54 offen offset:1024 sc1
    s_mov_b32 s54, 38731776
    buffer_load_dwordx4 v[32:35], v245, s[20:23], s54 offen offset:3072 sc1
    s_mov_b32 s54, 38735872
    buffer_load_dwordx4 v[36:39], v245, s[20:23], s54 offen offset:0 sc1
    s_mov_b32 s54, 38772736
    buffer_load_dwordx4 v[40:43], v245, s[20:23], s54 offen offset:1024 sc1
    buffer_load_dwordx4 v[44:47], v245, s[20:23], s54 offen offset:2048 sc1
    s_mov_b32 s54, 38797312
    buffer_load_dwordx4 v[48:51], v245, s[20:23], s54 offen offset:0 sc1
    s_mov_b32 s54, 38834176
    buffer_load_dwordx4 v[52:55], v245, s[20:23], s54 offen offset:0 sc1
    s_mov_b32 s54, 38854656
    buffer_load_dwordx4 v[56:59], v245, s[20:23], s54 offen offset:2048 sc1
    buffer_load_dwordx4 v[60:63], v245, s[20:23], s54 offen offset:3072 sc1
    s_mov_b32 s54, 38895616
    buffer_load_dwordx4 v[64:67], v245, s[20:23], s54 offen offset:0 sc1
    buffer_load_dwordx4 v[68:71], v245, s[20:23], s54 offen offset:1024 sc1
    s_mov_b32 s54, 38936576
    buffer_load_dwordx4 v[72:75], v245, s[20:23], s54 offen offset:3072 sc1
    s_mov_b32 s54, 38940672
    buffer_load_dwordx4 v[76:79], v245, s[20:23], s54 offen offset:0 sc1
    s_mov_b32 s54, 39092224
    buffer_load_dwordx4 v[80:83], v246, s[20:23], s54 offen offset:1024 sc1
    buffer_load_dwordx4 v[84:87], v246, s[20:23], s54 offen offset:2048 sc1
    s_mov_b32 s54, 39378944
    buffer_load_dwordx4 v[88:91], v246, s[20:23], s54 offen offset:1024 sc1
    buffer_load_dwordx4 v[92:95], v246, s[20:23], s54 offen offset:2048 sc1
    s_mov_b32 s54, 39665664
    buffer_load_dwordx4 v[96:99], v246, s[20:23], s54 offen offset:1024 sc1
    buffer_load_dwordx4 v[100:103], v246, s[20:23], s54 offen offset:2048 sc1
    s_mov_b32 s54, 39952384
    buffer_load_dwordx4 v[104:107], v246, s[20:23], s54 offen offset:1024 sc1
    buffer_load_dwordx4 v[108:111], v246, s[20:23], s54 offen offset:2048 sc1
    s_mov_b32 s54, 38977536
    buffer_load_dwordx4 v[112:115], v246, s[20:23], s54 offen offset:1024 sc1
    buffer_load_dwordx4 v[116:119], v246, s[20:23], s54 offen offset:2048 sc1
    s_mov_b32 s54, 39034880
    buffer_load_dwordx4 v[120:123], v246, s[20:23], s54 offen offset:1024 sc1
    buffer_load_dwordx4 v[124:127], v246, s[20:23], s54 offen offset:2048 sc1
    s_mov_b32 s54, 39149568
    buffer_load_dwordx4 v[128:131], v246, s[20:23], s54 offen offset:1024 sc1
    buffer_load_dwordx4 v[132:135], v246, s[20:23], s54 offen offset:2048 sc1
    s_mov_b32 s54, 39206912
    buffer_load_dwordx4 v[136:139], v246, s[20:23], s54 offen offset:1024 sc1
    buffer_load_dwordx4 v[140:143], v246, s[20:23], s54 offen offset:2048 sc1
    s_mov_b32 s55, 131072
K2_HP_111:
    ds_read_b32 v9, v6 offset:1552
    s_sub_u32 s55, s55, 1
    s_cmp_eq_u32 s55, 0
    s_cbranch_scc1 K2_HD_112
    s_waitcnt lgkmcnt(0)
    v_cmp_gt_u32 vcc, 2, v9
    s_cbranch_vccz K2_HD_112
    s_sleep 1
    s_branch K2_HP_111
K2_HD_112:
    ds_write_b128 v12, v[152:155] offset:2048
    ds_write_b128 v12, v[156:159] offset:3072
    ds_write_b128 v12, v[160:163] offset:4096
    ds_write_b128 v12, v[164:167] offset:5120
    ds_write_b128 v12, v[168:171] offset:6144
    ds_write_b128 v12, v[172:175] offset:22528
    ds_write_b128 v12, v[176:179] offset:23552
    ds_write_b128 v12, v[180:183] offset:24576
    ds_write_b128 v12, v[184:187] offset:25600
    ds_write_b128 v12, v[188:191] offset:26624
    v_mov_b32 v8, 3
    ds_write_b32 v7, v8 offset:1536
    ds_write_b128 v12, v[192:195] offset:43008
    ds_write_b128 v12, v[196:199] offset:44032
    ds_write_b128 v12, v[200:203] offset:45056
    ds_write_b128 v12, v[204:207] offset:46080
    ds_write_b128 v12, v[208:211] offset:47104
    ds_write_b128 v12, v[212:215] offset:63488
    ds_write_b128 v12, v[216:219] offset:64512
    ds_write_b128 v13, v[220:223] offset:0
    ds_write_b128 v13, v[224:227] offset:1024
    ds_write_b128 v13, v[228:231] offset:2048
    s_waitcnt vmcnt(31)
    ds_write_b128 v13, v[16:19] offset:15360
    s_waitcnt vmcnt(30)
    ds_write_b128 v13, v[20:23] offset:16384
    s_waitcnt vmcnt(29)
    ds_write_b128 v13, v[24:27] offset:23552
    s_waitcnt vmcnt(28)
    ds_write_b128 v13, v[28:31] offset:24576
    s_waitcnt vmcnt(27)
    ds_write_b128 v13, v[32:35] offset:31744
    s_waitcnt vmcnt(26)
    ds_write_b128 v13, v[36:39] offset:32768
    v_mov_b32 v8, 4
    ds_write_b32 v7, v8 offset:1536
    s_mov_b32 s55, 131072
K2_HP_113:
    ds_read_b32 v9, v6 offset:1552
    s_sub_u32 s55, s55, 1
    s_cmp_eq_u32 s55, 0
    s_cbranch_scc1 K2_HD_114
    s_waitcnt lgkmcnt(0)
    v_cmp_gt_u32 vcc, 3, v9
    s_cbranch_vccz K2_HD_114
    s_sleep 1
    s_branch K2_HP_113
K2_HD_114:
    s_mov_b32 s54, 39264256
    buffer_load_dwordx4 v[144:147], v246, s[20:23], s54 offen offset:1024 sc1
    buffer_load_dwordx4 v[152:155], v246, s[20:23], s54 offen offset:2048 sc1
    s_mov_b32 s54, 39321600
    buffer_load_dwordx4 v[156:159], v246, s[20:23], s54 offen offset:1024 sc1
    buffer_load_dwordx4 v[160:163], v246, s[20:23], s54 offen offset:2048 sc1
    s_mov_b32 s54, 39436288
    buffer_load_dwordx4 v[164:167], v246, s[20:23], s54 offen offset:1024 sc1
    buffer_load_dwordx4 v[168:171], v246, s[20:23], s54 offen offset:2048 sc1
    s_mov_b32 s54, 39493632
    buffer_load_dwordx4 v[172:175], v246, s[20:23], s54 offen offset:1024 sc1
    buffer_load_dwordx4 v[176:179], v246, s[20:23], s54 offen offset:2048 sc1
    s_mov_b32 s54, 39550976
    buffer_load_dwordx4 v[180:183], v246, s[20:23], s54 offen offset:1024 sc1
    buffer_load_dwordx4 v[184:187], v246, s[20:23], s54 offen offset:2048 sc1
    s_mov_b32 s54, 39608320
    buffer_load_dwordx4 v[188:191], v246, s[20:23], s54 offen offset:1024 sc1
    buffer_load_dwordx4 v[192:195], v246, s[20:23], s54 offen offset:2048 sc1
    s_mov_b32 s54, 39723008
    buffer_load_dwordx4 v[196:199], v246, s[20:23], s54 offen offset:1024 sc1
    buffer_load_dwordx4 v[200:203], v246, s[20:23], s54 offen offset:2048 sc1
    s_mov_b32 s54, 39780352
    buffer_load_dwordx4 v[204:207], v246, s[20:23], s54 offen offset:1024 sc1
    buffer_load_dwordx4 v[208:211], v246, s[20:23], s54 offen offset:2048 sc1
    s_mov_b32 s54, 39837696
    buffer_load_dwordx4 v[212:215], v246, s[20:23], s54 offen offset:1024 sc1
    buffer_load_dwordx4 v[216:219], v246, s[20:23], s54 offen offset:2048 sc1
    s_mov_b32 s54, 39895040
    buffer_load_dwordx4 v[220:223], v246, s[20:23], s54 offen offset:1024 sc1
    buffer_load_dwordx4 v[224:227], v246, s[20:23], s54 offen offset:2048 sc1
    s_mov_b32 s54, 40009728
    buffer_load_dwordx4 v[228:231], v246, s[20:23], s54 offen offset:1024 sc1
    buffer_load_dwordx4 v[16:19], v246, s[20:23], s54 offen offset:2048 sc1
    s_mov_b32 s54, 40067072
    buffer_load_dwordx4 v[20:23], v246, s[20:23], s54 offen offset:1024 sc1
    buffer_load_dwordx4 v[24:27], v246, s[20:23], s54 offen offset:2048 sc1
    s_mov_b32 s55, 131072
K2_HP_115:
    ds_read_b32 v9, v6 offset:1552
    s_sub_u32 s55, s55, 1
    s_cmp_eq_u32 s55, 0
    s_cbranch_scc1 K2_HD_116
    s_waitcnt lgkmcnt(0)
    v_cmp_gt_u32 vcc, 4, v9
    s_cbranch_vccz K2_HD_116
    s_sleep 1
    s_branch K2_HP_115
K2_HD_116:
    s_waitcnt vmcnt(49)
    ds_write_b128 v13, v[40:43] offset:39936
    s_waitcnt vmcnt(48)
    ds_write_b128 v13, v[44:47] offset:40960
    s_waitcnt vmcnt(47)
    ds_write_b128 v13, v[48:51] offset:48128
    s_waitcnt vmcnt(46)
    ds_write_b128 v13, v[52:55] offset:49152
    s_waitcnt vmcnt(45)
    ds_write_b128 v13, v[56:59] offset:56320
    s_waitcnt vmcnt(44)
    ds_write_b128 v13, v[60:63] offset:57344
    s_waitcnt vmcnt(43)
    ds_write_b128 v13, v[64:67] offset:64512
    s_waitcnt vmcnt(42)
    ds_write_b128 v14, v[68:71] offset:0
    s_waitcnt vmcnt(41)
    ds_write_b128 v14, v[72:75] offset:7168
    s_waitcnt vmcnt(40)
    ds_write_b128 v14, v[76:79] offset:8192
    v_mov_b32 v8, 5
    ds_write_b32 v7, v8 offset:1536
    s_waitcnt vmcnt(39)
    ds_write_b128 v14, v[80:83] offset:15360
    s_waitcnt vmcnt(38)
    ds_write_b128 v14, v[84:87] offset:16384
    s_waitcnt vmcnt(37)
    ds_write_b128 v14, v[88:91] offset:23552
    s_waitcnt vmcnt(36)
    ds_write_b128 v14, v[92:95] offset:24576
    s_waitcnt vmcnt(35)
    ds_write_b128 v12, v[96:99] offset:1024
    s_waitcnt vmcnt(34)
    ds_write_b128 v12, v[100:103] offset:2048
    s_waitcnt vmcnt(33)
    ds_write_b128 v12, v[104:107] offset:9216
    s_waitcnt vmcnt(32)
    ds_write_b128 v12, v[108:111] offset:10240
    s_waitcnt vmcnt(31)
    ds_write_b128 v12, v[112:115] offset:17408
    s_waitcnt vmcnt(30)
    ds_write_b128 v12, v[116:119] offset:18432
    s_waitcnt vmcnt(29)
    ds_write_b128 v12, v[120:123] offset:25600
    s_waitcnt vmcnt(28)
    ds_write_b128 v12, v[124:127] offset:26624
    s_waitcnt vmcnt(27)
    ds_write_b128 v12, v[128:131] offset:33792
    s_waitcnt vmcnt(26)
    ds_write_b128 v12, v[132:135] offset:34816
    s_waitcnt vmcnt(25)
    ds_write_b128 v12, v[136:139] offset:41984
    v_mov_b32 v8, 6
    ds_write_b32 v7, v8 offset:1536
    s_mov_b32 s55, 131072
K2_HP_117:
    ds_read_b32 v9, v6 offset:1552
    s_sub_u32 s55, s55, 1
    s_cmp_eq_u32 s55, 0
    s_cbranch_scc1 K2_HD_118
    s_waitcnt lgkmcnt(0)
    v_cmp_gt_u32 vcc, 6, v9
    s_cbranch_vccz K2_HD_118
    s_sleep 1
    s_branch K2_HP_117
K2_HD_118:
    s_waitcnt vmcnt(24)
    ds_write_b128 v12, v[140:143] offset:43008
    s_waitcnt vmcnt(23)
    ds_write_b128 v12, v[144:147] offset:50176
    s_waitcnt vmcnt(22)
    ds_write_b128 v12, v[152:155] offset:51200
    s_waitcnt vmcnt(21)
    ds_write_b128 v12, v[156:159] offset:58368
    s_waitcnt vmcnt(20)
    ds_write_b128 v12, v[160:163] offset:59392
    s_waitcnt vmcnt(19)
    ds_write_b128 v13, v[164:167] offset:1024
    s_waitcnt vmcnt(18)
    ds_write_b128 v13, v[168:171] offset:2048
    s_waitcnt vmcnt(17)
    ds_write_b128 v13, v[172:175] offset:9216
    s_waitcnt vmcnt(16)
    ds_write_b128 v13, v[176:179] offset:10240
    s_waitcnt vmcnt(15)
    ds_write_b128 v13, v[180:183] offset:17408
    s_waitcnt vmcnt(14)
    ds_write_b128 v13, v[184:187] offset:18432
    s_waitcnt vmcnt(13)
    ds_write_b128 v13, v[188:191] offset:25600
    s_waitcnt vmcnt(12)
    ds_write_b128 v13, v[192:195] offset:26624
    s_waitcnt vmcnt(11)
    ds_write_b128 v13, v[196:199] offset:33792
    s_waitcnt vmcnt(10)
    ds_write_b128 v13, v[200:203] offset:34816
    s_waitcnt vmcnt(9)
    ds_write_b128 v13, v[204:207] offset:41984
    s_waitcnt vmcnt(8)
    ds_write_b128 v13, v[208:211] offset:43008
    s_waitcnt vmcnt(7)
    ds_write_b128 v13, v[212:215] offset:50176
    s_waitcnt vmcnt(6)
    ds_write_b128 v13, v[216:219] offset:51200
    s_waitcnt vmcnt(5)
    ds_write_b128 v13, v[220:223] offset:58368
    s_waitcnt vmcnt(4)
    ds_write_b128 v13, v[224:227] offset:59392
    s_waitcnt vmcnt(3)
    ds_write_b128 v14, v[228:231] offset:1024
    s_waitcnt vmcnt(2)
    ds_write_b128 v14, v[16:19] offset:2048
    s_waitcnt vmcnt(1)
    ds_write_b128 v14, v[20:23] offset:9216
    s_waitcnt vmcnt(0)
    ds_write_b128 v14, v[24:27] offset:10240
    v_mov_b32 v8, 7
    ds_write_b32 v7, v8 offset:1536
    ds_read_b32 v9, v6 offset:1552
    s_waitcnt lgkmcnt(0)
    v_cmp_gt_u32 vcc, 7, v9
    s_cbranch_vccz K2_HD_120
    s_mov_b32 s55, 131072
K2_HP_119:
    ds_read_b32 v9, v6 offset:1552
    s_sub_u32 s55, s55, 1
    s_cmp_eq_u32 s55, 0
    s_cbranch_scc1 K2_HD_120
    s_waitcnt lgkmcnt(0)
    v_cmp_gt_u32 vcc, 7, v9
    s_cbranch_vccz K2_HD_120
    s_sleep 1
    s_branch K2_HP_119
K2_HD_120:
    s_mov_b32 m0, 149504
    s_mov_b32 s54, 39100416
    buffer_load_dwordx4 v246, s[20:23], s54 offen offset:0 sc1 lds
    buffer_load_dwordx4 v246, s[20:23], s54 offen offset:1024 sc1 lds
    buffer_load_dwordx4 v246, s[20:23], s54 offen offset:2048 sc1 lds
    buffer_load_dwordx4 v246, s[20:23], s54 offen offset:3072 sc1 lds
    s_mov_b32 m0, 6144
    s_mov_b32 s54, 39960576
    buffer_load_dwordx4 v246, s[20:23], s54 offen offset:0 sc1 lds
    buffer_load_dwordx4 v246, s[20:23], s54 offen offset:1024 sc1 lds
    buffer_load_dwordx4 v246, s[20:23], s54 offen offset:2048 sc1 lds
    buffer_load_dwordx4 v246, s[20:23], s54 offen offset:3072 sc1 lds
    ds_read_b32 v9, v6 offset:1552
    s_waitcnt lgkmcnt(0)
    v_cmp_gt_u32 vcc, 8, v9
    s_cbranch_vccz K2_HD_122
    s_waitcnt vmcnt(0)
    v_mov_b32 v8, 8
    ds_write_b32 v7, v8 offset:1536
    s_mov_b32 s55, 131072
K2_HP_121:
    ds_read_b32 v9, v6 offset:1552
    s_sub_u32 s55, s55, 1
    s_cmp_eq_u32 s55, 0
    s_cbranch_scc1 K2_HD_122
    s_waitcnt lgkmcnt(0)
    v_cmp_gt_u32 vcc, 8, v9
    s_cbranch_vccz K2_HD_122
    s_sleep 1
    s_branch K2_HP_121
K2_HD_122:
    s_mov_b32 m0, 22528
    s_mov_b32 s54, 39047168
    buffer_load_dwordx4 v246, s[20:23], s54 offen offset:0 sc1 lds
    buffer_load_dwordx4 v246, s[20:23], s54 offen offset:1024 sc1 lds
    s_mov_b32 m0, 30720
    s_mov_b32 s54, 39215104
    buffer_load_dwordx4 v246, s[20:23], s54 offen offset:0 sc1 lds
    buffer_load_dwordx4 v246, s[20:23], s54 offen offset:1024 sc1 lds
    buffer_load_dwordx4 v246, s[20:23], s54 offen offset:2048 sc1 lds
    buffer_load_dwordx4 v246, s[20:23], s54 offen offset:3072 sc1 lds
    s_mov_b32 m0, 47104
    s_mov_b32 s54, 39333888
    buffer_load_dwordx4 v246, s[20:23], s54 offen offset:0 sc1 lds
    buffer_load_dwordx4 v246, s[20:23], s54 offen offset:1024 sc1 lds
    s_waitcnt vmcnt(8)
    v_mov_b32 v8, 8
    ds_write_b32 v7, v8 offset:1536
    ds_read_b32 v9, v6 offset:1552
    s_waitcnt lgkmcnt(0)
    v_cmp_gt_u32 vcc, 9, v9
    s_cbranch_vccz K2_HD_124
    s_waitcnt vmcnt(0)
    v_mov_b32 v8, 9
    ds_write_b32 v7, v8 offset:1536
    s_mov_b32 s55, 131072
K2_HP_123:
    ds_read_b32 v9, v6 offset:1552
    s_sub_u32 s55, s55, 1
    s_cmp_eq_u32 s55, 0
    s_cbranch_scc1 K2_HD_124
    s_waitcnt lgkmcnt(0)
    v_cmp_gt_u32 vcc, 9, v9
    s_cbranch_vccz K2_HD_124
    s_sleep 1
    s_branch K2_HP_123
K2_HD_124:
    s_mov_b32 m0, 55296
    s_mov_b32 s54, 39501824
    buffer_load_dwordx4 v246, s[20:23], s54 offen offset:0 sc1 lds
    buffer_load_dwordx4 v246, s[20:23], s54 offen offset:1024 sc1 lds
    buffer_load_dwordx4 v246, s[20:23], s54 offen offset:2048 sc1 lds
    buffer_load_dwordx4 v246, s[20:23], s54 offen offset:3072 sc1 lds
    s_mov_b32 m0, 71680
    s_mov_b32 s54, 39620608
    buffer_load_dwordx4 v246, s[20:23], s54 offen offset:0 sc1 lds
    buffer_load_dwordx4 v246, s[20:23], s54 offen offset:1024 sc1 lds
    s_mov_b32 m0, 79872
    s_mov_b32 s54, 39788544
    buffer_load_dwordx4 v246, s[20:23], s54 offen offset:0 sc1 lds
    buffer_load_dwordx4 v246, s[20:23], s54 offen offset:1024 sc1 lds
    buffer_load_dwordx4 v246, s[20:23], s54 offen offset:2048 sc1 lds
    buffer_load_dwordx4 v246, s[20:23], s54 offen offset:3072 sc1 lds
    s_waitcnt vmcnt(10)
    v_mov_b32 v8, 9
    ds_write_b32 v7, v8 offset:1536
    ds_read_b32 v9, v6 offset:1552
    s_waitcnt lgkmcnt(0)
    v_cmp_gt_u32 vcc, 10, v9
    s_cbranch_vccz K2_HD_126
    s_waitcnt vmcnt(0)
    v_mov_b32 v8, 10
    ds_write_b32 v7, v8 offset:1536
    s_mov_b32 s55, 131072
K2_HP_125:
    ds_read_b32 v9, v6 offset:1552
    s_sub_u32 s55, s55, 1
    s_cmp_eq_u32 s55, 0
    s_cbranch_scc1 K2_HD_126
    s_waitcnt lgkmcnt(0)
    v_cmp_gt_u32 vcc, 10, v9
    s_cbranch_vccz K2_HD_126
    s_sleep 1
    s_branch K2_HP_125
K2_HD_126:
    s_mov_b32 m0, 96256
    s_mov_b32 s54, 39907328
    buffer_load_dwordx4 v246, s[20:23], s54 offen offset:0 sc1 lds
    buffer_load_dwordx4 v246, s[20:23], s54 offen offset:1024 sc1 lds
    s_mov_b32 m0, 104448
    s_mov_b32 s54, 40075264
    buffer_load_dwordx4 v246, s[20:23], s54 offen offset:0 sc1 lds
    buffer_load_dwordx4 v246, s[20:23], s54 offen offset:1024 sc1 lds
    buffer_load_dwordx4 v246, s[20:23], s54 offen offset:2048 sc1 lds
    buffer_load_dwordx4 v246, s[20:23], s54 offen offset:3072 sc1 lds
    s_waitcnt vmcnt(6)
    v_mov_b32 v8, 10
    ds_write_b32 v7, v8 offset:1536
    ds_read_b32 v9, v6 offset:1552
    s_waitcnt lgkmcnt(0)
    v_cmp_gt_u32 vcc, 11, v9
    s_cbranch_vccz K2_HD_128
    s_waitcnt vmcnt(0)
    v_mov_b32 v8, 11
    ds_write_b32 v7, v8 offset:1536
    s_mov_b32 s55, 131072
K2_HP_127:
    ds_read_b32 v9, v6 offset:1552
    s_sub_u32 s55, s55, 1
    s_cmp_eq_u32 s55, 0
    s_cbranch_scc1 K2_HD_128
    s_waitcnt lgkmcnt(0)
    v_cmp_gt_u32 vcc, 11, v9
    s_cbranch_vccz K2_HD_128
    s_sleep 1
    s_branch K2_HP_127
K2_HD_128:
    s_mov_b32 m0, 124928
    s_mov_b32 s54, 40169472
    buffer_load_dwordx4 v245, s[20:23], s54 offen offset:0 sc1 lds
    s_mov_b32 m0, 125952
    s_mov_b32 s54, 40185856
    buffer_load_dwordx4 v245, s[20:23], s54 offen offset:0 sc1 lds
    buffer_load_dwordx4 v245, s[20:23], s54 offen offset:1024 sc1 lds
    buffer_load_dwordx4 v245, s[20:23], s54 offen offset:2048 sc1 lds
    buffer_load_dwordx4 v245, s[20:23], s54 offen offset:3072 sc1 lds
    s_mov_b32 m0, 141312
    s_mov_b32 s54, 40308736
    buffer_load_dwordx4 v245, s[20:23], s54 offen offset:0 sc1 lds
    buffer_load_dwordx4 v245, s[20:23], s54 offen offset:1024 sc1 lds
    buffer_load_dwordx4 v245, s[20:23], s54 offen offset:2048 sc1 lds
    buffer_load_dwordx4 v245, s[20:23], s54 offen offset:3072 sc1 lds
    s_waitcnt vmcnt(9)
    v_mov_b32 v8, 11
    ds_write_b32 v7, v8 offset:1536
    ds_read_b32 v9, v6 offset:1552
    s_waitcnt lgkmcnt(0)
    v_cmp_gt_u32 vcc, 12, v9
    s_cbranch_vccz K2_HD_130
    s_waitcnt vmcnt(0)
    v_mov_b32 v8, 12
    ds_write_b32 v7, v8 offset:1536
    s_mov_b32 s55, 131072
K2_HP_129:
    ds_read_b32 v9, v6 offset:1552
    s_sub_u32 s55, s55, 1
    s_cmp_eq_u32 s55, 0
    s_cbranch_scc1 K2_HD_130
    s_waitcnt lgkmcnt(0)
    v_cmp_gt_u32 vcc, 12, v9
    s_cbranch_vccz K2_HD_130
    s_sleep 1
    s_branch K2_HP_129
K2_HD_130:
    s_mov_b32 m0, 156672
    s_mov_b32 s54, 40431616
    buffer_load_dwordx4 v245, s[20:23], s54 offen offset:0 sc1 lds
    buffer_load_dwordx4 v245, s[20:23], s54 offen offset:1024 sc1 lds
    buffer_load_dwordx4 v245, s[20:23], s54 offen offset:2048 sc1 lds
    buffer_load_dwordx4 v245, s[20:23], s54 offen offset:3072 sc1 lds
    s_mov_b32 m0, 14336
    s_mov_b32 s54, 40558592
    buffer_load_dwordx4 v245, s[20:23], s54 offen offset:0 sc1 lds
    s_waitcnt vmcnt(5)
    v_mov_b32 v8, 12
    ds_write_b32 v7, v8 offset:1536
    ds_read_b32 v9, v6 offset:1552
    s_waitcnt lgkmcnt(0)
    v_cmp_gt_u32 vcc, 13, v9
    s_cbranch_vccz K2_HD_132
    s_waitcnt vmcnt(0)
    v_mov_b32 v8, 13
    ds_write_b32 v7, v8 offset:1536
    s_mov_b32 s55, 131072
K2_HP_131:
    ds_read_b32 v9, v6 offset:1552
    s_sub_u32 s55, s55, 1
    s_cmp_eq_u32 s55, 0
    s_cbranch_scc1 K2_HD_132
    s_waitcnt lgkmcnt(0)
    v_cmp_gt_u32 vcc, 13, v9
    s_cbranch_vccz K2_HD_132
    s_sleep 1
    s_branch K2_HP_131
K2_HD_132:
    s_mov_b32 m0, 18432
    s_mov_b32 s54, 40578048
    buffer_load_dwordx4 v245, s[20:23], s54 offen offset:0 sc1 lds
    buffer_load_dwordx4 v245, s[20:23], s54 offen offset:1024 sc1 lds
    s_mov_b32 m0, 24576
    s_mov_b32 s54, 40599552
    buffer_load_dwordx4 v245, s[20:23], s54 offen offset:0 sc1 lds
    s_mov_b32 m0, 30720
    s_mov_b32 s54, 40697856
    buffer_load_dwordx4 v245, s[20:23], s54 offen offset:0 sc1 lds
    buffer_load_dwordx4 v245, s[20:23], s54 offen offset:1024 sc1 lds
    buffer_load_dwordx4 v245, s[20:23], s54 offen offset:2048 sc1 lds
    buffer_load_dwordx4 v245, s[20:23], s54 offen offset:3072 sc1 lds
    s_mov_b32 m0, 46080
    s_mov_b32 s54, 40759296
    buffer_load_dwordx4 v245, s[20:23], s54 offen offset:0 sc1 lds
    buffer_load_dwordx4 v245, s[20:23], s54 offen offset:1024 sc1 lds
    buffer_load_dwordx4 v245, s[20:23], s54 offen offset:2048 sc1 lds
    s_waitcnt vmcnt(10)
    v_mov_b32 v8, 13
    ds_write_b32 v7, v8 offset:1536
    ds_read_b32 v9, v6 offset:1552
    s_waitcnt lgkmcnt(0)
    v_cmp_gt_u32 vcc, 14, v9
    s_cbranch_vccz K2_HD_134
    s_waitcnt vmcnt(0)
    v_mov_b32 v8, 14
    ds_write_b32 v7, v8 offset:1536
    s_mov_b32 s55, 131072
K2_HP_133:
    ds_read_b32 v9, v6 offset:1552
    s_sub_u32 s55, s55, 1
    s_cmp_eq_u32 s55, 0
    s_cbranch_scc1 K2_HD_134
    s_waitcnt lgkmcnt(0)
    v_cmp_gt_u32 vcc, 14, v9
    s_cbranch_vccz K2_HD_134
    s_sleep 1
    s_branch K2_HP_133
K2_HD_134:
    s_mov_b32 m0, 56320
    s_mov_b32 s54, 40861696
    buffer_load_dwordx4 v245, s[20:23], s54 offen offset:0 sc1 lds
    buffer_load_dwordx4 v245, s[20:23], s54 offen offset:1024 sc1 lds
    buffer_load_dwordx4 v245, s[20:23], s54 offen offset:2048 sc1 lds
    buffer_load_dwordx4 v245, s[20:23], s54 offen offset:3072 sc1 lds
    s_mov_b32 m0, 75776
    s_mov_b32 s54, 40988672
    buffer_load_dwordx4 v245, s[20:23], s54 offen offset:0 sc1 lds
    s_waitcnt vmcnt(5)
    v_mov_b32 v8, 14
    ds_write_b32 v7, v8 offset:1536
    ds_read_b32 v9, v6 offset:1552
    s_waitcnt lgkmcnt(0)
    v_cmp_gt_u32 vcc, 15, v9
    s_cbranch_vccz K2_HD_136
    s_waitcnt vmcnt(0)
    v_mov_b32 v8, 15
    ds_write_b32 v7, v8 offset:1536
    s_mov_b32 s55, 131072
K2_HP_135:
    ds_read_b32 v9, v6 offset:1552
    s_sub_u32 s55, s55, 1
    s_cmp_eq_u32 s55, 0
    s_cbranch_scc1 K2_HD_136
    s_waitcnt lgkmcnt(0)
    v_cmp_gt_u32 vcc, 15, v9
    s_cbranch_vccz K2_HD_136
    s_sleep 1
    s_branch K2_HP_135
K2_HD_136:
    s_mov_b32 m0, 79872
    s_mov_b32 s54, 41008128
    buffer_load_dwordx4 v245, s[20:23], s54 offen offset:0 sc1 lds
    buffer_load_dwordx4 v245, s[20:23], s54 offen offset:1024 sc1 lds
    s_mov_b32 m0, 86016
    s_mov_b32 s54, 41029632
    buffer_load_dwordx4 v245, s[20:23], s54 offen offset:0 sc1 lds
    s_mov_b32 m0, 92160
    s_mov_b32 s54, 41086976
    buffer_load_dwordx4 v245, s[20:23], s54 offen offset:0 sc1 lds
    buffer_load_dwordx4 v245, s[20:23], s54 offen offset:1024 sc1 lds
    buffer_load_dwordx4 v245, s[20:23], s54 offen offset:2048 sc1 lds
    buffer_load_dwordx4 v245, s[20:23], s54 offen offset:3072 sc1 lds
    s_mov_b32 m0, 107520
    s_mov_b32 s54, 41148416
    buffer_load_dwordx4 v245, s[20:23], s54 offen offset:0 sc1 lds
    buffer_load_dwordx4 v245, s[20:23], s54 offen offset:1024 sc1 lds
    buffer_load_dwordx4 v245, s[20:23], s54 offen offset:2048 sc1 lds
    s_waitcnt vmcnt(10)
    v_mov_b32 v8, 15
    ds_write_b32 v7, v8 offset:1536
    ds_read_b32 v9, v6 offset:1552
    s_waitcnt lgkmcnt(0)
    v_cmp_gt_u32 vcc, 16, v9
    s_cbranch_vccz K2_HD_138
    s_waitcnt vmcnt(0)
    v_mov_b32 v8, 16
    ds_write_b32 v7, v8 offset:1536
    s_mov_b32 s55, 131072
K2_HP_137:
    ds_read_b32 v9, v6 offset:1552
    s_sub_u32 s55, s55, 1
    s_cmp_eq_u32 s55, 0
    s_cbranch_scc1 K2_HD_138
    s_waitcnt lgkmcnt(0)
    v_cmp_gt_u32 vcc, 16, v9
    s_cbranch_vccz K2_HD_138
    s_sleep 1
    s_branch K2_HP_137
K2_HD_138:
    s_mov_b32 m0, 117760
    s_mov_b32 s54, 40226816
    buffer_load_dwordx4 v245, s[20:23], s54 offen offset:0 sc1 lds
    buffer_load_dwordx4 v245, s[20:23], s54 offen offset:1024 sc1 lds
    buffer_load_dwordx4 v245, s[20:23], s54 offen offset:2048 sc1 lds
    buffer_load_dwordx4 v245, s[20:23], s54 offen offset:3072 sc1 lds
    s_mov_b32 m0, 137216
    s_mov_b32 s54, 40374272
    buffer_load_dwordx4 v245, s[20:23], s54 offen offset:0 sc1 lds
    s_waitcnt vmcnt(5)
    v_mov_b32 v8, 16
    ds_write_b32 v7, v8 offset:1536
    ds_read_b32 v9, v6 offset:1552
    s_waitcnt lgkmcnt(0)
    v_cmp_gt_u32 vcc, 17, v9
    s_cbranch_vccz K2_HD_140
    s_waitcnt vmcnt(0)
    v_mov_b32 v8, 17
    ds_write_b32 v7, v8 offset:1536
    s_mov_b32 s55, 131072
K2_HP_139:
    ds_read_b32 v9, v6 offset:1552
    s_sub_u32 s55, s55, 1
    s_cmp_eq_u32 s55, 0
    s_cbranch_scc1 K2_HD_140
    s_waitcnt lgkmcnt(0)
    v_cmp_gt_u32 vcc, 17, v9
    s_cbranch_vccz K2_HD_140
    s_sleep 1
    s_branch K2_HP_139
K2_HD_140:
    s_mov_b32 m0, 141312
    s_mov_b32 s54, 40393728
    buffer_load_dwordx4 v245, s[20:23], s54 offen offset:0 sc1 lds
    buffer_load_dwordx4 v245, s[20:23], s54 offen offset:1024 sc1 lds
    s_mov_b32 m0, 147456
    s_mov_b32 s54, 40497152
    buffer_load_dwordx4 v245, s[20:23], s54 offen offset:0 sc1 lds
    s_mov_b32 m0, 153600
    s_mov_b32 s54, 40534016
    buffer_load_dwordx4 v245, s[20:23], s54 offen offset:0 sc1 lds
    buffer_load_dwordx4 v245, s[20:23], s54 offen offset:1024 sc1 lds
    buffer_load_dwordx4 v245, s[20:23], s54 offen offset:2048 sc1 lds
    buffer_load_dwordx4 v245, s[20:23], s54 offen offset:3072 sc1 lds
    s_mov_b32 m0, 7168
    s_mov_b32 s54, 40677376
    buffer_load_dwordx4 v245, s[20:23], s54 offen offset:0 sc1 lds
    buffer_load_dwordx4 v245, s[20:23], s54 offen offset:1024 sc1 lds
    buffer_load_dwordx4 v245, s[20:23], s54 offen offset:2048 sc1 lds
    s_waitcnt vmcnt(10)
    v_mov_b32 v8, 17
    ds_write_b32 v7, v8 offset:1536
    ds_read_b32 v9, v6 offset:1552
    s_waitcnt lgkmcnt(0)
    v_cmp_gt_u32 vcc, 18, v9
    s_cbranch_vccz K2_HD_142
    s_waitcnt vmcnt(0)
    v_mov_b32 v8, 18
    ds_write_b32 v7, v8 offset:1536
    s_mov_b32 s55, 131072
K2_HP_141:
    ds_read_b32 v9, v6 offset:1552
    s_sub_u32 s55, s55, 1
    s_cmp_eq_u32 s55, 0
    s_cbranch_scc1 K2_HD_142
    s_waitcnt lgkmcnt(0)
    v_cmp_gt_u32 vcc, 18, v9
    s_cbranch_vccz K2_HD_142
    s_sleep 1
    s_branch K2_HP_141
K2_HD_142:
    s_mov_b32 m0, 17408
    s_mov_b32 s54, 40800256
    buffer_load_dwordx4 v245, s[20:23], s54 offen offset:0 sc1 lds
    buffer_load_dwordx4 v245, s[20:23], s54 offen offset:1024 sc1 lds
    buffer_load_dwordx4 v245, s[20:23], s54 offen offset:2048 sc1 lds
    buffer_load_dwordx4 v245, s[20:23], s54 offen offset:3072 sc1 lds
    s_mov_b32 m0, 36864
    s_mov_b32 s54, 40947712
    buffer_load_dwordx4 v245, s[20:23], s54 offen offset:0 sc1 lds
    s_waitcnt vmcnt(5)
    v_mov_b32 v8, 18
    ds_write_b32 v7, v8 offset:1536
    ds_read_b32 v9, v6 offset:1552
    s_waitcnt lgkmcnt(0)
    v_cmp_gt_u32 vcc, 19, v9
    s_cbranch_vccz K2_HD_144
    s_waitcnt vmcnt(0)
    v_mov_b32 v8, 19
    ds_write_b32 v7, v8 offset:1536
    s_mov_b32 s55, 131072
K2_HP_143:
    ds_read_b32 v9, v6 offset:1552
    s_sub_u32 s55, s55, 1
    s_cmp_eq_u32 s55, 0
    s_cbranch_scc1 K2_HD_144
    s_waitcnt lgkmcnt(0)
    v_cmp_gt_u32 vcc, 19, v9
    s_cbranch_vccz K2_HD_144
    s_sleep 1
    s_branch K2_HP_143
K2_HD_144:
    s_mov_b32 m0, 40960
    s_mov_b32 s54, 40967168
    buffer_load_dwordx4 v245, s[20:23], s54 offen offset:0 sc1 lds
    buffer_load_dwordx4 v245, s[20:23], s54 offen offset:1024 sc1 lds
    s_mov_b32 m0, 47104
    s_mov_b32 s54, 41070592
    buffer_load_dwordx4 v245, s[20:23], s54 offen offset:0 sc1 lds
    s_mov_b32 m0, 53248
    s_mov_b32 s54, 41189376
    buffer_load_dwordx4 v245, s[20:23], s54 offen offset:0 sc1 lds
    buffer_load_dwordx4 v245, s[20:23], s54 offen offset:1024 sc1 lds
    buffer_load_dwordx4 v245, s[20:23], s54 offen offset:2048 sc1 lds
    buffer_load_dwordx4 v245, s[20:23], s54 offen offset:3072 sc1 lds
    s_waitcnt vmcnt(7)
    v_mov_b32 v8, 19
    ds_write_b32 v7, v8 offset:1536
    s_waitcnt vmcnt(0)
    v_mov_b32 v8, 20
    ds_write_b32 v7, v8 offset:1536
    s_endpgm
K2_H2:
    s_mov_b32 s54, 38653952
    buffer_load_dwordx4 v[16:19], v245, s[20:23], s54 offen offset:0 sc1
    s_mov_b32 s54, 38670336
    buffer_load_dwordx4 v[20:23], v245, s[20:23], s54 offen offset:0 sc1
    s_mov_b32 s54, 38690816
    buffer_load_dwordx4 v[24:27], v245, s[20:23], s54 offen offset:2048 sc1
    buffer_load_dwordx4 v[28:31], v245, s[20:23], s54 offen offset:3072 sc1
    s_mov_b32 s54, 38752256
    buffer_load_dwordx4 v[32:35], v245, s[20:23], s54 offen offset:0 sc1
    buffer_load_dwordx4 v[36:39], v245, s[20:23], s54 offen offset:1024 sc1
    s_mov_b32 s54, 38772736
    buffer_load_dwordx4 v[40:43], v245, s[20:23], s54 offen offset:3072 sc1
    s_mov_b32 s54, 38776832
    buffer_load_dwordx4 v[44:47], v245, s[20:23], s54 offen offset:0 sc1
    s_mov_b32 s54, 38834176
    buffer_load_dwordx4 v[48:51], v245, s[20:23], s54 offen offset:1024 sc1
    buffer_load_dwordx4 v[52:55], v245, s[20:23], s54 offen offset:2048 sc1
    s_mov_b32 s54, 38858752
    buffer_load_dwordx4 v[56:59], v245, s[20:23], s54 offen offset:0 sc1
    s_mov_b32 s54, 38875136
    buffer_load_dwordx4 v[60:63], v245, s[20:23], s54 offen offset:0 sc1
    s_mov_b32 s54, 38895616
    buffer_load_dwordx4 v[64:67], v245, s[20:23], s54 offen offset:2048 sc1
    buffer_load_dwordx4 v[68:71], v245, s[20:23], s54 offen offset:3072 sc1
    s_mov_b32 s54, 38957056
    buffer_load_dwordx4 v[72:75], v245, s[20:23], s54 offen offset:0 sc1
    buffer_load_dwordx4 v[76:79], v245, s[20:23], s54 offen offset:1024 sc1
    s_mov_b32 s54, 39092224
    buffer_load_dwordx4 v[80:83], v246, s[20:23], s54 offen offset:3072 sc1
    s_mov_b32 s54, 39096320
    buffer_load_dwordx4 v[84:87], v246, s[20:23], s54 offen offset:0 sc1
    s_mov_b32 s54, 39378944
    buffer_load_dwordx4 v[88:91], v246, s[20:23], s54 offen offset:3072 sc1
    s_mov_b32 s54, 39383040
    buffer_load_dwordx4 v[92:95], v246, s[20:23], s54 offen offset:0 sc1
    s_mov_b32 s54, 39665664
    buffer_load_dwordx4 v[96:99], v246, s[20:23], s54 offen offset:3072 sc1
    s_mov_b32 s54, 39669760
    buffer_load_dwordx4 v[100:103], v246, s[20:23], s54 offen offset:0 sc1
    s_mov_b32 s54, 39952384
    buffer_load_dwordx4 v[104:107], v246, s[20:23], s54 offen offset:3072 sc1
    s_mov_b32 s54, 39956480
    buffer_load_dwordx4 v[108:111], v246, s[20:23], s54 offen offset:0 sc1
    s_mov_b32 s54, 38977536
    buffer_load_dwordx4 v[112:115], v246, s[20:23], s54 offen offset:3072 sc1
    s_mov_b32 s54, 38981632
    buffer_load_dwordx4 v[116:119], v246, s[20:23], s54 offen offset:0 sc1
    s_mov_b32 s54, 39034880
    buffer_load_dwordx4 v[120:123], v246, s[20:23], s54 offen offset:3072 sc1
    s_mov_b32 s54, 39038976
    buffer_load_dwordx4 v[124:127], v246, s[20:23], s54 offen offset:0 sc1
    s_mov_b32 s54, 39149568
    buffer_load_dwordx4 v[128:131], v246, s[20:23], s54 offen offset:3072 sc1
    s_mov_b32 s54, 39153664
    buffer_load_dwordx4 v[132:135], v246, s[20:23], s54 offen offset:0 sc1
    s_mov_b32 s54, 39206912
    buffer_load_dwordx4 v[136:139], v246, s[20:23], s54 offen offset:3072 sc1
    s_mov_b32 s54, 39211008
    buffer_load_dwordx4 v[140:143], v246, s[20:23], s54 offen offset:0 sc1
    s_mov_b32 s55, 131072
K2_HP_145:
    ds_read_b32 v9, v6 offset:1552
    s_sub_u32 s55, s55, 1
    s_cmp_eq_u32 s55, 0
    s_cbranch_scc1 K2_HD_146
    s_waitcnt lgkmcnt(0)
    v_cmp_gt_u32 vcc, 2, v9
    s_cbranch_vccz K2_HD_146
    s_sleep 1
    s_branch K2_HP_145
K2_HD_146:
    ds_write_b128 v12, v[152:155] offset:7168
    ds_write_b128 v12, v[156:159] offset:8192
    ds_write_b128 v12, v[160:163] offset:9216
    ds_write_b128 v12, v[164:167] offset:10240
    ds_write_b128 v12, v[168:171] offset:11264
    ds_write_b128 v12, v[172:175] offset:27648
    ds_write_b128 v12, v[176:179] offset:28672
    ds_write_b128 v12, v[180:183] offset:29696
    ds_write_b128 v12, v[184:187] offset:30720
    ds_write_b128 v12, v[188:191] offset:31744
    v_mov_b32 v8, 3
    ds_write_b32 v7, v8 offset:1536
    ds_write_b128 v12, v[192:195] offset:48128
    ds_write_b128 v12, v[196:199] offset:49152
    ds_write_b128 v12, v[200:203] offset:50176
    ds_write_b128 v12, v[204:207] offset:51200
    ds_write_b128 v12, v[208:211] offset:52224
    ds_write_b128 v13, v[212:215] offset:3072
    ds_write_b128 v13, v[216:219] offset:4096
    ds_write_b128 v13, v[220:223] offset:5120
    ds_write_b128 v13, v[224:227] offset:6144
    ds_write_b128 v13, v[228:231] offset:7168
    s_waitcnt vmcnt(31)
    ds_write_b128 v13, v[16:19] offset:17408
    s_waitcnt vmcnt(30)
    ds_write_b128 v13, v[20:23] offset:18432
    s_waitcnt vmcnt(29)
    ds_write_b128 v13, v[24:27] offset:25600
    s_waitcnt vmcnt(28)
    ds_write_b128 v13, v[28:31] offset:26624
    s_waitcnt vmcnt(27)
    ds_write_b128 v13, v[32:35] offset:33792
    s_waitcnt vmcnt(26)
    ds_write_b128 v13, v[36:39] offset:34816
    v_mov_b32 v8, 4
    ds_write_b32 v7, v8 offset:1536
    s_mov_b32 s55, 131072
K2_HP_147:
    ds_read_b32 v9, v6 offset:1552
    s_sub_u32 s55, s55, 1
    s_cmp_eq_u32 s55, 0
    s_cbranch_scc1 K2_HD_148
    s_waitcnt lgkmcnt(0)
    v_cmp_gt_u32 vcc, 3, v9
    s_cbranch_vccz K2_HD_148
    s_sleep 1
    s_branch K2_HP_147
K2_HD_148:
    s_mov_b32 s54, 39264256
    buffer_load_dwordx4 v[144:147], v246, s[20:23], s54 offen offset:3072 sc1
    s_mov_b32 s54, 39268352
    buffer_load_dwordx4 v[152:155], v246, s[20:23], s54 offen offset:0 sc1
    s_mov_b32 s54, 39321600
    buffer_load_dwordx4 v[156:159], v246, s[20:23], s54 offen offset:3072 sc1
    s_mov_b32 s54, 39325696
    buffer_load_dwordx4 v[160:163], v246, s[20:23], s54 offen offset:0 sc1
    s_mov_b32 s54, 39436288
    buffer_load_dwordx4 v[164:167], v246, s[20:23], s54 offen offset:3072 sc1
    s_mov_b32 s54, 39440384
    buffer_load_dwordx4 v[168:171], v246, s[20:23], s54 offen offset:0 sc1
    s_mov_b32 s54, 39493632
    buffer_load_dwordx4 v[172:175], v246, s[20:23], s54 offen offset:3072 sc1
    s_mov_b32 s54, 39497728
    buffer_load_dwordx4 v[176:179], v246, s[20:23], s54 offen offset:0 sc1
    s_mov_b32 s54, 39550976
    buffer_load_dwordx4 v[180:183], v246, s[20:23], s54 offen offset:3072 sc1
    s_mov_b32 s54, 39555072
    buffer_load_dwordx4 v[184:187], v246, s[20:23], s54 offen offset:0 sc1
    s_mov_b32 s54, 39608320
    buffer_load_dwordx4 v[188:191], v246, s[20:23], s54 offen offset:3072 sc1
    s_mov_b32 s54, 39612416
    buffer_load_dwordx4 v[192:195], v246, s[20:23], s54 offen offset:0 sc1
    s_mov_b32 s54, 39723008
    buffer_load_dwordx4 v[196:199], v246, s[20:23], s54 offen offset:3072 sc1
    s_mov_b32 s54, 39727104
    buffer_load_dwordx4 v[200:203], v246, s[20:23], s54 offen offset:0 sc1
    s_mov_b32 s54, 39780352
    buffer_load_dwordx4 v[204:207], v246, s[20:23], s54 offen offset:3072 sc1
    s_mov_b32 s54, 39784448
    buffer_load_dwordx4 v[208:211], v246, s[20:23], s54 offen offset:0 sc1
    s_mov_b32 s54, 39837696
    buffer_load_dwordx4 v[212:215], v246, s[20:23], s54 offen offset:3072 sc1
    s_mov_b32 s54, 39841792
    buffer_load_dwordx4 v[216:219], v246, s[20:23], s54 offen offset:0 sc1
    s_mov_b32 s54, 39895040
    buffer_load_dwordx4 v[220:223], v246, s[20:23], s54 offen offset:3072 sc1
    s_mov_b32 s54, 39899136
    buffer_load_dwordx4 v[224:227], v246, s[20:23], s54 offen offset:0 sc1
    s_mov_b32 s54, 40009728
    buffer_load_dwordx4 v[228:231], v246, s[20:23], s54 offen offset:3072 sc1
    s_mov_b32 s54, 40013824
    buffer_load_dwordx4 v[16:19], v246, s[20:23], s54 offen offset:0 sc1
    s_mov_b32 s54, 40067072
    buffer_load_dwordx4 v[20:23], v246, s[20:23], s54 offen offset:3072 sc1
    s_mov_b32 s54, 40071168
    buffer_load_dwordx4 v[24:27], v246, s[20:23], s54 offen offset:0 sc1
    s_mov_b32 s55, 131072
K2_HP_149:
    ds_read_b32 v9, v6 offset:1552
    s_sub_u32 s55, s55, 1
    s_cmp_eq_u32 s55, 0
    s_cbranch_scc1 K2_HD_150
    s_waitcnt lgkmcnt(0)
    v_cmp_gt_u32 vcc, 4, v9
    s_cbranch_vccz K2_HD_150
    s_sleep 1
    s_branch K2_HP_149
K2_HD_150:
    s_waitcnt vmcnt(49)
    ds_write_b128 v13, v[40:43] offset:41984
    s_waitcnt vmcnt(48)
    ds_write_b128 v13, v[44:47] offset:43008
    s_waitcnt vmcnt(47)
    ds_write_b128 v13, v[48:51] offset:50176
    s_waitcnt vmcnt(46)
    ds_write_b128 v13, v[52:55] offset:51200
    s_waitcnt vmcnt(45)
    ds_write_b128 v13, v[56:59] offset:58368
    s_waitcnt vmcnt(44)
    ds_write_b128 v13, v[60:63] offset:59392
    s_waitcnt vmcnt(43)
    ds_write_b128 v14, v[64:67] offset:1024
    s_waitcnt vmcnt(42)
    ds_write_b128 v14, v[68:71] offset:2048
    s_waitcnt vmcnt(41)
    ds_write_b128 v14, v[72:75] offset:9216
    s_waitcnt vmcnt(40)
    ds_write_b128 v14, v[76:79] offset:10240
    v_mov_b32 v8, 5
    ds_write_b32 v7, v8 offset:1536
    s_waitcnt vmcnt(39)
    ds_write_b128 v14, v[80:83] offset:17408
    s_waitcnt vmcnt(38)
    ds_write_b128 v14, v[84:87] offset:18432
    s_waitcnt vmcnt(37)
    ds_write_b128 v14, v[88:91] offset:25600
    s_waitcnt vmcnt(36)
    ds_write_b128 v14, v[92:95] offset:26624
    s_waitcnt vmcnt(35)
    ds_write_b128 v12, v[96:99] offset:3072
    s_waitcnt vmcnt(34)
    ds_write_b128 v12, v[100:103] offset:4096
    s_waitcnt vmcnt(33)
    ds_write_b128 v12, v[104:107] offset:11264
    s_waitcnt vmcnt(32)
    ds_write_b128 v12, v[108:111] offset:12288
    s_waitcnt vmcnt(31)
    ds_write_b128 v12, v[112:115] offset:19456
    s_waitcnt vmcnt(30)
    ds_write_b128 v12, v[116:119] offset:20480
    s_waitcnt vmcnt(29)
    ds_write_b128 v12, v[120:123] offset:27648
    s_waitcnt vmcnt(28)
    ds_write_b128 v12, v[124:127] offset:28672
    s_waitcnt vmcnt(27)
    ds_write_b128 v12, v[128:131] offset:35840
    s_waitcnt vmcnt(26)
    ds_write_b128 v12, v[132:135] offset:36864
    v_mov_b32 v8, 6
    ds_write_b32 v7, v8 offset:1536
    s_mov_b32 s55, 131072
K2_HP_151:
    ds_read_b32 v9, v6 offset:1552
    s_sub_u32 s55, s55, 1
    s_cmp_eq_u32 s55, 0
    s_cbranch_scc1 K2_HD_152
    s_waitcnt lgkmcnt(0)
    v_cmp_gt_u32 vcc, 6, v9
    s_cbranch_vccz K2_HD_152
    s_sleep 1
    s_branch K2_HP_151
K2_HD_152:
    s_waitcnt vmcnt(25)
    ds_write_b128 v12, v[136:139] offset:44032
    s_waitcnt vmcnt(24)
    ds_write_b128 v12, v[140:143] offset:45056
    s_waitcnt vmcnt(23)
    ds_write_b128 v12, v[144:147] offset:52224
    s_waitcnt vmcnt(22)
    ds_write_b128 v12, v[152:155] offset:53248
    s_waitcnt vmcnt(21)
    ds_write_b128 v12, v[156:159] offset:60416
    s_waitcnt vmcnt(20)
    ds_write_b128 v12, v[160:163] offset:61440
    s_waitcnt vmcnt(19)
    ds_write_b128 v13, v[164:167] offset:3072
    s_waitcnt vmcnt(18)
    ds_write_b128 v13, v[168:171] offset:4096
    s_waitcnt vmcnt(17)
    ds_write_b128 v13, v[172:175] offset:11264
    s_waitcnt vmcnt(16)
    ds_write_b128 v13, v[176:179] offset:12288
    s_waitcnt vmcnt(15)
    ds_write_b128 v13, v[180:183] offset:19456
    s_waitcnt vmcnt(14)
    ds_write_b128 v13, v[184:187] offset:20480
    s_waitcnt vmcnt(13)
    ds_write_b128 v13, v[188:191] offset:27648
    s_waitcnt vmcnt(12)
    ds_write_b128 v13, v[192:195] offset:28672
    s_waitcnt vmcnt(11)
    ds_write_b128 v13, v[196:199] offset:35840
    s_waitcnt vmcnt(10)
    ds_write_b128 v13, v[200:203] offset:36864
    s_waitcnt vmcnt(9)
    ds_write_b128 v13, v[204:207] offset:44032
    s_waitcnt vmcnt(8)
    ds_write_b128 v13, v[208:211] offset:45056
    s_waitcnt vmcnt(7)
    ds_write_b128 v13, v[212:215] offset:52224
    s_waitcnt vmcnt(6)
    ds_write_b128 v13, v[216:219] offset:53248
    s_waitcnt vmcnt(5)
    ds_write_b128 v13, v[220:223] offset:60416
    s_waitcnt vmcnt(4)
    ds_write_b128 v13, v[224:227] offset:61440
    s_waitcnt vmcnt(3)
    ds_write_b128 v14, v[228:231] offset:3072
    s_waitcnt vmcnt(2)
    ds_write_b128 v14, v[16:19] offset:4096
    s_waitcnt vmcnt(1)
    ds_write_b128 v14, v[20:23] offset:11264
    s_waitcnt vmcnt(0)
    ds_write_b128 v14, v[24:27] offset:12288
    v_mov_b32 v8, 7
    ds_write_b32 v7, v8 offset:1536
    ds_read_b32 v9, v6 offset:1552
    s_waitcnt lgkmcnt(0)
    v_cmp_gt_u32 vcc, 7, v9
    s_cbranch_vccz K2_HD_154
    s_mov_b32 s55, 131072
K2_HP_153:
    ds_read_b32 v9, v6 offset:1552
    s_sub_u32 s55, s55, 1
    s_cmp_eq_u32 s55, 0
    s_cbranch_scc1 K2_HD_154
    s_waitcnt lgkmcnt(0)
    v_cmp_gt_u32 vcc, 7, v9
    s_cbranch_vccz K2_HD_154
    s_sleep 1
    s_branch K2_HP_153
K2_HD_154:
    s_mov_b32 m0, 153600
    s_mov_b32 s54, 39104512
    buffer_load_dwordx4 v246, s[20:23], s54 offen offset:0 sc1 lds
    buffer_load_dwordx4 v246, s[20:23], s54 offen offset:1024 sc1 lds
    s_mov_b32 m0, 161792
    s_mov_b32 s54, 39673856
    buffer_load_dwordx4 v246, s[20:23], s54 offen offset:0 sc1 lds
    buffer_load_dwordx4 v246, s[20:23], s54 offen offset:1024 sc1 lds
    s_mov_b32 m0, 10240
    s_mov_b32 s54, 39964672
    buffer_load_dwordx4 v246, s[20:23], s54 offen offset:0 sc1 lds
    buffer_load_dwordx4 v246, s[20:23], s54 offen offset:1024 sc1 lds
    s_mov_b32 m0, 16384
    s_mov_b32 s54, 38989824
    buffer_load_dwordx4 v246, s[20:23], s54 offen offset:0 sc1 lds
    buffer_load_dwordx4 v246, s[20:23], s54 offen offset:1024 sc1 lds
    ds_read_b32 v9, v6 offset:1552
    s_waitcnt lgkmcnt(0)
    v_cmp_gt_u32 vcc, 8, v9
    s_cbranch_vccz K2_HD_156
    s_waitcnt vmcnt(0)
    v_mov_b32 v8, 8
    ds_write_b32 v7, v8 offset:1536
    s_mov_b32 s55, 131072
K2_HP_155:
    ds_read_b32 v9, v6 offset:1552
    s_sub_u32 s55, s55, 1
    s_cmp_eq_u32 s55, 0
    s_cbranch_scc1 K2_HD_156
    s_waitcnt lgkmcnt(0)
    v_cmp_gt_u32 vcc, 8, v9
    s_cbranch_vccz K2_HD_156
    s_sleep 1
    s_branch K2_HP_155
K2_HD_156:
    s_mov_b32 m0, 24576
    s_mov_b32 s54, 39157760
    buffer_load_dwordx4 v246, s[20:23], s54 offen offset:0 sc1 lds
    buffer_load_dwordx4 v246, s[20:23], s54 offen offset:1024 sc1 lds
    buffer_load_dwordx4 v246, s[20:23], s54 offen offset:2048 sc1 lds
    buffer_load_dwordx4 v246, s[20:23], s54 offen offset:3072 sc1 lds
    s_mov_b32 m0, 40960
    s_mov_b32 s54, 39276544
    buffer_load_dwordx4 v246, s[20:23], s54 offen offset:0 sc1 lds
    buffer_load_dwordx4 v246, s[20:23], s54 offen offset:1024 sc1 lds
    s_mov_b32 m0, 49152
    s_mov_b32 s54, 39444480
    buffer_load_dwordx4 v246, s[20:23], s54 offen offset:0 sc1 lds
    buffer_load_dwordx4 v246, s[20:23], s54 offen offset:1024 sc1 lds
    s_waitcnt vmcnt(8)
    v_mov_b32 v8, 8
    ds_write_b32 v7, v8 offset:1536
    ds_read_b32 v9, v6 offset:1552
    s_waitcnt lgkmcnt(0)
    v_cmp_gt_u32 vcc, 9, v9
    s_cbranch_vccz K2_HD_158
    s_waitcnt vmcnt(0)
    v_mov_b32 v8, 9
    ds_write_b32 v7, v8 offset:1536
    s_mov_b32 s55, 131072
K2_HP_157:
    ds_read_b32 v9, v6 offset:1552
    s_sub_u32 s55, s55, 1
    s_cmp_eq_u32 s55, 0
    s_cbranch_scc1 K2_HD_158
    s_waitcnt lgkmcnt(0)
    v_cmp_gt_u32 vcc, 9, v9
    s_cbranch_vccz K2_HD_158
    s_sleep 1
    s_branch K2_HP_157
K2_HD_158:
    s_mov_b32 m0, 59392
    s_mov_b32 s54, 39505920
    buffer_load_dwordx4 v246, s[20:23], s54 offen offset:0 sc1 lds
    buffer_load_dwordx4 v246, s[20:23], s54 offen offset:1024 sc1 lds
    s_mov_b32 m0, 65536
    s_mov_b32 s54, 39563264
    buffer_load_dwordx4 v246, s[20:23], s54 offen offset:0 sc1 lds
    buffer_load_dwordx4 v246, s[20:23], s54 offen offset:1024 sc1 lds
    s_mov_b32 m0, 73728
    s_mov_b32 s54, 39731200
    buffer_load_dwordx4 v246, s[20:23], s54 offen offset:0 sc1 lds
    buffer_load_dwordx4 v246, s[20:23], s54 offen offset:1024 sc1 lds
    buffer_load_dwordx4 v246, s[20:23], s54 offen offset:2048 sc1 lds
    buffer_load_dwordx4 v246, s[20:23], s54 offen offset:3072 sc1 lds
    s_waitcnt vmcnt(8)
    v_mov_b32 v8, 9
    ds_write_b32 v7, v8 offset:1536
    ds_read_b32 v9, v6 offset:1552
    s_waitcnt lgkmcnt(0)
    v_cmp_gt_u32 vcc, 10, v9
    s_cbranch_vccz K2_HD_160
    s_waitcnt vmcnt(0)
    v_mov_b32 v8, 10
    ds_write_b32 v7, v8 offset:1536
    s_mov_b32 s55, 131072
K2_HP_159:
    ds_read_b32 v9, v6 offset:1552
    s_sub_u32 s55, s55, 1
    s_cmp_eq_u32 s55, 0
    s_cbranch_scc1 K2_HD_160
    s_waitcnt lgkmcnt(0)
    v_cmp_gt_u32 vcc, 10, v9
    s_cbranch_vccz K2_HD_160
    s_sleep 1
    s_branch K2_HP_159
K2_HD_160:
    s_mov_b32 m0, 90112
    s_mov_b32 s54, 39849984
    buffer_load_dwordx4 v246, s[20:23], s54 offen offset:0 sc1 lds
    buffer_load_dwordx4 v246, s[20:23], s54 offen offset:1024 sc1 lds
    s_mov_b32 m0, 98304
    s_mov_b32 s54, 40017920
    buffer_load_dwordx4 v246, s[20:23], s54 offen offset:0 sc1 lds
    buffer_load_dwordx4 v246, s[20:23], s54 offen offset:1024 sc1 lds
    buffer_load_dwordx4 v246, s[20:23], s54 offen offset:2048 sc1 lds
    buffer_load_dwordx4 v246, s[20:23], s54 offen offset:3072 sc1 lds
    s_mov_b32 m0, 114688
    s_mov_b32 s54, 40128512
    buffer_load_dwordx4 v245, s[20:23], s54 offen offset:0 sc1 lds
    s_waitcnt vmcnt(7)
    v_mov_b32 v8, 10
    ds_write_b32 v7, v8 offset:1536
    ds_read_b32 v9, v6 offset:1552
    s_waitcnt lgkmcnt(0)
    v_cmp_gt_u32 vcc, 11, v9
    s_cbranch_vccz K2_HD_162
    s_waitcnt vmcnt(0)
    v_mov_b32 v8, 11
    ds_write_b32 v7, v8 offset:1536
    s_mov_b32 s55, 131072
K2_HP_161:
    ds_read_b32 v9, v6 offset:1552
    s_sub_u32 s55, s55, 1
    s_cmp_eq_u32 s55, 0
    s_cbranch_scc1 K2_HD_162
    s_waitcnt lgkmcnt(0)
    v_cmp_gt_u32 vcc, 11, v9
    s_cbranch_vccz K2_HD_162
    s_sleep 1
    s_branch K2_HP_161
K2_HD_162:
    s_mov_b32 m0, 116736
    s_mov_b32 s54, 40145920
    buffer_load_dwordx4 v245, s[20:23], s54 offen offset:0 sc1 lds
    buffer_load_dwordx4 v245, s[20:23], s54 offen offset:1024 sc1 lds
    buffer_load_dwordx4 v245, s[20:23], s54 offen offset:2048 sc1 lds
    buffer_load_dwordx4 v245, s[20:23], s54 offen offset:3072 sc1 lds
    s_mov_b32 m0, 135168
    s_mov_b32 s54, 40271872
    buffer_load_dwordx4 v245, s[20:23], s54 offen offset:0 sc1 lds
    s_mov_b32 m0, 140288
    s_mov_b32 s54, 40292352
    buffer_load_dwordx4 v245, s[20:23], s54 offen offset:0 sc1 lds
    s_mov_b32 m0, 145408
    s_mov_b32 s54, 40312832
    buffer_load_dwordx4 v245, s[20:23], s54 offen offset:0 sc1 lds
    s_mov_b32 m0, 146432
    s_mov_b32 s54, 40329216
    buffer_load_dwordx4 v245, s[20:23], s54 offen offset:0 sc1 lds
    buffer_load_dwordx4 v245, s[20:23], s54 offen offset:1024 sc1 lds
    buffer_load_dwordx4 v245, s[20:23], s54 offen offset:2048 sc1 lds
    s_waitcnt vmcnt(10)
    v_mov_b32 v8, 11
    ds_write_b32 v7, v8 offset:1536
    ds_read_b32 v9, v6 offset:1552
    s_waitcnt lgkmcnt(0)
    v_cmp_gt_u32 vcc, 12, v9
    s_cbranch_vccz K2_HD_164
    s_waitcnt vmcnt(0)
    v_mov_b32 v8, 12
    ds_write_b32 v7, v8 offset:1536
    s_mov_b32 s55, 131072
K2_HP_163:
    ds_read_b32 v9, v6 offset:1552
    s_sub_u32 s55, s55, 1
    s_cmp_eq_u32 s55, 0
    s_cbranch_scc1 K2_HD_164
    s_waitcnt lgkmcnt(0)
    v_cmp_gt_u32 vcc, 12, v9
    s_cbranch_vccz K2_HD_164
    s_sleep 1
    s_branch K2_HP_163
K2_HD_164:
    s_mov_b32 m0, 160768
    s_mov_b32 s54, 40435712
    buffer_load_dwordx4 v245, s[20:23], s54 offen offset:0 sc1 lds
    s_mov_b32 m0, 2048
    s_mov_b32 s54, 40454144
    buffer_load_dwordx4 v245, s[20:23], s54 offen offset:0 sc1 lds
    buffer_load_dwordx4 v245, s[20:23], s54 offen offset:1024 sc1 lds
    buffer_load_dwordx4 v245, s[20:23], s54 offen offset:2048 sc1 lds
    s_mov_b32 m0, 15360
    s_mov_b32 s54, 40574976
    buffer_load_dwordx4 v245, s[20:23], s54 offen offset:0 sc1 lds
    buffer_load_dwordx4 v245, s[20:23], s54 offen offset:1024 sc1 lds
    buffer_load_dwordx4 v245, s[20:23], s54 offen offset:2048 sc1 lds
    s_waitcnt vmcnt(7)
    v_mov_b32 v8, 12
    ds_write_b32 v7, v8 offset:1536
    ds_read_b32 v9, v6 offset:1552
    s_waitcnt lgkmcnt(0)
    v_cmp_gt_u32 vcc, 13, v9
    s_cbranch_vccz K2_HD_166
    s_waitcnt vmcnt(0)
    v_mov_b32 v8, 13
    ds_write_b32 v7, v8 offset:1536
    s_mov_b32 s55, 131072
K2_HP_165:
    ds_read_b32 v9, v6 offset:1552
    s_sub_u32 s55, s55, 1
    s_cmp_eq_u32 s55, 0
    s_cbranch_scc1 K2_HD_166
    s_waitcnt lgkmcnt(0)
    v_cmp_gt_u32 vcc, 13, v9
    s_cbranch_vccz K2_HD_166
    s_sleep 1
    s_branch K2_HP_165
K2_HD_166:
    s_mov_b32 m0, 25600
    s_mov_b32 s54, 40615936
    buffer_load_dwordx4 v245, s[20:23], s54 offen offset:0 sc1 lds
    buffer_load_dwordx4 v245, s[20:23], s54 offen offset:1024 sc1 lds
    buffer_load_dwordx4 v245, s[20:23], s54 offen offset:2048 sc1 lds
    buffer_load_dwordx4 v245, s[20:23], s54 offen offset:3072 sc1 lds
    s_mov_b32 m0, 40960
    s_mov_b32 s54, 40738816
    buffer_load_dwordx4 v245, s[20:23], s54 offen offset:0 sc1 lds
    buffer_load_dwordx4 v245, s[20:23], s54 offen offset:1024 sc1 lds
    buffer_load_dwordx4 v245, s[20:23], s54 offen offset:2048 sc1 lds
    buffer_load_dwordx4 v245, s[20:23], s54 offen offset:3072 sc1 lds
    s_waitcnt vmcnt(8)
    v_mov_b32 v8, 13
    ds_write_b32 v7, v8 offset:1536
    ds_read_b32 v9, v6 offset:1552
    s_waitcnt lgkmcnt(0)
    v_cmp_gt_u32 vcc, 14, v9
    s_cbranch_vccz K2_HD_168
    s_waitcnt vmcnt(0)
    v_mov_b32 v8, 14
    ds_write_b32 v7, v8 offset:1536
    s_mov_b32 s55, 131072
K2_HP_167:
    ds_read_b32 v9, v6 offset:1552
    s_sub_u32 s55, s55, 1
    s_cmp_eq_u32 s55, 0
    s_cbranch_scc1 K2_HD_168
    s_waitcnt lgkmcnt(0)
    v_cmp_gt_u32 vcc, 14, v9
    s_cbranch_vccz K2_HD_168
    s_sleep 1
    s_branch K2_HP_167
K2_HD_168:
    s_mov_b32 m0, 60416
    s_mov_b32 s54, 40865792
    buffer_load_dwordx4 v245, s[20:23], s54 offen offset:0 sc1 lds
    s_mov_b32 m0, 65536
    s_mov_b32 s54, 40886272
    buffer_load_dwordx4 v245, s[20:23], s54 offen offset:0 sc1 lds
    s_mov_b32 m0, 66560
    s_mov_b32 s54, 40902656
    buffer_load_dwordx4 v245, s[20:23], s54 offen offset:0 sc1 lds
    buffer_load_dwordx4 v245, s[20:23], s54 offen offset:1024 sc1 lds
    buffer_load_dwordx4 v245, s[20:23], s54 offen offset:2048 sc1 lds
    buffer_load_dwordx4 v245, s[20:23], s54 offen offset:3072 sc1 lds
    s_waitcnt vmcnt(6)
    v_mov_b32 v8, 14
    ds_write_b32 v7, v8 offset:1536
    ds_read_b32 v9, v6 offset:1552
    s_waitcnt lgkmcnt(0)
    v_cmp_gt_u32 vcc, 15, v9
    s_cbranch_vccz K2_HD_170
    s_waitcnt vmcnt(0)
    v_mov_b32 v8, 15
    ds_write_b32 v7, v8 offset:1536
    s_mov_b32 s55, 131072
K2_HP_169:
    ds_read_b32 v9, v6 offset:1552
    s_sub_u32 s55, s55, 1
    s_cmp_eq_u32 s55, 0
    s_cbranch_scc1 K2_HD_170
    s_waitcnt lgkmcnt(0)
    v_cmp_gt_u32 vcc, 15, v9
    s_cbranch_vccz K2_HD_170
    s_sleep 1
    s_branch K2_HP_169
K2_HD_170:
    s_mov_b32 m0, 81920
    s_mov_b32 s54, 41025536
    buffer_load_dwordx4 v245, s[20:23], s54 offen offset:0 sc1 lds
    buffer_load_dwordx4 v245, s[20:23], s54 offen offset:1024 sc1 lds
    buffer_load_dwordx4 v245, s[20:23], s54 offen offset:2048 sc1 lds
    buffer_load_dwordx4 v245, s[20:23], s54 offen offset:3072 sc1 lds
    s_mov_b32 m0, 101376
    s_mov_b32 s54, 41111552
    buffer_load_dwordx4 v245, s[20:23], s54 offen offset:0 sc1 lds
    s_mov_b32 m0, 102400
    s_mov_b32 s54, 41127936
    buffer_load_dwordx4 v245, s[20:23], s54 offen offset:0 sc1 lds
    buffer_load_dwordx4 v245, s[20:23], s54 offen offset:1024 sc1 lds
    buffer_load_dwordx4 v245, s[20:23], s54 offen offset:2048 sc1 lds
    buffer_load_dwordx4 v245, s[20:23], s54 offen offset:3072 sc1 lds
    s_waitcnt vmcnt(9)
    v_mov_b32 v8, 15
    ds_write_b32 v7, v8 offset:1536
    ds_read_b32 v9, v6 offset:1552
    s_waitcnt lgkmcnt(0)
    v_cmp_gt_u32 vcc, 16, v9
    s_cbranch_vccz K2_HD_172
    s_waitcnt vmcnt(0)
    v_mov_b32 v8, 16
    ds_write_b32 v7, v8 offset:1536
    s_mov_b32 s55, 131072
K2_HP_171:
    ds_read_b32 v9, v6 offset:1552
    s_sub_u32 s55, s55, 1
    s_cmp_eq_u32 s55, 0
    s_cbranch_scc1 K2_HD_172
    s_waitcnt lgkmcnt(0)
    v_cmp_gt_u32 vcc, 16, v9
    s_cbranch_vccz K2_HD_172
    s_sleep 1
    s_branch K2_HP_171
K2_HD_172:
    s_mov_b32 m0, 121856
    s_mov_b32 s54, 40230912
    buffer_load_dwordx4 v245, s[20:23], s54 offen offset:0 sc1 lds
    s_mov_b32 m0, 126976
    s_mov_b32 s54, 40251392
    buffer_load_dwordx4 v245, s[20:23], s54 offen offset:0 sc1 lds
    s_mov_b32 m0, 128000
    s_mov_b32 s54, 40349696
    buffer_load_dwordx4 v245, s[20:23], s54 offen offset:0 sc1 lds
    buffer_load_dwordx4 v245, s[20:23], s54 offen offset:1024 sc1 lds
    buffer_load_dwordx4 v245, s[20:23], s54 offen offset:2048 sc1 lds
    buffer_load_dwordx4 v245, s[20:23], s54 offen offset:3072 sc1 lds
    s_waitcnt vmcnt(6)
    v_mov_b32 v8, 16
    ds_write_b32 v7, v8 offset:1536
    ds_read_b32 v9, v6 offset:1552
    s_waitcnt lgkmcnt(0)
    v_cmp_gt_u32 vcc, 17, v9
    s_cbranch_vccz K2_HD_174
    s_waitcnt vmcnt(0)
    v_mov_b32 v8, 17
    ds_write_b32 v7, v8 offset:1536
    s_mov_b32 s55, 131072
K2_HP_173:
    ds_read_b32 v9, v6 offset:1552
    s_sub_u32 s55, s55, 1
    s_cmp_eq_u32 s55, 0
    s_cbranch_scc1 K2_HD_174
    s_waitcnt lgkmcnt(0)
    v_cmp_gt_u32 vcc, 17, v9
    s_cbranch_vccz K2_HD_174
    s_sleep 1
    s_branch K2_HP_173
K2_HD_174:
    s_mov_b32 m0, 143360
    s_mov_b32 s54, 40493056
    buffer_load_dwordx4 v245, s[20:23], s54 offen offset:0 sc1 lds
    buffer_load_dwordx4 v245, s[20:23], s54 offen offset:1024 sc1 lds
    buffer_load_dwordx4 v245, s[20:23], s54 offen offset:2048 sc1 lds
    buffer_load_dwordx4 v245, s[20:23], s54 offen offset:3072 sc1 lds
    s_mov_b32 m0, 162816
    s_mov_b32 s54, 40640512
    buffer_load_dwordx4 v245, s[20:23], s54 offen offset:0 sc1 lds
    s_mov_b32 m0, 2048
    s_mov_b32 s54, 40656896
    buffer_load_dwordx4 v245, s[20:23], s54 offen offset:0 sc1 lds
    buffer_load_dwordx4 v245, s[20:23], s54 offen offset:1024 sc1 lds
    buffer_load_dwordx4 v245, s[20:23], s54 offen offset:2048 sc1 lds
    buffer_load_dwordx4 v245, s[20:23], s54 offen offset:3072 sc1 lds
    s_waitcnt vmcnt(9)
    v_mov_b32 v8, 17
    ds_write_b32 v7, v8 offset:1536
    ds_read_b32 v9, v6 offset:1552
    s_waitcnt lgkmcnt(0)
    v_cmp_gt_u32 vcc, 18, v9
    s_cbranch_vccz K2_HD_176
    s_waitcnt vmcnt(0)
    v_mov_b32 v8, 18
    ds_write_b32 v7, v8 offset:1536
    s_mov_b32 s55, 131072
K2_HP_175:
    ds_read_b32 v9, v6 offset:1552
    s_sub_u32 s55, s55, 1
    s_cmp_eq_u32 s55, 0
    s_cbranch_scc1 K2_HD_176
    s_waitcnt lgkmcnt(0)
    v_cmp_gt_u32 vcc, 18, v9
    s_cbranch_vccz K2_HD_176
    s_sleep 1
    s_branch K2_HP_175
K2_HD_176:
    s_mov_b32 m0, 21504
    s_mov_b32 s54, 40804352
    buffer_load_dwordx4 v245, s[20:23], s54 offen offset:0 sc1 lds
    s_mov_b32 m0, 26624
    s_mov_b32 s54, 40824832
    buffer_load_dwordx4 v245, s[20:23], s54 offen offset:0 sc1 lds
    s_mov_b32 m0, 27648
    s_mov_b32 s54, 40923136
    buffer_load_dwordx4 v245, s[20:23], s54 offen offset:0 sc1 lds
    buffer_load_dwordx4 v245, s[20:23], s54 offen offset:1024 sc1 lds
    buffer_load_dwordx4 v245, s[20:23], s54 offen offset:2048 sc1 lds
    buffer_load_dwordx4 v245, s[20:23], s54 offen offset:3072 sc1 lds
    s_waitcnt vmcnt(6)
    v_mov_b32 v8, 18
    ds_write_b32 v7, v8 offset:1536
    ds_read_b32 v9, v6 offset:1552
    s_waitcnt lgkmcnt(0)
    v_cmp_gt_u32 vcc, 19, v9
    s_cbranch_vccz K2_HD_178
    s_waitcnt vmcnt(0)
    v_mov_b32 v8, 19
    ds_write_b32 v7, v8 offset:1536
    s_mov_b32 s55, 131072
K2_HP_177:
    ds_read_b32 v9, v6 offset:1552
    s_sub_u32 s55, s55, 1
    s_cmp_eq_u32 s55, 0
    s_cbranch_scc1 K2_HD_178
    s_waitcnt lgkmcnt(0)
    v_cmp_gt_u32 vcc, 19, v9
    s_cbranch_vccz K2_HD_178
    s_sleep 1
    s_branch K2_HP_177
K2_HD_178:
    s_mov_b32 m0, 43008
    s_mov_b32 s54, 41066496
    buffer_load_dwordx4 v245, s[20:23], s54 offen offset:0 sc1 lds
    buffer_load_dwordx4 v245, s[20:23], s54 offen offset:1024 sc1 lds
    buffer_load_dwordx4 v245, s[20:23], s54 offen offset:2048 sc1 lds
    buffer_load_dwordx4 v245, s[20:23], s54 offen offset:3072 sc1 lds
    s_mov_b32 m0, 62464
    s_mov_b32 s54, 41213952
    buffer_load_dwordx4 v245, s[20:23], s54 offen offset:0 sc1 lds
    s_waitcnt vmcnt(5)
    v_mov_b32 v8, 19
    ds_write_b32 v7, v8 offset:1536
    s_waitcnt vmcnt(0)
    v_mov_b32 v8, 20
    ds_write_b32 v7, v8 offset:1536
    s_endpgm
K2_H3:
    s_mov_b32 s54, 38670336
    buffer_load_dwordx4 v[16:19], v245, s[20:23], s54 offen offset:1024 sc1
    buffer_load_dwordx4 v[20:23], v245, s[20:23], s54 offen offset:2048 sc1
    s_mov_b32 s54, 38694912
    buffer_load_dwordx4 v[24:27], v245, s[20:23], s54 offen offset:0 sc1
    s_mov_b32 s54, 38731776
    buffer_load_dwordx4 v[28:31], v245, s[20:23], s54 offen offset:0 sc1
    s_mov_b32 s54, 38752256
    buffer_load_dwordx4 v[32:35], v245, s[20:23], s54 offen offset:2048 sc1
    buffer_load_dwordx4 v[36:39], v245, s[20:23], s54 offen offset:3072 sc1
    s_mov_b32 s54, 38793216
    buffer_load_dwordx4 v[40:43], v245, s[20:23], s54 offen offset:0 sc1
    buffer_load_dwordx4 v[44:47], v245, s[20:23], s54 offen offset:1024 sc1
    s_mov_b32 s54, 38834176
    buffer_load_dwordx4 v[48:51], v245, s[20:23], s54 offen offset:3072 sc1
    s_mov_b32 s54, 38838272
    buffer_load_dwordx4 v[52:55], v245, s[20:23], s54 offen offset:0 sc1
    s_mov_b32 s54, 38875136
    buffer_load_dwordx4 v[56:59], v245, s[20:23], s54 offen offset:1024 sc1
    buffer_load_dwordx4 v[60:63], v245, s[20:23], s54 offen offset:2048 sc1
    s_mov_b32 s54, 38899712
    buffer_load_dwordx4 v[64:67], v245, s[20:23], s54 offen offset:0 sc1
    s_mov_b32 s54, 38936576
    buffer_load_dwordx4 v[68:71], v245, s[20:23], s54 offen offset:0 sc1
    s_mov_b32 s54, 38957056
    buffer_load_dwordx4 v[72:75], v245, s[20:23], s54 offen offset:2048 sc1
    buffer_load_dwordx4 v[76:79], v245, s[20:23], s54 offen offset:3072 sc1
    s_mov_b32 s54, 39096320
    buffer_load_dwordx4 v[80:83], v246, s[20:23], s54 offen offset:1024 sc1
    buffer_load_dwordx4 v[84:87], v246, s[20:23], s54 offen offset:2048 sc1
    s_mov_b32 s54, 39383040
    buffer_load_dwordx4 v[88:91], v246, s[20:23], s54 offen offset:1024 sc1
    buffer_load_dwordx4 v[92:95], v246, s[20:23], s54 offen offset:2048 sc1
    s_mov_b32 s54, 39669760
    buffer_load_dwordx4 v[96:99], v246, s[20:23], s54 offen offset:1024 sc1
    buffer_load_dwordx4 v[100:103], v246, s[20:23], s54 offen offset:2048 sc1
    s_mov_b32 s54, 39956480
    buffer_load_dwordx4 v[104:107], v246, s[20:23], s54 offen offset:1024 sc1
    buffer_load_dwordx4 v[108:111], v246, s[20:23], s54 offen offset:2048 sc1
    s_mov_b32 s54, 38981632
    buffer_load_dwordx4 v[112:115], v246, s[20:23], s54 offen offset:1024 sc1
    buffer_load_dwordx4 v[116:119], v246, s[20:23], s54 offen offset:2048 sc1
    s_mov_b32 s54, 39038976
    buffer_load_dwordx4 v[120:123], v246, s[20:23], s54 offen offset:1024 sc1
    buffer_load_dwordx4 v[124:127], v246, s[20:23], s54 offen offset:2048 sc1
    s_mov_b32 s54, 39153664
    buffer_load_dwordx4 v[128:131], v246, s[20:23], s54 offen offset:1024 sc1
    buffer_load_dwordx4 v[132:135], v246, s[20:23], s54 offen offset:2048 sc1
    s_mov_b32 s54, 39211008
    buffer_load_dwordx4 v[136:139], v246, s[20:23], s54 offen offset:1024 sc1
    buffer_load_dwordx4 v[140:143], v246, s[20:23], s54 offen offset:2048 sc1
    s_mov_b32 s55, 131072
K2_HP_179:
    ds_read_b32 v9, v6 offset:1552
    s_sub_u32 s55, s55, 1
    s_cmp_eq_u32 s55, 0
    s_cbranch_scc1 K2_HD_180
    s_waitcnt lgkmcnt(0)
    v_cmp_gt_u32 vcc, 2, v9
    s_cbranch_vccz K2_HD_180
    s_sleep 1
    s_branch K2_HP_179
K2_HD_180:
    ds_write_b128 v12, v[152:155] offset:12288
    ds_write_b128 v12, v[156:159] offset:13312
    ds_write_b128 v12, v[160:163] offset:14336
    ds_write_b128 v12, v[164:167] offset:15360
    ds_write_b128 v12, v[168:171] offset:16384
    ds_write_b128 v12, v[172:175] offset:32768
    ds_write_b128 v12, v[176:179] offset:33792
    ds_write_b128 v12, v[180:183] offset:34816
    ds_write_b128 v12, v[184:187] offset:35840
    ds_write_b128 v12, v[188:191] offset:36864
    v_mov_b32 v8, 3
    ds_write_b32 v7, v8 offset:1536
    ds_write_b128 v12, v[192:195] offset:53248
    ds_write_b128 v12, v[196:199] offset:54272
    ds_write_b128 v12, v[200:203] offset:55296
    ds_write_b128 v12, v[204:207] offset:56320
    ds_write_b128 v12, v[208:211] offset:57344
    ds_write_b128 v13, v[212:215] offset:8192
    ds_write_b128 v13, v[216:219] offset:9216
    ds_write_b128 v13, v[220:223] offset:10240
    ds_write_b128 v13, v[224:227] offset:11264
    ds_write_b128 v13, v[228:231] offset:12288
    s_waitcnt vmcnt(31)
    ds_write_b128 v13, v[16:19] offset:19456
    s_waitcnt vmcnt(30)
    ds_write_b128 v13, v[20:23] offset:20480
    s_waitcnt vmcnt(29)
    ds_write_b128 v13, v[24:27] offset:27648
    s_waitcnt vmcnt(28)
    ds_write_b128 v13, v[28:31] offset:28672
    s_waitcnt vmcnt(27)
    ds_write_b128 v13, v[32:35] offset:35840
    v_mov_b32 v8, 4
    ds_write_b32 v7, v8 offset:1536
    s_mov_b32 s55, 131072
K2_HP_181:
    ds_read_b32 v9, v6 offset:1552
    s_sub_u32 s55, s55, 1
    s_cmp_eq_u32 s55, 0
    s_cbranch_scc1 K2_HD_182
    s_waitcnt lgkmcnt(0)
    v_cmp_gt_u32 vcc, 3, v9
    s_cbranch_vccz K2_HD_182
    s_sleep 1
    s_branch K2_HP_181
K2_HD_182:
    s_mov_b32 s54, 39268352
    buffer_load_dwordx4 v[144:147], v246, s[20:23], s54 offen offset:1024 sc1
    buffer_load_dwordx4 v[152:155], v246, s[20:23], s54 offen offset:2048 sc1
    s_mov_b32 s54, 39325696
    buffer_load_dwordx4 v[156:159], v246, s[20:23], s54 offen offset:1024 sc1
    buffer_load_dwordx4 v[160:163], v246, s[20:23], s54 offen offset:2048 sc1
    s_mov_b32 s54, 39440384
    buffer_load_dwordx4 v[164:167], v246, s[20:23], s54 offen offset:1024 sc1
    buffer_load_dwordx4 v[168:171], v246, s[20:23], s54 offen offset:2048 sc1
    s_mov_b32 s54, 39497728
    buffer_load_dwordx4 v[172:175], v246, s[20:23], s54 offen offset:1024 sc1
    buffer_load_dwordx4 v[176:179], v246, s[20:23], s54 offen offset:2048 sc1
    s_mov_b32 s54, 39555072
    buffer_load_dwordx4 v[180:183], v246, s[20:23], s54 offen offset:1024 sc1
    buffer_load_dwordx4 v[184:187], v246, s[20:23], s54 offen offset:2048 sc1
    s_mov_b32 s54, 39612416
    buffer_load_dwordx4 v[188:191], v246, s[20:23], s54 offen offset:1024 sc1
    buffer_load_dwordx4 v[192:195], v246, s[20:23], s54 offen offset:2048 sc1
    s_mov_b32 s54, 39727104
    buffer_load_dwordx4 v[196:199], v246, s[20:23], s54 offen offset:1024 sc1
    buffer_load_dwordx4 v[200:203], v246, s[20:23], s54 offen offset:2048 sc1
    s_mov_b32 s54, 39784448
    buffer_load_dwordx4 v[204:207], v246, s[20:23], s54 offen offset:1024 sc1
    buffer_load_dwordx4 v[208:211], v246, s[20:23], s54 offen offset:2048 sc1
    s_mov_b32 s54, 39841792
    buffer_load_dwordx4 v[212:215], v246, s[20:23], s54 offen offset:1024 sc1
    buffer_load_dwordx4 v[216:219], v246, s[20:23], s54 offen offset:2048 sc1
    s_mov_b32 s54, 39899136
    buffer_load_dwordx4 v[220:223], v246, s[20:23], s54 offen offset:1024 sc1
    buffer_load_dwordx4 v[224:227], v246, s[20:23], s54 offen offset:2048 sc1
    s_mov_b32 s54, 40013824
    buffer_load_dwordx4 v[228:231], v246, s[20:23], s54 offen offset:1024 sc1
    buffer_load_dwordx4 v[16:19], v246, s[20:23], s54 offen offset:2048 sc1
    s_mov_b32 s54, 40071168
    buffer_load_dwordx4 v[20:23], v246, s[20:23], s54 offen offset:1024 sc1
    s_mov_b32 s55, 131072
K2_HP_183:
    ds_read_b32 v9, v6 offset:1552
    s_sub_u32 s55, s55, 1
    s_cmp_eq_u32 s55, 0
    s_cbranch_scc1 K2_HD_184
    s_waitcnt lgkmcnt(0)
    v_cmp_gt_u32 vcc, 4, v9
    s_cbranch_vccz K2_HD_184
    s_sleep 1
    s_branch K2_HP_183
K2_HD_184:
    s_waitcnt vmcnt(49)
    ds_write_b128 v13, v[36:39] offset:36864
    s_waitcnt vmcnt(48)
    ds_write_b128 v13, v[40:43] offset:44032
    s_waitcnt vmcnt(47)
    ds_write_b128 v13, v[44:47] offset:45056
    s_waitcnt vmcnt(46)
    ds_write_b128 v13, v[48:51] offset:52224
    s_waitcnt vmcnt(45)
    ds_write_b128 v13, v[52:55] offset:53248
    s_waitcnt vmcnt(44)
    ds_write_b128 v13, v[56:59] offset:60416
    s_waitcnt vmcnt(43)
    ds_write_b128 v13, v[60:63] offset:61440
    s_waitcnt vmcnt(42)
    ds_write_b128 v14, v[64:67] offset:3072
    s_waitcnt vmcnt(41)
    ds_write_b128 v14, v[68:71] offset:4096
    s_waitcnt vmcnt(40)
    ds_write_b128 v14, v[72:75] offset:11264
    s_waitcnt vmcnt(39)
    ds_write_b128 v14, v[76:79] offset:12288
    v_mov_b32 v8, 5
    ds_write_b32 v7, v8 offset:1536
    s_waitcnt vmcnt(38)
    ds_write_b128 v14, v[80:83] offset:19456
    s_waitcnt vmcnt(37)
    ds_write_b128 v14, v[84:87] offset:20480
    s_waitcnt vmcnt(36)
    ds_write_b128 v14, v[88:91] offset:27648
    s_waitcnt vmcnt(35)
    ds_write_b128 v14, v[92:95] offset:28672
    s_waitcnt vmcnt(34)
    ds_write_b128 v12, v[96:99] offset:5120
    s_waitcnt vmcnt(33)
    ds_write_b128 v12, v[100:103] offset:6144
    s_waitcnt vmcnt(32)
    ds_write_b128 v12, v[104:107] offset:13312
    s_waitcnt vmcnt(31)
    ds_write_b128 v12, v[108:111] offset:14336
    s_waitcnt vmcnt(30)
    ds_write_b128 v12, v[112:115] offset:21504
    s_waitcnt vmcnt(29)
    ds_write_b128 v12, v[116:119] offset:22528
    s_waitcnt vmcnt(28)
    ds_write_b128 v12, v[120:123] offset:29696
    s_waitcnt vmcnt(27)
    ds_write_b128 v12, v[124:127] offset:30720
    s_waitcnt vmcnt(26)
    ds_write_b128 v12, v[128:131] offset:37888
    s_waitcnt vmcnt(25)
    ds_write_b128 v12, v[132:135] offset:38912
    v_mov_b32 v8, 6
    ds_write_b32 v7, v8 offset:1536
    s_mov_b32 s55, 131072
K2_HP_185:
    ds_read_b32 v9, v6 offset:1552
    s_sub_u32 s55, s55, 1
    s_cmp_eq_u32 s55, 0
    s_cbranch_scc1 K2_HD_186
    s_waitcnt lgkmcnt(0)
    v_cmp_gt_u32 vcc, 6, v9
    s_cbranch_vccz K2_HD_186
    s_sleep 1
    s_branch K2_HP_185
K2_HD_186:
    s_waitcnt vmcnt(24)
    ds_write_b128 v12, v[136:139] offset:46080
    s_waitcnt vmcnt(23)
    ds_write_b128 v12, v[140:143] offset:47104
    s_waitcnt vmcnt(22)
    ds_write_b128 v12, v[144:147] offset:54272
    s_waitcnt vmcnt(21)
    ds_write_b128 v12, v[152:155] offset:55296
    s_waitcnt vmcnt(20)
    ds_write_b128 v12, v[156:159] offset:62464
    s_waitcnt vmcnt(19)
    ds_write_b128 v12, v[160:163] offset:63488
    s_waitcnt vmcnt(18)
    ds_write_b128 v13, v[164:167] offset:5120
    s_waitcnt vmcnt(17)
    ds_write_b128 v13, v[168:171] offset:6144
    s_waitcnt vmcnt(16)
    ds_write_b128 v13, v[172:175] offset:13312
    s_waitcnt vmcnt(15)
    ds_write_b128 v13, v[176:179] offset:14336
    s_waitcnt vmcnt(14)
    ds_write_b128 v13, v[180:183] offset:21504
    s_waitcnt vmcnt(13)
    ds_write_b128 v13, v[184:187] offset:22528
    s_waitcnt vmcnt(12)
    ds_write_b128 v13, v[188:191] offset:29696
    s_waitcnt vmcnt(11)
    ds_write_b128 v13, v[192:195] offset:30720
    s_waitcnt vmcnt(10)
    ds_write_b128 v13, v[196:199] offset:37888
    s_waitcnt vmcnt(9)
    ds_write_b128 v13, v[200:203] offset:38912
    s_waitcnt vmcnt(8)
    ds_write_b128 v13, v[204:207] offset:46080
    s_waitcnt vmcnt(7)
    ds_write_b128 v13, v[208:211] offset:47104
    s_waitcnt vmcnt(6)
    ds_write_b128 v13, v[212:215] offset:54272
    s_waitcnt vmcnt(5)
    ds_write_b128 v13, v[216:219] offset:55296
    s_waitcnt vmcnt(4)
    ds_write_b128 v13, v[220:223] offset:62464
    s_waitcnt vmcnt(3)
    ds_write_b128 v13, v[224:227] offset:63488
    s_waitcnt vmcnt(2)
    ds_write_b128 v14, v[228:231] offset:5120
    s_waitcnt vmcnt(1)
    ds_write_b128 v14, v[16:19] offset:6144
    s_waitcnt vmcnt(0)
    ds_write_b128 v14, v[20:23] offset:13312
    v_mov_b32 v8, 7
    ds_write_b32 v7, v8 offset:1536
    ds_read_b32 v9, v6 offset:1552
    s_waitcnt lgkmcnt(0)
    v_cmp_gt_u32 vcc, 7, v9
    s_cbranch_vccz K2_HD_188
    s_mov_b32 s55, 131072
K2_HP_187:
    ds_read_b32 v9, v6 offset:1552
    s_sub_u32 s55, s55, 1
    s_cmp_eq_u32 s55, 0
    s_cbranch_scc1 K2_HD_188
    s_waitcnt lgkmcnt(0)
    v_cmp_gt_u32 vcc, 7, v9
    s_cbranch_vccz K2_HD_188
    s_sleep 1
    s_branch K2_HP_187
K2_HD_188:
    s_mov_b32 m0, 155648
    s_mov_b32 s54, 39387136
    buffer_load_dwordx4 v246, s[20:23], s54 offen offset:0 sc1 lds
    buffer_load_dwordx4 v246, s[20:23], s54 offen offset:1024 sc1 lds
    buffer_load_dwordx4 v246, s[20:23], s54 offen offset:2048 sc1 lds
    buffer_load_dwordx4 v246, s[20:23], s54 offen offset:3072 sc1 lds
    s_mov_b32 m0, 12288
    s_mov_b32 s54, 38985728
    buffer_load_dwordx4 v246, s[20:23], s54 offen offset:0 sc1 lds
    buffer_load_dwordx4 v246, s[20:23], s54 offen offset:1024 sc1 lds
    buffer_load_dwordx4 v246, s[20:23], s54 offen offset:2048 sc1 lds
    buffer_load_dwordx4 v246, s[20:23], s54 offen offset:3072 sc1 lds
    ds_read_b32 v9, v6 offset:1552
    s_waitcnt lgkmcnt(0)
    v_cmp_gt_u32 vcc, 8, v9
    s_cbranch_vccz K2_HD_190
    s_waitcnt vmcnt(0)
    v_mov_b32 v8, 8
    ds_write_b32 v7, v8 offset:1536
    s_mov_b32 s55, 131072
K2_HP_189:
    ds_read_b32 v9, v6 offset:1552
    s_sub_u32 s55, s55, 1
    s_cmp_eq_u32 s55, 0
    s_cbranch_scc1 K2_HD_190
    s_waitcnt lgkmcnt(0)
    v_cmp_gt_u32 vcc, 8, v9
    s_cbranch_vccz K2_HD_190
    s_sleep 1
    s_branch K2_HP_189
K2_HD_190:
    s_mov_b32 m0, 28672
    s_mov_b32 s54, 39161856
    buffer_load_dwordx4 v246, s[20:23], s54 offen offset:0 sc1 lds
    buffer_load_dwordx4 v246, s[20:23], s54 offen offset:1024 sc1 lds
    s_mov_b32 m0, 34816
    s_mov_b32 s54, 39219200
    buffer_load_dwordx4 v246, s[20:23], s54 offen offset:0 sc1 lds
    buffer_load_dwordx4 v246, s[20:23], s54 offen offset:1024 sc1 lds
    s_mov_b32 m0, 43008
    s_mov_b32 s54, 39329792
    buffer_load_dwordx4 v246, s[20:23], s54 offen offset:0 sc1 lds
    buffer_load_dwordx4 v246, s[20:23], s54 offen offset:1024 sc1 lds
    buffer_load_dwordx4 v246, s[20:23], s54 offen offset:2048 sc1 lds
    buffer_load_dwordx4 v246, s[20:23], s54 offen offset:3072 sc1 lds
    s_waitcnt vmcnt(8)
    v_mov_b32 v8, 8
    ds_write_b32 v7, v8 offset:1536
    ds_read_b32 v9, v6 offset:1552
    s_waitcnt lgkmcnt(0)
    v_cmp_gt_u32 vcc, 9, v9
    s_cbranch_vccz K2_HD_192
    s_waitcnt vmcnt(0)
    v_mov_b32 v8, 9
    ds_write_b32 v7, v8 offset:1536
    s_mov_b32 s55, 131072
K2_HP_191:
    ds_read_b32 v9, v6 offset:1552
    s_sub_u32 s55, s55, 1
    s_cmp_eq_u32 s55, 0
    s_cbranch_scc1 K2_HD_192
    s_waitcnt lgkmcnt(0)
    v_cmp_gt_u32 vcc, 9, v9
    s_cbranch_vccz K2_HD_192
    s_sleep 1
    s_branch K2_HP_191
K2_HD_192:
    s_mov_b32 m0, 61440
    s_mov_b32 s54, 39559168
    buffer_load_dwordx4 v246, s[20:23], s54 offen offset:0 sc1 lds
    buffer_load_dwordx4 v246, s[20:23], s54 offen offset:1024 sc1 lds
    buffer_load_dwordx4 v246, s[20:23], s54 offen offset:2048 sc1 lds
    buffer_load_dwordx4 v246, s[20:23], s54 offen offset:3072 sc1 lds
    s_mov_b32 m0, 77824
    s_mov_b32 s54, 39735296
    buffer_load_dwordx4 v246, s[20:23], s54 offen offset:0 sc1 lds
    buffer_load_dwordx4 v246, s[20:23], s54 offen offset:1024 sc1 lds
    s_waitcnt vmcnt(6)
    v_mov_b32 v8, 9
    ds_write_b32 v7, v8 offset:1536
    ds_read_b32 v9, v6 offset:1552
    s_waitcnt lgkmcnt(0)
    v_cmp_gt_u32 vcc, 10, v9
    s_cbranch_vccz K2_HD_194
    s_waitcnt vmcnt(0)
    v_mov_b32 v8, 10
    ds_write_b32 v7, v8 offset:1536
    s_mov_b32 s55, 131072
K2_HP_193:
    ds_read_b32 v9, v6 offset:1552
    s_sub_u32 s55, s55, 1
    s_cmp_eq_u32 s55, 0
    s_cbranch_scc1 K2_HD_194
    s_waitcnt lgkmcnt(0)
    v_cmp_gt_u32 vcc, 10, v9
    s_cbranch_vccz K2_HD_194
    s_sleep 1
    s_branch K2_HP_193
K2_HD_194:
    s_mov_b32 m0, 83968
    s_mov_b32 s54, 39792640
    buffer_load_dwordx4 v246, s[20:23], s54 offen offset:0 sc1 lds
    buffer_load_dwordx4 v246, s[20:23], s54 offen offset:1024 sc1 lds
    s_mov_b32 m0, 92160
    s_mov_b32 s54, 39903232
    buffer_load_dwordx4 v246, s[20:23], s54 offen offset:0 sc1 lds
    buffer_load_dwordx4 v246, s[20:23], s54 offen offset:1024 sc1 lds
    buffer_load_dwordx4 v246, s[20:23], s54 offen offset:2048 sc1 lds
    buffer_load_dwordx4 v246, s[20:23], s54 offen offset:3072 sc1 lds
    s_mov_b32 m0, 108544
    s_mov_b32 s54, 40079360
    buffer_load_dwordx4 v246, s[20:23], s54 offen offset:0 sc1 lds
    buffer_load_dwordx4 v246, s[20:23], s54 offen offset:1024 sc1 lds
    s_mov_b32 m0, 115712
    s_mov_b32 s54, 40144896
    buffer_load_dwordx4 v245, s[20:23], s54 offen offset:0 sc1 lds
    s_waitcnt vmcnt(9)
    v_mov_b32 v8, 10
    ds_write_b32 v7, v8 offset:1536
    ds_read_b32 v9, v6 offset:1552
    s_waitcnt lgkmcnt(0)
    v_cmp_gt_u32 vcc, 11, v9
    s_cbranch_vccz K2_HD_196
    s_waitcnt vmcnt(0)
    v_mov_b32 v8, 11
    ds_write_b32 v7, v8 offset:1536
    s_mov_b32 s55, 131072
K2_HP_195:
    ds_read_b32 v9, v6 offset:1552
    s_sub_u32 s55, s55, 1
    s_cmp_eq_u32 s55, 0
    s_cbranch_scc1 K2_HD_196
    s_waitcnt lgkmcnt(0)
    v_cmp_gt_u32 vcc, 11, v9
    s_cbranch_vccz K2_HD_196
    s_sleep 1
    s_branch K2_HP_195
K2_HD_196:
    s_mov_b32 m0, 120832
    s_mov_b32 s54, 40165376
    buffer_load_dwordx4 v245, s[20:23], s54 offen offset:0 sc1 lds
    buffer_load_dwordx4 v245, s[20:23], s54 offen offset:1024 sc1 lds
    buffer_load_dwordx4 v245, s[20:23], s54 offen offset:2048 sc1 lds
    buffer_load_dwordx4 v245, s[20:23], s54 offen offset:3072 sc1 lds
    s_mov_b32 m0, 136192
    s_mov_b32 s54, 40288256
    buffer_load_dwordx4 v245, s[20:23], s54 offen offset:0 sc1 lds
    buffer_load_dwordx4 v245, s[20:23], s54 offen offset:1024 sc1 lds
    buffer_load_dwordx4 v245, s[20:23], s54 offen offset:2048 sc1 lds
    buffer_load_dwordx4 v245, s[20:23], s54 offen offset:3072 sc1 lds
    s_waitcnt vmcnt(8)
    v_mov_b32 v8, 11
    ds_write_b32 v7, v8 offset:1536
    ds_read_b32 v9, v6 offset:1552
    s_waitcnt lgkmcnt(0)
    v_cmp_gt_u32 vcc, 12, v9
    s_cbranch_vccz K2_HD_198
    s_waitcnt vmcnt(0)
    v_mov_b32 v8, 12
    ds_write_b32 v7, v8 offset:1536
    s_mov_b32 s55, 131072
K2_HP_197:
    ds_read_b32 v9, v6 offset:1552
    s_sub_u32 s55, s55, 1
    s_cmp_eq_u32 s55, 0
    s_cbranch_scc1 K2_HD_198
    s_waitcnt lgkmcnt(0)
    v_cmp_gt_u32 vcc, 12, v9
    s_cbranch_vccz K2_HD_198
    s_sleep 1
    s_branch K2_HP_197
K2_HD_198:
    s_mov_b32 m0, 151552
    s_mov_b32 s54, 40411136
    buffer_load_dwordx4 v245, s[20:23], s54 offen offset:0 sc1 lds
    buffer_load_dwordx4 v245, s[20:23], s54 offen offset:1024 sc1 lds
    buffer_load_dwordx4 v245, s[20:23], s54 offen offset:2048 sc1 lds
    buffer_load_dwordx4 v245, s[20:23], s54 offen offset:3072 sc1 lds
    s_mov_b32 m0, 5120
    s_mov_b32 s54, 40472576
    buffer_load_dwordx4 v245, s[20:23], s54 offen offset:0 sc1 lds
    buffer_load_dwordx4 v245, s[20:23], s54 offen offset:1024 sc1 lds
    buffer_load_dwordx4 v245, s[20:23], s54 offen offset:2048 sc1 lds
    buffer_load_dwordx4 v245, s[20:23], s54 offen offset:3072 sc1 lds
    s_waitcnt vmcnt(8)
    v_mov_b32 v8, 12
    ds_write_b32 v7, v8 offset:1536
    ds_read_b32 v9, v6 offset:1552
    s_waitcnt lgkmcnt(0)
    v_cmp_gt_u32 vcc, 13, v9
    s_cbranch_vccz K2_HD_200
    s_waitcnt vmcnt(0)
    v_mov_b32 v8, 13
    ds_write_b32 v7, v8 offset:1536
    s_mov_b32 s55, 131072
K2_HP_199:
    ds_read_b32 v9, v6 offset:1552
    s_sub_u32 s55, s55, 1
    s_cmp_eq_u32 s55, 0
    s_cbranch_scc1 K2_HD_200
    s_waitcnt lgkmcnt(0)
    v_cmp_gt_u32 vcc, 13, v9
    s_cbranch_vccz K2_HD_200
    s_sleep 1
    s_branch K2_HP_199
K2_HD_200:
    s_mov_b32 m0, 20480
    s_mov_b32 s54, 40595456
    buffer_load_dwordx4 v245, s[20:23], s54 offen offset:0 sc1 lds
    buffer_load_dwordx4 v245, s[20:23], s54 offen offset:1024 sc1 lds
    buffer_load_dwordx4 v245, s[20:23], s54 offen offset:2048 sc1 lds
    buffer_load_dwordx4 v245, s[20:23], s54 offen offset:3072 sc1 lds
    s_mov_b32 m0, 39936
    s_mov_b32 s54, 40722432
    buffer_load_dwordx4 v245, s[20:23], s54 offen offset:0 sc1 lds
    s_mov_b32 m0, 45056
    s_mov_b32 s54, 40742912
    buffer_load_dwordx4 v245, s[20:23], s54 offen offset:0 sc1 lds
    s_waitcnt vmcnt(6)
    v_mov_b32 v8, 13
    ds_write_b32 v7, v8 offset:1536
    ds_read_b32 v9, v6 offset:1552
    s_waitcnt lgkmcnt(0)
    v_cmp_gt_u32 vcc, 14, v9
    s_cbranch_vccz K2_HD_202
    s_waitcnt vmcnt(0)
    v_mov_b32 v8, 14
    ds_write_b32 v7, v8 offset:1536
    s_mov_b32 s55, 131072
K2_HP_201:
    ds_read_b32 v9, v6 offset:1552
    s_sub_u32 s55, s55, 1
    s_cmp_eq_u32 s55, 0
    s_cbranch_scc1 K2_HD_202
    s_waitcnt lgkmcnt(0)
    v_cmp_gt_u32 vcc, 14, v9
    s_cbranch_vccz K2_HD_202
    s_sleep 1
    s_branch K2_HP_201
K2_HD_202:
    s_mov_b32 m0, 49152
    s_mov_b32 s54, 40762368
    buffer_load_dwordx4 v245, s[20:23], s54 offen offset:0 sc1 lds
    buffer_load_dwordx4 v245, s[20:23], s54 offen offset:1024 sc1 lds
    s_mov_b32 m0, 55296
    s_mov_b32 s54, 40845312
    buffer_load_dwordx4 v245, s[20:23], s54 offen offset:0 sc1 lds
    s_mov_b32 m0, 61440
    s_mov_b32 s54, 40882176
    buffer_load_dwordx4 v245, s[20:23], s54 offen offset:0 sc1 lds
    buffer_load_dwordx4 v245, s[20:23], s54 offen offset:1024 sc1 lds
    buffer_load_dwordx4 v245, s[20:23], s54 offen offset:2048 sc1 lds
    buffer_load_dwordx4 v245, s[20:23], s54 offen offset:3072 sc1 lds
    s_mov_b32 m0, 76800
    s_mov_b32 s54, 41005056
    buffer_load_dwordx4 v245, s[20:23], s54 offen offset:0 sc1 lds
    buffer_load_dwordx4 v245, s[20:23], s54 offen offset:1024 sc1 lds
    buffer_load_dwordx4 v245, s[20:23], s54 offen offset:2048 sc1 lds
    s_waitcnt vmcnt(10)
    v_mov_b32 v8, 14
    ds_write_b32 v7, v8 offset:1536
    ds_read_b32 v9, v6 offset:1552
    s_waitcnt lgkmcnt(0)
    v_cmp_gt_u32 vcc, 15, v9
    s_cbranch_vccz K2_HD_204
    s_waitcnt vmcnt(0)
    v_mov_b32 v8, 15
    ds_write_b32 v7, v8 offset:1536
    s_mov_b32 s55, 131072
K2_HP_203:
    ds_read_b32 v9, v6 offset:1552
    s_sub_u32 s55, s55, 1
    s_cmp_eq_u32 s55, 0
    s_cbranch_scc1 K2_HD_204
    s_waitcnt lgkmcnt(0)
    v_cmp_gt_u32 vcc, 15, v9
    s_cbranch_vccz K2_HD_204
    s_sleep 1
    s_branch K2_HP_203
K2_HD_204:
    s_mov_b32 m0, 87040
    s_mov_b32 s54, 41046016
    buffer_load_dwordx4 v245, s[20:23], s54 offen offset:0 sc1 lds
    buffer_load_dwordx4 v245, s[20:23], s54 offen offset:1024 sc1 lds
    buffer_load_dwordx4 v245, s[20:23], s54 offen offset:2048 sc1 lds
    buffer_load_dwordx4 v245, s[20:23], s54 offen offset:3072 sc1 lds
    s_mov_b32 m0, 106496
    s_mov_b32 s54, 41132032
    buffer_load_dwordx4 v245, s[20:23], s54 offen offset:0 sc1 lds
    s_waitcnt vmcnt(5)
    v_mov_b32 v8, 15
    ds_write_b32 v7, v8 offset:1536
    ds_read_b32 v9, v6 offset:1552
    s_waitcnt lgkmcnt(0)
    v_cmp_gt_u32 vcc, 16, v9
    s_cbranch_vccz K2_HD_206
    s_waitcnt vmcnt(0)
    v_mov_b32 v8, 16
    ds_write_b32 v7, v8 offset:1536
    s_mov_b32 s55, 131072
K2_HP_205:
    ds_read_b32 v9, v6 offset:1552
    s_sub_u32 s55, s55, 1
    s_cmp_eq_u32 s55, 0
    s_cbranch_scc1 K2_HD_206
    s_waitcnt lgkmcnt(0)
    v_cmp_gt_u32 vcc, 16, v9
    s_cbranch_vccz K2_HD_206
    s_sleep 1
    s_branch K2_HP_205
K2_HD_206:
    s_mov_b32 m0, 110592
    s_mov_b32 s54, 41151488
    buffer_load_dwordx4 v245, s[20:23], s54 offen offset:0 sc1 lds
    buffer_load_dwordx4 v245, s[20:23], s54 offen offset:1024 sc1 lds
    s_mov_b32 m0, 116736
    s_mov_b32 s54, 40210432
    buffer_load_dwordx4 v245, s[20:23], s54 offen offset:0 sc1 lds
    s_mov_b32 m0, 122880
    s_mov_b32 s54, 40247296
    buffer_load_dwordx4 v245, s[20:23], s54 offen offset:0 sc1 lds
    buffer_load_dwordx4 v245, s[20:23], s54 offen offset:1024 sc1 lds
    buffer_load_dwordx4 v245, s[20:23], s54 offen offset:2048 sc1 lds
    buffer_load_dwordx4 v245, s[20:23], s54 offen offset:3072 sc1 lds
    s_mov_b32 m0, 138240
    s_mov_b32 s54, 40390656
    buffer_load_dwordx4 v245, s[20:23], s54 offen offset:0 sc1 lds
    buffer_load_dwordx4 v245, s[20:23], s54 offen offset:1024 sc1 lds
    buffer_load_dwordx4 v245, s[20:23], s54 offen offset:2048 sc1 lds
    s_waitcnt vmcnt(10)
    v_mov_b32 v8, 16
    ds_write_b32 v7, v8 offset:1536
    ds_read_b32 v9, v6 offset:1552
    s_waitcnt lgkmcnt(0)
    v_cmp_gt_u32 vcc, 17, v9
    s_cbranch_vccz K2_HD_208
    s_waitcnt vmcnt(0)
    v_mov_b32 v8, 17
    ds_write_b32 v7, v8 offset:1536
    s_mov_b32 s55, 131072
K2_HP_207:
    ds_read_b32 v9, v6 offset:1552
    s_sub_u32 s55, s55, 1
    s_cmp_eq_u32 s55, 0
    s_cbranch_scc1 K2_HD_208
    s_waitcnt lgkmcnt(0)
    v_cmp_gt_u32 vcc, 17, v9
    s_cbranch_vccz K2_HD_208
    s_sleep 1
    s_branch K2_HP_207
K2_HD_208:
    s_mov_b32 m0, 148480
    s_mov_b32 s54, 40513536
    buffer_load_dwordx4 v245, s[20:23], s54 offen offset:0 sc1 lds
    buffer_load_dwordx4 v245, s[20:23], s54 offen offset:1024 sc1 lds
    buffer_load_dwordx4 v245, s[20:23], s54 offen offset:2048 sc1 lds
    buffer_load_dwordx4 v245, s[20:23], s54 offen offset:3072 sc1 lds
    s_mov_b32 m0, 6144
    s_mov_b32 s54, 40660992
    buffer_load_dwordx4 v245, s[20:23], s54 offen offset:0 sc1 lds
    s_waitcnt vmcnt(5)
    v_mov_b32 v8, 17
    ds_write_b32 v7, v8 offset:1536
    ds_read_b32 v9, v6 offset:1552
    s_waitcnt lgkmcnt(0)
    v_cmp_gt_u32 vcc, 18, v9
    s_cbranch_vccz K2_HD_210
    s_waitcnt vmcnt(0)
    v_mov_b32 v8, 18
    ds_write_b32 v7, v8 offset:1536
    s_mov_b32 s55, 131072
K2_HP_209:
    ds_read_b32 v9, v6 offset:1552
    s_sub_u32 s55, s55, 1
    s_cmp_eq_u32 s55, 0
    s_cbranch_scc1 K2_HD_210
    s_waitcnt lgkmcnt(0)
    v_cmp_gt_u32 vcc, 18, v9
    s_cbranch_vccz K2_HD_210
    s_sleep 1
    s_branch K2_HP_209
K2_HD_210:
    s_mov_b32 m0, 10240
    s_mov_b32 s54, 40680448
    buffer_load_dwordx4 v245, s[20:23], s54 offen offset:0 sc1 lds
    buffer_load_dwordx4 v245, s[20:23], s54 offen offset:1024 sc1 lds
    s_mov_b32 m0, 16384
    s_mov_b32 s54, 40783872
    buffer_load_dwordx4 v245, s[20:23], s54 offen offset:0 sc1 lds
    s_mov_b32 m0, 22528
    s_mov_b32 s54, 40820736
    buffer_load_dwordx4 v245, s[20:23], s54 offen offset:0 sc1 lds
    buffer_load_dwordx4 v245, s[20:23], s54 offen offset:1024 sc1 lds
    buffer_load_dwordx4 v245, s[20:23], s54 offen offset:2048 sc1 lds
    buffer_load_dwordx4 v245, s[20:23], s54 offen offset:3072 sc1 lds
    s_mov_b32 m0, 37888
    s_mov_b32 s54, 40964096
    buffer_load_dwordx4 v245, s[20:23], s54 offen offset:0 sc1 lds
    buffer_load_dwordx4 v245, s[20:23], s54 offen offset:1024 sc1 lds
    buffer_load_dwordx4 v245, s[20:23], s54 offen offset:2048 sc1 lds
    s_waitcnt vmcnt(10)
    v_mov_b32 v8, 18
    ds_write_b32 v7, v8 offset:1536
    ds_read_b32 v9, v6 offset:1552
    s_waitcnt lgkmcnt(0)
    v_cmp_gt_u32 vcc, 19, v9
    s_cbranch_vccz K2_HD_212
    s_waitcnt vmcnt(0)
    v_mov_b32 v8, 19
    ds_write_b32 v7, v8 offset:1536
    s_mov_b32 s55, 131072
K2_HP_211:
    ds_read_b32 v9, v6 offset:1552
    s_sub_u32 s55, s55, 1
    s_cmp_eq_u32 s55, 0
    s_cbranch_scc1 K2_HD_212
    s_waitcnt lgkmcnt(0)
    v_cmp_gt_u32 vcc, 19, v9
    s_cbranch_vccz K2_HD_212
    s_sleep 1
    s_branch K2_HP_211
K2_HD_212:
    s_mov_b32 m0, 48128
    s_mov_b32 s54, 41168896
    buffer_load_dwordx4 v245, s[20:23], s54 offen offset:0 sc1 lds
    buffer_load_dwordx4 v245, s[20:23], s54 offen offset:1024 sc1 lds
    buffer_load_dwordx4 v245, s[20:23], s54 offen offset:2048 sc1 lds
    buffer_load_dwordx4 v245, s[20:23], s54 offen offset:3072 sc1 lds
    s_waitcnt vmcnt(4)
    v_mov_b32 v8, 19
    ds_write_b32 v7, v8 offset:1536
    s_waitcnt vmcnt(0)
    v_mov_b32 v8, 20
    ds_write_b32 v7, v8 offset:1536
    s_endpgm
K2_FALLBACK:
    s_mov_b32 s56, s48
    s_mov_b32 s57, 64
    v_mov_b32 v22, 0xff7fffff
K2_FB1:
    buffer_load_dwordx4 v[104:107], v3, s[20:23], s56 offen sc1
    buffer_load_dword v112, v6, s[20:23], s56 offen sc1
    s_waitcnt vmcnt(0)
    v_mfma_f32_32x32x16_bf16 v[48:63], v[104:107], v[12:15], 0
    v_mfma_f32_32x32x8_bf16 v[48:63], v[112:113], v[16:17], v[48:63]
    s_nop 15
    v_max3_f32 v22, v22, v48, v49
    v_max3_f32 v22, v22, v50, v51
    v_max3_f32 v22, v22, v52, v53
    v_max3_f32 v22, v22, v54, v55
    v_max3_f32 v22, v22, v56, v57
    v_max3_f32 v22, v22, v58, v59
    v_max3_f32 v22, v22, v60, v61
    v_max3_f32 v22, v22, v62, v63
    s_add_u32 s56, s56, 2560
    s_sub_u32 s57, s57, 1
    s_cmp_lg_u32 s57, 0
    s_cbranch_scc1 K2_FB1
    v_mov_b32 v23, v22
    s_nop 1
    v_permlane32_swap_b32 v22, v23
    v_max_f32 v22, v22, v23
    v_sub_f32 v32, 0, v22
    v_sub_f32 v33, 0, v22
    v_sub_f32 v34, 0, v22
    v_sub_f32 v35, 0, v22
    v_sub_f32 v36, 0, v22
    v_sub_f32 v37, 0, v22
    v_sub_f32 v38, 0, v22
    v_sub_f32 v39, 0, v22
    v_sub_f32 v40, 0, v22
    v_sub_f32 v41, 0, v22
    v_sub_f32 v42, 0, v22
    v_sub_f32 v43, 0, v22
    v_sub_f32 v44, 0, v22
    v_sub_f32 v45, 0, v22
    v_sub_f32 v46, 0, v22
    v_sub_f32 v47, 0, v22
    v_mov_b32 v80, 0
    v_mov_b32 v81, 0
    v_mov_b32 v82, 0
    v_mov_b32 v83, 0
    v_mov_b32 v84, 0
    v_mov_b32 v85, 0
    v_mov_b32 v86, 0
    v_mov_b32 v87, 0
    v_mov_b32 v88, 0
    v_mov_b32 v89, 0
    v_mov_b32 v90, 0
    v_mov_b32 v91, 0
    v_mov_b32 v92, 0
    v_mov_b32 v93, 0
    v_mov_b32 v94, 0
    v_mov_b32 v95, 0
    s_mov_b32 s56, s48
    s_mov_b32 s57, 64
K2_FB2:
    buffer_load_dwordx4 v[104:107], v3, s[20:23], s56 offen sc1
    buffer_load_dword v112, v6, s[20:23], s56 offen sc1
    s_mov_b64 exec, s[60:61]
    buffer_load_dwordx4 v[116:119], v9, s[20:23], s56 offen sc1
    buffer_load_dwordx4 v[120:123], v9, s[20:23], s56 offen offset:640 sc1
    s_mov_b64 exec, -1
    s_waitcnt vmcnt(0)
    v_mfma_f32_32x32x16_bf16 v[48:63], v[104:107], v[12:15], v[32:47]
    v_mfma_f32_32x32x8_bf16 v[48:63], v[112:113], v[16:17], v[48:63]
    s_nop 15
    v_exp_f32 v48, v48
    v_exp_f32 v49, v49
    v_exp_f32 v50, v50
    v_exp_f32 v51, v51
    v_exp_f32 v52, v52
    v_exp_f32 v53, v53
    v_exp_f32 v54, v54
    v_exp_f32 v55, v55
    v_exp_f32 v56, v56
    v_exp_f32 v57, v57
    v_exp_f32 v58, v58
    v_exp_f32 v59, v59
    v_exp_f32 v60, v60
    v_exp_f32 v61, v61
    v_exp_f32 v62, v62
    v_exp_f32 v63, v63
    v_cvt_pk_bf16_f32 v96, v48, v49
    v_cvt_pk_bf16_f32 v97, v50, v51
    v_cvt_pk_bf16_f32 v98, v52, v53
    v_cvt_pk_bf16_f32 v99, v54, v55
    v_cvt_pk_bf16_f32 v100, v56, v57
    v_cvt_pk_bf16_f32 v101, v58, v59
    v_cvt_pk_bf16_f32 v102, v60, v61
    v_cvt_pk_bf16_f32 v103, v62, v63
    s_nop 1
    v_mfma_f32_32x32x16_bf16 v[80:95], v[116:119], v[96:99], v[80:95]
    v_mfma_f32_32x32x16_bf16 v[80:95], v[120:123], v[100:103], v[80:95]
    s_nop 15
    s_add_u32 s56, s56, 2560
    s_sub_u32 s57, s57, 1
    s_cmp_lg_u32 s57, 0
    s_cbranch_scc1 K2_FB2
    s_branch K2_NORM
K2_END:
    s_endpgm
CODE_END:
.section .rodata,"a"
.p2align 6
.amdhsa_kernel sequential_preLN__mha_block__mixer_s_mlp__prompt_kernel
  .amdhsa_next_free_vgpr 256
  .amdhsa_next_free_sgpr 102
  .amdhsa_accum_offset 256
  .amdhsa_group_segment_fixed_size 0
  .amdhsa_kernarg_size 88
  .amdhsa_user_sgpr_count 2
  .amdhsa_user_sgpr_kernarg_segment_ptr 1
  .amdhsa_system_sgpr_workgroup_id_x 1
.end_amdhsa_kernel
.text
```
